```python
import torch

def _softmax(x, axis=-1):
    return torch.softmax(x, dim=axis)
def _gelu(x):
    return torch.nn.functional.gelu(x, approximate="tanh")
def _silu(x):
    return torch.nn.functional.silu(x)
def _sigmoid(x):
    return torch.sigmoid(x)
def _layernorm(x, axis=-1, eps=1e-5):
    m = x.mean(dim=axis, keepdim=True)
    v = x.var(dim=axis, keepdim=True, unbiased=False)
    return (x - m) / torch.sqrt(v + eps)
def _scatter_add(tgt, idx, src, axis=0):
    return tgt.clone().index_add_(axis, idx, src)
def _segment_sum(src, seg, n):
    out = torch.zeros((n,) + src.shape[1:], dtype=src.dtype)
    return out.index_add_(0, seg, src)
def _pad(x, pw):
    flat = tuple(v for pair in reversed(pw) for v in pair)
    return torch.nn.functional.pad(x, flat)

kernel_name = 'sequential_preLN__compressed_kv_cla__moe_arch_mod__prompt'

def setup_inputs():

    _w = (lambda a: (lambda t: t.to(torch.bfloat16) if t.is_floating_point() else t)(torch.as_tensor(a)))
    def _A_setup():
        B, H, Sq, Sk, D, M = 1, 32, 2048, 2048, 128, 640
        Dc = 4 * D
        return {
            "x": _w((lambda *s: torch.randn(*s, dtype=torch.bfloat16) * 0.05)(B, Sq, M)),
            "c_kv": _w((lambda *s: torch.randn(*s, dtype=torch.bfloat16) * 0.4)(B, Sk, Dc)),
            "w_q": _w((lambda *s: torch.randn(*s, dtype=torch.bfloat16) * 3.2)(M, H, D) * (M ** -0.5)),
            "w_uk": _w((lambda *s: torch.randn(*s, dtype=torch.bfloat16) * 3.2)(Dc, H, D) * (Dc ** -0.5)),
            "w_uv": _w((lambda *s: torch.randn(*s, dtype=torch.bfloat16) * 0.4)(Dc, H, D) * (Dc ** -0.5)),
            "w_o": _w((lambda *s: torch.randn(*s, dtype=torch.bfloat16) * 0.4)(H, D, M) * ((H * D) ** -0.5)),
        }
    _A_in = _A_setup()

    def _B_setup():
        B, S, D, F, C = 1, 2048, 640, 1728, 2
        return {
            "x": _w((lambda *s: torch.randn(*s, dtype=torch.bfloat16) * 0.05)(B, S, D)),
            "w_r": _w((lambda *s: torch.randn(*s, dtype=torch.bfloat16) * 0.05)(D)),
            "w_gate": _w((lambda *s: torch.randn(*s, dtype=torch.bfloat16) * 0.05)(D, F)),
            "w_up": _w((lambda *s: torch.randn(*s, dtype=torch.bfloat16) * 0.05)(D, F)),
            "w_down": _w((lambda *s: torch.randn(*s, dtype=torch.bfloat16) * 0.05)(F, D)),
        }
    _B_in = _B_setup()

    return {
        "A_x": _A_in["x"],
        "A_c_kv": _A_in["c_kv"],
        "A_w_q": _A_in["w_q"],
        "A_w_uk": _A_in["w_uk"],
        "A_w_uv": _A_in["w_uv"],
        "A_w_o": _A_in["w_o"],
        "B_x": _B_in["x"],
        "B_w_r": _B_in["w_r"],
        "B_w_gate": _B_in["w_gate"],
        "B_w_up": _B_in["w_up"],
        "B_w_down": _B_in["w_down"],
    }

def reference(A_x, A_c_kv, A_w_q, A_w_uk, A_w_uv, A_w_o, B_x, B_w_r, B_w_gate, B_w_up, B_w_down):
    def _A_ref(x, c_kv, w_q, w_uk, w_uv, w_o):
        B, Sq, M = x.shape[0], x.shape[1], x.shape[2]
        Sk = c_kv.shape[1]
        H, D = w_q.shape[1], w_q.shape[2]
        q = torch.einsum("bqm,mhd->bhqd", x, w_q)
        k = torch.einsum("bkc,chd->bhkd", c_kv, w_uk)
        v = torch.einsum("bkc,chd->bhkd", c_kv, w_uv)
        scores = torch.einsum("bhqd,bhkd->bhqk", q, k) * (D ** -0.5)
        off = Sk - Sq
        qi = torch.arange(Sq)[:, None]
        kj = torch.arange(Sk)[None, :]
        cmask = kj <= (qi + off)
        scores = torch.where(cmask[None, None], scores, -1e9)
        p = _softmax(scores, axis=-1)
        ctx = torch.einsum("bhqk,bhkd->bhqd", p, v)
        return torch.einsum("bhqd,hdm->bqm", ctx, w_o)

    def _B_ref(x, w_r, w_gate, w_up, w_down):
        B, S, D = x.shape
        C = 2
        r = x @ w_r
        idx = torch.argsort(-r, axis=-1)[:, :C]
        idx_e = (lambda x, n, axis: torch.repeat_interleave(x, n, dim=axis))(idx.reshape(B, C, 1), D, axis=2)
        x_sel = (lambda x, i, axis: torch.take_along_dim(x, i, dim=axis))(x, idx_e, axis=1)
        g = _silu(x_sel @ w_gate)
        u = x_sel @ w_up
        y = (g * u) @ w_down
        r_sel = _sigmoid((lambda x, i, axis: torch.take_along_dim(x, i, dim=axis))(r, idx, axis=1))
        y = y * r_sel.reshape(B, C, 1)
        b_off = (torch.arange(B) * S).reshape(B, 1)
        flat_idx = (idx + b_off).reshape(B * C)
        zero = (x * 0.0).reshape(B * S, D)
        upd = _scatter_add(zero, flat_idx, y.reshape(B * C, D), axis=0)
        return x + upd.reshape(B, S, D)

    x = A_x
    h = x + _A_ref(_layernorm(x, axis=-1), A_c_kv, A_w_q, A_w_uk, A_w_uv, A_w_o)
    h2 = h + _B_ref(_layernorm(h, axis=-1), B_w_r, B_w_gate, B_w_up, B_w_down)
    return h2
```

```asm
; @launch grid=(256,1,1) block=(256,1,1) lds=163840
.amdgcn_target "amdgcn-amd-amdhsa--gfx950"
.text
.globl sequential_preLN__compressed_kv_cla__moe_arch_mod__prompt_kernel
.p2align 8
.type sequential_preLN__compressed_kv_cla__moe_arch_mod__prompt_kernel,@function
sequential_preLN__compressed_kv_cla__moe_arch_mod__prompt_kernel:
s_cmp_ge_u32 s2, 256
s_cbranch_scc1 LA_end
s_load_dwordx4 s[4:7], s[0:1], 0
s_load_dwordx4 s[8:11], s[0:1], 16
s_load_dwordx2 s[12:13], s[0:1], 32
s_load_dwordx4 s[16:19], s[0:1], 96
v_and_b32 v1, 63, v0
v_lshrrev_b32 v2, 6, v0
s_and_b32 s60, s2, 7
s_lshl_b32 s60, s60, 2
s_bfe_u32 s61, s2, 0x20003
s_add_u32 s20, s60, s61
s_lshr_b32 s21, s2, 5
v_readfirstlane_b32 s22, v2
s_waitcnt lgkmcnt(0)
s_lshl_b32 s60, s21, 18
s_add_u32 s24, s6, s60
s_addc_u32 s25, s7, 0
s_mov_b32 s26, 0x40000
s_mov_b32 s27, 0x20000
s_lshl_b32 s60, s20, 8
s_sub_u32 s61, 0x400000, s60
s_add_u32 s28, s10, s60
s_addc_u32 s29, s11, 0
s_mov_b32 s30, 0x0
s_mov_b32 s31, 0x20000
s_mov_b32 s30, s61
s_add_u32 s32, s12, s60
s_addc_u32 s33, s13, 0
s_mov_b32 s34, 0x0
s_mov_b32 s35, 0x20000
s_mov_b32 s34, s61
s_add_u32 s36, s8, s60
s_addc_u32 s37, s9, 0
s_mov_b32 s38, 0x0
s_mov_b32 s39, 0x20000
s_sub_u32 s38, 0x500000, s60
s_mov_b32 s40, s18
s_mov_b32 s41, s19
s_mov_b32 s42, 0x280000
s_mov_b32 s43, 0x20000
s_lshl_b32 s60, s20, 19
s_add_u32 s61, s60, 0x400000
s_add_u32 s44, s18, s61
s_addc_u32 s45, s19, 0
s_mov_b32 s46, 0x80000
s_mov_b32 s47, 0x20000
s_add_u32 s61, s60, 0x1400000
s_add_u32 s48, s18, s61
s_addc_u32 s49, s19, 0
s_mov_b32 s50, 0x80000
s_mov_b32 s51, 0x20000
s_mov_b32 s61, 0x2400000
s_add_u32 s52, s18, s61
s_addc_u32 s53, s19, 0
s_mov_b32 s54, 0x1000000
s_mov_b32 s55, 0x20000
s_mov_b32 s56, s4
s_mov_b32 s57, s5
s_mov_b32 s58, 0x280000
s_mov_b32 s59, 0x20000
s_mov_b32 s82, 0
s_mov_b32 s83, 0
s_lshl_b32 s60, s2, 3
s_lshl_b32 s61, s22, 1
s_add_u32 s60, s60, s61
v_lshrrev_b32 v36, 5, v1
v_add_u32 v36, s60, v36
v_and_b32 v37, 31, v1
s_movk_i32 s61, 1280
v_mul_lo_u32 v38, v36, s61
v_lshlrev_b32 v39, 4, v37
v_add_u32 v38, v38, v39
v_add_u32 v39, 1024, v38
v_cmp_gt_u32 vcc, 16, v37
v_mov_b32 v40, 0x7ffffff0
s_nop 0
v_cndmask_b32 v39, v40, v39, vcc
buffer_load_dwordx4 v[44:47], v38, s[56:59], 0 offen
buffer_load_dwordx4 v[48:51], v38, s[56:59], 0 offen offset:512
buffer_load_dwordx4 v[52:55], v39, s[56:59], 0 offen
v_lshlrev_b32 v26, 4, v1
v_lshrrev_b32 v27, 3, v1
v_and_b32 v28, 7, v1
v_lshrrev_b32 v29, 1, v27
v_add_u32 v30, 0, v29
v_and_b32 v30, 7, v30
v_xor_b32 v30, v30, v28
v_lshlrev_b32 v30, 4, v30
v_add_u32 v31, 0, v27
v_lshlrev_b32 v31, 10, v31
v_add_u32 v2, v30, v31
v_add_u32 v30, 4, v29
v_and_b32 v30, 7, v30
v_xor_b32 v30, v30, v28
v_lshlrev_b32 v30, 4, v30
v_add_u32 v31, 7, v27
v_lshlrev_b32 v31, 10, v31
v_add_u32 v3, v30, v31
v_add_u32 v30, 8, v29
v_and_b32 v30, 7, v30
v_xor_b32 v30, v30, v28
v_lshlrev_b32 v30, 4, v30
v_add_u32 v31, 14, v27
v_lshlrev_b32 v31, 10, v31
v_add_u32 v4, v30, v31
v_add_u32 v30, 12, v29
v_and_b32 v30, 7, v30
v_xor_b32 v30, v30, v28
v_lshlrev_b32 v30, 4, v30
v_add_u32 v31, 21, v27
v_lshlrev_b32 v31, 10, v31
v_add_u32 v5, v30, v31
v_lshlrev_b32 v26, 4, v1
v_lshrrev_b32 v27, 4, v1
v_and_b32 v28, 15, v1
v_lshlrev_b32 v29, 2, v27
v_xor_b32 v28, v28, v29
v_lshlrev_b32 v28, 4, v28
v_lshlrev_b32 v27, 13, v27
v_add_u32 v27, v27, v28
v_add_u32 v6, 0, v27
v_add_u32 v7, 31744, v27
v_add_u32 v8, 63488, v27
v_add_u32 v9, 95232, v27
v_and_b32 v27, 31, v1
v_lshrrev_b32 v28, 5, v1
v_lshrrev_b32 v29, 1, v27
v_and_b32 v29, 7, v29
v_lshlrev_b32 v30, 7, v27
s_and_b32 s60, s22, 1
s_lshl_b32 s60, s60, 14
v_add_u32 v30, s60, v30
v_add_u32 v31, 0, v28
v_xor_b32 v31, v31, v29
v_lshlrev_b32 v31, 4, v31
v_add_u32 v10, v30, v31
v_add_u32 v14, 0x10000, v10
v_add_u32 v31, 2, v28
v_xor_b32 v31, v31, v29
v_lshlrev_b32 v31, 4, v31
v_add_u32 v11, v30, v31
v_add_u32 v15, 0x10000, v11
v_add_u32 v31, 4, v28
v_xor_b32 v31, v31, v29
v_lshlrev_b32 v31, 4, v31
v_add_u32 v12, v30, v31
v_add_u32 v16, 0x10000, v12
v_add_u32 v31, 6, v28
v_xor_b32 v31, v31, v29
v_lshlrev_b32 v31, 4, v31
v_add_u32 v13, v30, v31
v_add_u32 v17, 0x10000, v13
v_lshrrev_b32 v28, 2, v1
v_and_b32 v28, 3, v28
v_lshrrev_b32 v27, 5, v1
v_lshlrev_b32 v27, 3, v27
v_add_u32 v27, v27, v28
v_lshlrev_b32 v27, 8, v27
v_lshrrev_b32 v29, 4, v1
v_and_b32 v29, 1, v29
v_lshlrev_b32 v29, 5, v29
v_add_u32 v27, v27, v29
v_and_b32 v29, 3, v1
v_lshlrev_b32 v29, 3, v29
v_add_u32 v27, v27, v29
s_lshr_b32 s60, s22, 1
s_lshl_b32 s60, s60, 14
s_add_u32 s60, s60, 32768
v_add_u32 v27, s60, v27
v_xor_b32 v29, 0, v28
v_lshlrev_b32 v29, 6, v29
v_add_u32 v18, v27, v29
v_add_u32 v22, 0x10000, v18
v_xor_b32 v29, 1, v28
v_lshlrev_b32 v29, 6, v29
v_add_u32 v19, v27, v29
v_add_u32 v23, 0x10000, v19
v_xor_b32 v29, 2, v28
v_lshlrev_b32 v29, 6, v29
v_add_u32 v20, v27, v29
v_add_u32 v24, 0x10000, v20
v_xor_b32 v29, 3, v28
v_lshlrev_b32 v29, 6, v29
v_add_u32 v21, v27, v29
v_add_u32 v25, 0x10000, v21
s_lshl_b32 s62, s22, 13
s_lshl_b32 s63, s22, 16
s_lshl_b32 s64, s22, 17
s_lshl_b32 s65, s22, 12
s_add_u32 m0, s62, 0
s_add_u32 s66, s63, 0
buffer_load_dwordx4 v2, s[24:27], s66 offen offset:0 lds
buffer_load_dwordx4 v3, s[24:27], s66 offen offset:1024 lds
buffer_load_dwordx4 v4, s[24:27], s66 offen offset:2048 lds
buffer_load_dwordx4 v5, s[24:27], s66 offen offset:3072 lds
s_add_u32 m0, s62, 4096
s_add_u32 s66, s63, 32768
buffer_load_dwordx4 v2, s[24:27], s66 offen offset:0 lds
buffer_load_dwordx4 v3, s[24:27], s66 offen offset:1024 lds
buffer_load_dwordx4 v4, s[24:27], s66 offen offset:2048 lds
buffer_load_dwordx4 v5, s[24:27], s66 offen offset:3072 lds
s_add_u32 m0, s65, 32768
s_nop 0
buffer_load_dwordx4 v6, s[28:31], s64 offen offset:0 lds
buffer_load_dwordx4 v7, s[28:31], s64 offen offset:1024 lds
buffer_load_dwordx4 v8, s[28:31], s64 offen offset:2048 lds
buffer_load_dwordx4 v9, s[28:31], s64 offen offset:3072 lds
s_add_u32 m0, s65, 49152
s_nop 0
buffer_load_dwordx4 v6, s[32:35], s64 offen offset:0 lds
buffer_load_dwordx4 v7, s[32:35], s64 offen offset:1024 lds
buffer_load_dwordx4 v8, s[32:35], s64 offen offset:2048 lds
buffer_load_dwordx4 v9, s[32:35], s64 offen offset:3072 lds
s_add_u32 s63, s63, 128
s_add_u32 s64, s64, 524288
s_add_u32 m0, s62, 65536
s_add_u32 s66, s63, 0
buffer_load_dwordx4 v2, s[24:27], s66 offen offset:0 lds
buffer_load_dwordx4 v3, s[24:27], s66 offen offset:1024 lds
buffer_load_dwordx4 v4, s[24:27], s66 offen offset:2048 lds
buffer_load_dwordx4 v5, s[24:27], s66 offen offset:3072 lds
s_add_u32 m0, s62, 69632
s_add_u32 s66, s63, 32768
buffer_load_dwordx4 v2, s[24:27], s66 offen offset:0 lds
buffer_load_dwordx4 v3, s[24:27], s66 offen offset:1024 lds
buffer_load_dwordx4 v4, s[24:27], s66 offen offset:2048 lds
buffer_load_dwordx4 v5, s[24:27], s66 offen offset:3072 lds
s_add_u32 m0, s65, 98304
s_nop 0
buffer_load_dwordx4 v6, s[28:31], s64 offen offset:0 lds
buffer_load_dwordx4 v7, s[28:31], s64 offen offset:1024 lds
buffer_load_dwordx4 v8, s[28:31], s64 offen offset:2048 lds
buffer_load_dwordx4 v9, s[28:31], s64 offen offset:3072 lds
s_add_u32 m0, s65, 114688
s_nop 0
buffer_load_dwordx4 v6, s[32:35], s64 offen offset:0 lds
buffer_load_dwordx4 v7, s[32:35], s64 offen offset:1024 lds
buffer_load_dwordx4 v8, s[32:35], s64 offen offset:2048 lds
buffer_load_dwordx4 v9, s[32:35], s64 offen offset:3072 lds
s_add_u32 s63, s63, 128
s_add_u32 s64, s64, 524288
s_cmp_eq_u32 s22, 1
s_cselect_b32 s4, s28, s24
s_cmp_eq_u32 s22, 2
s_cselect_b32 s4, s32, s4
s_cmp_eq_u32 s22, 3
s_cselect_b32 s4, s36, s4
s_cmp_eq_u32 s22, 1
s_cselect_b32 s5, s29, s25
s_cmp_eq_u32 s22, 2
s_cselect_b32 s5, s33, s5
s_cmp_eq_u32 s22, 3
s_cselect_b32 s5, s37, s5
s_cmp_eq_u32 s22, 1
s_cselect_b32 s6, s30, s26
s_cmp_eq_u32 s22, 2
s_cselect_b32 s6, s34, s6
s_cmp_eq_u32 s22, 3
s_cselect_b32 s6, s38, s6
s_cmp_eq_u32 s22, 1
s_cselect_b32 s7, s31, s27
s_cmp_eq_u32 s22, 2
s_cselect_b32 s7, s35, s7
s_cmp_eq_u32 s22, 3
s_cselect_b32 s7, s39, s7
s_mov_b32 s7, 0x20000
s_mov_b32 s9, 524288
s_mov_b32 s8, 524288
s_cmp_eq_u32 s22, 0
s_cselect_b32 s9, 128, s9
s_cselect_b32 s8, 128, s8
s_cmp_eq_u32 s22, 3
s_cselect_b32 s9, 655360, s9
s_cselect_b32 s8, 0, s8
s_and_b32 s60, s20, 3
s_lshl_b32 s60, s60, 6
v_add_u32 v33, s60, v1
v_lshlrev_b32 v33, 10, v33
s_lshl_b32 s60, s21, 3
s_mul_i32 s61, s21, 10
s_cmp_eq_u32 s22, 3
s_cselect_b32 s60, s61, s60
s_cselect_b32 s61, 20, 16
v_lshrrev_b32 v34, 1, v1
v_add_u32 v34, s60, v34
v_lshlrev_b32 v34, 13, v34
v_and_b32 v35, 1, v1
v_lshlrev_b32 v35, 7, v35
v_add_u32 v34, v34, v35
v_mov_b32 v35, 0x7ffffff0
v_cmp_gt_u32 vcc, s61, v1
s_nop 1
v_cndmask_b32 v34, v35, v34, vcc
s_cmp_eq_u32 s22, 0
s_cselect_b64 vcc, -1, 0
s_nop 1
v_cndmask_b32 v33, v34, v33, vcc
buffer_load_dword v34, v33, s[4:7], s8 offen
s_add_u32 s8, s8, s9
buffer_load_dword v34, v33, s[4:7], s8 offen
s_add_u32 s8, s8, s9
s_getreg_b32 s14, hwreg(HW_REG_XCC_ID)
s_and_b32 s14, s14, 7
s_lshl_b32 s14, s14, 2
s_cmp_lg_u32 s22, 0
s_cbranch_scc1 Lxc_1
s_add_u32 s60, s20, 16
s_lshl_b32 s60, s60, 2
s_lshl_b32 s61, 1, s14
v_mov_b32 v27, s60
v_mov_b32 v28, s61
s_mov_b64 s[60:61], exec
s_mov_b64 exec, 1
global_atomic_add v27, v28, s[16:17] sc1
s_mov_b64 exec, s[60:61]
s_lshl_b32 s60, s20, 7
s_lshl_b32 s61, s21, 2
s_add_u32 s60, s60, s61
s_add_u32 s60, s60, 0x5800000
v_mov_b32 v27, s60
v_mov_b32 v28, 0
s_mov_b64 s[60:61], exec
s_mov_b64 exec, 1
global_store_dword v27, v28, s[18:19] sc1
s_mov_b64 exec, s[60:61]
s_sub_u32 s79, 15, s21
s_lshl_b32 s60, s21, 2
s_lshr_b32 s61, s20, 3
s_add_u32 s60, s60, s61
s_lshl_b32 s60, s60, 7
s_and_b32 s61, s20, 7
s_lshl_b32 s61, s61, 2
s_add_u32 s60, s60, s61
s_add_u32 s60, s60, 4096
s_add_u32 s60, s60, 0x5800000
v_mov_b32 v27, s60
v_mov_b32 v28, 0
s_mov_b64 s[60:61], exec
s_mov_b64 exec, 1
global_store_dword v27, v28, s[18:19] sc1
s_mov_b64 exec, s[60:61]
s_lshl_b32 s60, s79, 2
s_lshr_b32 s61, s20, 3
s_add_u32 s60, s60, s61
s_lshl_b32 s60, s60, 7
s_and_b32 s61, s20, 7
s_lshl_b32 s61, s61, 2
s_add_u32 s60, s60, s61
s_add_u32 s60, s60, 4096
s_add_u32 s60, s60, 0x5800000
v_mov_b32 v27, s60
v_mov_b32 v28, 0
s_mov_b64 s[60:61], exec
s_mov_b64 exec, 1
global_store_dword v27, v28, s[18:19] sc1
s_mov_b64 exec, s[60:61]
s_and_b32 s12, s2, 3
s_bfe_u32 s13, s2, 0x10002
s_lshr_b32 s15, s2, 3
s_and_b32 s60, s15, 7
s_lshl_b32 s13, s13, 3
s_add_u32 s13, s13, s60
s_lshr_b32 s15, s15, 3
s_lshl_b32 s60, s13, 7
s_lshl_b32 s61, s15, 4
s_add_u32 s60, s60, s61
s_lshl_b32 s61, s12, 2
s_add_u32 s60, s60, s61
s_add_u32 s60, s60, 16384
s_add_u32 s60, s60, 0x5800000
v_mov_b32 v27, s60
v_mov_b32 v28, 0
s_mov_b64 s[60:61], exec
s_mov_b64 exec, 1
global_store_dword v27, v28, s[18:19] sc1
s_mov_b64 exec, s[60:61]
s_lshl_b32 s60, s13, 7
s_lshl_b32 s61, s15, 5
s_add_u32 s60, s60, s61
s_lshl_b32 s61, s12, 3
s_add_u32 s60, s60, s61
v_add_u32 v27, s60, v1
v_lshlrev_b32 v27, 2, v27
v_add_u32 v27, 0x5400000, v27
v_mov_b32 v28, 0x7fc0dead
s_mov_b64 s[60:61], exec
s_mov_b64 exec, 0xff
global_store_dword v27, v28, s[18:19] sc1
s_mov_b64 exec, s[60:61]
s_cmp_ge_u32 s2, 7
s_cbranch_scc1 Lyz_2
v_mov_b32 v28, -1
v_mov_b32 v29, -1
v_mov_b32 v30, -1
v_mov_b32 v31, -1
s_lshl_b32 s60, s2, 10
s_add_u32 s60, s60, 0x5500000
v_lshlrev_b32 v27, 4, v1
v_add_u32 v27, s60, v27
global_store_dwordx4 v27, v[28:31], s[18:19] sc1
Lyz_2:
Lxc_1:
s_load_dwordx2 s[76:77], s[0:1], 40
s_load_dwordx2 s[78:79], s[0:1], 64
s_load_dwordx2 s[80:81], s[0:1], 72
s_load_dwordx2 s[68:69], s[0:1], 80
s_lshl_b32 s60, s2, 2
s_add_u32 s60, s60, s22
s_lshl_b32 s60, s60, 6
v_add_u32 v41, s60, v1
v_lshlrev_b32 v41, 7, v41
v_min_u32 v42, 0x4fffc0, v41
v_min_u32 v43, 0x21bfc0, v41
s_lshl_b32 s85, s22, 17
s_lshl_b32 s84, s22, 12
s_add_u32 s84, s84, 98304
s_sub_u32 s75, 15, s21
s_cmp_ge_u32 s22, 2
s_cselect_b32 s60, s21, s75
s_lshl_b32 s60, s60, 2
s_and_b32 s61, s22, 1
s_lshl_b32 s61, s61, 1
s_add_u32 s60, s60, s61
s_mul_i32 s72, s60, 40960
s_add_u32 s73, s72, 40960
s_waitcnt vmcnt(34)
v_lshlrev_b32 v64, 16, v44
v_and_b32 v65, 0xffff0000, v44
v_lshlrev_b32 v66, 16, v45
v_and_b32 v67, 0xffff0000, v45
v_lshlrev_b32 v68, 16, v46
v_and_b32 v69, 0xffff0000, v46
v_lshlrev_b32 v70, 16, v47
v_and_b32 v71, 0xffff0000, v47
v_lshlrev_b32 v72, 16, v48
v_and_b32 v73, 0xffff0000, v48
v_lshlrev_b32 v74, 16, v49
v_and_b32 v75, 0xffff0000, v49
v_lshlrev_b32 v76, 16, v50
v_and_b32 v77, 0xffff0000, v50
v_lshlrev_b32 v78, 16, v51
v_and_b32 v79, 0xffff0000, v51
v_lshlrev_b32 v80, 16, v52
v_and_b32 v81, 0xffff0000, v52
v_lshlrev_b32 v82, 16, v53
v_and_b32 v83, 0xffff0000, v53
v_lshlrev_b32 v84, 16, v54
v_and_b32 v85, 0xffff0000, v54
v_lshlrev_b32 v86, 16, v55
v_and_b32 v87, 0xffff0000, v55
v_add_f32 v56, v64, v65
v_add_f32 v56, v56, v66
v_add_f32 v56, v56, v67
v_add_f32 v56, v56, v68
v_add_f32 v56, v56, v69
v_add_f32 v56, v56, v70
v_add_f32 v56, v56, v71
v_add_f32 v56, v56, v72
v_add_f32 v56, v56, v73
v_add_f32 v56, v56, v74
v_add_f32 v56, v56, v75
v_add_f32 v56, v56, v76
v_add_f32 v56, v56, v77
v_add_f32 v56, v56, v78
v_add_f32 v56, v56, v79
v_add_f32 v56, v56, v80
v_add_f32 v56, v56, v81
v_add_f32 v56, v56, v82
v_add_f32 v56, v56, v83
v_add_f32 v56, v56, v84
v_add_f32 v56, v56, v85
v_add_f32 v56, v56, v86
v_add_f32 v56, v56, v87
s_nop 1
v_add_f32_dpp v56, v56, v56 row_ror:8 row_mask:0xf bank_mask:0xf
s_nop 1
v_add_f32_dpp v56, v56, v56 row_ror:4 row_mask:0xf bank_mask:0xf
s_nop 1
v_add_f32_dpp v56, v56, v56 row_ror:2 row_mask:0xf bank_mask:0xf
s_nop 1
v_add_f32_dpp v56, v56, v56 row_ror:1 row_mask:0xf bank_mask:0xf
ds_swizzle_b32 v57, v56 offset:0x401F
s_waitcnt lgkmcnt(0)
v_add_f32 v56, v56, v57
v_mul_f32 v56, 0x3acccccd, v56
v_sub_f32 v64, v64, v56
v_sub_f32 v65, v65, v56
v_sub_f32 v66, v66, v56
v_sub_f32 v67, v67, v56
v_sub_f32 v68, v68, v56
v_sub_f32 v69, v69, v56
v_sub_f32 v70, v70, v56
v_sub_f32 v71, v71, v56
v_sub_f32 v72, v72, v56
v_sub_f32 v73, v73, v56
v_sub_f32 v74, v74, v56
v_sub_f32 v75, v75, v56
v_sub_f32 v76, v76, v56
v_sub_f32 v77, v77, v56
v_sub_f32 v78, v78, v56
v_sub_f32 v79, v79, v56
v_sub_f32 v80, v80, v56
v_sub_f32 v81, v81, v56
v_sub_f32 v82, v82, v56
v_sub_f32 v83, v83, v56
v_sub_f32 v84, v84, v56
v_sub_f32 v85, v85, v56
v_sub_f32 v86, v86, v56
v_sub_f32 v87, v87, v56
v_cmp_gt_u32 vcc, 16, v37
s_nop 1
v_cndmask_b32 v80, 0, v80, vcc
v_cndmask_b32 v81, 0, v81, vcc
v_cndmask_b32 v82, 0, v82, vcc
v_cndmask_b32 v83, 0, v83, vcc
v_cndmask_b32 v84, 0, v84, vcc
v_cndmask_b32 v85, 0, v85, vcc
v_cndmask_b32 v86, 0, v86, vcc
v_cndmask_b32 v87, 0, v87, vcc
v_mul_f32 v57, v64, v64
v_fmac_f32 v57, v65, v65
v_fmac_f32 v57, v66, v66
v_fmac_f32 v57, v67, v67
v_fmac_f32 v57, v68, v68
v_fmac_f32 v57, v69, v69
v_fmac_f32 v57, v70, v70
v_fmac_f32 v57, v71, v71
v_fmac_f32 v57, v72, v72
v_fmac_f32 v57, v73, v73
v_fmac_f32 v57, v74, v74
v_fmac_f32 v57, v75, v75
v_fmac_f32 v57, v76, v76
v_fmac_f32 v57, v77, v77
v_fmac_f32 v57, v78, v78
v_fmac_f32 v57, v79, v79
v_fmac_f32 v57, v80, v80
v_fmac_f32 v57, v81, v81
v_fmac_f32 v57, v82, v82
v_fmac_f32 v57, v83, v83
v_fmac_f32 v57, v84, v84
v_fmac_f32 v57, v85, v85
v_fmac_f32 v57, v86, v86
v_fmac_f32 v57, v87, v87
s_nop 1
v_add_f32_dpp v57, v57, v57 row_ror:8 row_mask:0xf bank_mask:0xf
s_nop 1
v_add_f32_dpp v57, v57, v57 row_ror:4 row_mask:0xf bank_mask:0xf
s_nop 1
v_add_f32_dpp v57, v57, v57 row_ror:2 row_mask:0xf bank_mask:0xf
s_nop 1
v_add_f32_dpp v57, v57, v57 row_ror:1 row_mask:0xf bank_mask:0xf
ds_swizzle_b32 v58, v57 offset:0x401F
s_waitcnt lgkmcnt(0)
v_add_f32 v57, v57, v58
v_mov_b32 v58, 0x3727c5ac
v_fmac_f32 v58, 0x3acccccd, v57
v_rsq_f32 v58, v58
s_nop 0
v_mul_f32 v58, 0x3e0293ee, v58
v_mul_f32 v64, v64, v58
v_mul_f32 v65, v65, v58
v_mul_f32 v66, v66, v58
v_mul_f32 v67, v67, v58
v_mul_f32 v68, v68, v58
v_mul_f32 v69, v69, v58
v_mul_f32 v70, v70, v58
v_mul_f32 v71, v71, v58
v_mul_f32 v72, v72, v58
v_mul_f32 v73, v73, v58
v_mul_f32 v74, v74, v58
v_mul_f32 v75, v75, v58
v_mul_f32 v76, v76, v58
v_mul_f32 v77, v77, v58
v_mul_f32 v78, v78, v58
v_mul_f32 v79, v79, v58
v_mul_f32 v80, v80, v58
v_mul_f32 v81, v81, v58
v_mul_f32 v82, v82, v58
v_mul_f32 v83, v83, v58
v_mul_f32 v84, v84, v58
v_mul_f32 v85, v85, v58
v_mul_f32 v86, v86, v58
v_mul_f32 v87, v87, v58
v_cvt_pk_bf16_f32 v44, v64, v65
v_cvt_pk_bf16_f32 v45, v66, v67
v_cvt_pk_bf16_f32 v46, v68, v69
v_cvt_pk_bf16_f32 v47, v70, v71
v_cvt_pk_bf16_f32 v48, v72, v73
v_cvt_pk_bf16_f32 v49, v74, v75
v_cvt_pk_bf16_f32 v50, v76, v77
v_cvt_pk_bf16_f32 v51, v78, v79
v_cvt_pk_bf16_f32 v52, v80, v81
v_cvt_pk_bf16_f32 v53, v82, v83
v_cvt_pk_bf16_f32 v54, v84, v85
v_cvt_pk_bf16_f32 v55, v86, v87
v_lshrrev_b32 v59, 5, v36
v_mul_u32_u24 v59, 40, v59
v_lshrrev_b32 v60, 1, v37
v_add_u32 v59, v59, v60
v_lshlrev_b32 v59, 6, v59
v_and_b32 v60, 1, v37
v_lshlrev_b32 v60, 5, v60
v_and_b32 v61, 31, v36
v_add3_u32 v59, v59, v60, v61
v_lshlrev_b32 v59, 4, v59
v_add_u32 v60, 0x4000, v59
v_add_u32 v61, 0x8000, v59
v_mov_b32 v62, 0x7ffffff0
v_cndmask_b32 v61, v62, v61, vcc
buffer_store_dwordx4 v[44:47], v59, s[40:43], 0 offen sc1
buffer_store_dwordx4 v[48:51], v60, s[40:43], 0 offen sc1
buffer_store_dwordx4 v[52:55], v61, s[40:43], 0 offen sc1
s_waitcnt vmcnt(21)
s_barrier
s_lshr_b32 s15, s2, 4
s_cmp_ge_u32 s22, 2
s_cbranch_scc1 LA_p1V
ds_read_b128 a[64:67], v10 offset:0
ds_read_b128 a[68:71], v10 offset:4096
ds_read_b128 a[72:75], v10 offset:8192
ds_read_b128 a[76:79], v10 offset:12288
ds_read_b64_tr_b16 a[80:81], v18 offset:0
ds_read_b64_tr_b16 a[82:83], v18 offset:1024
ds_read_b64_tr_b16 a[84:85], v19 offset:0
ds_read_b64_tr_b16 a[86:87], v19 offset:1024
ds_read_b64_tr_b16 a[88:89], v20 offset:0
ds_read_b64_tr_b16 a[90:91], v20 offset:1024
ds_read_b64_tr_b16 a[92:93], v21 offset:0
ds_read_b64_tr_b16 a[94:95], v21 offset:1024
s_mov_b32 s70, 0
s_waitcnt lgkmcnt(6)
v_mfma_f32_32x32x16_bf16 v[64:79], a[80:83], a[64:67], 0
ds_read_b128 a[96:99], v11 offset:0
v_mfma_f32_32x32x16_bf16 v[128:143], a[80:83], a[68:71], 0
ds_read_b128 a[100:103], v11 offset:4096
v_mfma_f32_32x32x16_bf16 v[192:207], a[80:83], a[72:75], 0
ds_read_b128 a[104:107], v11 offset:8192
v_mfma_f32_32x32x16_bf16 a[0:15], a[80:83], a[76:79], 0
ds_read_b128 a[108:111], v11 offset:12288
s_waitcnt lgkmcnt(8)
v_mfma_f32_32x32x16_bf16 v[80:95], a[84:87], a[64:67], 0
ds_read_b64_tr_b16 a[112:113], v18 offset:4096
v_mfma_f32_32x32x16_bf16 v[144:159], a[84:87], a[68:71], 0
ds_read_b64_tr_b16 a[114:115], v18 offset:5120
v_mfma_f32_32x32x16_bf16 v[208:223], a[84:87], a[72:75], 0
ds_read_b64_tr_b16 a[116:117], v19 offset:4096
v_mfma_f32_32x32x16_bf16 a[16:31], a[84:87], a[76:79], 0
ds_read_b64_tr_b16 a[118:119], v19 offset:5120
s_waitcnt lgkmcnt(10)
v_mfma_f32_32x32x16_bf16 v[96:111], a[88:91], a[64:67], 0
ds_read_b64_tr_b16 a[120:121], v20 offset:4096
v_mfma_f32_32x32x16_bf16 v[160:175], a[88:91], a[68:71], 0
ds_read_b64_tr_b16 a[122:123], v20 offset:5120
v_mfma_f32_32x32x16_bf16 v[224:239], a[88:91], a[72:75], 0
ds_read_b64_tr_b16 a[124:125], v21 offset:4096
v_mfma_f32_32x32x16_bf16 a[32:47], a[88:91], a[76:79], 0
s_waitcnt lgkmcnt(11)
v_mfma_f32_32x32x16_bf16 v[112:127], a[92:95], a[64:67], 0
ds_read_b64_tr_b16 a[126:127], v21 offset:5120
v_mfma_f32_32x32x16_bf16 v[176:191], a[92:95], a[68:71], 0
v_mfma_f32_32x32x16_bf16 v[240:255], a[92:95], a[72:75], 0
v_mfma_f32_32x32x16_bf16 a[48:63], a[92:95], a[76:79], 0
s_waitcnt lgkmcnt(6)
v_mfma_f32_32x32x16_bf16 v[64:79], a[112:115], a[96:99], v[64:79]
ds_read_b128 a[64:67], v12 offset:0
buffer_load_dword v34, v33, s[4:7], s8 offen
s_add_u32 s8, s8, s9
v_mfma_f32_32x32x16_bf16 v[128:143], a[112:115], a[100:103], v[128:143]
ds_read_b128 a[68:71], v12 offset:4096
v_mfma_f32_32x32x16_bf16 v[192:207], a[112:115], a[104:107], v[192:207]
ds_read_b128 a[72:75], v12 offset:8192
v_mfma_f32_32x32x16_bf16 a[0:15], a[112:115], a[108:111], a[0:15]
ds_read_b128 a[76:79], v12 offset:12288
s_waitcnt lgkmcnt(8)
v_mfma_f32_32x32x16_bf16 v[80:95], a[116:119], a[96:99], v[80:95]
ds_read_b64_tr_b16 a[80:81], v18 offset:8192
v_mfma_f32_32x32x16_bf16 v[144:159], a[116:119], a[100:103], v[144:159]
ds_read_b64_tr_b16 a[82:83], v18 offset:9216
v_mfma_f32_32x32x16_bf16 v[208:223], a[116:119], a[104:107], v[208:223]
ds_read_b64_tr_b16 a[84:85], v19 offset:8192
v_mfma_f32_32x32x16_bf16 a[16:31], a[116:119], a[108:111], a[16:31]
ds_read_b64_tr_b16 a[86:87], v19 offset:9216
s_waitcnt lgkmcnt(10)
v_mfma_f32_32x32x16_bf16 v[96:111], a[120:123], a[96:99], v[96:111]
ds_read_b64_tr_b16 a[88:89], v20 offset:8192
v_mfma_f32_32x32x16_bf16 v[160:175], a[120:123], a[100:103], v[160:175]
ds_read_b64_tr_b16 a[90:91], v20 offset:9216
v_mfma_f32_32x32x16_bf16 v[224:239], a[120:123], a[104:107], v[224:239]
ds_read_b64_tr_b16 a[92:93], v21 offset:8192
v_mfma_f32_32x32x16_bf16 a[32:47], a[120:123], a[108:111], a[32:47]
s_waitcnt lgkmcnt(11)
v_mfma_f32_32x32x16_bf16 v[112:127], a[124:127], a[96:99], v[112:127]
ds_read_b64_tr_b16 a[94:95], v21 offset:9216
v_mfma_f32_32x32x16_bf16 v[176:191], a[124:127], a[100:103], v[176:191]
v_mfma_f32_32x32x16_bf16 v[240:255], a[124:127], a[104:107], v[240:255]
v_mfma_f32_32x32x16_bf16 a[48:63], a[124:127], a[108:111], a[48:63]
s_waitcnt lgkmcnt(6)
v_mfma_f32_32x32x16_bf16 v[64:79], a[80:83], a[64:67], v[64:79]
ds_read_b128 a[96:99], v13 offset:0
v_mfma_f32_32x32x16_bf16 v[128:143], a[80:83], a[68:71], v[128:143]
ds_read_b128 a[100:103], v13 offset:4096
v_mfma_f32_32x32x16_bf16 v[192:207], a[80:83], a[72:75], v[192:207]
ds_read_b128 a[104:107], v13 offset:8192
v_mfma_f32_32x32x16_bf16 a[0:15], a[80:83], a[76:79], a[0:15]
ds_read_b128 a[108:111], v13 offset:12288
s_waitcnt lgkmcnt(8)
v_mfma_f32_32x32x16_bf16 v[80:95], a[84:87], a[64:67], v[80:95]
ds_read_b64_tr_b16 a[112:113], v18 offset:12288
v_mfma_f32_32x32x16_bf16 v[144:159], a[84:87], a[68:71], v[144:159]
ds_read_b64_tr_b16 a[114:115], v18 offset:13312
v_mfma_f32_32x32x16_bf16 v[208:223], a[84:87], a[72:75], v[208:223]
ds_read_b64_tr_b16 a[116:117], v19 offset:12288
v_mfma_f32_32x32x16_bf16 a[16:31], a[84:87], a[76:79], a[16:31]
ds_read_b64_tr_b16 a[118:119], v19 offset:13312
s_waitcnt lgkmcnt(10)
v_mfma_f32_32x32x16_bf16 v[96:111], a[88:91], a[64:67], v[96:111]
ds_read_b64_tr_b16 a[120:121], v20 offset:12288
v_mfma_f32_32x32x16_bf16 v[160:175], a[88:91], a[68:71], v[160:175]
ds_read_b64_tr_b16 a[122:123], v20 offset:13312
v_mfma_f32_32x32x16_bf16 v[224:239], a[88:91], a[72:75], v[224:239]
ds_read_b64_tr_b16 a[124:125], v21 offset:12288
v_mfma_f32_32x32x16_bf16 a[32:47], a[88:91], a[76:79], a[32:47]
s_waitcnt lgkmcnt(11)
v_mfma_f32_32x32x16_bf16 v[112:127], a[92:95], a[64:67], v[112:127]
ds_read_b64_tr_b16 a[126:127], v21 offset:13312
v_mfma_f32_32x32x16_bf16 v[176:191], a[92:95], a[68:71], v[176:191]
v_mfma_f32_32x32x16_bf16 v[240:255], a[92:95], a[72:75], v[240:255]
v_mfma_f32_32x32x16_bf16 a[48:63], a[92:95], a[76:79], a[48:63]
s_waitcnt vmcnt(1) lgkmcnt(0)
s_barrier
s_cmp_lg_u32 s22, 0
s_cbranch_scc1 Lsig_3
s_lshr_b32 s60, s15, 2
s_add_u32 s60, s60, 8
s_lshl_b32 s60, s60, 2
s_and_b32 s61, s15, 3
s_lshl_b32 s61, s61, 3
s_lshl_b32 s61, 1, s61
v_mov_b32 v27, s60
v_mov_b32 v28, s61
s_mov_b64 s[60:61], exec
s_mov_b64 exec, 1
global_atomic_add v27, v28, s[16:17] sc1
s_mov_b64 exec, s[60:61]
Lsig_3:
v_mfma_f32_32x32x16_bf16 v[64:79], a[112:115], a[96:99], v[64:79]
ds_read_b128 a[64:67], v14 offset:0
s_add_u32 m0, s62, 0
s_add_u32 s66, s63, 0
buffer_load_dwordx4 v2, s[24:27], s66 offen offset:0 lds
v_mfma_f32_32x32x16_bf16 v[128:143], a[112:115], a[100:103], v[128:143]
ds_read_b128 a[68:71], v14 offset:4096
v_mfma_f32_32x32x16_bf16 v[192:207], a[112:115], a[104:107], v[192:207]
ds_read_b128 a[72:75], v14 offset:8192
buffer_load_dwordx4 v3, s[24:27], s66 offen offset:1024 lds
v_mfma_f32_32x32x16_bf16 a[0:15], a[112:115], a[108:111], a[0:15]
ds_read_b128 a[76:79], v14 offset:12288
v_mfma_f32_32x32x16_bf16 v[80:95], a[116:119], a[96:99], v[80:95]
buffer_load_dwordx4 v4, s[24:27], s66 offen offset:2048 lds
ds_read_b64_tr_b16 a[80:81], v22 offset:0
v_mfma_f32_32x32x16_bf16 v[144:159], a[116:119], a[100:103], v[144:159]
ds_read_b64_tr_b16 a[82:83], v22 offset:1024
v_mfma_f32_32x32x16_bf16 v[208:223], a[116:119], a[104:107], v[208:223]
buffer_load_dwordx4 v5, s[24:27], s66 offen offset:3072 lds
ds_read_b64_tr_b16 a[84:85], v23 offset:0
v_mfma_f32_32x32x16_bf16 a[16:31], a[116:119], a[108:111], a[16:31]
ds_read_b64_tr_b16 a[86:87], v23 offset:1024
v_mfma_f32_32x32x16_bf16 v[96:111], a[120:123], a[96:99], v[96:111]
s_add_u32 m0, s62, 4096
s_add_u32 s66, s63, 32768
buffer_load_dwordx4 v2, s[24:27], s66 offen offset:0 lds
ds_read_b64_tr_b16 a[88:89], v24 offset:0
v_mfma_f32_32x32x16_bf16 v[160:175], a[120:123], a[100:103], v[160:175]
ds_read_b64_tr_b16 a[90:91], v24 offset:1024
buffer_load_dwordx4 v3, s[24:27], s66 offen offset:1024 lds
v_mfma_f32_32x32x16_bf16 v[224:239], a[120:123], a[104:107], v[224:239]
ds_read_b64_tr_b16 a[92:93], v25 offset:0
v_mfma_f32_32x32x16_bf16 a[32:47], a[120:123], a[108:111], a[32:47]
buffer_load_dwordx4 v4, s[24:27], s66 offen offset:2048 lds
v_mfma_f32_32x32x16_bf16 v[112:127], a[124:127], a[96:99], v[112:127]
ds_read_b64_tr_b16 a[94:95], v25 offset:1024
v_mfma_f32_32x32x16_bf16 v[176:191], a[124:127], a[100:103], v[176:191]
buffer_load_dwordx4 v5, s[24:27], s66 offen offset:3072 lds
s_add_u32 s63, s63, 128
v_mfma_f32_32x32x16_bf16 v[240:255], a[124:127], a[104:107], v[240:255]
v_mfma_f32_32x32x16_bf16 a[48:63], a[124:127], a[108:111], a[48:63]
s_waitcnt lgkmcnt(6)
v_mfma_f32_32x32x16_bf16 v[64:79], a[80:83], a[64:67], v[64:79]
ds_read_b128 a[96:99], v15 offset:0
s_add_u32 m0, s65, 32768
s_nop 0
buffer_load_dwordx4 v6, s[28:31], s64 offen offset:0 lds
v_mfma_f32_32x32x16_bf16 v[128:143], a[80:83], a[68:71], v[128:143]
ds_read_b128 a[100:103], v15 offset:4096
v_mfma_f32_32x32x16_bf16 v[192:207], a[80:83], a[72:75], v[192:207]
ds_read_b128 a[104:107], v15 offset:8192
buffer_load_dwordx4 v7, s[28:31], s64 offen offset:1024 lds
v_mfma_f32_32x32x16_bf16 a[0:15], a[80:83], a[76:79], a[0:15]
ds_read_b128 a[108:111], v15 offset:12288
s_waitcnt lgkmcnt(8)
v_mfma_f32_32x32x16_bf16 v[80:95], a[84:87], a[64:67], v[80:95]
buffer_load_dwordx4 v8, s[28:31], s64 offen offset:2048 lds
ds_read_b64_tr_b16 a[112:113], v22 offset:4096
v_mfma_f32_32x32x16_bf16 v[144:159], a[84:87], a[68:71], v[144:159]
ds_read_b64_tr_b16 a[114:115], v22 offset:5120
v_mfma_f32_32x32x16_bf16 v[208:223], a[84:87], a[72:75], v[208:223]
buffer_load_dwordx4 v9, s[28:31], s64 offen offset:3072 lds
ds_read_b64_tr_b16 a[116:117], v23 offset:4096
v_mfma_f32_32x32x16_bf16 a[16:31], a[84:87], a[76:79], a[16:31]
ds_read_b64_tr_b16 a[118:119], v23 offset:5120
s_waitcnt lgkmcnt(10)
v_mfma_f32_32x32x16_bf16 v[96:111], a[88:91], a[64:67], v[96:111]
s_add_u32 m0, s65, 49152
s_nop 0
buffer_load_dwordx4 v6, s[32:35], s64 offen offset:0 lds
ds_read_b64_tr_b16 a[120:121], v24 offset:4096
v_mfma_f32_32x32x16_bf16 v[160:175], a[88:91], a[68:71], v[160:175]
ds_read_b64_tr_b16 a[122:123], v24 offset:5120
buffer_load_dwordx4 v7, s[32:35], s64 offen offset:1024 lds
v_mfma_f32_32x32x16_bf16 v[224:239], a[88:91], a[72:75], v[224:239]
ds_read_b64_tr_b16 a[124:125], v25 offset:4096
v_mfma_f32_32x32x16_bf16 a[32:47], a[88:91], a[76:79], a[32:47]
buffer_load_dwordx4 v8, s[32:35], s64 offen offset:2048 lds
s_waitcnt lgkmcnt(11)
v_mfma_f32_32x32x16_bf16 v[112:127], a[92:95], a[64:67], v[112:127]
ds_read_b64_tr_b16 a[126:127], v25 offset:5120
v_mfma_f32_32x32x16_bf16 v[176:191], a[92:95], a[68:71], v[176:191]
buffer_load_dwordx4 v9, s[32:35], s64 offen offset:3072 lds
s_add_u32 s64, s64, 524288
v_mfma_f32_32x32x16_bf16 v[240:255], a[92:95], a[72:75], v[240:255]
v_mfma_f32_32x32x16_bf16 a[48:63], a[92:95], a[76:79], a[48:63]
s_waitcnt lgkmcnt(6)
v_mfma_f32_32x32x16_bf16 v[64:79], a[112:115], a[96:99], v[64:79]
ds_read_b128 a[64:67], v16 offset:0
buffer_load_dword v34, v33, s[4:7], s8 offen
s_add_u32 s8, s8, s9
v_mfma_f32_32x32x16_bf16 v[128:143], a[112:115], a[100:103], v[128:143]
ds_read_b128 a[68:71], v16 offset:4096
v_mfma_f32_32x32x16_bf16 v[192:207], a[112:115], a[104:107], v[192:207]
ds_read_b128 a[72:75], v16 offset:8192
v_mfma_f32_32x32x16_bf16 a[0:15], a[112:115], a[108:111], a[0:15]
ds_read_b128 a[76:79], v16 offset:12288
global_load_dword v34, v42, s[76:77]
s_waitcnt lgkmcnt(8)
v_mfma_f32_32x32x16_bf16 v[80:95], a[116:119], a[96:99], v[80:95]
ds_read_b64_tr_b16 a[80:81], v22 offset:8192
v_mfma_f32_32x32x16_bf16 v[144:159], a[116:119], a[100:103], v[144:159]
ds_read_b64_tr_b16 a[82:83], v22 offset:9216
v_mfma_f32_32x32x16_bf16 v[208:223], a[116:119], a[104:107], v[208:223]
global_load_dword v34, v43, s[78:79]
ds_read_b64_tr_b16 a[84:85], v23 offset:8192
v_mfma_f32_32x32x16_bf16 a[16:31], a[116:119], a[108:111], a[16:31]
ds_read_b64_tr_b16 a[86:87], v23 offset:9216
s_waitcnt lgkmcnt(10)
v_mfma_f32_32x32x16_bf16 v[96:111], a[120:123], a[96:99], v[96:111]
ds_read_b64_tr_b16 a[88:89], v24 offset:8192
v_mfma_f32_32x32x16_bf16 v[160:175], a[120:123], a[100:103], v[160:175]
global_load_dword v34, v43, s[80:81]
ds_read_b64_tr_b16 a[90:91], v24 offset:9216
v_mfma_f32_32x32x16_bf16 v[224:239], a[120:123], a[104:107], v[224:239]
ds_read_b64_tr_b16 a[92:93], v25 offset:8192
v_mfma_f32_32x32x16_bf16 a[32:47], a[120:123], a[108:111], a[32:47]
s_waitcnt lgkmcnt(11)
v_mfma_f32_32x32x16_bf16 v[112:127], a[124:127], a[96:99], v[112:127]
ds_read_b64_tr_b16 a[94:95], v25 offset:9216
global_load_dword v34, v43, s[68:69]
v_mfma_f32_32x32x16_bf16 v[176:191], a[124:127], a[100:103], v[176:191]
v_mfma_f32_32x32x16_bf16 v[240:255], a[124:127], a[104:107], v[240:255]
v_mfma_f32_32x32x16_bf16 a[48:63], a[124:127], a[108:111], a[48:63]
s_waitcnt lgkmcnt(6)
v_mfma_f32_32x32x16_bf16 v[64:79], a[80:83], a[64:67], v[64:79]
ds_read_b128 a[96:99], v17 offset:0
v_mfma_f32_32x32x16_bf16 v[128:143], a[80:83], a[68:71], v[128:143]
ds_read_b128 a[100:103], v17 offset:4096
v_mfma_f32_32x32x16_bf16 v[192:207], a[80:83], a[72:75], v[192:207]
ds_read_b128 a[104:107], v17 offset:8192
v_mfma_f32_32x32x16_bf16 a[0:15], a[80:83], a[76:79], a[0:15]
ds_read_b128 a[108:111], v17 offset:12288
s_waitcnt lgkmcnt(8)
v_mfma_f32_32x32x16_bf16 v[80:95], a[84:87], a[64:67], v[80:95]
ds_read_b64_tr_b16 a[112:113], v22 offset:12288
v_mfma_f32_32x32x16_bf16 v[144:159], a[84:87], a[68:71], v[144:159]
ds_read_b64_tr_b16 a[114:115], v22 offset:13312
v_mfma_f32_32x32x16_bf16 v[208:223], a[84:87], a[72:75], v[208:223]
ds_read_b64_tr_b16 a[116:117], v23 offset:12288
v_mfma_f32_32x32x16_bf16 a[16:31], a[84:87], a[76:79], a[16:31]
ds_read_b64_tr_b16 a[118:119], v23 offset:13312
s_waitcnt lgkmcnt(10)
v_mfma_f32_32x32x16_bf16 v[96:111], a[88:91], a[64:67], v[96:111]
ds_read_b64_tr_b16 a[120:121], v24 offset:12288
v_mfma_f32_32x32x16_bf16 v[160:175], a[88:91], a[68:71], v[160:175]
ds_read_b64_tr_b16 a[122:123], v24 offset:13312
v_mfma_f32_32x32x16_bf16 v[224:239], a[88:91], a[72:75], v[224:239]
ds_read_b64_tr_b16 a[124:125], v25 offset:12288
v_mfma_f32_32x32x16_bf16 a[32:47], a[88:91], a[76:79], a[32:47]
s_waitcnt lgkmcnt(11)
v_mfma_f32_32x32x16_bf16 v[112:127], a[92:95], a[64:67], v[112:127]
ds_read_b64_tr_b16 a[126:127], v25 offset:13312
v_mfma_f32_32x32x16_bf16 v[176:191], a[92:95], a[68:71], v[176:191]
v_mfma_f32_32x32x16_bf16 v[240:255], a[92:95], a[72:75], v[240:255]
v_mfma_f32_32x32x16_bf16 a[48:63], a[92:95], a[76:79], a[48:63]
s_waitcnt vmcnt(5) lgkmcnt(0)
s_barrier
v_mfma_f32_32x32x16_bf16 v[64:79], a[112:115], a[96:99], v[64:79]
ds_read_b128 a[64:67], v10 offset:0
s_add_u32 m0, s62, 65536
s_add_u32 s66, s63, 0
buffer_load_dwordx4 v2, s[24:27], s66 offen offset:0 lds
v_mfma_f32_32x32x16_bf16 v[128:143], a[112:115], a[100:103], v[128:143]
ds_read_b128 a[68:71], v10 offset:4096
v_mfma_f32_32x32x16_bf16 v[192:207], a[112:115], a[104:107], v[192:207]
ds_read_b128 a[72:75], v10 offset:8192
buffer_load_dwordx4 v3, s[24:27], s66 offen offset:1024 lds
v_mfma_f32_32x32x16_bf16 a[0:15], a[112:115], a[108:111], a[0:15]
ds_read_b128 a[76:79], v10 offset:12288
v_mfma_f32_32x32x16_bf16 v[80:95], a[116:119], a[96:99], v[80:95]
buffer_load_dwordx4 v4, s[24:27], s66 offen offset:2048 lds
ds_read_b64_tr_b16 a[80:81], v18 offset:0
v_mfma_f32_32x32x16_bf16 v[144:159], a[116:119], a[100:103], v[144:159]
ds_read_b64_tr_b16 a[82:83], v18 offset:1024
v_mfma_f32_32x32x16_bf16 v[208:223], a[116:119], a[104:107], v[208:223]
buffer_load_dwordx4 v5, s[24:27], s66 offen offset:3072 lds
ds_read_b64_tr_b16 a[84:85], v19 offset:0
v_mfma_f32_32x32x16_bf16 a[16:31], a[116:119], a[108:111], a[16:31]
ds_read_b64_tr_b16 a[86:87], v19 offset:1024
v_mfma_f32_32x32x16_bf16 v[96:111], a[120:123], a[96:99], v[96:111]
s_add_u32 m0, s62, 69632
s_add_u32 s66, s63, 32768
buffer_load_dwordx4 v2, s[24:27], s66 offen offset:0 lds
ds_read_b64_tr_b16 a[88:89], v20 offset:0
v_mfma_f32_32x32x16_bf16 v[160:175], a[120:123], a[100:103], v[160:175]
ds_read_b64_tr_b16 a[90:91], v20 offset:1024
buffer_load_dwordx4 v3, s[24:27], s66 offen offset:1024 lds
v_mfma_f32_32x32x16_bf16 v[224:239], a[120:123], a[104:107], v[224:239]
ds_read_b64_tr_b16 a[92:93], v21 offset:0
v_mfma_f32_32x32x16_bf16 a[32:47], a[120:123], a[108:111], a[32:47]
buffer_load_dwordx4 v4, s[24:27], s66 offen offset:2048 lds
v_mfma_f32_32x32x16_bf16 v[112:127], a[124:127], a[96:99], v[112:127]
ds_read_b64_tr_b16 a[94:95], v21 offset:1024
v_mfma_f32_32x32x16_bf16 v[176:191], a[124:127], a[100:103], v[176:191]
buffer_load_dwordx4 v5, s[24:27], s66 offen offset:3072 lds
s_add_u32 s63, s63, 128
v_mfma_f32_32x32x16_bf16 v[240:255], a[124:127], a[104:107], v[240:255]
v_mfma_f32_32x32x16_bf16 a[48:63], a[124:127], a[108:111], a[48:63]
.p2align 6
LP1K_loop:
s_waitcnt lgkmcnt(6)
v_mfma_f32_32x32x16_bf16 v[64:79], a[80:83], a[64:67], v[64:79]
ds_read_b128 a[96:99], v11 offset:0
s_add_u32 m0, s65, 98304
s_nop 0
buffer_load_dwordx4 v6, s[28:31], s64 offen offset:0 lds
v_mfma_f32_32x32x16_bf16 v[128:143], a[80:83], a[68:71], v[128:143]
ds_read_b128 a[100:103], v11 offset:4096
v_mfma_f32_32x32x16_bf16 v[192:207], a[80:83], a[72:75], v[192:207]
ds_read_b128 a[104:107], v11 offset:8192
buffer_load_dwordx4 v7, s[28:31], s64 offen offset:1024 lds
v_mfma_f32_32x32x16_bf16 a[0:15], a[80:83], a[76:79], a[0:15]
ds_read_b128 a[108:111], v11 offset:12288
s_waitcnt lgkmcnt(8)
v_mfma_f32_32x32x16_bf16 v[80:95], a[84:87], a[64:67], v[80:95]
buffer_load_dwordx4 v8, s[28:31], s64 offen offset:2048 lds
ds_read_b64_tr_b16 a[112:113], v18 offset:4096
v_mfma_f32_32x32x16_bf16 v[144:159], a[84:87], a[68:71], v[144:159]
ds_read_b64_tr_b16 a[114:115], v18 offset:5120
v_mfma_f32_32x32x16_bf16 v[208:223], a[84:87], a[72:75], v[208:223]
buffer_load_dwordx4 v9, s[28:31], s64 offen offset:3072 lds
ds_read_b64_tr_b16 a[116:117], v19 offset:4096
v_mfma_f32_32x32x16_bf16 a[16:31], a[84:87], a[76:79], a[16:31]
ds_read_b64_tr_b16 a[118:119], v19 offset:5120
s_waitcnt lgkmcnt(10)
v_mfma_f32_32x32x16_bf16 v[96:111], a[88:91], a[64:67], v[96:111]
s_add_u32 m0, s65, 114688
s_nop 0
buffer_load_dwordx4 v6, s[32:35], s64 offen offset:0 lds
ds_read_b64_tr_b16 a[120:121], v20 offset:4096
v_mfma_f32_32x32x16_bf16 v[160:175], a[88:91], a[68:71], v[160:175]
ds_read_b64_tr_b16 a[122:123], v20 offset:5120
buffer_load_dwordx4 v7, s[32:35], s64 offen offset:1024 lds
v_mfma_f32_32x32x16_bf16 v[224:239], a[88:91], a[72:75], v[224:239]
ds_read_b64_tr_b16 a[124:125], v21 offset:4096
v_mfma_f32_32x32x16_bf16 a[32:47], a[88:91], a[76:79], a[32:47]
buffer_load_dwordx4 v8, s[32:35], s64 offen offset:2048 lds
s_waitcnt lgkmcnt(11)
v_mfma_f32_32x32x16_bf16 v[112:127], a[92:95], a[64:67], v[112:127]
ds_read_b64_tr_b16 a[126:127], v21 offset:5120
v_mfma_f32_32x32x16_bf16 v[176:191], a[92:95], a[68:71], v[176:191]
buffer_load_dwordx4 v9, s[32:35], s64 offen offset:3072 lds
s_add_u32 s64, s64, 524288
v_mfma_f32_32x32x16_bf16 v[240:255], a[92:95], a[72:75], v[240:255]
v_mfma_f32_32x32x16_bf16 a[48:63], a[92:95], a[76:79], a[48:63]
s_waitcnt lgkmcnt(6)
v_mfma_f32_32x32x16_bf16 v[64:79], a[112:115], a[96:99], v[64:79]
ds_read_b128 a[64:67], v12 offset:0
buffer_load_dword v34, v33, s[4:7], s8 offen
s_add_u32 s8, s8, s9
v_mfma_f32_32x32x16_bf16 v[128:143], a[112:115], a[100:103], v[128:143]
ds_read_b128 a[68:71], v12 offset:4096
v_mfma_f32_32x32x16_bf16 v[192:207], a[112:115], a[104:107], v[192:207]
ds_read_b128 a[72:75], v12 offset:8192
v_mfma_f32_32x32x16_bf16 a[0:15], a[112:115], a[108:111], a[0:15]
ds_read_b128 a[76:79], v12 offset:12288
s_waitcnt lgkmcnt(8)
v_mfma_f32_32x32x16_bf16 v[80:95], a[116:119], a[96:99], v[80:95]
ds_read_b64_tr_b16 a[80:81], v18 offset:8192
v_mfma_f32_32x32x16_bf16 v[144:159], a[116:119], a[100:103], v[144:159]
ds_read_b64_tr_b16 a[82:83], v18 offset:9216
v_mfma_f32_32x32x16_bf16 v[208:223], a[116:119], a[104:107], v[208:223]
ds_read_b64_tr_b16 a[84:85], v19 offset:8192
v_mfma_f32_32x32x16_bf16 a[16:31], a[116:119], a[108:111], a[16:31]
ds_read_b64_tr_b16 a[86:87], v19 offset:9216
s_waitcnt lgkmcnt(10)
v_mfma_f32_32x32x16_bf16 v[96:111], a[120:123], a[96:99], v[96:111]
ds_read_b64_tr_b16 a[88:89], v20 offset:8192
v_mfma_f32_32x32x16_bf16 v[160:175], a[120:123], a[100:103], v[160:175]
ds_read_b64_tr_b16 a[90:91], v20 offset:9216
v_mfma_f32_32x32x16_bf16 v[224:239], a[120:123], a[104:107], v[224:239]
ds_read_b64_tr_b16 a[92:93], v21 offset:8192
v_mfma_f32_32x32x16_bf16 a[32:47], a[120:123], a[108:111], a[32:47]
s_waitcnt lgkmcnt(11)
v_mfma_f32_32x32x16_bf16 v[112:127], a[124:127], a[96:99], v[112:127]
ds_read_b64_tr_b16 a[94:95], v21 offset:9216
v_mfma_f32_32x32x16_bf16 v[176:191], a[124:127], a[100:103], v[176:191]
v_mfma_f32_32x32x16_bf16 v[240:255], a[124:127], a[104:107], v[240:255]
v_mfma_f32_32x32x16_bf16 a[48:63], a[124:127], a[108:111], a[48:63]
s_waitcnt lgkmcnt(6)
v_mfma_f32_32x32x16_bf16 v[64:79], a[80:83], a[64:67], v[64:79]
ds_read_b128 a[96:99], v13 offset:0
v_mfma_f32_32x32x16_bf16 v[128:143], a[80:83], a[68:71], v[128:143]
ds_read_b128 a[100:103], v13 offset:4096
v_mfma_f32_32x32x16_bf16 v[192:207], a[80:83], a[72:75], v[192:207]
ds_read_b128 a[104:107], v13 offset:8192
v_mfma_f32_32x32x16_bf16 a[0:15], a[80:83], a[76:79], a[0:15]
ds_read_b128 a[108:111], v13 offset:12288
s_waitcnt lgkmcnt(8)
v_mfma_f32_32x32x16_bf16 v[80:95], a[84:87], a[64:67], v[80:95]
ds_read_b64_tr_b16 a[112:113], v18 offset:12288
v_mfma_f32_32x32x16_bf16 v[144:159], a[84:87], a[68:71], v[144:159]
ds_read_b64_tr_b16 a[114:115], v18 offset:13312
v_mfma_f32_32x32x16_bf16 v[208:223], a[84:87], a[72:75], v[208:223]
ds_read_b64_tr_b16 a[116:117], v19 offset:12288
v_mfma_f32_32x32x16_bf16 a[16:31], a[84:87], a[76:79], a[16:31]
ds_read_b64_tr_b16 a[118:119], v19 offset:13312
s_waitcnt lgkmcnt(10)
v_mfma_f32_32x32x16_bf16 v[96:111], a[88:91], a[64:67], v[96:111]
ds_read_b64_tr_b16 a[120:121], v20 offset:12288
v_mfma_f32_32x32x16_bf16 v[160:175], a[88:91], a[68:71], v[160:175]
ds_read_b64_tr_b16 a[122:123], v20 offset:13312
v_mfma_f32_32x32x16_bf16 v[224:239], a[88:91], a[72:75], v[224:239]
ds_read_b64_tr_b16 a[124:125], v21 offset:12288
v_mfma_f32_32x32x16_bf16 a[32:47], a[88:91], a[76:79], a[32:47]
s_waitcnt lgkmcnt(11)
v_mfma_f32_32x32x16_bf16 v[112:127], a[92:95], a[64:67], v[112:127]
ds_read_b64_tr_b16 a[126:127], v21 offset:13312
v_mfma_f32_32x32x16_bf16 v[176:191], a[92:95], a[68:71], v[176:191]
v_mfma_f32_32x32x16_bf16 v[240:255], a[92:95], a[72:75], v[240:255]
v_mfma_f32_32x32x16_bf16 a[48:63], a[92:95], a[76:79], a[48:63]
s_waitcnt vmcnt(1) lgkmcnt(0)
s_barrier
v_mfma_f32_32x32x16_bf16 v[64:79], a[112:115], a[96:99], v[64:79]
ds_read_b128 a[64:67], v14 offset:0
s_add_u32 m0, s62, 0
s_add_u32 s66, s63, 0
buffer_load_dwordx4 v2, s[24:27], s66 offen offset:0 lds
v_mfma_f32_32x32x16_bf16 v[128:143], a[112:115], a[100:103], v[128:143]
ds_read_b128 a[68:71], v14 offset:4096
v_mfma_f32_32x32x16_bf16 v[192:207], a[112:115], a[104:107], v[192:207]
ds_read_b128 a[72:75], v14 offset:8192
buffer_load_dwordx4 v3, s[24:27], s66 offen offset:1024 lds
v_mfma_f32_32x32x16_bf16 a[0:15], a[112:115], a[108:111], a[0:15]
ds_read_b128 a[76:79], v14 offset:12288
v_mfma_f32_32x32x16_bf16 v[80:95], a[116:119], a[96:99], v[80:95]
buffer_load_dwordx4 v4, s[24:27], s66 offen offset:2048 lds
ds_read_b64_tr_b16 a[80:81], v22 offset:0
v_mfma_f32_32x32x16_bf16 v[144:159], a[116:119], a[100:103], v[144:159]
ds_read_b64_tr_b16 a[82:83], v22 offset:1024
v_mfma_f32_32x32x16_bf16 v[208:223], a[116:119], a[104:107], v[208:223]
buffer_load_dwordx4 v5, s[24:27], s66 offen offset:3072 lds
ds_read_b64_tr_b16 a[84:85], v23 offset:0
v_mfma_f32_32x32x16_bf16 a[16:31], a[116:119], a[108:111], a[16:31]
ds_read_b64_tr_b16 a[86:87], v23 offset:1024
v_mfma_f32_32x32x16_bf16 v[96:111], a[120:123], a[96:99], v[96:111]
s_add_u32 m0, s62, 4096
s_add_u32 s66, s63, 32768
buffer_load_dwordx4 v2, s[24:27], s66 offen offset:0 lds
ds_read_b64_tr_b16 a[88:89], v24 offset:0
v_mfma_f32_32x32x16_bf16 v[160:175], a[120:123], a[100:103], v[160:175]
ds_read_b64_tr_b16 a[90:91], v24 offset:1024
buffer_load_dwordx4 v3, s[24:27], s66 offen offset:1024 lds
v_mfma_f32_32x32x16_bf16 v[224:239], a[120:123], a[104:107], v[224:239]
ds_read_b64_tr_b16 a[92:93], v25 offset:0
v_mfma_f32_32x32x16_bf16 a[32:47], a[120:123], a[108:111], a[32:47]
buffer_load_dwordx4 v4, s[24:27], s66 offen offset:2048 lds
v_mfma_f32_32x32x16_bf16 v[112:127], a[124:127], a[96:99], v[112:127]
ds_read_b64_tr_b16 a[94:95], v25 offset:1024
v_mfma_f32_32x32x16_bf16 v[176:191], a[124:127], a[100:103], v[176:191]
buffer_load_dwordx4 v5, s[24:27], s66 offen offset:3072 lds
s_add_u32 s63, s63, 128
v_mfma_f32_32x32x16_bf16 v[240:255], a[124:127], a[104:107], v[240:255]
v_mfma_f32_32x32x16_bf16 a[48:63], a[124:127], a[108:111], a[48:63]
s_waitcnt lgkmcnt(6)
v_mfma_f32_32x32x16_bf16 v[64:79], a[80:83], a[64:67], v[64:79]
ds_read_b128 a[96:99], v15 offset:0
s_add_u32 m0, s65, 32768
s_nop 0
buffer_load_dwordx4 v6, s[28:31], s64 offen offset:0 lds
v_mfma_f32_32x32x16_bf16 v[128:143], a[80:83], a[68:71], v[128:143]
ds_read_b128 a[100:103], v15 offset:4096
v_mfma_f32_32x32x16_bf16 v[192:207], a[80:83], a[72:75], v[192:207]
ds_read_b128 a[104:107], v15 offset:8192
buffer_load_dwordx4 v7, s[28:31], s64 offen offset:1024 lds
v_mfma_f32_32x32x16_bf16 a[0:15], a[80:83], a[76:79], a[0:15]
ds_read_b128 a[108:111], v15 offset:12288
s_waitcnt lgkmcnt(8)
v_mfma_f32_32x32x16_bf16 v[80:95], a[84:87], a[64:67], v[80:95]
buffer_load_dwordx4 v8, s[28:31], s64 offen offset:2048 lds
ds_read_b64_tr_b16 a[112:113], v22 offset:4096
v_mfma_f32_32x32x16_bf16 v[144:159], a[84:87], a[68:71], v[144:159]
ds_read_b64_tr_b16 a[114:115], v22 offset:5120
v_mfma_f32_32x32x16_bf16 v[208:223], a[84:87], a[72:75], v[208:223]
buffer_load_dwordx4 v9, s[28:31], s64 offen offset:3072 lds
ds_read_b64_tr_b16 a[116:117], v23 offset:4096
v_mfma_f32_32x32x16_bf16 a[16:31], a[84:87], a[76:79], a[16:31]
ds_read_b64_tr_b16 a[118:119], v23 offset:5120
s_waitcnt lgkmcnt(10)
v_mfma_f32_32x32x16_bf16 v[96:111], a[88:91], a[64:67], v[96:111]
s_add_u32 m0, s65, 49152
s_nop 0
buffer_load_dwordx4 v6, s[32:35], s64 offen offset:0 lds
ds_read_b64_tr_b16 a[120:121], v24 offset:4096
v_mfma_f32_32x32x16_bf16 v[160:175], a[88:91], a[68:71], v[160:175]
ds_read_b64_tr_b16 a[122:123], v24 offset:5120
buffer_load_dwordx4 v7, s[32:35], s64 offen offset:1024 lds
v_mfma_f32_32x32x16_bf16 v[224:239], a[88:91], a[72:75], v[224:239]
ds_read_b64_tr_b16 a[124:125], v25 offset:4096
v_mfma_f32_32x32x16_bf16 a[32:47], a[88:91], a[76:79], a[32:47]
buffer_load_dwordx4 v8, s[32:35], s64 offen offset:2048 lds
s_waitcnt lgkmcnt(11)
v_mfma_f32_32x32x16_bf16 v[112:127], a[92:95], a[64:67], v[112:127]
ds_read_b64_tr_b16 a[126:127], v25 offset:5120
v_mfma_f32_32x32x16_bf16 v[176:191], a[92:95], a[68:71], v[176:191]
buffer_load_dwordx4 v9, s[32:35], s64 offen offset:3072 lds
s_add_u32 s64, s64, 524288
v_mfma_f32_32x32x16_bf16 v[240:255], a[92:95], a[72:75], v[240:255]
v_mfma_f32_32x32x16_bf16 a[48:63], a[92:95], a[76:79], a[48:63]
s_waitcnt lgkmcnt(6)
v_mfma_f32_32x32x16_bf16 v[64:79], a[112:115], a[96:99], v[64:79]
ds_read_b128 a[64:67], v16 offset:0
buffer_load_dword v34, v33, s[4:7], s8 offen
s_add_u32 s8, s8, s9
v_mfma_f32_32x32x16_bf16 v[128:143], a[112:115], a[100:103], v[128:143]
ds_read_b128 a[68:71], v16 offset:4096
v_mfma_f32_32x32x16_bf16 v[192:207], a[112:115], a[104:107], v[192:207]
ds_read_b128 a[72:75], v16 offset:8192
v_mfma_f32_32x32x16_bf16 a[0:15], a[112:115], a[108:111], a[0:15]
ds_read_b128 a[76:79], v16 offset:12288
s_waitcnt lgkmcnt(8)
v_mfma_f32_32x32x16_bf16 v[80:95], a[116:119], a[96:99], v[80:95]
ds_read_b64_tr_b16 a[80:81], v22 offset:8192
v_mfma_f32_32x32x16_bf16 v[144:159], a[116:119], a[100:103], v[144:159]
ds_read_b64_tr_b16 a[82:83], v22 offset:9216
v_mfma_f32_32x32x16_bf16 v[208:223], a[116:119], a[104:107], v[208:223]
ds_read_b64_tr_b16 a[84:85], v23 offset:8192
v_mfma_f32_32x32x16_bf16 a[16:31], a[116:119], a[108:111], a[16:31]
ds_read_b64_tr_b16 a[86:87], v23 offset:9216
s_waitcnt lgkmcnt(10)
v_mfma_f32_32x32x16_bf16 v[96:111], a[120:123], a[96:99], v[96:111]
ds_read_b64_tr_b16 a[88:89], v24 offset:8192
v_mfma_f32_32x32x16_bf16 v[160:175], a[120:123], a[100:103], v[160:175]
ds_read_b64_tr_b16 a[90:91], v24 offset:9216
v_mfma_f32_32x32x16_bf16 v[224:239], a[120:123], a[104:107], v[224:239]
ds_read_b64_tr_b16 a[92:93], v25 offset:8192
v_mfma_f32_32x32x16_bf16 a[32:47], a[120:123], a[108:111], a[32:47]
s_waitcnt lgkmcnt(11)
v_mfma_f32_32x32x16_bf16 v[112:127], a[124:127], a[96:99], v[112:127]
ds_read_b64_tr_b16 a[94:95], v25 offset:9216
v_mfma_f32_32x32x16_bf16 v[176:191], a[124:127], a[100:103], v[176:191]
v_mfma_f32_32x32x16_bf16 v[240:255], a[124:127], a[104:107], v[240:255]
v_mfma_f32_32x32x16_bf16 a[48:63], a[124:127], a[108:111], a[48:63]
s_waitcnt lgkmcnt(6)
v_mfma_f32_32x32x16_bf16 v[64:79], a[80:83], a[64:67], v[64:79]
ds_read_b128 a[96:99], v17 offset:0
v_mfma_f32_32x32x16_bf16 v[128:143], a[80:83], a[68:71], v[128:143]
ds_read_b128 a[100:103], v17 offset:4096
v_mfma_f32_32x32x16_bf16 v[192:207], a[80:83], a[72:75], v[192:207]
ds_read_b128 a[104:107], v17 offset:8192
v_mfma_f32_32x32x16_bf16 a[0:15], a[80:83], a[76:79], a[0:15]
ds_read_b128 a[108:111], v17 offset:12288
s_waitcnt lgkmcnt(8)
v_mfma_f32_32x32x16_bf16 v[80:95], a[84:87], a[64:67], v[80:95]
ds_read_b64_tr_b16 a[112:113], v22 offset:12288
v_mfma_f32_32x32x16_bf16 v[144:159], a[84:87], a[68:71], v[144:159]
ds_read_b64_tr_b16 a[114:115], v22 offset:13312
v_mfma_f32_32x32x16_bf16 v[208:223], a[84:87], a[72:75], v[208:223]
ds_read_b64_tr_b16 a[116:117], v23 offset:12288
v_mfma_f32_32x32x16_bf16 a[16:31], a[84:87], a[76:79], a[16:31]
ds_read_b64_tr_b16 a[118:119], v23 offset:13312
s_waitcnt lgkmcnt(10)
v_mfma_f32_32x32x16_bf16 v[96:111], a[88:91], a[64:67], v[96:111]
ds_read_b64_tr_b16 a[120:121], v24 offset:12288
v_mfma_f32_32x32x16_bf16 v[160:175], a[88:91], a[68:71], v[160:175]
ds_read_b64_tr_b16 a[122:123], v24 offset:13312
v_mfma_f32_32x32x16_bf16 v[224:239], a[88:91], a[72:75], v[224:239]
ds_read_b64_tr_b16 a[124:125], v25 offset:12288
v_mfma_f32_32x32x16_bf16 a[32:47], a[88:91], a[76:79], a[32:47]
s_waitcnt lgkmcnt(11)
v_mfma_f32_32x32x16_bf16 v[112:127], a[92:95], a[64:67], v[112:127]
ds_read_b64_tr_b16 a[126:127], v25 offset:13312
v_mfma_f32_32x32x16_bf16 v[176:191], a[92:95], a[68:71], v[176:191]
v_mfma_f32_32x32x16_bf16 v[240:255], a[92:95], a[72:75], v[240:255]
v_mfma_f32_32x32x16_bf16 a[48:63], a[92:95], a[76:79], a[48:63]
s_waitcnt vmcnt(1) lgkmcnt(0)
s_barrier
v_mfma_f32_32x32x16_bf16 v[64:79], a[112:115], a[96:99], v[64:79]
ds_read_b128 a[64:67], v10 offset:0
s_add_u32 m0, s62, 65536
s_add_u32 s66, s63, 0
buffer_load_dwordx4 v2, s[24:27], s66 offen offset:0 lds
v_mfma_f32_32x32x16_bf16 v[128:143], a[112:115], a[100:103], v[128:143]
ds_read_b128 a[68:71], v10 offset:4096
v_mfma_f32_32x32x16_bf16 v[192:207], a[112:115], a[104:107], v[192:207]
ds_read_b128 a[72:75], v10 offset:8192
buffer_load_dwordx4 v3, s[24:27], s66 offen offset:1024 lds
v_mfma_f32_32x32x16_bf16 a[0:15], a[112:115], a[108:111], a[0:15]
ds_read_b128 a[76:79], v10 offset:12288
v_mfma_f32_32x32x16_bf16 v[80:95], a[116:119], a[96:99], v[80:95]
buffer_load_dwordx4 v4, s[24:27], s66 offen offset:2048 lds
ds_read_b64_tr_b16 a[80:81], v18 offset:0
v_mfma_f32_32x32x16_bf16 v[144:159], a[116:119], a[100:103], v[144:159]
ds_read_b64_tr_b16 a[82:83], v18 offset:1024
v_mfma_f32_32x32x16_bf16 v[208:223], a[116:119], a[104:107], v[208:223]
buffer_load_dwordx4 v5, s[24:27], s66 offen offset:3072 lds
ds_read_b64_tr_b16 a[84:85], v19 offset:0
v_mfma_f32_32x32x16_bf16 a[16:31], a[116:119], a[108:111], a[16:31]
ds_read_b64_tr_b16 a[86:87], v19 offset:1024
v_mfma_f32_32x32x16_bf16 v[96:111], a[120:123], a[96:99], v[96:111]
s_add_u32 m0, s62, 69632
s_add_u32 s66, s63, 32768
buffer_load_dwordx4 v2, s[24:27], s66 offen offset:0 lds
ds_read_b64_tr_b16 a[88:89], v20 offset:0
v_mfma_f32_32x32x16_bf16 v[160:175], a[120:123], a[100:103], v[160:175]
ds_read_b64_tr_b16 a[90:91], v20 offset:1024
buffer_load_dwordx4 v3, s[24:27], s66 offen offset:1024 lds
v_mfma_f32_32x32x16_bf16 v[224:239], a[120:123], a[104:107], v[224:239]
ds_read_b64_tr_b16 a[92:93], v21 offset:0
v_mfma_f32_32x32x16_bf16 a[32:47], a[120:123], a[108:111], a[32:47]
buffer_load_dwordx4 v4, s[24:27], s66 offen offset:2048 lds
v_mfma_f32_32x32x16_bf16 v[112:127], a[124:127], a[96:99], v[112:127]
ds_read_b64_tr_b16 a[94:95], v21 offset:1024
v_mfma_f32_32x32x16_bf16 v[176:191], a[124:127], a[100:103], v[176:191]
buffer_load_dwordx4 v5, s[24:27], s66 offen offset:3072 lds
s_add_u32 s63, s63, 128
v_mfma_f32_32x32x16_bf16 v[240:255], a[124:127], a[104:107], v[240:255]
v_mfma_f32_32x32x16_bf16 a[48:63], a[124:127], a[108:111], a[48:63]
s_add_u32 s70, s70, 1
s_cmp_lt_u32 s70, 2
s_cbranch_scc1 LP1K_loop
s_waitcnt lgkmcnt(6)
v_mfma_f32_32x32x16_bf16 v[64:79], a[80:83], a[64:67], v[64:79]
ds_read_b128 a[96:99], v11 offset:0
s_add_u32 m0, s65, 98304
s_nop 0
buffer_load_dwordx4 v6, s[28:31], s64 offen offset:0 lds
v_mfma_f32_32x32x16_bf16 v[128:143], a[80:83], a[68:71], v[128:143]
ds_read_b128 a[100:103], v11 offset:4096
v_mfma_f32_32x32x16_bf16 v[192:207], a[80:83], a[72:75], v[192:207]
ds_read_b128 a[104:107], v11 offset:8192
buffer_load_dwordx4 v7, s[28:31], s64 offen offset:1024 lds
v_mfma_f32_32x32x16_bf16 a[0:15], a[80:83], a[76:79], a[0:15]
ds_read_b128 a[108:111], v11 offset:12288
s_waitcnt lgkmcnt(8)
v_mfma_f32_32x32x16_bf16 v[80:95], a[84:87], a[64:67], v[80:95]
buffer_load_dwordx4 v8, s[28:31], s64 offen offset:2048 lds
ds_read_b64_tr_b16 a[112:113], v18 offset:4096
v_mfma_f32_32x32x16_bf16 v[144:159], a[84:87], a[68:71], v[144:159]
ds_read_b64_tr_b16 a[114:115], v18 offset:5120
v_mfma_f32_32x32x16_bf16 v[208:223], a[84:87], a[72:75], v[208:223]
buffer_load_dwordx4 v9, s[28:31], s64 offen offset:3072 lds
ds_read_b64_tr_b16 a[116:117], v19 offset:4096
v_mfma_f32_32x32x16_bf16 a[16:31], a[84:87], a[76:79], a[16:31]
ds_read_b64_tr_b16 a[118:119], v19 offset:5120
s_waitcnt lgkmcnt(10)
v_mfma_f32_32x32x16_bf16 v[96:111], a[88:91], a[64:67], v[96:111]
s_add_u32 m0, s65, 114688
s_nop 0
buffer_load_dwordx4 v6, s[32:35], s64 offen offset:0 lds
ds_read_b64_tr_b16 a[120:121], v20 offset:4096
v_mfma_f32_32x32x16_bf16 v[160:175], a[88:91], a[68:71], v[160:175]
ds_read_b64_tr_b16 a[122:123], v20 offset:5120
buffer_load_dwordx4 v7, s[32:35], s64 offen offset:1024 lds
v_mfma_f32_32x32x16_bf16 v[224:239], a[88:91], a[72:75], v[224:239]
ds_read_b64_tr_b16 a[124:125], v21 offset:4096
v_mfma_f32_32x32x16_bf16 a[32:47], a[88:91], a[76:79], a[32:47]
buffer_load_dwordx4 v8, s[32:35], s64 offen offset:2048 lds
s_waitcnt lgkmcnt(11)
v_mfma_f32_32x32x16_bf16 v[112:127], a[92:95], a[64:67], v[112:127]
ds_read_b64_tr_b16 a[126:127], v21 offset:5120
v_mfma_f32_32x32x16_bf16 v[176:191], a[92:95], a[68:71], v[176:191]
buffer_load_dwordx4 v9, s[32:35], s64 offen offset:3072 lds
s_add_u32 s64, s64, 524288
v_mfma_f32_32x32x16_bf16 v[240:255], a[92:95], a[72:75], v[240:255]
v_mfma_f32_32x32x16_bf16 a[48:63], a[92:95], a[76:79], a[48:63]
s_waitcnt lgkmcnt(6)
v_mfma_f32_32x32x16_bf16 v[64:79], a[112:115], a[96:99], v[64:79]
ds_read_b128 a[64:67], v12 offset:0
v_mov_b32 v60, 32
global_load_dwordx4 v[56:59], v60, s[16:17] sc1
v_mfma_f32_32x32x16_bf16 v[128:143], a[112:115], a[100:103], v[128:143]
ds_read_b128 a[68:71], v12 offset:4096
v_mfma_f32_32x32x16_bf16 v[192:207], a[112:115], a[104:107], v[192:207]
ds_read_b128 a[72:75], v12 offset:8192
s_add_u32 s60, s20, 16
s_lshl_b32 s60, s60, 2
v_mov_b32 v61, s60
global_load_dword v62, v61, s[16:17] sc1
v_mfma_f32_32x32x16_bf16 a[0:15], a[112:115], a[108:111], a[0:15]
ds_read_b128 a[76:79], v12 offset:12288
s_waitcnt lgkmcnt(8)
v_mfma_f32_32x32x16_bf16 v[80:95], a[116:119], a[96:99], v[80:95]
s_and_b32 s12, s2, 3
s_bfe_u32 s13, s2, 0x10002
s_lshr_b32 s15, s2, 3
s_and_b32 s60, s15, 7
s_lshl_b32 s13, s13, 3
s_add_u32 s13, s13, s60
s_lshr_b32 s15, s15, 3
s_lshl_b32 s60, s13, 7
s_lshl_b32 s61, s15, 5
s_add_u32 s60, s60, s61
s_lshl_b32 s61, s12, 3
s_add_u32 s60, s60, s61
s_mul_i32 s15, s60, 1280
v_mov_b32 v52, -1
v_mov_b32 v53, -1
v_mov_b32 v54, -1
v_mov_b32 v55, -1
v_lshlrev_b32 v51, 4, v0
s_add_u32 s61, s15, 0x4c00000
s_add_u32 s56, s18, s61
s_addc_u32 s57, s19, 0
s_mov_b32 s58, 10240
s_mov_b32 s59, 0x20000
s_mov_b32 s61, 0
buffer_store_dwordx4 v[52:55], v51, s[56:59], s61 offen sc1
ds_read_b64_tr_b16 a[80:81], v18 offset:8192
v_mfma_f32_32x32x16_bf16 v[144:159], a[116:119], a[100:103], v[144:159]
ds_read_b64_tr_b16 a[82:83], v18 offset:9216
v_mfma_f32_32x32x16_bf16 v[208:223], a[116:119], a[104:107], v[208:223]
s_mov_b32 s61, 4096
buffer_store_dwordx4 v[52:55], v51, s[56:59], s61 offen sc1
ds_read_b64_tr_b16 a[84:85], v19 offset:8192
v_mfma_f32_32x32x16_bf16 a[16:31], a[116:119], a[108:111], a[16:31]
ds_read_b64_tr_b16 a[86:87], v19 offset:9216
s_waitcnt lgkmcnt(10)
v_mfma_f32_32x32x16_bf16 v[96:111], a[120:123], a[96:99], v[96:111]
s_mov_b32 s61, 8192
buffer_store_dwordx4 v[52:55], v51, s[56:59], s61 offen sc1
ds_read_b64_tr_b16 a[88:89], v20 offset:8192
v_mfma_f32_32x32x16_bf16 v[160:175], a[120:123], a[100:103], v[160:175]
ds_read_b64_tr_b16 a[90:91], v20 offset:9216
s_add_u32 s61, s15, 0x5000000
s_add_u32 s56, s18, s61
s_addc_u32 s57, s19, 0
s_mov_b32 s58, 10240
s_mov_b32 s59, 0x20000
s_mov_b32 s61, 0
buffer_store_dwordx4 v[52:55], v51, s[56:59], s61 offen sc1
v_mfma_f32_32x32x16_bf16 v[224:239], a[120:123], a[104:107], v[224:239]
ds_read_b64_tr_b16 a[92:93], v21 offset:8192
v_mfma_f32_32x32x16_bf16 a[32:47], a[120:123], a[108:111], a[32:47]
s_mov_b32 s61, 4096
buffer_store_dwordx4 v[52:55], v51, s[56:59], s61 offen sc1
s_waitcnt lgkmcnt(11)
v_mfma_f32_32x32x16_bf16 v[112:127], a[124:127], a[96:99], v[112:127]
ds_read_b64_tr_b16 a[94:95], v21 offset:9216
v_mfma_f32_32x32x16_bf16 v[176:191], a[124:127], a[100:103], v[176:191]
s_mov_b32 s61, 8192
buffer_store_dwordx4 v[52:55], v51, s[56:59], s61 offen sc1
v_mfma_f32_32x32x16_bf16 v[240:255], a[124:127], a[104:107], v[240:255]
v_mfma_f32_32x32x16_bf16 a[48:63], a[124:127], a[108:111], a[48:63]
s_waitcnt lgkmcnt(6)
v_mfma_f32_32x32x16_bf16 v[64:79], a[80:83], a[64:67], v[64:79]
ds_read_b128 a[96:99], v13 offset:0
v_mfma_f32_32x32x16_bf16 v[128:143], a[80:83], a[68:71], v[128:143]
ds_read_b128 a[100:103], v13 offset:4096
v_mfma_f32_32x32x16_bf16 v[192:207], a[80:83], a[72:75], v[192:207]
ds_read_b128 a[104:107], v13 offset:8192
v_mfma_f32_32x32x16_bf16 a[0:15], a[80:83], a[76:79], a[0:15]
ds_read_b128 a[108:111], v13 offset:12288
s_waitcnt lgkmcnt(8)
v_mfma_f32_32x32x16_bf16 v[80:95], a[84:87], a[64:67], v[80:95]
ds_read_b64_tr_b16 a[112:113], v18 offset:12288
v_mfma_f32_32x32x16_bf16 v[144:159], a[84:87], a[68:71], v[144:159]
ds_read_b64_tr_b16 a[114:115], v18 offset:13312
v_mfma_f32_32x32x16_bf16 v[208:223], a[84:87], a[72:75], v[208:223]
ds_read_b64_tr_b16 a[116:117], v19 offset:12288
v_mfma_f32_32x32x16_bf16 a[16:31], a[84:87], a[76:79], a[16:31]
ds_read_b64_tr_b16 a[118:119], v19 offset:13312
s_waitcnt lgkmcnt(10)
v_mfma_f32_32x32x16_bf16 v[96:111], a[88:91], a[64:67], v[96:111]
ds_read_b64_tr_b16 a[120:121], v20 offset:12288
v_mfma_f32_32x32x16_bf16 v[160:175], a[88:91], a[68:71], v[160:175]
ds_read_b64_tr_b16 a[122:123], v20 offset:13312
v_mfma_f32_32x32x16_bf16 v[224:239], a[88:91], a[72:75], v[224:239]
ds_read_b64_tr_b16 a[124:125], v21 offset:12288
v_mfma_f32_32x32x16_bf16 a[32:47], a[88:91], a[76:79], a[32:47]
s_waitcnt lgkmcnt(11)
v_mfma_f32_32x32x16_bf16 v[112:127], a[92:95], a[64:67], v[112:127]
ds_read_b64_tr_b16 a[126:127], v21 offset:13312
v_mfma_f32_32x32x16_bf16 v[176:191], a[92:95], a[68:71], v[176:191]
v_mfma_f32_32x32x16_bf16 v[240:255], a[92:95], a[72:75], v[240:255]
v_mfma_f32_32x32x16_bf16 a[48:63], a[92:95], a[76:79], a[48:63]
s_waitcnt vmcnt(0) lgkmcnt(0)
v_readfirstlane_b32 s63, v62
s_lshl_b32 s23, 8, s14
s_cmp_eq_u32 s63, s23
s_cselect_b32 s23, 1, 0
v_and_b32 v56, v56, v57
v_and_b32 v58, v58, v59
v_and_b32 v56, v56, v58
s_nop 0
v_readfirstlane_b32 s60, v56
s_nop 3
s_cmp_eq_u32 s60, 0x10101010
s_cbranch_scc1 Lxok_4
s_mov_b32 s61, 0
Lxsp_5:
global_load_dwordx4 v[56:59], v60, s[16:17] sc1
s_waitcnt vmcnt(0)
v_and_b32 v56, v56, v57
v_and_b32 v58, v58, v59
v_and_b32 v56, v56, v58
s_nop 0
v_readfirstlane_b32 s60, v56
s_nop 3
s_cmp_eq_u32 s60, 0x10101010
s_cbranch_scc1 Lxok_4
s_add_u32 s61, s61, 1
s_cmp_lt_u32 s61, 0x40000
s_sleep 2
s_cbranch_scc1 Lxsp_5
Lxok_4:
s_barrier
v_mfma_f32_32x32x16_bf16 v[64:79], a[112:115], a[96:99], v[64:79]
ds_read_b128 a[64:67], v14 offset:0
s_add_u32 m0, s84, 32768
s_add_u32 s66, s85, 0
buffer_load_dwordx4 v6, s[36:39], s66 offen offset:0 lds
v_mfma_f32_32x32x16_bf16 v[128:143], a[112:115], a[100:103], v[128:143]
ds_read_b128 a[68:71], v14 offset:4096
v_mfma_f32_32x32x16_bf16 v[192:207], a[112:115], a[104:107], v[192:207]
ds_read_b128 a[72:75], v14 offset:8192
buffer_load_dwordx4 v7, s[36:39], s66 offen offset:1024 lds
v_mfma_f32_32x32x16_bf16 a[0:15], a[112:115], a[108:111], a[0:15]
ds_read_b128 a[76:79], v14 offset:12288
v_mfma_f32_32x32x16_bf16 v[80:95], a[116:119], a[96:99], v[80:95]
buffer_load_dwordx4 v8, s[36:39], s66 offen offset:2048 lds
ds_read_b64_tr_b16 a[80:81], v22 offset:0
v_mfma_f32_32x32x16_bf16 v[144:159], a[116:119], a[100:103], v[144:159]
ds_read_b64_tr_b16 a[82:83], v22 offset:1024
v_mfma_f32_32x32x16_bf16 v[208:223], a[116:119], a[104:107], v[208:223]
buffer_load_dwordx4 v9, s[36:39], s66 offen offset:3072 lds
ds_read_b64_tr_b16 a[84:85], v23 offset:0
v_mfma_f32_32x32x16_bf16 a[16:31], a[116:119], a[108:111], a[16:31]
ds_read_b64_tr_b16 a[86:87], v23 offset:1024
v_mfma_f32_32x32x16_bf16 v[96:111], a[120:123], a[96:99], v[96:111]
s_add_u32 m0, s84, 49152
s_add_u32 s66, s85, 524288
buffer_load_dwordx4 v6, s[36:39], s66 offen offset:0 lds
ds_read_b64_tr_b16 a[88:89], v24 offset:0
v_mfma_f32_32x32x16_bf16 v[160:175], a[120:123], a[100:103], v[160:175]
ds_read_b64_tr_b16 a[90:91], v24 offset:1024
buffer_load_dwordx4 v7, s[36:39], s66 offen offset:1024 lds
v_mfma_f32_32x32x16_bf16 v[224:239], a[120:123], a[104:107], v[224:239]
ds_read_b64_tr_b16 a[92:93], v25 offset:0
v_mfma_f32_32x32x16_bf16 a[32:47], a[120:123], a[108:111], a[32:47]
buffer_load_dwordx4 v8, s[36:39], s66 offen offset:2048 lds
v_mfma_f32_32x32x16_bf16 v[112:127], a[124:127], a[96:99], v[112:127]
ds_read_b64_tr_b16 a[94:95], v25 offset:1024
v_mfma_f32_32x32x16_bf16 v[176:191], a[124:127], a[100:103], v[176:191]
buffer_load_dwordx4 v9, s[36:39], s66 offen offset:3072 lds
v_mfma_f32_32x32x16_bf16 v[240:255], a[124:127], a[104:107], v[240:255]
v_mfma_f32_32x32x16_bf16 a[48:63], a[124:127], a[108:111], a[48:63]
s_waitcnt lgkmcnt(6)
v_mfma_f32_32x32x16_bf16 v[64:79], a[80:83], a[64:67], v[64:79]
ds_read_b128 a[96:99], v15 offset:0
s_add_u32 s86, s72, 0
s_add_u32 s88, s73, 0
buffer_load_dwordx4 a[128:131], v26, s[40:43], s86 offen offset:0 sc1
v_mfma_f32_32x32x16_bf16 v[128:143], a[80:83], a[68:71], v[128:143]
ds_read_b128 a[100:103], v15 offset:4096
v_mfma_f32_32x32x16_bf16 v[192:207], a[80:83], a[72:75], v[192:207]
buffer_load_dwordx4 a[132:135], v26, s[40:43], s88 offen offset:0 sc1
ds_read_b128 a[104:107], v15 offset:8192
v_mfma_f32_32x32x16_bf16 a[0:15], a[80:83], a[76:79], a[0:15]
ds_read_b128 a[108:111], v15 offset:12288
buffer_load_dwordx4 a[136:139], v26, s[40:43], s86 offen offset:1024 sc1
s_waitcnt lgkmcnt(8)
v_mfma_f32_32x32x16_bf16 v[80:95], a[84:87], a[64:67], v[80:95]
ds_read_b64_tr_b16 a[112:113], v22 offset:4096
v_mfma_f32_32x32x16_bf16 v[144:159], a[84:87], a[68:71], v[144:159]
buffer_load_dwordx4 a[140:143], v26, s[40:43], s88 offen offset:1024 sc1
ds_read_b64_tr_b16 a[114:115], v22 offset:5120
v_mfma_f32_32x32x16_bf16 v[208:223], a[84:87], a[72:75], v[208:223]
buffer_load_dwordx4 a[144:147], v26, s[40:43], s86 offen offset:2048 sc1
ds_read_b64_tr_b16 a[116:117], v23 offset:4096
v_mfma_f32_32x32x16_bf16 a[16:31], a[84:87], a[76:79], a[16:31]
ds_read_b64_tr_b16 a[118:119], v23 offset:5120
s_waitcnt lgkmcnt(10)
v_mfma_f32_32x32x16_bf16 v[96:111], a[88:91], a[64:67], v[96:111]
buffer_load_dwordx4 a[148:151], v26, s[40:43], s88 offen offset:2048 sc1
ds_read_b64_tr_b16 a[120:121], v24 offset:4096
v_mfma_f32_32x32x16_bf16 v[160:175], a[88:91], a[68:71], v[160:175]
buffer_load_dwordx4 a[152:155], v26, s[40:43], s86 offen offset:3072 sc1
ds_read_b64_tr_b16 a[122:123], v24 offset:5120
v_mfma_f32_32x32x16_bf16 v[224:239], a[88:91], a[72:75], v[224:239]
ds_read_b64_tr_b16 a[124:125], v25 offset:4096
v_mfma_f32_32x32x16_bf16 a[32:47], a[88:91], a[76:79], a[32:47]
buffer_load_dwordx4 a[156:159], v26, s[40:43], s88 offen offset:3072 sc1
s_waitcnt lgkmcnt(11)
v_mfma_f32_32x32x16_bf16 v[112:127], a[92:95], a[64:67], v[112:127]
ds_read_b64_tr_b16 a[126:127], v25 offset:5120
s_add_u32 s87, s72, 4096
s_add_u32 s89, s73, 4096
buffer_load_dwordx4 a[160:163], v26, s[40:43], s87 offen offset:0 sc1
v_mfma_f32_32x32x16_bf16 v[176:191], a[92:95], a[68:71], v[176:191]
v_mfma_f32_32x32x16_bf16 v[240:255], a[92:95], a[72:75], v[240:255]
buffer_load_dwordx4 a[164:167], v26, s[40:43], s89 offen offset:0 sc1
v_mfma_f32_32x32x16_bf16 a[48:63], a[92:95], a[76:79], a[48:63]
s_waitcnt lgkmcnt(6)
v_mfma_f32_32x32x16_bf16 v[64:79], a[112:115], a[96:99], v[64:79]
ds_read_b128 a[64:67], v16 offset:0
buffer_load_dwordx4 a[168:171], v26, s[40:43], s87 offen offset:1024 sc1
v_mfma_f32_32x32x16_bf16 v[128:143], a[112:115], a[100:103], v[128:143]
ds_read_b128 a[68:71], v16 offset:4096
v_mfma_f32_32x32x16_bf16 v[192:207], a[112:115], a[104:107], v[192:207]
buffer_load_dwordx4 a[172:175], v26, s[40:43], s89 offen offset:1024 sc1
ds_read_b128 a[72:75], v16 offset:8192
v_mfma_f32_32x32x16_bf16 a[0:15], a[112:115], a[108:111], a[0:15]
ds_read_b128 a[76:79], v16 offset:12288
buffer_load_dwordx4 a[176:179], v26, s[40:43], s87 offen offset:2048 sc1
s_waitcnt lgkmcnt(8)
v_mfma_f32_32x32x16_bf16 v[80:95], a[116:119], a[96:99], v[80:95]
ds_read_b64_tr_b16 a[80:81], v22 offset:8192
v_mfma_f32_32x32x16_bf16 v[144:159], a[116:119], a[100:103], v[144:159]
buffer_load_dwordx4 a[180:183], v26, s[40:43], s89 offen offset:2048 sc1
ds_read_b64_tr_b16 a[82:83], v22 offset:9216
v_mfma_f32_32x32x16_bf16 v[208:223], a[116:119], a[104:107], v[208:223]
buffer_load_dwordx4 a[184:187], v26, s[40:43], s87 offen offset:3072 sc1
ds_read_b64_tr_b16 a[84:85], v23 offset:8192
v_mfma_f32_32x32x16_bf16 a[16:31], a[116:119], a[108:111], a[16:31]
ds_read_b64_tr_b16 a[86:87], v23 offset:9216
s_waitcnt lgkmcnt(10)
v_mfma_f32_32x32x16_bf16 v[96:111], a[120:123], a[96:99], v[96:111]
buffer_load_dwordx4 a[188:191], v26, s[40:43], s89 offen offset:3072 sc1
ds_read_b64_tr_b16 a[88:89], v24 offset:8192
v_mfma_f32_32x32x16_bf16 v[160:175], a[120:123], a[100:103], v[160:175]
s_add_u32 s86, s72, 8192
s_add_u32 s88, s73, 8192
buffer_load_dwordx4 a[192:195], v26, s[40:43], s86 offen offset:0 sc1
ds_read_b64_tr_b16 a[90:91], v24 offset:9216
v_mfma_f32_32x32x16_bf16 v[224:239], a[120:123], a[104:107], v[224:239]
ds_read_b64_tr_b16 a[92:93], v25 offset:8192
v_mfma_f32_32x32x16_bf16 a[32:47], a[120:123], a[108:111], a[32:47]
buffer_load_dwordx4 a[196:199], v26, s[40:43], s88 offen offset:0 sc1
s_waitcnt lgkmcnt(11)
v_mfma_f32_32x32x16_bf16 v[112:127], a[124:127], a[96:99], v[112:127]
ds_read_b64_tr_b16 a[94:95], v25 offset:9216
buffer_load_dwordx4 a[200:203], v26, s[40:43], s86 offen offset:1024 sc1
v_mfma_f32_32x32x16_bf16 v[176:191], a[124:127], a[100:103], v[176:191]
v_mfma_f32_32x32x16_bf16 v[240:255], a[124:127], a[104:107], v[240:255]
buffer_load_dwordx4 a[204:207], v26, s[40:43], s88 offen offset:1024 sc1
v_mfma_f32_32x32x16_bf16 a[48:63], a[124:127], a[108:111], a[48:63]
s_waitcnt lgkmcnt(6)
v_mfma_f32_32x32x16_bf16 v[64:79], a[80:83], a[64:67], v[64:79]
ds_read_b128 a[96:99], v17 offset:0
buffer_load_dwordx4 a[208:211], v26, s[40:43], s86 offen offset:2048 sc1
v_mfma_f32_32x32x16_bf16 v[128:143], a[80:83], a[68:71], v[128:143]
ds_read_b128 a[100:103], v17 offset:4096
v_mfma_f32_32x32x16_bf16 v[192:207], a[80:83], a[72:75], v[192:207]
buffer_load_dwordx4 a[212:215], v26, s[40:43], s88 offen offset:2048 sc1
ds_read_b128 a[104:107], v17 offset:8192
v_mfma_f32_32x32x16_bf16 a[0:15], a[80:83], a[76:79], a[0:15]
ds_read_b128 a[108:111], v17 offset:12288
buffer_load_dwordx4 a[216:219], v26, s[40:43], s86 offen offset:3072 sc1
s_waitcnt lgkmcnt(8)
v_mfma_f32_32x32x16_bf16 v[80:95], a[84:87], a[64:67], v[80:95]
ds_read_b64_tr_b16 a[112:113], v22 offset:12288
v_mfma_f32_32x32x16_bf16 v[144:159], a[84:87], a[68:71], v[144:159]
buffer_load_dwordx4 a[220:223], v26, s[40:43], s88 offen offset:3072 sc1
ds_read_b64_tr_b16 a[114:115], v22 offset:13312
v_mfma_f32_32x32x16_bf16 v[208:223], a[84:87], a[72:75], v[208:223]
s_add_u32 s87, s72, 12288
s_add_u32 s89, s73, 12288
buffer_load_dwordx4 a[224:227], v26, s[40:43], s87 offen offset:0 sc1
ds_read_b64_tr_b16 a[116:117], v23 offset:12288
v_mfma_f32_32x32x16_bf16 a[16:31], a[84:87], a[76:79], a[16:31]
ds_read_b64_tr_b16 a[118:119], v23 offset:13312
s_waitcnt lgkmcnt(10)
v_mfma_f32_32x32x16_bf16 v[96:111], a[88:91], a[64:67], v[96:111]
buffer_load_dwordx4 a[228:231], v26, s[40:43], s89 offen offset:0 sc1
ds_read_b64_tr_b16 a[120:121], v24 offset:12288
v_mfma_f32_32x32x16_bf16 v[160:175], a[88:91], a[68:71], v[160:175]
buffer_load_dwordx4 a[232:235], v26, s[40:43], s87 offen offset:1024 sc1
ds_read_b64_tr_b16 a[122:123], v24 offset:13312
v_mfma_f32_32x32x16_bf16 v[224:239], a[88:91], a[72:75], v[224:239]
ds_read_b64_tr_b16 a[124:125], v25 offset:12288
v_mfma_f32_32x32x16_bf16 a[32:47], a[88:91], a[76:79], a[32:47]
buffer_load_dwordx4 a[236:239], v26, s[40:43], s89 offen offset:1024 sc1
s_waitcnt lgkmcnt(11)
v_mfma_f32_32x32x16_bf16 v[112:127], a[92:95], a[64:67], v[112:127]
ds_read_b64_tr_b16 a[126:127], v25 offset:13312
buffer_load_dwordx4 a[240:243], v26, s[40:43], s87 offen offset:2048 sc1
v_mfma_f32_32x32x16_bf16 v[176:191], a[92:95], a[68:71], v[176:191]
v_mfma_f32_32x32x16_bf16 v[240:255], a[92:95], a[72:75], v[240:255]
buffer_load_dwordx4 a[244:247], v26, s[40:43], s89 offen offset:2048 sc1
v_mfma_f32_32x32x16_bf16 a[48:63], a[92:95], a[76:79], a[48:63]
s_waitcnt lgkmcnt(0)
s_barrier
v_mfma_f32_32x32x16_bf16 v[64:79], a[112:115], a[96:99], v[64:79]
s_add_u32 m0, s84, 0
s_add_u32 s66, s85, 1048576
buffer_load_dwordx4 v6, s[36:39], s66 offen offset:0 lds
v_mfma_f32_32x32x16_bf16 v[128:143], a[112:115], a[100:103], v[128:143]
v_mfma_f32_32x32x16_bf16 v[192:207], a[112:115], a[104:107], v[192:207]
buffer_load_dwordx4 v7, s[36:39], s66 offen offset:1024 lds
v_mfma_f32_32x32x16_bf16 a[0:15], a[112:115], a[108:111], a[0:15]
v_mfma_f32_32x32x16_bf16 v[80:95], a[116:119], a[96:99], v[80:95]
buffer_load_dwordx4 v8, s[36:39], s66 offen offset:2048 lds
v_mfma_f32_32x32x16_bf16 v[144:159], a[116:119], a[100:103], v[144:159]
v_mfma_f32_32x32x16_bf16 v[208:223], a[116:119], a[104:107], v[208:223]
buffer_load_dwordx4 v9, s[36:39], s66 offen offset:3072 lds
v_mfma_f32_32x32x16_bf16 a[16:31], a[116:119], a[108:111], a[16:31]
v_mfma_f32_32x32x16_bf16 v[96:111], a[120:123], a[96:99], v[96:111]
s_add_u32 m0, s84, 16384
s_add_u32 s66, s85, 1572864
buffer_load_dwordx4 v6, s[36:39], s66 offen offset:0 lds
v_mfma_f32_32x32x16_bf16 v[160:175], a[120:123], a[100:103], v[160:175]
buffer_load_dwordx4 v7, s[36:39], s66 offen offset:1024 lds
v_mfma_f32_32x32x16_bf16 v[224:239], a[120:123], a[104:107], v[224:239]
v_mfma_f32_32x32x16_bf16 a[32:47], a[120:123], a[108:111], a[32:47]
buffer_load_dwordx4 v8, s[36:39], s66 offen offset:2048 lds
v_mfma_f32_32x32x16_bf16 v[112:127], a[124:127], a[96:99], v[112:127]
v_mfma_f32_32x32x16_bf16 v[176:191], a[124:127], a[100:103], v[176:191]
buffer_load_dwordx4 v9, s[36:39], s66 offen offset:3072 lds
v_mfma_f32_32x32x16_bf16 v[240:255], a[124:127], a[104:107], v[240:255]
v_mfma_f32_32x32x16_bf16 a[48:63], a[124:127], a[108:111], a[48:63]
s_nop 15
v_cvt_pk_bf16_f32 v32, v64, v65
v_cvt_pk_bf16_f32 v33, v66, v67
v_cvt_pk_bf16_f32 v34, v68, v69
v_cvt_pk_bf16_f32 v35, v70, v71
v_cvt_pk_bf16_f32 v36, v72, v73
v_cvt_pk_bf16_f32 v37, v74, v75
v_cvt_pk_bf16_f32 v38, v76, v77
v_cvt_pk_bf16_f32 v39, v78, v79
v_cvt_pk_bf16_f32 v40, v80, v81
v_cvt_pk_bf16_f32 v41, v82, v83
v_cvt_pk_bf16_f32 v42, v84, v85
v_cvt_pk_bf16_f32 v43, v86, v87
v_cvt_pk_bf16_f32 v44, v88, v89
v_cvt_pk_bf16_f32 v45, v90, v91
v_cvt_pk_bf16_f32 v46, v92, v93
v_cvt_pk_bf16_f32 v47, v94, v95
v_cvt_pk_bf16_f32 v48, v96, v97
v_cvt_pk_bf16_f32 v49, v98, v99
v_cvt_pk_bf16_f32 v50, v100, v101
v_cvt_pk_bf16_f32 v51, v102, v103
v_cvt_pk_bf16_f32 v52, v104, v105
v_cvt_pk_bf16_f32 v53, v106, v107
v_cvt_pk_bf16_f32 v54, v108, v109
v_cvt_pk_bf16_f32 v55, v110, v111
v_cvt_pk_bf16_f32 v56, v112, v113
v_cvt_pk_bf16_f32 v57, v114, v115
v_cvt_pk_bf16_f32 v58, v116, v117
v_cvt_pk_bf16_f32 v59, v118, v119
v_cvt_pk_bf16_f32 v60, v120, v121
v_cvt_pk_bf16_f32 v61, v122, v123
v_cvt_pk_bf16_f32 v62, v124, v125
v_cvt_pk_bf16_f32 v63, v126, v127
v_cvt_pk_bf16_f32 v64, v128, v129
v_cvt_pk_bf16_f32 v65, v130, v131
v_cvt_pk_bf16_f32 v66, v132, v133
v_cvt_pk_bf16_f32 v67, v134, v135
v_cvt_pk_bf16_f32 v68, v136, v137
v_cvt_pk_bf16_f32 v69, v138, v139
v_cvt_pk_bf16_f32 v70, v140, v141
v_cvt_pk_bf16_f32 v71, v142, v143
v_cvt_pk_bf16_f32 v72, v144, v145
v_cvt_pk_bf16_f32 v73, v146, v147
v_cvt_pk_bf16_f32 v74, v148, v149
v_cvt_pk_bf16_f32 v75, v150, v151
v_cvt_pk_bf16_f32 v76, v152, v153
v_cvt_pk_bf16_f32 v77, v154, v155
v_cvt_pk_bf16_f32 v78, v156, v157
v_cvt_pk_bf16_f32 v79, v158, v159
v_cvt_pk_bf16_f32 v80, v160, v161
v_cvt_pk_bf16_f32 v81, v162, v163
v_cvt_pk_bf16_f32 v82, v164, v165
v_cvt_pk_bf16_f32 v83, v166, v167
v_cvt_pk_bf16_f32 v84, v168, v169
v_cvt_pk_bf16_f32 v85, v170, v171
v_cvt_pk_bf16_f32 v86, v172, v173
v_cvt_pk_bf16_f32 v87, v174, v175
v_cvt_pk_bf16_f32 v88, v176, v177
v_cvt_pk_bf16_f32 v89, v178, v179
v_cvt_pk_bf16_f32 v90, v180, v181
v_cvt_pk_bf16_f32 v91, v182, v183
v_cvt_pk_bf16_f32 v92, v184, v185
v_cvt_pk_bf16_f32 v93, v186, v187
v_cvt_pk_bf16_f32 v94, v188, v189
v_cvt_pk_bf16_f32 v95, v190, v191
v_cvt_pk_bf16_f32 v96, v192, v193
v_cvt_pk_bf16_f32 v97, v194, v195
v_cvt_pk_bf16_f32 v98, v196, v197
v_cvt_pk_bf16_f32 v99, v198, v199
v_cvt_pk_bf16_f32 v100, v200, v201
v_cvt_pk_bf16_f32 v101, v202, v203
v_cvt_pk_bf16_f32 v102, v204, v205
v_cvt_pk_bf16_f32 v103, v206, v207
v_cvt_pk_bf16_f32 v104, v208, v209
v_cvt_pk_bf16_f32 v105, v210, v211
v_cvt_pk_bf16_f32 v106, v212, v213
v_cvt_pk_bf16_f32 v107, v214, v215
v_cvt_pk_bf16_f32 v108, v216, v217
v_cvt_pk_bf16_f32 v109, v218, v219
v_cvt_pk_bf16_f32 v110, v220, v221
v_cvt_pk_bf16_f32 v111, v222, v223
v_cvt_pk_bf16_f32 v112, v224, v225
v_cvt_pk_bf16_f32 v113, v226, v227
v_cvt_pk_bf16_f32 v114, v228, v229
v_cvt_pk_bf16_f32 v115, v230, v231
v_cvt_pk_bf16_f32 v116, v232, v233
v_cvt_pk_bf16_f32 v117, v234, v235
v_cvt_pk_bf16_f32 v118, v236, v237
v_cvt_pk_bf16_f32 v119, v238, v239
v_cvt_pk_bf16_f32 v120, v240, v241
v_cvt_pk_bf16_f32 v121, v242, v243
v_cvt_pk_bf16_f32 v122, v244, v245
v_cvt_pk_bf16_f32 v123, v246, v247
v_cvt_pk_bf16_f32 v124, v248, v249
v_cvt_pk_bf16_f32 v125, v250, v251
v_cvt_pk_bf16_f32 v126, v252, v253
v_cvt_pk_bf16_f32 v127, v254, v255
v_accvgpr_read_b32 v128, a0
v_accvgpr_read_b32 v129, a1
v_accvgpr_read_b32 v130, a2
v_accvgpr_read_b32 v131, a3
v_accvgpr_read_b32 v132, a4
v_accvgpr_read_b32 v133, a5
v_accvgpr_read_b32 v134, a6
v_accvgpr_read_b32 v135, a7
v_cvt_pk_bf16_f32 v144, v128, v129
v_cvt_pk_bf16_f32 v145, v130, v131
v_cvt_pk_bf16_f32 v146, v132, v133
v_cvt_pk_bf16_f32 v147, v134, v135
v_accvgpr_write_b32 a96, v144
v_accvgpr_write_b32 a97, v145
v_accvgpr_write_b32 a98, v146
v_accvgpr_write_b32 a99, v147
v_accvgpr_read_b32 v136, a8
v_accvgpr_read_b32 v137, a9
v_accvgpr_read_b32 v138, a10
v_accvgpr_read_b32 v139, a11
v_accvgpr_read_b32 v140, a12
v_accvgpr_read_b32 v141, a13
v_accvgpr_read_b32 v142, a14
v_accvgpr_read_b32 v143, a15
v_cvt_pk_bf16_f32 v148, v136, v137
v_cvt_pk_bf16_f32 v149, v138, v139
v_cvt_pk_bf16_f32 v150, v140, v141
v_cvt_pk_bf16_f32 v151, v142, v143
v_accvgpr_write_b32 a100, v148
v_accvgpr_write_b32 a101, v149
v_accvgpr_write_b32 a102, v150
v_accvgpr_write_b32 a103, v151
v_accvgpr_read_b32 v128, a16
v_accvgpr_read_b32 v129, a17
v_accvgpr_read_b32 v130, a18
v_accvgpr_read_b32 v131, a19
v_accvgpr_read_b32 v132, a20
v_accvgpr_read_b32 v133, a21
v_accvgpr_read_b32 v134, a22
v_accvgpr_read_b32 v135, a23
v_cvt_pk_bf16_f32 v144, v128, v129
v_cvt_pk_bf16_f32 v145, v130, v131
v_cvt_pk_bf16_f32 v146, v132, v133
v_cvt_pk_bf16_f32 v147, v134, v135
v_accvgpr_write_b32 a104, v144
v_accvgpr_write_b32 a105, v145
v_accvgpr_write_b32 a106, v146
v_accvgpr_write_b32 a107, v147
v_accvgpr_read_b32 v136, a24
v_accvgpr_read_b32 v137, a25
v_accvgpr_read_b32 v138, a26
v_accvgpr_read_b32 v139, a27
v_accvgpr_read_b32 v140, a28
v_accvgpr_read_b32 v141, a29
v_accvgpr_read_b32 v142, a30
v_accvgpr_read_b32 v143, a31
v_cvt_pk_bf16_f32 v148, v136, v137
v_cvt_pk_bf16_f32 v149, v138, v139
v_cvt_pk_bf16_f32 v150, v140, v141
v_cvt_pk_bf16_f32 v151, v142, v143
v_accvgpr_write_b32 a108, v148
v_accvgpr_write_b32 a109, v149
v_accvgpr_write_b32 a110, v150
v_accvgpr_write_b32 a111, v151
v_accvgpr_read_b32 v128, a32
v_accvgpr_read_b32 v129, a33
v_accvgpr_read_b32 v130, a34
v_accvgpr_read_b32 v131, a35
v_accvgpr_read_b32 v132, a36
v_accvgpr_read_b32 v133, a37
v_accvgpr_read_b32 v134, a38
v_accvgpr_read_b32 v135, a39
v_cvt_pk_bf16_f32 v144, v128, v129
v_cvt_pk_bf16_f32 v145, v130, v131
v_cvt_pk_bf16_f32 v146, v132, v133
v_cvt_pk_bf16_f32 v147, v134, v135
v_accvgpr_write_b32 a112, v144
v_accvgpr_write_b32 a113, v145
v_accvgpr_write_b32 a114, v146
v_accvgpr_write_b32 a115, v147
v_accvgpr_read_b32 v136, a40
v_accvgpr_read_b32 v137, a41
v_accvgpr_read_b32 v138, a42
v_accvgpr_read_b32 v139, a43
v_accvgpr_read_b32 v140, a44
v_accvgpr_read_b32 v141, a45
v_accvgpr_read_b32 v142, a46
v_accvgpr_read_b32 v143, a47
v_cvt_pk_bf16_f32 v148, v136, v137
v_cvt_pk_bf16_f32 v149, v138, v139
v_cvt_pk_bf16_f32 v150, v140, v141
v_cvt_pk_bf16_f32 v151, v142, v143
v_accvgpr_write_b32 a116, v148
v_accvgpr_write_b32 a117, v149
v_accvgpr_write_b32 a118, v150
v_accvgpr_write_b32 a119, v151
v_accvgpr_read_b32 v128, a48
v_accvgpr_read_b32 v129, a49
v_accvgpr_read_b32 v130, a50
v_accvgpr_read_b32 v131, a51
v_accvgpr_read_b32 v132, a52
v_accvgpr_read_b32 v133, a53
v_accvgpr_read_b32 v134, a54
v_accvgpr_read_b32 v135, a55
v_cvt_pk_bf16_f32 v144, v128, v129
v_cvt_pk_bf16_f32 v145, v130, v131
v_cvt_pk_bf16_f32 v146, v132, v133
v_cvt_pk_bf16_f32 v147, v134, v135
v_accvgpr_write_b32 a120, v144
v_accvgpr_write_b32 a121, v145
v_accvgpr_write_b32 a122, v146
v_accvgpr_write_b32 a123, v147
v_accvgpr_read_b32 v136, a56
v_accvgpr_read_b32 v137, a57
v_accvgpr_read_b32 v138, a58
v_accvgpr_read_b32 v139, a59
v_accvgpr_read_b32 v140, a60
v_accvgpr_read_b32 v141, a61
v_accvgpr_read_b32 v142, a62
v_accvgpr_read_b32 v143, a63
v_cvt_pk_bf16_f32 v148, v136, v137
v_cvt_pk_bf16_f32 v149, v138, v139
v_cvt_pk_bf16_f32 v150, v140, v141
v_cvt_pk_bf16_f32 v151, v142, v143
v_accvgpr_write_b32 a124, v148
v_accvgpr_write_b32 a125, v149
v_accvgpr_write_b32 a126, v150
v_accvgpr_write_b32 a127, v151
s_mov_b32 s4, s44
s_mov_b32 s5, s45
s_mov_b32 s6, s46
s_mov_b32 s7, 0x20000
s_lshl_b32 s67, s21, 16
s_and_b32 s68, s22, 1
s_lshl_b32 s68, s68, 15
s_add_u32 s67, s67, s68
s_branch LA_p1done
LA_p1V:
ds_read_b128 a[64:67], v10 offset:0
ds_read_b128 a[68:71], v10 offset:4096
ds_read_b128 a[72:75], v10 offset:8192
ds_read_b128 a[76:79], v10 offset:12288
ds_read_b64_tr_b16 a[80:81], v18 offset:0
ds_read_b64_tr_b16 a[82:83], v18 offset:1024
ds_read_b64_tr_b16 a[84:85], v19 offset:0
ds_read_b64_tr_b16 a[86:87], v19 offset:1024
ds_read_b64_tr_b16 a[88:89], v20 offset:0
ds_read_b64_tr_b16 a[90:91], v20 offset:1024
ds_read_b64_tr_b16 a[92:93], v21 offset:0
ds_read_b64_tr_b16 a[94:95], v21 offset:1024
s_mov_b32 s70, 0
s_waitcnt lgkmcnt(6)
v_mfma_f32_32x32x16_bf16 v[64:79], a[64:67], a[80:83], 0
ds_read_b128 a[96:99], v11 offset:0
v_mfma_f32_32x32x16_bf16 v[128:143], a[68:71], a[80:83], 0
ds_read_b128 a[100:103], v11 offset:4096
v_mfma_f32_32x32x16_bf16 v[192:207], a[72:75], a[80:83], 0
ds_read_b128 a[104:107], v11 offset:8192
v_mfma_f32_32x32x16_bf16 a[0:15], a[76:79], a[80:83], 0
ds_read_b128 a[108:111], v11 offset:12288
s_waitcnt lgkmcnt(8)
v_mfma_f32_32x32x16_bf16 v[80:95], a[64:67], a[84:87], 0
ds_read_b64_tr_b16 a[112:113], v18 offset:4096
v_mfma_f32_32x32x16_bf16 v[144:159], a[68:71], a[84:87], 0
ds_read_b64_tr_b16 a[114:115], v18 offset:5120
v_mfma_f32_32x32x16_bf16 v[208:223], a[72:75], a[84:87], 0
ds_read_b64_tr_b16 a[116:117], v19 offset:4096
v_mfma_f32_32x32x16_bf16 a[16:31], a[76:79], a[84:87], 0
ds_read_b64_tr_b16 a[118:119], v19 offset:5120
s_waitcnt lgkmcnt(10)
v_mfma_f32_32x32x16_bf16 v[96:111], a[64:67], a[88:91], 0
ds_read_b64_tr_b16 a[120:121], v20 offset:4096
v_mfma_f32_32x32x16_bf16 v[160:175], a[68:71], a[88:91], 0
ds_read_b64_tr_b16 a[122:123], v20 offset:5120
v_mfma_f32_32x32x16_bf16 v[224:239], a[72:75], a[88:91], 0
ds_read_b64_tr_b16 a[124:125], v21 offset:4096
v_mfma_f32_32x32x16_bf16 a[32:47], a[76:79], a[88:91], 0
s_waitcnt lgkmcnt(11)
v_mfma_f32_32x32x16_bf16 v[112:127], a[64:67], a[92:95], 0
ds_read_b64_tr_b16 a[126:127], v21 offset:5120
v_mfma_f32_32x32x16_bf16 v[176:191], a[68:71], a[92:95], 0
v_mfma_f32_32x32x16_bf16 v[240:255], a[72:75], a[92:95], 0
v_mfma_f32_32x32x16_bf16 a[48:63], a[76:79], a[92:95], 0
s_waitcnt lgkmcnt(6)
v_mfma_f32_32x32x16_bf16 v[64:79], a[96:99], a[112:115], v[64:79]
ds_read_b128 a[64:67], v12 offset:0
buffer_load_dword v34, v33, s[4:7], s8 offen
s_add_u32 s8, s8, s9
v_mfma_f32_32x32x16_bf16 v[128:143], a[100:103], a[112:115], v[128:143]
ds_read_b128 a[68:71], v12 offset:4096
v_mfma_f32_32x32x16_bf16 v[192:207], a[104:107], a[112:115], v[192:207]
ds_read_b128 a[72:75], v12 offset:8192
v_mfma_f32_32x32x16_bf16 a[0:15], a[108:111], a[112:115], a[0:15]
ds_read_b128 a[76:79], v12 offset:12288
s_waitcnt lgkmcnt(8)
v_mfma_f32_32x32x16_bf16 v[80:95], a[96:99], a[116:119], v[80:95]
ds_read_b64_tr_b16 a[80:81], v18 offset:8192
v_mfma_f32_32x32x16_bf16 v[144:159], a[100:103], a[116:119], v[144:159]
ds_read_b64_tr_b16 a[82:83], v18 offset:9216
v_mfma_f32_32x32x16_bf16 v[208:223], a[104:107], a[116:119], v[208:223]
ds_read_b64_tr_b16 a[84:85], v19 offset:8192
v_mfma_f32_32x32x16_bf16 a[16:31], a[108:111], a[116:119], a[16:31]
ds_read_b64_tr_b16 a[86:87], v19 offset:9216
s_waitcnt lgkmcnt(10)
v_mfma_f32_32x32x16_bf16 v[96:111], a[96:99], a[120:123], v[96:111]
ds_read_b64_tr_b16 a[88:89], v20 offset:8192
v_mfma_f32_32x32x16_bf16 v[160:175], a[100:103], a[120:123], v[160:175]
ds_read_b64_tr_b16 a[90:91], v20 offset:9216
v_mfma_f32_32x32x16_bf16 v[224:239], a[104:107], a[120:123], v[224:239]
ds_read_b64_tr_b16 a[92:93], v21 offset:8192
v_mfma_f32_32x32x16_bf16 a[32:47], a[108:111], a[120:123], a[32:47]
s_waitcnt lgkmcnt(11)
v_mfma_f32_32x32x16_bf16 v[112:127], a[96:99], a[124:127], v[112:127]
ds_read_b64_tr_b16 a[94:95], v21 offset:9216
v_mfma_f32_32x32x16_bf16 v[176:191], a[100:103], a[124:127], v[176:191]
v_mfma_f32_32x32x16_bf16 v[240:255], a[104:107], a[124:127], v[240:255]
v_mfma_f32_32x32x16_bf16 a[48:63], a[108:111], a[124:127], a[48:63]
s_waitcnt lgkmcnt(6)
v_mfma_f32_32x32x16_bf16 v[64:79], a[64:67], a[80:83], v[64:79]
ds_read_b128 a[96:99], v13 offset:0
v_mfma_f32_32x32x16_bf16 v[128:143], a[68:71], a[80:83], v[128:143]
ds_read_b128 a[100:103], v13 offset:4096
v_mfma_f32_32x32x16_bf16 v[192:207], a[72:75], a[80:83], v[192:207]
ds_read_b128 a[104:107], v13 offset:8192
v_mfma_f32_32x32x16_bf16 a[0:15], a[76:79], a[80:83], a[0:15]
ds_read_b128 a[108:111], v13 offset:12288
s_waitcnt lgkmcnt(8)
v_mfma_f32_32x32x16_bf16 v[80:95], a[64:67], a[84:87], v[80:95]
ds_read_b64_tr_b16 a[112:113], v18 offset:12288
v_mfma_f32_32x32x16_bf16 v[144:159], a[68:71], a[84:87], v[144:159]
ds_read_b64_tr_b16 a[114:115], v18 offset:13312
v_mfma_f32_32x32x16_bf16 v[208:223], a[72:75], a[84:87], v[208:223]
ds_read_b64_tr_b16 a[116:117], v19 offset:12288
v_mfma_f32_32x32x16_bf16 a[16:31], a[76:79], a[84:87], a[16:31]
ds_read_b64_tr_b16 a[118:119], v19 offset:13312
s_waitcnt lgkmcnt(10)
v_mfma_f32_32x32x16_bf16 v[96:111], a[64:67], a[88:91], v[96:111]
ds_read_b64_tr_b16 a[120:121], v20 offset:12288
v_mfma_f32_32x32x16_bf16 v[160:175], a[68:71], a[88:91], v[160:175]
ds_read_b64_tr_b16 a[122:123], v20 offset:13312
v_mfma_f32_32x32x16_bf16 v[224:239], a[72:75], a[88:91], v[224:239]
ds_read_b64_tr_b16 a[124:125], v21 offset:12288
v_mfma_f32_32x32x16_bf16 a[32:47], a[76:79], a[88:91], a[32:47]
s_waitcnt lgkmcnt(11)
v_mfma_f32_32x32x16_bf16 v[112:127], a[64:67], a[92:95], v[112:127]
ds_read_b64_tr_b16 a[126:127], v21 offset:13312
v_mfma_f32_32x32x16_bf16 v[176:191], a[68:71], a[92:95], v[176:191]
v_mfma_f32_32x32x16_bf16 v[240:255], a[72:75], a[92:95], v[240:255]
v_mfma_f32_32x32x16_bf16 a[48:63], a[76:79], a[92:95], a[48:63]
s_waitcnt vmcnt(1) lgkmcnt(0)
s_barrier
s_cmp_lg_u32 s22, 0
s_cbranch_scc1 Lsig_6
s_lshr_b32 s60, s15, 2
s_add_u32 s60, s60, 8
s_lshl_b32 s60, s60, 2
s_and_b32 s61, s15, 3
s_lshl_b32 s61, s61, 3
s_lshl_b32 s61, 1, s61
v_mov_b32 v27, s60
v_mov_b32 v28, s61
s_mov_b64 s[60:61], exec
s_mov_b64 exec, 1
global_atomic_add v27, v28, s[16:17] sc1
s_mov_b64 exec, s[60:61]
Lsig_6:
v_mfma_f32_32x32x16_bf16 v[64:79], a[96:99], a[112:115], v[64:79]
ds_read_b128 a[64:67], v14 offset:0
s_add_u32 m0, s62, 0
s_add_u32 s66, s63, 0
buffer_load_dwordx4 v2, s[24:27], s66 offen offset:0 lds
v_mfma_f32_32x32x16_bf16 v[128:143], a[100:103], a[112:115], v[128:143]
ds_read_b128 a[68:71], v14 offset:4096
v_mfma_f32_32x32x16_bf16 v[192:207], a[104:107], a[112:115], v[192:207]
ds_read_b128 a[72:75], v14 offset:8192
buffer_load_dwordx4 v3, s[24:27], s66 offen offset:1024 lds
v_mfma_f32_32x32x16_bf16 a[0:15], a[108:111], a[112:115], a[0:15]
ds_read_b128 a[76:79], v14 offset:12288
v_mfma_f32_32x32x16_bf16 v[80:95], a[96:99], a[116:119], v[80:95]
buffer_load_dwordx4 v4, s[24:27], s66 offen offset:2048 lds
ds_read_b64_tr_b16 a[80:81], v22 offset:0
v_mfma_f32_32x32x16_bf16 v[144:159], a[100:103], a[116:119], v[144:159]
ds_read_b64_tr_b16 a[82:83], v22 offset:1024
v_mfma_f32_32x32x16_bf16 v[208:223], a[104:107], a[116:119], v[208:223]
buffer_load_dwordx4 v5, s[24:27], s66 offen offset:3072 lds
ds_read_b64_tr_b16 a[84:85], v23 offset:0
v_mfma_f32_32x32x16_bf16 a[16:31], a[108:111], a[116:119], a[16:31]
ds_read_b64_tr_b16 a[86:87], v23 offset:1024
v_mfma_f32_32x32x16_bf16 v[96:111], a[96:99], a[120:123], v[96:111]
s_add_u32 m0, s62, 4096
s_add_u32 s66, s63, 32768
buffer_load_dwordx4 v2, s[24:27], s66 offen offset:0 lds
ds_read_b64_tr_b16 a[88:89], v24 offset:0
v_mfma_f32_32x32x16_bf16 v[160:175], a[100:103], a[120:123], v[160:175]
ds_read_b64_tr_b16 a[90:91], v24 offset:1024
buffer_load_dwordx4 v3, s[24:27], s66 offen offset:1024 lds
v_mfma_f32_32x32x16_bf16 v[224:239], a[104:107], a[120:123], v[224:239]
ds_read_b64_tr_b16 a[92:93], v25 offset:0
v_mfma_f32_32x32x16_bf16 a[32:47], a[108:111], a[120:123], a[32:47]
buffer_load_dwordx4 v4, s[24:27], s66 offen offset:2048 lds
v_mfma_f32_32x32x16_bf16 v[112:127], a[96:99], a[124:127], v[112:127]
ds_read_b64_tr_b16 a[94:95], v25 offset:1024
v_mfma_f32_32x32x16_bf16 v[176:191], a[100:103], a[124:127], v[176:191]
buffer_load_dwordx4 v5, s[24:27], s66 offen offset:3072 lds
s_add_u32 s63, s63, 128
v_mfma_f32_32x32x16_bf16 v[240:255], a[104:107], a[124:127], v[240:255]
v_mfma_f32_32x32x16_bf16 a[48:63], a[108:111], a[124:127], a[48:63]
s_waitcnt lgkmcnt(6)
v_mfma_f32_32x32x16_bf16 v[64:79], a[64:67], a[80:83], v[64:79]
ds_read_b128 a[96:99], v15 offset:0
s_add_u32 m0, s65, 32768
s_nop 0
buffer_load_dwordx4 v6, s[28:31], s64 offen offset:0 lds
v_mfma_f32_32x32x16_bf16 v[128:143], a[68:71], a[80:83], v[128:143]
ds_read_b128 a[100:103], v15 offset:4096
v_mfma_f32_32x32x16_bf16 v[192:207], a[72:75], a[80:83], v[192:207]
ds_read_b128 a[104:107], v15 offset:8192
buffer_load_dwordx4 v7, s[28:31], s64 offen offset:1024 lds
v_mfma_f32_32x32x16_bf16 a[0:15], a[76:79], a[80:83], a[0:15]
ds_read_b128 a[108:111], v15 offset:12288
s_waitcnt lgkmcnt(8)
v_mfma_f32_32x32x16_bf16 v[80:95], a[64:67], a[84:87], v[80:95]
buffer_load_dwordx4 v8, s[28:31], s64 offen offset:2048 lds
ds_read_b64_tr_b16 a[112:113], v22 offset:4096
v_mfma_f32_32x32x16_bf16 v[144:159], a[68:71], a[84:87], v[144:159]
ds_read_b64_tr_b16 a[114:115], v22 offset:5120
v_mfma_f32_32x32x16_bf16 v[208:223], a[72:75], a[84:87], v[208:223]
buffer_load_dwordx4 v9, s[28:31], s64 offen offset:3072 lds
ds_read_b64_tr_b16 a[116:117], v23 offset:4096
v_mfma_f32_32x32x16_bf16 a[16:31], a[76:79], a[84:87], a[16:31]
ds_read_b64_tr_b16 a[118:119], v23 offset:5120
s_waitcnt lgkmcnt(10)
v_mfma_f32_32x32x16_bf16 v[96:111], a[64:67], a[88:91], v[96:111]
s_add_u32 m0, s65, 49152
s_nop 0
buffer_load_dwordx4 v6, s[32:35], s64 offen offset:0 lds
ds_read_b64_tr_b16 a[120:121], v24 offset:4096
v_mfma_f32_32x32x16_bf16 v[160:175], a[68:71], a[88:91], v[160:175]
ds_read_b64_tr_b16 a[122:123], v24 offset:5120
buffer_load_dwordx4 v7, s[32:35], s64 offen offset:1024 lds
v_mfma_f32_32x32x16_bf16 v[224:239], a[72:75], a[88:91], v[224:239]
ds_read_b64_tr_b16 a[124:125], v25 offset:4096
v_mfma_f32_32x32x16_bf16 a[32:47], a[76:79], a[88:91], a[32:47]
buffer_load_dwordx4 v8, s[32:35], s64 offen offset:2048 lds
s_waitcnt lgkmcnt(11)
v_mfma_f32_32x32x16_bf16 v[112:127], a[64:67], a[92:95], v[112:127]
ds_read_b64_tr_b16 a[126:127], v25 offset:5120
v_mfma_f32_32x32x16_bf16 v[176:191], a[68:71], a[92:95], v[176:191]
buffer_load_dwordx4 v9, s[32:35], s64 offen offset:3072 lds
s_add_u32 s64, s64, 524288
v_mfma_f32_32x32x16_bf16 v[240:255], a[72:75], a[92:95], v[240:255]
v_mfma_f32_32x32x16_bf16 a[48:63], a[76:79], a[92:95], a[48:63]
s_waitcnt lgkmcnt(6)
v_mfma_f32_32x32x16_bf16 v[64:79], a[96:99], a[112:115], v[64:79]
ds_read_b128 a[64:67], v16 offset:0
buffer_load_dword v34, v33, s[4:7], s8 offen
s_add_u32 s8, s8, s9
v_mfma_f32_32x32x16_bf16 v[128:143], a[100:103], a[112:115], v[128:143]
ds_read_b128 a[68:71], v16 offset:4096
v_mfma_f32_32x32x16_bf16 v[192:207], a[104:107], a[112:115], v[192:207]
ds_read_b128 a[72:75], v16 offset:8192
v_mfma_f32_32x32x16_bf16 a[0:15], a[108:111], a[112:115], a[0:15]
ds_read_b128 a[76:79], v16 offset:12288
global_load_dword v34, v42, s[76:77]
s_waitcnt lgkmcnt(8)
v_mfma_f32_32x32x16_bf16 v[80:95], a[96:99], a[116:119], v[80:95]
ds_read_b64_tr_b16 a[80:81], v22 offset:8192
v_mfma_f32_32x32x16_bf16 v[144:159], a[100:103], a[116:119], v[144:159]
ds_read_b64_tr_b16 a[82:83], v22 offset:9216
v_mfma_f32_32x32x16_bf16 v[208:223], a[104:107], a[116:119], v[208:223]
global_load_dword v34, v43, s[78:79]
ds_read_b64_tr_b16 a[84:85], v23 offset:8192
v_mfma_f32_32x32x16_bf16 a[16:31], a[108:111], a[116:119], a[16:31]
ds_read_b64_tr_b16 a[86:87], v23 offset:9216
s_waitcnt lgkmcnt(10)
v_mfma_f32_32x32x16_bf16 v[96:111], a[96:99], a[120:123], v[96:111]
ds_read_b64_tr_b16 a[88:89], v24 offset:8192
v_mfma_f32_32x32x16_bf16 v[160:175], a[100:103], a[120:123], v[160:175]
global_load_dword v34, v43, s[80:81]
ds_read_b64_tr_b16 a[90:91], v24 offset:9216
v_mfma_f32_32x32x16_bf16 v[224:239], a[104:107], a[120:123], v[224:239]
ds_read_b64_tr_b16 a[92:93], v25 offset:8192
v_mfma_f32_32x32x16_bf16 a[32:47], a[108:111], a[120:123], a[32:47]
s_waitcnt lgkmcnt(11)
v_mfma_f32_32x32x16_bf16 v[112:127], a[96:99], a[124:127], v[112:127]
ds_read_b64_tr_b16 a[94:95], v25 offset:9216
global_load_dword v34, v43, s[68:69]
v_mfma_f32_32x32x16_bf16 v[176:191], a[100:103], a[124:127], v[176:191]
v_mfma_f32_32x32x16_bf16 v[240:255], a[104:107], a[124:127], v[240:255]
v_mfma_f32_32x32x16_bf16 a[48:63], a[108:111], a[124:127], a[48:63]
s_waitcnt lgkmcnt(6)
v_mfma_f32_32x32x16_bf16 v[64:79], a[64:67], a[80:83], v[64:79]
ds_read_b128 a[96:99], v17 offset:0
v_mfma_f32_32x32x16_bf16 v[128:143], a[68:71], a[80:83], v[128:143]
ds_read_b128 a[100:103], v17 offset:4096
v_mfma_f32_32x32x16_bf16 v[192:207], a[72:75], a[80:83], v[192:207]
ds_read_b128 a[104:107], v17 offset:8192
v_mfma_f32_32x32x16_bf16 a[0:15], a[76:79], a[80:83], a[0:15]
ds_read_b128 a[108:111], v17 offset:12288
s_waitcnt lgkmcnt(8)
v_mfma_f32_32x32x16_bf16 v[80:95], a[64:67], a[84:87], v[80:95]
ds_read_b64_tr_b16 a[112:113], v22 offset:12288
v_mfma_f32_32x32x16_bf16 v[144:159], a[68:71], a[84:87], v[144:159]
ds_read_b64_tr_b16 a[114:115], v22 offset:13312
v_mfma_f32_32x32x16_bf16 v[208:223], a[72:75], a[84:87], v[208:223]
ds_read_b64_tr_b16 a[116:117], v23 offset:12288
v_mfma_f32_32x32x16_bf16 a[16:31], a[76:79], a[84:87], a[16:31]
ds_read_b64_tr_b16 a[118:119], v23 offset:13312
s_waitcnt lgkmcnt(10)
v_mfma_f32_32x32x16_bf16 v[96:111], a[64:67], a[88:91], v[96:111]
ds_read_b64_tr_b16 a[120:121], v24 offset:12288
v_mfma_f32_32x32x16_bf16 v[160:175], a[68:71], a[88:91], v[160:175]
ds_read_b64_tr_b16 a[122:123], v24 offset:13312
v_mfma_f32_32x32x16_bf16 v[224:239], a[72:75], a[88:91], v[224:239]
ds_read_b64_tr_b16 a[124:125], v25 offset:12288
v_mfma_f32_32x32x16_bf16 a[32:47], a[76:79], a[88:91], a[32:47]
s_waitcnt lgkmcnt(11)
v_mfma_f32_32x32x16_bf16 v[112:127], a[64:67], a[92:95], v[112:127]
ds_read_b64_tr_b16 a[126:127], v25 offset:13312
v_mfma_f32_32x32x16_bf16 v[176:191], a[68:71], a[92:95], v[176:191]
v_mfma_f32_32x32x16_bf16 v[240:255], a[72:75], a[92:95], v[240:255]
v_mfma_f32_32x32x16_bf16 a[48:63], a[76:79], a[92:95], a[48:63]
s_waitcnt vmcnt(5) lgkmcnt(0)
s_barrier
v_mfma_f32_32x32x16_bf16 v[64:79], a[96:99], a[112:115], v[64:79]
ds_read_b128 a[64:67], v10 offset:0
s_add_u32 m0, s62, 65536
s_add_u32 s66, s63, 0
buffer_load_dwordx4 v2, s[24:27], s66 offen offset:0 lds
v_mfma_f32_32x32x16_bf16 v[128:143], a[100:103], a[112:115], v[128:143]
ds_read_b128 a[68:71], v10 offset:4096
v_mfma_f32_32x32x16_bf16 v[192:207], a[104:107], a[112:115], v[192:207]
ds_read_b128 a[72:75], v10 offset:8192
buffer_load_dwordx4 v3, s[24:27], s66 offen offset:1024 lds
v_mfma_f32_32x32x16_bf16 a[0:15], a[108:111], a[112:115], a[0:15]
ds_read_b128 a[76:79], v10 offset:12288
v_mfma_f32_32x32x16_bf16 v[80:95], a[96:99], a[116:119], v[80:95]
buffer_load_dwordx4 v4, s[24:27], s66 offen offset:2048 lds
ds_read_b64_tr_b16 a[80:81], v18 offset:0
v_mfma_f32_32x32x16_bf16 v[144:159], a[100:103], a[116:119], v[144:159]
ds_read_b64_tr_b16 a[82:83], v18 offset:1024
v_mfma_f32_32x32x16_bf16 v[208:223], a[104:107], a[116:119], v[208:223]
buffer_load_dwordx4 v5, s[24:27], s66 offen offset:3072 lds
ds_read_b64_tr_b16 a[84:85], v19 offset:0
v_mfma_f32_32x32x16_bf16 a[16:31], a[108:111], a[116:119], a[16:31]
ds_read_b64_tr_b16 a[86:87], v19 offset:1024
v_mfma_f32_32x32x16_bf16 v[96:111], a[96:99], a[120:123], v[96:111]
s_add_u32 m0, s62, 69632
s_add_u32 s66, s63, 32768
buffer_load_dwordx4 v2, s[24:27], s66 offen offset:0 lds
ds_read_b64_tr_b16 a[88:89], v20 offset:0
v_mfma_f32_32x32x16_bf16 v[160:175], a[100:103], a[120:123], v[160:175]
ds_read_b64_tr_b16 a[90:91], v20 offset:1024
buffer_load_dwordx4 v3, s[24:27], s66 offen offset:1024 lds
v_mfma_f32_32x32x16_bf16 v[224:239], a[104:107], a[120:123], v[224:239]
ds_read_b64_tr_b16 a[92:93], v21 offset:0
v_mfma_f32_32x32x16_bf16 a[32:47], a[108:111], a[120:123], a[32:47]
buffer_load_dwordx4 v4, s[24:27], s66 offen offset:2048 lds
v_mfma_f32_32x32x16_bf16 v[112:127], a[96:99], a[124:127], v[112:127]
ds_read_b64_tr_b16 a[94:95], v21 offset:1024
v_mfma_f32_32x32x16_bf16 v[176:191], a[100:103], a[124:127], v[176:191]
buffer_load_dwordx4 v5, s[24:27], s66 offen offset:3072 lds
s_add_u32 s63, s63, 128
v_mfma_f32_32x32x16_bf16 v[240:255], a[104:107], a[124:127], v[240:255]
v_mfma_f32_32x32x16_bf16 a[48:63], a[108:111], a[124:127], a[48:63]
.p2align 6
LP1V_loop:
s_waitcnt lgkmcnt(6)
v_mfma_f32_32x32x16_bf16 v[64:79], a[64:67], a[80:83], v[64:79]
ds_read_b128 a[96:99], v11 offset:0
s_add_u32 m0, s65, 98304
s_nop 0
buffer_load_dwordx4 v6, s[28:31], s64 offen offset:0 lds
v_mfma_f32_32x32x16_bf16 v[128:143], a[68:71], a[80:83], v[128:143]
ds_read_b128 a[100:103], v11 offset:4096
v_mfma_f32_32x32x16_bf16 v[192:207], a[72:75], a[80:83], v[192:207]
ds_read_b128 a[104:107], v11 offset:8192
buffer_load_dwordx4 v7, s[28:31], s64 offen offset:1024 lds
v_mfma_f32_32x32x16_bf16 a[0:15], a[76:79], a[80:83], a[0:15]
ds_read_b128 a[108:111], v11 offset:12288
s_waitcnt lgkmcnt(8)
v_mfma_f32_32x32x16_bf16 v[80:95], a[64:67], a[84:87], v[80:95]
buffer_load_dwordx4 v8, s[28:31], s64 offen offset:2048 lds
ds_read_b64_tr_b16 a[112:113], v18 offset:4096
v_mfma_f32_32x32x16_bf16 v[144:159], a[68:71], a[84:87], v[144:159]
ds_read_b64_tr_b16 a[114:115], v18 offset:5120
v_mfma_f32_32x32x16_bf16 v[208:223], a[72:75], a[84:87], v[208:223]
buffer_load_dwordx4 v9, s[28:31], s64 offen offset:3072 lds
ds_read_b64_tr_b16 a[116:117], v19 offset:4096
v_mfma_f32_32x32x16_bf16 a[16:31], a[76:79], a[84:87], a[16:31]
ds_read_b64_tr_b16 a[118:119], v19 offset:5120
s_waitcnt lgkmcnt(10)
v_mfma_f32_32x32x16_bf16 v[96:111], a[64:67], a[88:91], v[96:111]
s_add_u32 m0, s65, 114688
s_nop 0
buffer_load_dwordx4 v6, s[32:35], s64 offen offset:0 lds
ds_read_b64_tr_b16 a[120:121], v20 offset:4096
v_mfma_f32_32x32x16_bf16 v[160:175], a[68:71], a[88:91], v[160:175]
ds_read_b64_tr_b16 a[122:123], v20 offset:5120
buffer_load_dwordx4 v7, s[32:35], s64 offen offset:1024 lds
v_mfma_f32_32x32x16_bf16 v[224:239], a[72:75], a[88:91], v[224:239]
ds_read_b64_tr_b16 a[124:125], v21 offset:4096
v_mfma_f32_32x32x16_bf16 a[32:47], a[76:79], a[88:91], a[32:47]
buffer_load_dwordx4 v8, s[32:35], s64 offen offset:2048 lds
s_waitcnt lgkmcnt(11)
v_mfma_f32_32x32x16_bf16 v[112:127], a[64:67], a[92:95], v[112:127]
ds_read_b64_tr_b16 a[126:127], v21 offset:5120
v_mfma_f32_32x32x16_bf16 v[176:191], a[68:71], a[92:95], v[176:191]
buffer_load_dwordx4 v9, s[32:35], s64 offen offset:3072 lds
s_add_u32 s64, s64, 524288
v_mfma_f32_32x32x16_bf16 v[240:255], a[72:75], a[92:95], v[240:255]
v_mfma_f32_32x32x16_bf16 a[48:63], a[76:79], a[92:95], a[48:63]
s_waitcnt lgkmcnt(6)
v_mfma_f32_32x32x16_bf16 v[64:79], a[96:99], a[112:115], v[64:79]
ds_read_b128 a[64:67], v12 offset:0
buffer_load_dword v34, v33, s[4:7], s8 offen
s_add_u32 s8, s8, s9
v_mfma_f32_32x32x16_bf16 v[128:143], a[100:103], a[112:115], v[128:143]
ds_read_b128 a[68:71], v12 offset:4096
v_mfma_f32_32x32x16_bf16 v[192:207], a[104:107], a[112:115], v[192:207]
ds_read_b128 a[72:75], v12 offset:8192
v_mfma_f32_32x32x16_bf16 a[0:15], a[108:111], a[112:115], a[0:15]
ds_read_b128 a[76:79], v12 offset:12288
s_waitcnt lgkmcnt(8)
v_mfma_f32_32x32x16_bf16 v[80:95], a[96:99], a[116:119], v[80:95]
ds_read_b64_tr_b16 a[80:81], v18 offset:8192
v_mfma_f32_32x32x16_bf16 v[144:159], a[100:103], a[116:119], v[144:159]
ds_read_b64_tr_b16 a[82:83], v18 offset:9216
v_mfma_f32_32x32x16_bf16 v[208:223], a[104:107], a[116:119], v[208:223]
ds_read_b64_tr_b16 a[84:85], v19 offset:8192
v_mfma_f32_32x32x16_bf16 a[16:31], a[108:111], a[116:119], a[16:31]
ds_read_b64_tr_b16 a[86:87], v19 offset:9216
s_waitcnt lgkmcnt(10)
v_mfma_f32_32x32x16_bf16 v[96:111], a[96:99], a[120:123], v[96:111]
ds_read_b64_tr_b16 a[88:89], v20 offset:8192
v_mfma_f32_32x32x16_bf16 v[160:175], a[100:103], a[120:123], v[160:175]
ds_read_b64_tr_b16 a[90:91], v20 offset:9216
v_mfma_f32_32x32x16_bf16 v[224:239], a[104:107], a[120:123], v[224:239]
ds_read_b64_tr_b16 a[92:93], v21 offset:8192
v_mfma_f32_32x32x16_bf16 a[32:47], a[108:111], a[120:123], a[32:47]
s_waitcnt lgkmcnt(11)
v_mfma_f32_32x32x16_bf16 v[112:127], a[96:99], a[124:127], v[112:127]
ds_read_b64_tr_b16 a[94:95], v21 offset:9216
v_mfma_f32_32x32x16_bf16 v[176:191], a[100:103], a[124:127], v[176:191]
v_mfma_f32_32x32x16_bf16 v[240:255], a[104:107], a[124:127], v[240:255]
v_mfma_f32_32x32x16_bf16 a[48:63], a[108:111], a[124:127], a[48:63]
s_waitcnt lgkmcnt(6)
v_mfma_f32_32x32x16_bf16 v[64:79], a[64:67], a[80:83], v[64:79]
ds_read_b128 a[96:99], v13 offset:0
v_mfma_f32_32x32x16_bf16 v[128:143], a[68:71], a[80:83], v[128:143]
ds_read_b128 a[100:103], v13 offset:4096
v_mfma_f32_32x32x16_bf16 v[192:207], a[72:75], a[80:83], v[192:207]
ds_read_b128 a[104:107], v13 offset:8192
v_mfma_f32_32x32x16_bf16 a[0:15], a[76:79], a[80:83], a[0:15]
ds_read_b128 a[108:111], v13 offset:12288
s_waitcnt lgkmcnt(8)
v_mfma_f32_32x32x16_bf16 v[80:95], a[64:67], a[84:87], v[80:95]
ds_read_b64_tr_b16 a[112:113], v18 offset:12288
v_mfma_f32_32x32x16_bf16 v[144:159], a[68:71], a[84:87], v[144:159]
ds_read_b64_tr_b16 a[114:115], v18 offset:13312
v_mfma_f32_32x32x16_bf16 v[208:223], a[72:75], a[84:87], v[208:223]
ds_read_b64_tr_b16 a[116:117], v19 offset:12288
v_mfma_f32_32x32x16_bf16 a[16:31], a[76:79], a[84:87], a[16:31]
ds_read_b64_tr_b16 a[118:119], v19 offset:13312
s_waitcnt lgkmcnt(10)
v_mfma_f32_32x32x16_bf16 v[96:111], a[64:67], a[88:91], v[96:111]
ds_read_b64_tr_b16 a[120:121], v20 offset:12288
v_mfma_f32_32x32x16_bf16 v[160:175], a[68:71], a[88:91], v[160:175]
ds_read_b64_tr_b16 a[122:123], v20 offset:13312
v_mfma_f32_32x32x16_bf16 v[224:239], a[72:75], a[88:91], v[224:239]
ds_read_b64_tr_b16 a[124:125], v21 offset:12288
v_mfma_f32_32x32x16_bf16 a[32:47], a[76:79], a[88:91], a[32:47]
s_waitcnt lgkmcnt(11)
v_mfma_f32_32x32x16_bf16 v[112:127], a[64:67], a[92:95], v[112:127]
ds_read_b64_tr_b16 a[126:127], v21 offset:13312
v_mfma_f32_32x32x16_bf16 v[176:191], a[68:71], a[92:95], v[176:191]
v_mfma_f32_32x32x16_bf16 v[240:255], a[72:75], a[92:95], v[240:255]
v_mfma_f32_32x32x16_bf16 a[48:63], a[76:79], a[92:95], a[48:63]
s_waitcnt vmcnt(1) lgkmcnt(0)
s_barrier
v_mfma_f32_32x32x16_bf16 v[64:79], a[96:99], a[112:115], v[64:79]
ds_read_b128 a[64:67], v14 offset:0
s_add_u32 m0, s62, 0
s_add_u32 s66, s63, 0
buffer_load_dwordx4 v2, s[24:27], s66 offen offset:0 lds
v_mfma_f32_32x32x16_bf16 v[128:143], a[100:103], a[112:115], v[128:143]
ds_read_b128 a[68:71], v14 offset:4096
v_mfma_f32_32x32x16_bf16 v[192:207], a[104:107], a[112:115], v[192:207]
ds_read_b128 a[72:75], v14 offset:8192
buffer_load_dwordx4 v3, s[24:27], s66 offen offset:1024 lds
v_mfma_f32_32x32x16_bf16 a[0:15], a[108:111], a[112:115], a[0:15]
ds_read_b128 a[76:79], v14 offset:12288
v_mfma_f32_32x32x16_bf16 v[80:95], a[96:99], a[116:119], v[80:95]
buffer_load_dwordx4 v4, s[24:27], s66 offen offset:2048 lds
ds_read_b64_tr_b16 a[80:81], v22 offset:0
v_mfma_f32_32x32x16_bf16 v[144:159], a[100:103], a[116:119], v[144:159]
ds_read_b64_tr_b16 a[82:83], v22 offset:1024
v_mfma_f32_32x32x16_bf16 v[208:223], a[104:107], a[116:119], v[208:223]
buffer_load_dwordx4 v5, s[24:27], s66 offen offset:3072 lds
ds_read_b64_tr_b16 a[84:85], v23 offset:0
v_mfma_f32_32x32x16_bf16 a[16:31], a[108:111], a[116:119], a[16:31]
ds_read_b64_tr_b16 a[86:87], v23 offset:1024
v_mfma_f32_32x32x16_bf16 v[96:111], a[96:99], a[120:123], v[96:111]
s_add_u32 m0, s62, 4096
s_add_u32 s66, s63, 32768
buffer_load_dwordx4 v2, s[24:27], s66 offen offset:0 lds
ds_read_b64_tr_b16 a[88:89], v24 offset:0
v_mfma_f32_32x32x16_bf16 v[160:175], a[100:103], a[120:123], v[160:175]
ds_read_b64_tr_b16 a[90:91], v24 offset:1024
buffer_load_dwordx4 v3, s[24:27], s66 offen offset:1024 lds
v_mfma_f32_32x32x16_bf16 v[224:239], a[104:107], a[120:123], v[224:239]
ds_read_b64_tr_b16 a[92:93], v25 offset:0
v_mfma_f32_32x32x16_bf16 a[32:47], a[108:111], a[120:123], a[32:47]
buffer_load_dwordx4 v4, s[24:27], s66 offen offset:2048 lds
v_mfma_f32_32x32x16_bf16 v[112:127], a[96:99], a[124:127], v[112:127]
ds_read_b64_tr_b16 a[94:95], v25 offset:1024
v_mfma_f32_32x32x16_bf16 v[176:191], a[100:103], a[124:127], v[176:191]
buffer_load_dwordx4 v5, s[24:27], s66 offen offset:3072 lds
s_add_u32 s63, s63, 128
v_mfma_f32_32x32x16_bf16 v[240:255], a[104:107], a[124:127], v[240:255]
v_mfma_f32_32x32x16_bf16 a[48:63], a[108:111], a[124:127], a[48:63]
s_waitcnt lgkmcnt(6)
v_mfma_f32_32x32x16_bf16 v[64:79], a[64:67], a[80:83], v[64:79]
ds_read_b128 a[96:99], v15 offset:0
s_add_u32 m0, s65, 32768
s_nop 0
buffer_load_dwordx4 v6, s[28:31], s64 offen offset:0 lds
v_mfma_f32_32x32x16_bf16 v[128:143], a[68:71], a[80:83], v[128:143]
ds_read_b128 a[100:103], v15 offset:4096
v_mfma_f32_32x32x16_bf16 v[192:207], a[72:75], a[80:83], v[192:207]
ds_read_b128 a[104:107], v15 offset:8192
buffer_load_dwordx4 v7, s[28:31], s64 offen offset:1024 lds
v_mfma_f32_32x32x16_bf16 a[0:15], a[76:79], a[80:83], a[0:15]
ds_read_b128 a[108:111], v15 offset:12288
s_waitcnt lgkmcnt(8)
v_mfma_f32_32x32x16_bf16 v[80:95], a[64:67], a[84:87], v[80:95]
buffer_load_dwordx4 v8, s[28:31], s64 offen offset:2048 lds
ds_read_b64_tr_b16 a[112:113], v22 offset:4096
v_mfma_f32_32x32x16_bf16 v[144:159], a[68:71], a[84:87], v[144:159]
ds_read_b64_tr_b16 a[114:115], v22 offset:5120
v_mfma_f32_32x32x16_bf16 v[208:223], a[72:75], a[84:87], v[208:223]
buffer_load_dwordx4 v9, s[28:31], s64 offen offset:3072 lds
ds_read_b64_tr_b16 a[116:117], v23 offset:4096
v_mfma_f32_32x32x16_bf16 a[16:31], a[76:79], a[84:87], a[16:31]
ds_read_b64_tr_b16 a[118:119], v23 offset:5120
s_waitcnt lgkmcnt(10)
v_mfma_f32_32x32x16_bf16 v[96:111], a[64:67], a[88:91], v[96:111]
s_add_u32 m0, s65, 49152
s_nop 0
buffer_load_dwordx4 v6, s[32:35], s64 offen offset:0 lds
ds_read_b64_tr_b16 a[120:121], v24 offset:4096
v_mfma_f32_32x32x16_bf16 v[160:175], a[68:71], a[88:91], v[160:175]
ds_read_b64_tr_b16 a[122:123], v24 offset:5120
buffer_load_dwordx4 v7, s[32:35], s64 offen offset:1024 lds
v_mfma_f32_32x32x16_bf16 v[224:239], a[72:75], a[88:91], v[224:239]
ds_read_b64_tr_b16 a[124:125], v25 offset:4096
v_mfma_f32_32x32x16_bf16 a[32:47], a[76:79], a[88:91], a[32:47]
buffer_load_dwordx4 v8, s[32:35], s64 offen offset:2048 lds
s_waitcnt lgkmcnt(11)
v_mfma_f32_32x32x16_bf16 v[112:127], a[64:67], a[92:95], v[112:127]
ds_read_b64_tr_b16 a[126:127], v25 offset:5120
v_mfma_f32_32x32x16_bf16 v[176:191], a[68:71], a[92:95], v[176:191]
buffer_load_dwordx4 v9, s[32:35], s64 offen offset:3072 lds
s_add_u32 s64, s64, 524288
v_mfma_f32_32x32x16_bf16 v[240:255], a[72:75], a[92:95], v[240:255]
v_mfma_f32_32x32x16_bf16 a[48:63], a[76:79], a[92:95], a[48:63]
s_waitcnt lgkmcnt(6)
v_mfma_f32_32x32x16_bf16 v[64:79], a[96:99], a[112:115], v[64:79]
ds_read_b128 a[64:67], v16 offset:0
buffer_load_dword v34, v33, s[4:7], s8 offen
s_add_u32 s8, s8, s9
v_mfma_f32_32x32x16_bf16 v[128:143], a[100:103], a[112:115], v[128:143]
ds_read_b128 a[68:71], v16 offset:4096
v_mfma_f32_32x32x16_bf16 v[192:207], a[104:107], a[112:115], v[192:207]
ds_read_b128 a[72:75], v16 offset:8192
v_mfma_f32_32x32x16_bf16 a[0:15], a[108:111], a[112:115], a[0:15]
ds_read_b128 a[76:79], v16 offset:12288
s_waitcnt lgkmcnt(8)
v_mfma_f32_32x32x16_bf16 v[80:95], a[96:99], a[116:119], v[80:95]
ds_read_b64_tr_b16 a[80:81], v22 offset:8192
v_mfma_f32_32x32x16_bf16 v[144:159], a[100:103], a[116:119], v[144:159]
ds_read_b64_tr_b16 a[82:83], v22 offset:9216
v_mfma_f32_32x32x16_bf16 v[208:223], a[104:107], a[116:119], v[208:223]
ds_read_b64_tr_b16 a[84:85], v23 offset:8192
v_mfma_f32_32x32x16_bf16 a[16:31], a[108:111], a[116:119], a[16:31]
ds_read_b64_tr_b16 a[86:87], v23 offset:9216
s_waitcnt lgkmcnt(10)
v_mfma_f32_32x32x16_bf16 v[96:111], a[96:99], a[120:123], v[96:111]
ds_read_b64_tr_b16 a[88:89], v24 offset:8192
v_mfma_f32_32x32x16_bf16 v[160:175], a[100:103], a[120:123], v[160:175]
ds_read_b64_tr_b16 a[90:91], v24 offset:9216
v_mfma_f32_32x32x16_bf16 v[224:239], a[104:107], a[120:123], v[224:239]
ds_read_b64_tr_b16 a[92:93], v25 offset:8192
v_mfma_f32_32x32x16_bf16 a[32:47], a[108:111], a[120:123], a[32:47]
s_waitcnt lgkmcnt(11)
v_mfma_f32_32x32x16_bf16 v[112:127], a[96:99], a[124:127], v[112:127]
ds_read_b64_tr_b16 a[94:95], v25 offset:9216
v_mfma_f32_32x32x16_bf16 v[176:191], a[100:103], a[124:127], v[176:191]
v_mfma_f32_32x32x16_bf16 v[240:255], a[104:107], a[124:127], v[240:255]
v_mfma_f32_32x32x16_bf16 a[48:63], a[108:111], a[124:127], a[48:63]
s_waitcnt lgkmcnt(6)
v_mfma_f32_32x32x16_bf16 v[64:79], a[64:67], a[80:83], v[64:79]
ds_read_b128 a[96:99], v17 offset:0
v_mfma_f32_32x32x16_bf16 v[128:143], a[68:71], a[80:83], v[128:143]
ds_read_b128 a[100:103], v17 offset:4096
v_mfma_f32_32x32x16_bf16 v[192:207], a[72:75], a[80:83], v[192:207]
ds_read_b128 a[104:107], v17 offset:8192
v_mfma_f32_32x32x16_bf16 a[0:15], a[76:79], a[80:83], a[0:15]
ds_read_b128 a[108:111], v17 offset:12288
s_waitcnt lgkmcnt(8)
v_mfma_f32_32x32x16_bf16 v[80:95], a[64:67], a[84:87], v[80:95]
ds_read_b64_tr_b16 a[112:113], v22 offset:12288
v_mfma_f32_32x32x16_bf16 v[144:159], a[68:71], a[84:87], v[144:159]
ds_read_b64_tr_b16 a[114:115], v22 offset:13312
v_mfma_f32_32x32x16_bf16 v[208:223], a[72:75], a[84:87], v[208:223]
ds_read_b64_tr_b16 a[116:117], v23 offset:12288
v_mfma_f32_32x32x16_bf16 a[16:31], a[76:79], a[84:87], a[16:31]
ds_read_b64_tr_b16 a[118:119], v23 offset:13312
s_waitcnt lgkmcnt(10)
v_mfma_f32_32x32x16_bf16 v[96:111], a[64:67], a[88:91], v[96:111]
ds_read_b64_tr_b16 a[120:121], v24 offset:12288
v_mfma_f32_32x32x16_bf16 v[160:175], a[68:71], a[88:91], v[160:175]
ds_read_b64_tr_b16 a[122:123], v24 offset:13312
v_mfma_f32_32x32x16_bf16 v[224:239], a[72:75], a[88:91], v[224:239]
ds_read_b64_tr_b16 a[124:125], v25 offset:12288
v_mfma_f32_32x32x16_bf16 a[32:47], a[76:79], a[88:91], a[32:47]
s_waitcnt lgkmcnt(11)
v_mfma_f32_32x32x16_bf16 v[112:127], a[64:67], a[92:95], v[112:127]
ds_read_b64_tr_b16 a[126:127], v25 offset:13312
v_mfma_f32_32x32x16_bf16 v[176:191], a[68:71], a[92:95], v[176:191]
v_mfma_f32_32x32x16_bf16 v[240:255], a[72:75], a[92:95], v[240:255]
v_mfma_f32_32x32x16_bf16 a[48:63], a[76:79], a[92:95], a[48:63]
s_waitcnt vmcnt(1) lgkmcnt(0)
s_barrier
v_mfma_f32_32x32x16_bf16 v[64:79], a[96:99], a[112:115], v[64:79]
ds_read_b128 a[64:67], v10 offset:0
s_add_u32 m0, s62, 65536
s_add_u32 s66, s63, 0
buffer_load_dwordx4 v2, s[24:27], s66 offen offset:0 lds
v_mfma_f32_32x32x16_bf16 v[128:143], a[100:103], a[112:115], v[128:143]
ds_read_b128 a[68:71], v10 offset:4096
v_mfma_f32_32x32x16_bf16 v[192:207], a[104:107], a[112:115], v[192:207]
ds_read_b128 a[72:75], v10 offset:8192
buffer_load_dwordx4 v3, s[24:27], s66 offen offset:1024 lds
v_mfma_f32_32x32x16_bf16 a[0:15], a[108:111], a[112:115], a[0:15]
ds_read_b128 a[76:79], v10 offset:12288
v_mfma_f32_32x32x16_bf16 v[80:95], a[96:99], a[116:119], v[80:95]
buffer_load_dwordx4 v4, s[24:27], s66 offen offset:2048 lds
ds_read_b64_tr_b16 a[80:81], v18 offset:0
v_mfma_f32_32x32x16_bf16 v[144:159], a[100:103], a[116:119], v[144:159]
ds_read_b64_tr_b16 a[82:83], v18 offset:1024
v_mfma_f32_32x32x16_bf16 v[208:223], a[104:107], a[116:119], v[208:223]
buffer_load_dwordx4 v5, s[24:27], s66 offen offset:3072 lds
ds_read_b64_tr_b16 a[84:85], v19 offset:0
v_mfma_f32_32x32x16_bf16 a[16:31], a[108:111], a[116:119], a[16:31]
ds_read_b64_tr_b16 a[86:87], v19 offset:1024
v_mfma_f32_32x32x16_bf16 v[96:111], a[96:99], a[120:123], v[96:111]
s_add_u32 m0, s62, 69632
s_add_u32 s66, s63, 32768
buffer_load_dwordx4 v2, s[24:27], s66 offen offset:0 lds
ds_read_b64_tr_b16 a[88:89], v20 offset:0
v_mfma_f32_32x32x16_bf16 v[160:175], a[100:103], a[120:123], v[160:175]
ds_read_b64_tr_b16 a[90:91], v20 offset:1024
buffer_load_dwordx4 v3, s[24:27], s66 offen offset:1024 lds
v_mfma_f32_32x32x16_bf16 v[224:239], a[104:107], a[120:123], v[224:239]
ds_read_b64_tr_b16 a[92:93], v21 offset:0
v_mfma_f32_32x32x16_bf16 a[32:47], a[108:111], a[120:123], a[32:47]
buffer_load_dwordx4 v4, s[24:27], s66 offen offset:2048 lds
v_mfma_f32_32x32x16_bf16 v[112:127], a[96:99], a[124:127], v[112:127]
ds_read_b64_tr_b16 a[94:95], v21 offset:1024
v_mfma_f32_32x32x16_bf16 v[176:191], a[100:103], a[124:127], v[176:191]
buffer_load_dwordx4 v5, s[24:27], s66 offen offset:3072 lds
s_add_u32 s63, s63, 128
v_mfma_f32_32x32x16_bf16 v[240:255], a[104:107], a[124:127], v[240:255]
v_mfma_f32_32x32x16_bf16 a[48:63], a[108:111], a[124:127], a[48:63]
s_add_u32 s70, s70, 1
s_cmp_lt_u32 s70, 2
s_cbranch_scc1 LP1V_loop
s_waitcnt lgkmcnt(6)
v_mfma_f32_32x32x16_bf16 v[64:79], a[64:67], a[80:83], v[64:79]
ds_read_b128 a[96:99], v11 offset:0
s_add_u32 m0, s65, 98304
s_nop 0
buffer_load_dwordx4 v6, s[28:31], s64 offen offset:0 lds
v_mfma_f32_32x32x16_bf16 v[128:143], a[68:71], a[80:83], v[128:143]
ds_read_b128 a[100:103], v11 offset:4096
v_mfma_f32_32x32x16_bf16 v[192:207], a[72:75], a[80:83], v[192:207]
ds_read_b128 a[104:107], v11 offset:8192
buffer_load_dwordx4 v7, s[28:31], s64 offen offset:1024 lds
v_mfma_f32_32x32x16_bf16 a[0:15], a[76:79], a[80:83], a[0:15]
ds_read_b128 a[108:111], v11 offset:12288
s_waitcnt lgkmcnt(8)
v_mfma_f32_32x32x16_bf16 v[80:95], a[64:67], a[84:87], v[80:95]
buffer_load_dwordx4 v8, s[28:31], s64 offen offset:2048 lds
ds_read_b64_tr_b16 a[112:113], v18 offset:4096
v_mfma_f32_32x32x16_bf16 v[144:159], a[68:71], a[84:87], v[144:159]
ds_read_b64_tr_b16 a[114:115], v18 offset:5120
v_mfma_f32_32x32x16_bf16 v[208:223], a[72:75], a[84:87], v[208:223]
buffer_load_dwordx4 v9, s[28:31], s64 offen offset:3072 lds
ds_read_b64_tr_b16 a[116:117], v19 offset:4096
v_mfma_f32_32x32x16_bf16 a[16:31], a[76:79], a[84:87], a[16:31]
ds_read_b64_tr_b16 a[118:119], v19 offset:5120
s_waitcnt lgkmcnt(10)
v_mfma_f32_32x32x16_bf16 v[96:111], a[64:67], a[88:91], v[96:111]
s_add_u32 m0, s65, 114688
s_nop 0
buffer_load_dwordx4 v6, s[32:35], s64 offen offset:0 lds
ds_read_b64_tr_b16 a[120:121], v20 offset:4096
v_mfma_f32_32x32x16_bf16 v[160:175], a[68:71], a[88:91], v[160:175]
ds_read_b64_tr_b16 a[122:123], v20 offset:5120
buffer_load_dwordx4 v7, s[32:35], s64 offen offset:1024 lds
v_mfma_f32_32x32x16_bf16 v[224:239], a[72:75], a[88:91], v[224:239]
ds_read_b64_tr_b16 a[124:125], v21 offset:4096
v_mfma_f32_32x32x16_bf16 a[32:47], a[76:79], a[88:91], a[32:47]
buffer_load_dwordx4 v8, s[32:35], s64 offen offset:2048 lds
s_waitcnt lgkmcnt(11)
v_mfma_f32_32x32x16_bf16 v[112:127], a[64:67], a[92:95], v[112:127]
ds_read_b64_tr_b16 a[126:127], v21 offset:5120
v_mfma_f32_32x32x16_bf16 v[176:191], a[68:71], a[92:95], v[176:191]
buffer_load_dwordx4 v9, s[32:35], s64 offen offset:3072 lds
s_add_u32 s64, s64, 524288
v_mfma_f32_32x32x16_bf16 v[240:255], a[72:75], a[92:95], v[240:255]
v_mfma_f32_32x32x16_bf16 a[48:63], a[76:79], a[92:95], a[48:63]
s_waitcnt lgkmcnt(6)
v_mfma_f32_32x32x16_bf16 v[64:79], a[96:99], a[112:115], v[64:79]
ds_read_b128 a[64:67], v12 offset:0
v_mov_b32 v60, 32
global_load_dwordx4 v[56:59], v60, s[16:17] sc1
v_mfma_f32_32x32x16_bf16 v[128:143], a[100:103], a[112:115], v[128:143]
ds_read_b128 a[68:71], v12 offset:4096
v_mfma_f32_32x32x16_bf16 v[192:207], a[104:107], a[112:115], v[192:207]
ds_read_b128 a[72:75], v12 offset:8192
s_add_u32 s60, s20, 16
s_lshl_b32 s60, s60, 2
v_mov_b32 v61, s60
global_load_dword v62, v61, s[16:17] sc1
v_mfma_f32_32x32x16_bf16 a[0:15], a[108:111], a[112:115], a[0:15]
ds_read_b128 a[76:79], v12 offset:12288
s_waitcnt lgkmcnt(8)
v_mfma_f32_32x32x16_bf16 v[80:95], a[96:99], a[116:119], v[80:95]
s_and_b32 s12, s2, 3
s_bfe_u32 s13, s2, 0x10002
s_lshr_b32 s15, s2, 3
s_and_b32 s60, s15, 7
s_lshl_b32 s13, s13, 3
s_add_u32 s13, s13, s60
s_lshr_b32 s15, s15, 3
s_lshl_b32 s60, s13, 7
s_lshl_b32 s61, s15, 5
s_add_u32 s60, s60, s61
s_lshl_b32 s61, s12, 3
s_add_u32 s60, s60, s61
s_mul_i32 s15, s60, 1280
v_mov_b32 v52, -1
v_mov_b32 v53, -1
v_mov_b32 v54, -1
v_mov_b32 v55, -1
v_lshlrev_b32 v51, 4, v0
s_add_u32 s61, s15, 0x4c00000
s_add_u32 s56, s18, s61
s_addc_u32 s57, s19, 0
s_mov_b32 s58, 10240
s_mov_b32 s59, 0x20000
s_mov_b32 s61, 0
buffer_store_dwordx4 v[52:55], v51, s[56:59], s61 offen sc1
ds_read_b64_tr_b16 a[80:81], v18 offset:8192
v_mfma_f32_32x32x16_bf16 v[144:159], a[100:103], a[116:119], v[144:159]
ds_read_b64_tr_b16 a[82:83], v18 offset:9216
v_mfma_f32_32x32x16_bf16 v[208:223], a[104:107], a[116:119], v[208:223]
s_mov_b32 s61, 4096
buffer_store_dwordx4 v[52:55], v51, s[56:59], s61 offen sc1
ds_read_b64_tr_b16 a[84:85], v19 offset:8192
v_mfma_f32_32x32x16_bf16 a[16:31], a[108:111], a[116:119], a[16:31]
ds_read_b64_tr_b16 a[86:87], v19 offset:9216
s_waitcnt lgkmcnt(10)
v_mfma_f32_32x32x16_bf16 v[96:111], a[96:99], a[120:123], v[96:111]
s_mov_b32 s61, 8192
buffer_store_dwordx4 v[52:55], v51, s[56:59], s61 offen sc1
ds_read_b64_tr_b16 a[88:89], v20 offset:8192
v_mfma_f32_32x32x16_bf16 v[160:175], a[100:103], a[120:123], v[160:175]
ds_read_b64_tr_b16 a[90:91], v20 offset:9216
s_add_u32 s61, s15, 0x5000000
s_add_u32 s56, s18, s61
s_addc_u32 s57, s19, 0
s_mov_b32 s58, 10240
s_mov_b32 s59, 0x20000
s_mov_b32 s61, 0
buffer_store_dwordx4 v[52:55], v51, s[56:59], s61 offen sc1
v_mfma_f32_32x32x16_bf16 v[224:239], a[104:107], a[120:123], v[224:239]
ds_read_b64_tr_b16 a[92:93], v21 offset:8192
v_mfma_f32_32x32x16_bf16 a[32:47], a[108:111], a[120:123], a[32:47]
s_mov_b32 s61, 4096
buffer_store_dwordx4 v[52:55], v51, s[56:59], s61 offen sc1
s_waitcnt lgkmcnt(11)
v_mfma_f32_32x32x16_bf16 v[112:127], a[96:99], a[124:127], v[112:127]
ds_read_b64_tr_b16 a[94:95], v21 offset:9216
v_mfma_f32_32x32x16_bf16 v[176:191], a[100:103], a[124:127], v[176:191]
s_mov_b32 s61, 8192
buffer_store_dwordx4 v[52:55], v51, s[56:59], s61 offen sc1
v_mfma_f32_32x32x16_bf16 v[240:255], a[104:107], a[124:127], v[240:255]
v_mfma_f32_32x32x16_bf16 a[48:63], a[108:111], a[124:127], a[48:63]
s_waitcnt lgkmcnt(6)
v_mfma_f32_32x32x16_bf16 v[64:79], a[64:67], a[80:83], v[64:79]
ds_read_b128 a[96:99], v13 offset:0
v_mfma_f32_32x32x16_bf16 v[128:143], a[68:71], a[80:83], v[128:143]
ds_read_b128 a[100:103], v13 offset:4096
v_mfma_f32_32x32x16_bf16 v[192:207], a[72:75], a[80:83], v[192:207]
ds_read_b128 a[104:107], v13 offset:8192
v_mfma_f32_32x32x16_bf16 a[0:15], a[76:79], a[80:83], a[0:15]
ds_read_b128 a[108:111], v13 offset:12288
s_waitcnt lgkmcnt(8)
v_mfma_f32_32x32x16_bf16 v[80:95], a[64:67], a[84:87], v[80:95]
ds_read_b64_tr_b16 a[112:113], v18 offset:12288
v_mfma_f32_32x32x16_bf16 v[144:159], a[68:71], a[84:87], v[144:159]
ds_read_b64_tr_b16 a[114:115], v18 offset:13312
v_mfma_f32_32x32x16_bf16 v[208:223], a[72:75], a[84:87], v[208:223]
ds_read_b64_tr_b16 a[116:117], v19 offset:12288
v_mfma_f32_32x32x16_bf16 a[16:31], a[76:79], a[84:87], a[16:31]
ds_read_b64_tr_b16 a[118:119], v19 offset:13312
s_waitcnt lgkmcnt(10)
v_mfma_f32_32x32x16_bf16 v[96:111], a[64:67], a[88:91], v[96:111]
ds_read_b64_tr_b16 a[120:121], v20 offset:12288
v_mfma_f32_32x32x16_bf16 v[160:175], a[68:71], a[88:91], v[160:175]
ds_read_b64_tr_b16 a[122:123], v20 offset:13312
v_mfma_f32_32x32x16_bf16 v[224:239], a[72:75], a[88:91], v[224:239]
ds_read_b64_tr_b16 a[124:125], v21 offset:12288
v_mfma_f32_32x32x16_bf16 a[32:47], a[76:79], a[88:91], a[32:47]
s_waitcnt lgkmcnt(11)
v_mfma_f32_32x32x16_bf16 v[112:127], a[64:67], a[92:95], v[112:127]
ds_read_b64_tr_b16 a[126:127], v21 offset:13312
v_mfma_f32_32x32x16_bf16 v[176:191], a[68:71], a[92:95], v[176:191]
v_mfma_f32_32x32x16_bf16 v[240:255], a[72:75], a[92:95], v[240:255]
v_mfma_f32_32x32x16_bf16 a[48:63], a[76:79], a[92:95], a[48:63]
s_waitcnt vmcnt(0) lgkmcnt(0)
v_readfirstlane_b32 s63, v62
s_lshl_b32 s23, 8, s14
s_cmp_eq_u32 s63, s23
s_cselect_b32 s23, 1, 0
v_and_b32 v56, v56, v57
v_and_b32 v58, v58, v59
v_and_b32 v56, v56, v58
s_nop 0
v_readfirstlane_b32 s60, v56
s_nop 3
s_cmp_eq_u32 s60, 0x10101010
s_cbranch_scc1 Lxok_7
s_mov_b32 s61, 0
Lxsp_8:
global_load_dwordx4 v[56:59], v60, s[16:17] sc1
s_waitcnt vmcnt(0)
v_and_b32 v56, v56, v57
v_and_b32 v58, v58, v59
v_and_b32 v56, v56, v58
s_nop 0
v_readfirstlane_b32 s60, v56
s_nop 3
s_cmp_eq_u32 s60, 0x10101010
s_cbranch_scc1 Lxok_7
s_add_u32 s61, s61, 1
s_cmp_lt_u32 s61, 0x40000
s_sleep 2
s_cbranch_scc1 Lxsp_8
Lxok_7:
s_barrier
v_mfma_f32_32x32x16_bf16 v[64:79], a[96:99], a[112:115], v[64:79]
ds_read_b128 a[64:67], v14 offset:0
s_add_u32 m0, s84, 32768
s_add_u32 s66, s85, 0
buffer_load_dwordx4 v6, s[36:39], s66 offen offset:0 lds
v_mfma_f32_32x32x16_bf16 v[128:143], a[100:103], a[112:115], v[128:143]
ds_read_b128 a[68:71], v14 offset:4096
v_mfma_f32_32x32x16_bf16 v[192:207], a[104:107], a[112:115], v[192:207]
ds_read_b128 a[72:75], v14 offset:8192
buffer_load_dwordx4 v7, s[36:39], s66 offen offset:1024 lds
v_mfma_f32_32x32x16_bf16 a[0:15], a[108:111], a[112:115], a[0:15]
ds_read_b128 a[76:79], v14 offset:12288
v_mfma_f32_32x32x16_bf16 v[80:95], a[96:99], a[116:119], v[80:95]
buffer_load_dwordx4 v8, s[36:39], s66 offen offset:2048 lds
ds_read_b64_tr_b16 a[80:81], v22 offset:0
v_mfma_f32_32x32x16_bf16 v[144:159], a[100:103], a[116:119], v[144:159]
ds_read_b64_tr_b16 a[82:83], v22 offset:1024
v_mfma_f32_32x32x16_bf16 v[208:223], a[104:107], a[116:119], v[208:223]
buffer_load_dwordx4 v9, s[36:39], s66 offen offset:3072 lds
ds_read_b64_tr_b16 a[84:85], v23 offset:0
v_mfma_f32_32x32x16_bf16 a[16:31], a[108:111], a[116:119], a[16:31]
ds_read_b64_tr_b16 a[86:87], v23 offset:1024
v_mfma_f32_32x32x16_bf16 v[96:111], a[96:99], a[120:123], v[96:111]
s_add_u32 m0, s84, 49152
s_add_u32 s66, s85, 524288
buffer_load_dwordx4 v6, s[36:39], s66 offen offset:0 lds
ds_read_b64_tr_b16 a[88:89], v24 offset:0
v_mfma_f32_32x32x16_bf16 v[160:175], a[100:103], a[120:123], v[160:175]
ds_read_b64_tr_b16 a[90:91], v24 offset:1024
buffer_load_dwordx4 v7, s[36:39], s66 offen offset:1024 lds
v_mfma_f32_32x32x16_bf16 v[224:239], a[104:107], a[120:123], v[224:239]
ds_read_b64_tr_b16 a[92:93], v25 offset:0
v_mfma_f32_32x32x16_bf16 a[32:47], a[108:111], a[120:123], a[32:47]
buffer_load_dwordx4 v8, s[36:39], s66 offen offset:2048 lds
v_mfma_f32_32x32x16_bf16 v[112:127], a[96:99], a[124:127], v[112:127]
ds_read_b64_tr_b16 a[94:95], v25 offset:1024
v_mfma_f32_32x32x16_bf16 v[176:191], a[100:103], a[124:127], v[176:191]
buffer_load_dwordx4 v9, s[36:39], s66 offen offset:3072 lds
v_mfma_f32_32x32x16_bf16 v[240:255], a[104:107], a[124:127], v[240:255]
v_mfma_f32_32x32x16_bf16 a[48:63], a[108:111], a[124:127], a[48:63]
s_waitcnt lgkmcnt(6)
v_mfma_f32_32x32x16_bf16 v[64:79], a[64:67], a[80:83], v[64:79]
ds_read_b128 a[96:99], v15 offset:0
s_add_u32 s86, s72, 0
s_add_u32 s88, s73, 0
buffer_load_dwordx4 a[128:131], v26, s[40:43], s86 offen offset:0 sc1
v_mfma_f32_32x32x16_bf16 v[128:143], a[68:71], a[80:83], v[128:143]
ds_read_b128 a[100:103], v15 offset:4096
v_mfma_f32_32x32x16_bf16 v[192:207], a[72:75], a[80:83], v[192:207]
buffer_load_dwordx4 a[132:135], v26, s[40:43], s88 offen offset:0 sc1
ds_read_b128 a[104:107], v15 offset:8192
v_mfma_f32_32x32x16_bf16 a[0:15], a[76:79], a[80:83], a[0:15]
ds_read_b128 a[108:111], v15 offset:12288
buffer_load_dwordx4 a[136:139], v26, s[40:43], s86 offen offset:1024 sc1
s_waitcnt lgkmcnt(8)
v_mfma_f32_32x32x16_bf16 v[80:95], a[64:67], a[84:87], v[80:95]
ds_read_b64_tr_b16 a[112:113], v22 offset:4096
v_mfma_f32_32x32x16_bf16 v[144:159], a[68:71], a[84:87], v[144:159]
buffer_load_dwordx4 a[140:143], v26, s[40:43], s88 offen offset:1024 sc1
ds_read_b64_tr_b16 a[114:115], v22 offset:5120
v_mfma_f32_32x32x16_bf16 v[208:223], a[72:75], a[84:87], v[208:223]
buffer_load_dwordx4 a[144:147], v26, s[40:43], s86 offen offset:2048 sc1
ds_read_b64_tr_b16 a[116:117], v23 offset:4096
v_mfma_f32_32x32x16_bf16 a[16:31], a[76:79], a[84:87], a[16:31]
ds_read_b64_tr_b16 a[118:119], v23 offset:5120
s_waitcnt lgkmcnt(10)
v_mfma_f32_32x32x16_bf16 v[96:111], a[64:67], a[88:91], v[96:111]
buffer_load_dwordx4 a[148:151], v26, s[40:43], s88 offen offset:2048 sc1
ds_read_b64_tr_b16 a[120:121], v24 offset:4096
v_mfma_f32_32x32x16_bf16 v[160:175], a[68:71], a[88:91], v[160:175]
buffer_load_dwordx4 a[152:155], v26, s[40:43], s86 offen offset:3072 sc1
ds_read_b64_tr_b16 a[122:123], v24 offset:5120
v_mfma_f32_32x32x16_bf16 v[224:239], a[72:75], a[88:91], v[224:239]
ds_read_b64_tr_b16 a[124:125], v25 offset:4096
v_mfma_f32_32x32x16_bf16 a[32:47], a[76:79], a[88:91], a[32:47]
buffer_load_dwordx4 a[156:159], v26, s[40:43], s88 offen offset:3072 sc1
s_waitcnt lgkmcnt(11)
v_mfma_f32_32x32x16_bf16 v[112:127], a[64:67], a[92:95], v[112:127]
ds_read_b64_tr_b16 a[126:127], v25 offset:5120
s_add_u32 s87, s72, 4096
s_add_u32 s89, s73, 4096
buffer_load_dwordx4 a[160:163], v26, s[40:43], s87 offen offset:0 sc1
v_mfma_f32_32x32x16_bf16 v[176:191], a[68:71], a[92:95], v[176:191]
v_mfma_f32_32x32x16_bf16 v[240:255], a[72:75], a[92:95], v[240:255]
buffer_load_dwordx4 a[164:167], v26, s[40:43], s89 offen offset:0 sc1
v_mfma_f32_32x32x16_bf16 a[48:63], a[76:79], a[92:95], a[48:63]
s_waitcnt lgkmcnt(6)
v_mfma_f32_32x32x16_bf16 v[64:79], a[96:99], a[112:115], v[64:79]
ds_read_b128 a[64:67], v16 offset:0
buffer_load_dwordx4 a[168:171], v26, s[40:43], s87 offen offset:1024 sc1
v_mfma_f32_32x32x16_bf16 v[128:143], a[100:103], a[112:115], v[128:143]
ds_read_b128 a[68:71], v16 offset:4096
v_mfma_f32_32x32x16_bf16 v[192:207], a[104:107], a[112:115], v[192:207]
buffer_load_dwordx4 a[172:175], v26, s[40:43], s89 offen offset:1024 sc1
ds_read_b128 a[72:75], v16 offset:8192
v_mfma_f32_32x32x16_bf16 a[0:15], a[108:111], a[112:115], a[0:15]
ds_read_b128 a[76:79], v16 offset:12288
buffer_load_dwordx4 a[176:179], v26, s[40:43], s87 offen offset:2048 sc1
s_waitcnt lgkmcnt(8)
v_mfma_f32_32x32x16_bf16 v[80:95], a[96:99], a[116:119], v[80:95]
ds_read_b64_tr_b16 a[80:81], v22 offset:8192
v_mfma_f32_32x32x16_bf16 v[144:159], a[100:103], a[116:119], v[144:159]
buffer_load_dwordx4 a[180:183], v26, s[40:43], s89 offen offset:2048 sc1
ds_read_b64_tr_b16 a[82:83], v22 offset:9216
v_mfma_f32_32x32x16_bf16 v[208:223], a[104:107], a[116:119], v[208:223]
buffer_load_dwordx4 a[184:187], v26, s[40:43], s87 offen offset:3072 sc1
ds_read_b64_tr_b16 a[84:85], v23 offset:8192
v_mfma_f32_32x32x16_bf16 a[16:31], a[108:111], a[116:119], a[16:31]
ds_read_b64_tr_b16 a[86:87], v23 offset:9216
s_waitcnt lgkmcnt(10)
v_mfma_f32_32x32x16_bf16 v[96:111], a[96:99], a[120:123], v[96:111]
buffer_load_dwordx4 a[188:191], v26, s[40:43], s89 offen offset:3072 sc1
ds_read_b64_tr_b16 a[88:89], v24 offset:8192
v_mfma_f32_32x32x16_bf16 v[160:175], a[100:103], a[120:123], v[160:175]
s_add_u32 s86, s72, 8192
s_add_u32 s88, s73, 8192
buffer_load_dwordx4 a[192:195], v26, s[40:43], s86 offen offset:0 sc1
ds_read_b64_tr_b16 a[90:91], v24 offset:9216
v_mfma_f32_32x32x16_bf16 v[224:239], a[104:107], a[120:123], v[224:239]
ds_read_b64_tr_b16 a[92:93], v25 offset:8192
v_mfma_f32_32x32x16_bf16 a[32:47], a[108:111], a[120:123], a[32:47]
buffer_load_dwordx4 a[196:199], v26, s[40:43], s88 offen offset:0 sc1
s_waitcnt lgkmcnt(11)
v_mfma_f32_32x32x16_bf16 v[112:127], a[96:99], a[124:127], v[112:127]
ds_read_b64_tr_b16 a[94:95], v25 offset:9216
buffer_load_dwordx4 a[200:203], v26, s[40:43], s86 offen offset:1024 sc1
v_mfma_f32_32x32x16_bf16 v[176:191], a[100:103], a[124:127], v[176:191]
v_mfma_f32_32x32x16_bf16 v[240:255], a[104:107], a[124:127], v[240:255]
buffer_load_dwordx4 a[204:207], v26, s[40:43], s88 offen offset:1024 sc1
v_mfma_f32_32x32x16_bf16 a[48:63], a[108:111], a[124:127], a[48:63]
s_waitcnt lgkmcnt(6)
v_mfma_f32_32x32x16_bf16 v[64:79], a[64:67], a[80:83], v[64:79]
ds_read_b128 a[96:99], v17 offset:0
buffer_load_dwordx4 a[208:211], v26, s[40:43], s86 offen offset:2048 sc1
v_mfma_f32_32x32x16_bf16 v[128:143], a[68:71], a[80:83], v[128:143]
ds_read_b128 a[100:103], v17 offset:4096
v_mfma_f32_32x32x16_bf16 v[192:207], a[72:75], a[80:83], v[192:207]
buffer_load_dwordx4 a[212:215], v26, s[40:43], s88 offen offset:2048 sc1
ds_read_b128 a[104:107], v17 offset:8192
v_mfma_f32_32x32x16_bf16 a[0:15], a[76:79], a[80:83], a[0:15]
ds_read_b128 a[108:111], v17 offset:12288
buffer_load_dwordx4 a[216:219], v26, s[40:43], s86 offen offset:3072 sc1
s_waitcnt lgkmcnt(8)
v_mfma_f32_32x32x16_bf16 v[80:95], a[64:67], a[84:87], v[80:95]
ds_read_b64_tr_b16 a[112:113], v22 offset:12288
v_mfma_f32_32x32x16_bf16 v[144:159], a[68:71], a[84:87], v[144:159]
buffer_load_dwordx4 a[220:223], v26, s[40:43], s88 offen offset:3072 sc1
ds_read_b64_tr_b16 a[114:115], v22 offset:13312
v_mfma_f32_32x32x16_bf16 v[208:223], a[72:75], a[84:87], v[208:223]
s_add_u32 s87, s72, 12288
s_add_u32 s89, s73, 12288
buffer_load_dwordx4 a[224:227], v26, s[40:43], s87 offen offset:0 sc1
ds_read_b64_tr_b16 a[116:117], v23 offset:12288
v_mfma_f32_32x32x16_bf16 a[16:31], a[76:79], a[84:87], a[16:31]
ds_read_b64_tr_b16 a[118:119], v23 offset:13312
s_waitcnt lgkmcnt(10)
v_mfma_f32_32x32x16_bf16 v[96:111], a[64:67], a[88:91], v[96:111]
buffer_load_dwordx4 a[228:231], v26, s[40:43], s89 offen offset:0 sc1
ds_read_b64_tr_b16 a[120:121], v24 offset:12288
v_mfma_f32_32x32x16_bf16 v[160:175], a[68:71], a[88:91], v[160:175]
buffer_load_dwordx4 a[232:235], v26, s[40:43], s87 offen offset:1024 sc1
ds_read_b64_tr_b16 a[122:123], v24 offset:13312
v_mfma_f32_32x32x16_bf16 v[224:239], a[72:75], a[88:91], v[224:239]
ds_read_b64_tr_b16 a[124:125], v25 offset:12288
v_mfma_f32_32x32x16_bf16 a[32:47], a[76:79], a[88:91], a[32:47]
buffer_load_dwordx4 a[236:239], v26, s[40:43], s89 offen offset:1024 sc1
s_waitcnt lgkmcnt(11)
v_mfma_f32_32x32x16_bf16 v[112:127], a[64:67], a[92:95], v[112:127]
ds_read_b64_tr_b16 a[126:127], v25 offset:13312
buffer_load_dwordx4 a[240:243], v26, s[40:43], s87 offen offset:2048 sc1
v_mfma_f32_32x32x16_bf16 v[176:191], a[68:71], a[92:95], v[176:191]
v_mfma_f32_32x32x16_bf16 v[240:255], a[72:75], a[92:95], v[240:255]
buffer_load_dwordx4 a[244:247], v26, s[40:43], s89 offen offset:2048 sc1
v_mfma_f32_32x32x16_bf16 a[48:63], a[76:79], a[92:95], a[48:63]
s_waitcnt lgkmcnt(0)
s_barrier
v_mfma_f32_32x32x16_bf16 v[64:79], a[96:99], a[112:115], v[64:79]
s_add_u32 m0, s84, 0
s_add_u32 s66, s85, 1048576
buffer_load_dwordx4 v6, s[36:39], s66 offen offset:0 lds
v_mfma_f32_32x32x16_bf16 v[128:143], a[100:103], a[112:115], v[128:143]
v_mfma_f32_32x32x16_bf16 v[192:207], a[104:107], a[112:115], v[192:207]
buffer_load_dwordx4 v7, s[36:39], s66 offen offset:1024 lds
v_mfma_f32_32x32x16_bf16 a[0:15], a[108:111], a[112:115], a[0:15]
v_mfma_f32_32x32x16_bf16 v[80:95], a[96:99], a[116:119], v[80:95]
buffer_load_dwordx4 v8, s[36:39], s66 offen offset:2048 lds
v_mfma_f32_32x32x16_bf16 v[144:159], a[100:103], a[116:119], v[144:159]
v_mfma_f32_32x32x16_bf16 v[208:223], a[104:107], a[116:119], v[208:223]
buffer_load_dwordx4 v9, s[36:39], s66 offen offset:3072 lds
v_mfma_f32_32x32x16_bf16 a[16:31], a[108:111], a[116:119], a[16:31]
v_mfma_f32_32x32x16_bf16 v[96:111], a[96:99], a[120:123], v[96:111]
s_add_u32 m0, s84, 16384
s_add_u32 s66, s85, 1572864
buffer_load_dwordx4 v6, s[36:39], s66 offen offset:0 lds
v_mfma_f32_32x32x16_bf16 v[160:175], a[100:103], a[120:123], v[160:175]
buffer_load_dwordx4 v7, s[36:39], s66 offen offset:1024 lds
v_mfma_f32_32x32x16_bf16 v[224:239], a[104:107], a[120:123], v[224:239]
v_mfma_f32_32x32x16_bf16 a[32:47], a[108:111], a[120:123], a[32:47]
buffer_load_dwordx4 v8, s[36:39], s66 offen offset:2048 lds
v_mfma_f32_32x32x16_bf16 v[112:127], a[96:99], a[124:127], v[112:127]
v_mfma_f32_32x32x16_bf16 v[176:191], a[100:103], a[124:127], v[176:191]
buffer_load_dwordx4 v9, s[36:39], s66 offen offset:3072 lds
v_mfma_f32_32x32x16_bf16 v[240:255], a[104:107], a[124:127], v[240:255]
v_mfma_f32_32x32x16_bf16 a[48:63], a[108:111], a[124:127], a[48:63]
s_nop 15
v_cvt_pk_bf16_f32 v32, v64, v65
v_cvt_pk_bf16_f32 v33, v66, v67
v_cvt_pk_bf16_f32 v34, v68, v69
v_cvt_pk_bf16_f32 v35, v70, v71
v_cvt_pk_bf16_f32 v48, v72, v73
v_cvt_pk_bf16_f32 v49, v74, v75
v_cvt_pk_bf16_f32 v50, v76, v77
v_cvt_pk_bf16_f32 v51, v78, v79
v_cvt_pk_bf16_f32 v36, v80, v81
v_cvt_pk_bf16_f32 v37, v82, v83
v_cvt_pk_bf16_f32 v38, v84, v85
v_cvt_pk_bf16_f32 v39, v86, v87
v_cvt_pk_bf16_f32 v52, v88, v89
v_cvt_pk_bf16_f32 v53, v90, v91
v_cvt_pk_bf16_f32 v54, v92, v93
v_cvt_pk_bf16_f32 v55, v94, v95
v_cvt_pk_bf16_f32 v40, v96, v97
v_cvt_pk_bf16_f32 v41, v98, v99
v_cvt_pk_bf16_f32 v42, v100, v101
v_cvt_pk_bf16_f32 v43, v102, v103
v_cvt_pk_bf16_f32 v56, v104, v105
v_cvt_pk_bf16_f32 v57, v106, v107
v_cvt_pk_bf16_f32 v58, v108, v109
v_cvt_pk_bf16_f32 v59, v110, v111
v_cvt_pk_bf16_f32 v44, v112, v113
v_cvt_pk_bf16_f32 v45, v114, v115
v_cvt_pk_bf16_f32 v46, v116, v117
v_cvt_pk_bf16_f32 v47, v118, v119
v_cvt_pk_bf16_f32 v60, v120, v121
v_cvt_pk_bf16_f32 v61, v122, v123
v_cvt_pk_bf16_f32 v62, v124, v125
v_cvt_pk_bf16_f32 v63, v126, v127
v_cvt_pk_bf16_f32 v64, v128, v129
v_cvt_pk_bf16_f32 v65, v130, v131
v_cvt_pk_bf16_f32 v66, v132, v133
v_cvt_pk_bf16_f32 v67, v134, v135
v_cvt_pk_bf16_f32 v80, v136, v137
v_cvt_pk_bf16_f32 v81, v138, v139
v_cvt_pk_bf16_f32 v82, v140, v141
v_cvt_pk_bf16_f32 v83, v142, v143
v_cvt_pk_bf16_f32 v68, v144, v145
v_cvt_pk_bf16_f32 v69, v146, v147
v_cvt_pk_bf16_f32 v70, v148, v149
v_cvt_pk_bf16_f32 v71, v150, v151
v_cvt_pk_bf16_f32 v84, v152, v153
v_cvt_pk_bf16_f32 v85, v154, v155
v_cvt_pk_bf16_f32 v86, v156, v157
v_cvt_pk_bf16_f32 v87, v158, v159
v_cvt_pk_bf16_f32 v72, v160, v161
v_cvt_pk_bf16_f32 v73, v162, v163
v_cvt_pk_bf16_f32 v74, v164, v165
v_cvt_pk_bf16_f32 v75, v166, v167
v_cvt_pk_bf16_f32 v88, v168, v169
v_cvt_pk_bf16_f32 v89, v170, v171
v_cvt_pk_bf16_f32 v90, v172, v173
v_cvt_pk_bf16_f32 v91, v174, v175
v_cvt_pk_bf16_f32 v76, v176, v177
v_cvt_pk_bf16_f32 v77, v178, v179
v_cvt_pk_bf16_f32 v78, v180, v181
v_cvt_pk_bf16_f32 v79, v182, v183
v_cvt_pk_bf16_f32 v92, v184, v185
v_cvt_pk_bf16_f32 v93, v186, v187
v_cvt_pk_bf16_f32 v94, v188, v189
v_cvt_pk_bf16_f32 v95, v190, v191
v_cvt_pk_bf16_f32 v96, v192, v193
v_cvt_pk_bf16_f32 v97, v194, v195
v_cvt_pk_bf16_f32 v98, v196, v197
v_cvt_pk_bf16_f32 v99, v198, v199
v_cvt_pk_bf16_f32 v112, v200, v201
v_cvt_pk_bf16_f32 v113, v202, v203
v_cvt_pk_bf16_f32 v114, v204, v205
v_cvt_pk_bf16_f32 v115, v206, v207
v_cvt_pk_bf16_f32 v100, v208, v209
v_cvt_pk_bf16_f32 v101, v210, v211
v_cvt_pk_bf16_f32 v102, v212, v213
v_cvt_pk_bf16_f32 v103, v214, v215
v_cvt_pk_bf16_f32 v116, v216, v217
v_cvt_pk_bf16_f32 v117, v218, v219
v_cvt_pk_bf16_f32 v118, v220, v221
v_cvt_pk_bf16_f32 v119, v222, v223
v_cvt_pk_bf16_f32 v104, v224, v225
v_cvt_pk_bf16_f32 v105, v226, v227
v_cvt_pk_bf16_f32 v106, v228, v229
v_cvt_pk_bf16_f32 v107, v230, v231
v_cvt_pk_bf16_f32 v120, v232, v233
v_cvt_pk_bf16_f32 v121, v234, v235
v_cvt_pk_bf16_f32 v122, v236, v237
v_cvt_pk_bf16_f32 v123, v238, v239
v_cvt_pk_bf16_f32 v108, v240, v241
v_cvt_pk_bf16_f32 v109, v242, v243
v_cvt_pk_bf16_f32 v110, v244, v245
v_cvt_pk_bf16_f32 v111, v246, v247
v_cvt_pk_bf16_f32 v124, v248, v249
v_cvt_pk_bf16_f32 v125, v250, v251
v_cvt_pk_bf16_f32 v126, v252, v253
v_cvt_pk_bf16_f32 v127, v254, v255
v_accvgpr_read_b32 v128, a0
v_accvgpr_read_b32 v129, a1
v_accvgpr_read_b32 v130, a2
v_accvgpr_read_b32 v131, a3
v_accvgpr_read_b32 v132, a4
v_accvgpr_read_b32 v133, a5
v_accvgpr_read_b32 v134, a6
v_accvgpr_read_b32 v135, a7
v_cvt_pk_bf16_f32 v144, v128, v129
v_cvt_pk_bf16_f32 v145, v130, v131
v_cvt_pk_bf16_f32 v146, v132, v133
v_cvt_pk_bf16_f32 v147, v134, v135
v_accvgpr_write_b32 a96, v144
v_accvgpr_write_b32 a97, v145
v_accvgpr_write_b32 a98, v146
v_accvgpr_write_b32 a99, v147
v_accvgpr_read_b32 v136, a8
v_accvgpr_read_b32 v137, a9
v_accvgpr_read_b32 v138, a10
v_accvgpr_read_b32 v139, a11
v_accvgpr_read_b32 v140, a12
v_accvgpr_read_b32 v141, a13
v_accvgpr_read_b32 v142, a14
v_accvgpr_read_b32 v143, a15
v_cvt_pk_bf16_f32 v148, v136, v137
v_cvt_pk_bf16_f32 v149, v138, v139
v_cvt_pk_bf16_f32 v150, v140, v141
v_cvt_pk_bf16_f32 v151, v142, v143
v_accvgpr_write_b32 a112, v148
v_accvgpr_write_b32 a113, v149
v_accvgpr_write_b32 a114, v150
v_accvgpr_write_b32 a115, v151
v_accvgpr_read_b32 v128, a16
v_accvgpr_read_b32 v129, a17
v_accvgpr_read_b32 v130, a18
v_accvgpr_read_b32 v131, a19
v_accvgpr_read_b32 v132, a20
v_accvgpr_read_b32 v133, a21
v_accvgpr_read_b32 v134, a22
v_accvgpr_read_b32 v135, a23
v_cvt_pk_bf16_f32 v144, v128, v129
v_cvt_pk_bf16_f32 v145, v130, v131
v_cvt_pk_bf16_f32 v146, v132, v133
v_cvt_pk_bf16_f32 v147, v134, v135
v_accvgpr_write_b32 a100, v144
v_accvgpr_write_b32 a101, v145
v_accvgpr_write_b32 a102, v146
v_accvgpr_write_b32 a103, v147
v_accvgpr_read_b32 v136, a24
v_accvgpr_read_b32 v137, a25
v_accvgpr_read_b32 v138, a26
v_accvgpr_read_b32 v139, a27
v_accvgpr_read_b32 v140, a28
v_accvgpr_read_b32 v141, a29
v_accvgpr_read_b32 v142, a30
v_accvgpr_read_b32 v143, a31
v_cvt_pk_bf16_f32 v148, v136, v137
v_cvt_pk_bf16_f32 v149, v138, v139
v_cvt_pk_bf16_f32 v150, v140, v141
v_cvt_pk_bf16_f32 v151, v142, v143
v_accvgpr_write_b32 a116, v148
v_accvgpr_write_b32 a117, v149
v_accvgpr_write_b32 a118, v150
v_accvgpr_write_b32 a119, v151
v_accvgpr_read_b32 v128, a32
v_accvgpr_read_b32 v129, a33
v_accvgpr_read_b32 v130, a34
v_accvgpr_read_b32 v131, a35
v_accvgpr_read_b32 v132, a36
v_accvgpr_read_b32 v133, a37
v_accvgpr_read_b32 v134, a38
v_accvgpr_read_b32 v135, a39
v_cvt_pk_bf16_f32 v144, v128, v129
v_cvt_pk_bf16_f32 v145, v130, v131
v_cvt_pk_bf16_f32 v146, v132, v133
v_cvt_pk_bf16_f32 v147, v134, v135
v_accvgpr_write_b32 a104, v144
v_accvgpr_write_b32 a105, v145
v_accvgpr_write_b32 a106, v146
v_accvgpr_write_b32 a107, v147
v_accvgpr_read_b32 v136, a40
v_accvgpr_read_b32 v137, a41
v_accvgpr_read_b32 v138, a42
v_accvgpr_read_b32 v139, a43
v_accvgpr_read_b32 v140, a44
v_accvgpr_read_b32 v141, a45
v_accvgpr_read_b32 v142, a46
v_accvgpr_read_b32 v143, a47
v_cvt_pk_bf16_f32 v148, v136, v137
v_cvt_pk_bf16_f32 v149, v138, v139
v_cvt_pk_bf16_f32 v150, v140, v141
v_cvt_pk_bf16_f32 v151, v142, v143
v_accvgpr_write_b32 a120, v148
v_accvgpr_write_b32 a121, v149
v_accvgpr_write_b32 a122, v150
v_accvgpr_write_b32 a123, v151
v_accvgpr_read_b32 v128, a48
v_accvgpr_read_b32 v129, a49
v_accvgpr_read_b32 v130, a50
v_accvgpr_read_b32 v131, a51
v_accvgpr_read_b32 v132, a52
v_accvgpr_read_b32 v133, a53
v_accvgpr_read_b32 v134, a54
v_accvgpr_read_b32 v135, a55
v_cvt_pk_bf16_f32 v144, v128, v129
v_cvt_pk_bf16_f32 v145, v130, v131
v_cvt_pk_bf16_f32 v146, v132, v133
v_cvt_pk_bf16_f32 v147, v134, v135
v_accvgpr_write_b32 a108, v144
v_accvgpr_write_b32 a109, v145
v_accvgpr_write_b32 a110, v146
v_accvgpr_write_b32 a111, v147
v_accvgpr_read_b32 v136, a56
v_accvgpr_read_b32 v137, a57
v_accvgpr_read_b32 v138, a58
v_accvgpr_read_b32 v139, a59
v_accvgpr_read_b32 v140, a60
v_accvgpr_read_b32 v141, a61
v_accvgpr_read_b32 v142, a62
v_accvgpr_read_b32 v143, a63
v_cvt_pk_bf16_f32 v148, v136, v137
v_cvt_pk_bf16_f32 v149, v138, v139
v_cvt_pk_bf16_f32 v150, v140, v141
v_cvt_pk_bf16_f32 v151, v142, v143
v_accvgpr_write_b32 a124, v148
v_accvgpr_write_b32 a125, v149
v_accvgpr_write_b32 a126, v150
v_accvgpr_write_b32 a127, v151
s_mov_b32 s4, s48
s_mov_b32 s5, s49
s_mov_b32 s6, s50
s_mov_b32 s7, 0x20000
s_lshl_b32 s67, s21, 16
s_and_b32 s68, s22, 1
s_lshl_b32 s68, s68, 15
s_add_u32 s67, s67, s68
LA_p1done:
LA_p2:
v_lshrrev_b32 v28, 2, v1
v_and_b32 v28, 3, v28
v_lshrrev_b32 v27, 5, v1
v_lshlrev_b32 v27, 3, v27
v_add_u32 v27, v27, v28
v_lshlrev_b32 v27, 8, v27
v_lshrrev_b32 v29, 4, v1
v_and_b32 v29, 1, v29
v_lshlrev_b32 v29, 5, v29
v_add_u32 v27, v27, v29
v_and_b32 v29, 3, v1
v_lshlrev_b32 v29, 3, v29
v_add_u32 v27, v27, v29
v_add_u32 v27, 98304, v27
v_xor_b32 v29, 0, v28
v_lshlrev_b32 v29, 6, v29
v_add_u32 v18, v27, v29
v_xor_b32 v29, 1, v28
v_lshlrev_b32 v29, 6, v29
v_add_u32 v19, v27, v29
v_xor_b32 v29, 2, v28
v_lshlrev_b32 v29, 6, v29
v_add_u32 v20, v27, v29
v_xor_b32 v29, 3, v28
v_lshlrev_b32 v29, 6, v29
v_add_u32 v21, v27, v29
s_barrier
ds_read_b64_tr_b16 a[64:65], v18 offset:32768
ds_read_b64_tr_b16 a[66:67], v18 offset:33792
ds_read_b64_tr_b16 a[68:69], v19 offset:32768
ds_read_b64_tr_b16 a[70:71], v19 offset:33792
ds_read_b64_tr_b16 a[72:73], v20 offset:32768
ds_read_b64_tr_b16 a[74:75], v20 offset:33792
ds_read_b64_tr_b16 a[76:77], v21 offset:32768
ds_read_b64_tr_b16 a[78:79], v21 offset:33792
s_waitcnt vmcnt(37) lgkmcnt(6)
v_mfma_f32_32x32x16_bf16 v[128:143], a[64:67], a[128:131], 0
ds_read_b64_tr_b16 a[80:81], v18 offset:36864
ds_read_b64_tr_b16 a[82:83], v18 offset:37888
s_waitcnt vmcnt(36)
v_mfma_f32_32x32x16_bf16 v[144:159], a[64:67], a[132:135], 0
ds_read_b64_tr_b16 a[84:85], v19 offset:36864
s_waitcnt lgkmcnt(7)
v_mfma_f32_32x32x16_bf16 v[160:175], a[68:71], a[128:131], 0
buffer_load_dwordx4 a[248:251], v26, s[40:43], s87 offen offset:3072 sc1
ds_read_b64_tr_b16 a[86:87], v19 offset:37888
v_mfma_f32_32x32x16_bf16 v[176:191], a[68:71], a[132:135], 0
ds_read_b64_tr_b16 a[88:89], v20 offset:36864
s_waitcnt lgkmcnt(7)
v_mfma_f32_32x32x16_bf16 v[192:207], a[72:75], a[128:131], 0
ds_read_b64_tr_b16 a[90:91], v20 offset:37888
ds_read_b64_tr_b16 a[92:93], v21 offset:36864
v_mfma_f32_32x32x16_bf16 v[208:223], a[72:75], a[132:135], 0
buffer_load_dwordx4 a[252:255], v26, s[40:43], s89 offen offset:3072 sc1
ds_read_b64_tr_b16 a[94:95], v21 offset:37888
s_waitcnt lgkmcnt(8)
v_mfma_f32_32x32x16_bf16 v[224:239], a[76:79], a[128:131], 0
s_cmp_lt_u32 s21, 2
s_cbranch_scc1 Lpf_10
s_add_u32 s69, s67, 0
buffer_store_dwordx4 v[32:35], v26, s[4:7], s69 offen offset:0
s_branch Lpn_9
Lpf_10:
s_add_u32 s69, s67, 0
buffer_store_dwordx4 v[32:35], v26, s[4:7], s69 offen offset:0
buffer_store_dwordx4 v[36:39], v26, s[4:7], s69 offen offset:1024
Lpn_9:
v_mfma_f32_32x32x16_bf16 v[240:255], a[76:79], a[132:135], 0
s_waitcnt vmcnt(37) lgkmcnt(6)
v_mfma_f32_32x32x16_bf16 v[128:143], a[80:83], a[136:139], v[128:143]
ds_read_b64_tr_b16 a[64:65], v18 offset:40960
ds_read_b64_tr_b16 a[66:67], v18 offset:41984
s_waitcnt vmcnt(36)
v_mfma_f32_32x32x16_bf16 v[144:159], a[80:83], a[140:143], v[144:159]
ds_read_b64_tr_b16 a[68:69], v19 offset:40960
s_waitcnt lgkmcnt(7)
v_mfma_f32_32x32x16_bf16 v[160:175], a[84:87], a[136:139], v[160:175]
s_add_u32 s86, s72, 16384
s_add_u32 s88, s73, 16384
buffer_load_dwordx4 a[128:131], v26, s[40:43], s86 offen offset:0 sc1
ds_read_b64_tr_b16 a[70:71], v19 offset:41984
v_mfma_f32_32x32x16_bf16 v[176:191], a[84:87], a[140:143], v[176:191]
ds_read_b64_tr_b16 a[72:73], v20 offset:40960
s_waitcnt lgkmcnt(7)
v_mfma_f32_32x32x16_bf16 v[192:207], a[88:91], a[136:139], v[192:207]
ds_read_b64_tr_b16 a[74:75], v20 offset:41984
ds_read_b64_tr_b16 a[76:77], v21 offset:40960
v_mfma_f32_32x32x16_bf16 v[208:223], a[88:91], a[140:143], v[208:223]
buffer_load_dwordx4 a[132:135], v26, s[40:43], s88 offen offset:0 sc1
ds_read_b64_tr_b16 a[78:79], v21 offset:41984
s_waitcnt lgkmcnt(8)
v_mfma_f32_32x32x16_bf16 v[224:239], a[92:95], a[136:139], v[224:239]
s_cmp_lt_u32 s21, 2
s_cbranch_scc1 Lpf_12
buffer_store_dwordx4 v[36:39], v26, s[4:7], s69 offen offset:1024
s_branch Lpn_11
Lpf_12:
buffer_store_dwordx4 v[40:43], v26, s[4:7], s69 offen offset:2048
buffer_store_dwordx4 v[44:47], v26, s[4:7], s69 offen offset:3072
Lpn_11:
v_mfma_f32_32x32x16_bf16 v[240:255], a[92:95], a[140:143], v[240:255]
s_waitcnt vmcnt(37) lgkmcnt(6)
v_mfma_f32_32x32x16_bf16 v[128:143], a[64:67], a[144:147], v[128:143]
ds_read_b64_tr_b16 a[80:81], v18 offset:45056
ds_read_b64_tr_b16 a[82:83], v18 offset:46080
s_waitcnt vmcnt(36)
v_mfma_f32_32x32x16_bf16 v[144:159], a[64:67], a[148:151], v[144:159]
ds_read_b64_tr_b16 a[84:85], v19 offset:45056
s_waitcnt lgkmcnt(7)
v_mfma_f32_32x32x16_bf16 v[160:175], a[68:71], a[144:147], v[160:175]
buffer_load_dwordx4 a[136:139], v26, s[40:43], s86 offen offset:1024 sc1
ds_read_b64_tr_b16 a[86:87], v19 offset:46080
v_mfma_f32_32x32x16_bf16 v[176:191], a[68:71], a[148:151], v[176:191]
ds_read_b64_tr_b16 a[88:89], v20 offset:45056
s_waitcnt lgkmcnt(7)
v_mfma_f32_32x32x16_bf16 v[192:207], a[72:75], a[144:147], v[192:207]
ds_read_b64_tr_b16 a[90:91], v20 offset:46080
ds_read_b64_tr_b16 a[92:93], v21 offset:45056
v_mfma_f32_32x32x16_bf16 v[208:223], a[72:75], a[148:151], v[208:223]
buffer_load_dwordx4 a[140:143], v26, s[40:43], s88 offen offset:1024 sc1
ds_read_b64_tr_b16 a[94:95], v21 offset:46080
s_waitcnt lgkmcnt(8)
v_mfma_f32_32x32x16_bf16 v[224:239], a[76:79], a[144:147], v[224:239]
s_cmp_lt_u32 s21, 2
s_cbranch_scc1 Lpf_14
buffer_store_dwordx4 v[40:43], v26, s[4:7], s69 offen offset:2048
s_branch Lpn_13
Lpf_14:
s_add_u32 s69, s67, 4096
buffer_store_dwordx4 v[48:51], v26, s[4:7], s69 offen offset:0
buffer_store_dwordx4 v[52:55], v26, s[4:7], s69 offen offset:1024
Lpn_13:
v_mfma_f32_32x32x16_bf16 v[240:255], a[76:79], a[148:151], v[240:255]
s_waitcnt lgkmcnt(0)
s_barrier
s_waitcnt vmcnt(37)
v_mfma_f32_32x32x16_bf16 v[128:143], a[80:83], a[152:155], v[128:143]
ds_read_b64_tr_b16 a[64:65], v18 offset:49152
s_add_u32 m0, s84, 32768
s_add_u32 s66, s85, 2097152
buffer_load_dwordx4 v6, s[36:39], s66 offen offset:0 lds
ds_read_b64_tr_b16 a[66:67], v18 offset:50176
s_waitcnt vmcnt(37)
v_mfma_f32_32x32x16_bf16 v[144:159], a[80:83], a[156:159], v[144:159]
ds_read_b64_tr_b16 a[68:69], v19 offset:49152
v_mfma_f32_32x32x16_bf16 v[160:175], a[84:87], a[152:155], v[160:175]
buffer_load_dwordx4 v7, s[36:39], s66 offen offset:1024 lds
buffer_load_dwordx4 a[144:147], v26, s[40:43], s86 offen offset:2048 sc1
ds_read_b64_tr_b16 a[70:71], v19 offset:50176
v_mfma_f32_32x32x16_bf16 v[176:191], a[84:87], a[156:159], v[176:191]
ds_read_b64_tr_b16 a[72:73], v20 offset:49152
v_mfma_f32_32x32x16_bf16 v[192:207], a[88:91], a[152:155], v[192:207]
ds_read_b64_tr_b16 a[74:75], v20 offset:50176
buffer_load_dwordx4 v8, s[36:39], s66 offen offset:2048 lds
ds_read_b64_tr_b16 a[76:77], v21 offset:49152
v_mfma_f32_32x32x16_bf16 v[208:223], a[88:91], a[156:159], v[208:223]
buffer_load_dwordx4 a[148:151], v26, s[40:43], s88 offen offset:2048 sc1
ds_read_b64_tr_b16 a[78:79], v21 offset:50176
v_mfma_f32_32x32x16_bf16 v[224:239], a[92:95], a[152:155], v[224:239]
buffer_load_dwordx4 v9, s[36:39], s66 offen offset:3072 lds
s_cmp_lt_u32 s21, 2
s_cbranch_scc1 Lpf_16
buffer_store_dwordx4 v[44:47], v26, s[4:7], s69 offen offset:3072
s_branch Lpn_15
Lpf_16:
buffer_store_dwordx4 v[56:59], v26, s[4:7], s69 offen offset:2048
buffer_store_dwordx4 v[60:63], v26, s[4:7], s69 offen offset:3072
Lpn_15:
v_mfma_f32_32x32x16_bf16 v[240:255], a[92:95], a[156:159], v[240:255]
s_waitcnt vmcnt(41) lgkmcnt(6)
v_mfma_f32_32x32x16_bf16 v[128:143], a[64:67], a[160:163], v[128:143]
ds_read_b64_tr_b16 a[80:81], v18 offset:53248
ds_read_b64_tr_b16 a[82:83], v18 offset:54272
s_waitcnt vmcnt(40)
v_mfma_f32_32x32x16_bf16 v[144:159], a[64:67], a[164:167], v[144:159]
ds_read_b64_tr_b16 a[84:85], v19 offset:53248
s_waitcnt lgkmcnt(7)
v_mfma_f32_32x32x16_bf16 v[160:175], a[68:71], a[160:163], v[160:175]
buffer_load_dwordx4 a[152:155], v26, s[40:43], s86 offen offset:3072 sc1
ds_read_b64_tr_b16 a[86:87], v19 offset:54272
v_mfma_f32_32x32x16_bf16 v[176:191], a[68:71], a[164:167], v[176:191]
ds_read_b64_tr_b16 a[88:89], v20 offset:53248
s_waitcnt lgkmcnt(7)
v_mfma_f32_32x32x16_bf16 v[192:207], a[72:75], a[160:163], v[192:207]
ds_read_b64_tr_b16 a[90:91], v20 offset:54272
ds_read_b64_tr_b16 a[92:93], v21 offset:53248
v_mfma_f32_32x32x16_bf16 v[208:223], a[72:75], a[164:167], v[208:223]
buffer_load_dwordx4 a[156:159], v26, s[40:43], s88 offen offset:3072 sc1
ds_read_b64_tr_b16 a[94:95], v21 offset:54272
s_waitcnt lgkmcnt(8)
v_mfma_f32_32x32x16_bf16 v[224:239], a[76:79], a[160:163], v[224:239]
s_cmp_lt_u32 s21, 2
s_cbranch_scc1 Lpf_18
s_add_u32 s69, s67, 4096
buffer_store_dwordx4 v[48:51], v26, s[4:7], s69 offen offset:0
s_branch Lpn_17
Lpf_18:
s_add_u32 s69, s67, 8192
buffer_store_dwordx4 v[64:67], v26, s[4:7], s69 offen offset:0
buffer_store_dwordx4 v[68:71], v26, s[4:7], s69 offen offset:1024
Lpn_17:
v_mfma_f32_32x32x16_bf16 v[240:255], a[76:79], a[164:167], v[240:255]
s_waitcnt vmcnt(41) lgkmcnt(6)
v_mfma_f32_32x32x16_bf16 v[128:143], a[80:83], a[168:171], v[128:143]
ds_read_b64_tr_b16 a[64:65], v18 offset:57344
ds_read_b64_tr_b16 a[66:67], v18 offset:58368
s_waitcnt vmcnt(40)
v_mfma_f32_32x32x16_bf16 v[144:159], a[80:83], a[172:175], v[144:159]
ds_read_b64_tr_b16 a[68:69], v19 offset:57344
s_waitcnt lgkmcnt(7)
v_mfma_f32_32x32x16_bf16 v[160:175], a[84:87], a[168:171], v[160:175]
s_add_u32 s87, s72, 20480
s_add_u32 s89, s73, 20480
buffer_load_dwordx4 a[160:163], v26, s[40:43], s87 offen offset:0 sc1
ds_read_b64_tr_b16 a[70:71], v19 offset:58368
v_mfma_f32_32x32x16_bf16 v[176:191], a[84:87], a[172:175], v[176:191]
ds_read_b64_tr_b16 a[72:73], v20 offset:57344
s_waitcnt lgkmcnt(7)
v_mfma_f32_32x32x16_bf16 v[192:207], a[88:91], a[168:171], v[192:207]
ds_read_b64_tr_b16 a[74:75], v20 offset:58368
ds_read_b64_tr_b16 a[76:77], v21 offset:57344
v_mfma_f32_32x32x16_bf16 v[208:223], a[88:91], a[172:175], v[208:223]
buffer_load_dwordx4 a[164:167], v26, s[40:43], s89 offen offset:0 sc1
ds_read_b64_tr_b16 a[78:79], v21 offset:58368
s_waitcnt lgkmcnt(8)
v_mfma_f32_32x32x16_bf16 v[224:239], a[92:95], a[168:171], v[224:239]
s_cmp_lt_u32 s21, 2
s_cbranch_scc1 Lpf_20
buffer_store_dwordx4 v[52:55], v26, s[4:7], s69 offen offset:1024
s_branch Lpn_19
Lpf_20:
buffer_store_dwordx4 v[72:75], v26, s[4:7], s69 offen offset:2048
buffer_store_dwordx4 v[76:79], v26, s[4:7], s69 offen offset:3072
Lpn_19:
v_mfma_f32_32x32x16_bf16 v[240:255], a[92:95], a[172:175], v[240:255]
s_waitcnt vmcnt(41) lgkmcnt(6)
v_mfma_f32_32x32x16_bf16 v[128:143], a[64:67], a[176:179], v[128:143]
ds_read_b64_tr_b16 a[80:81], v18 offset:61440
ds_read_b64_tr_b16 a[82:83], v18 offset:62464
s_waitcnt vmcnt(40)
v_mfma_f32_32x32x16_bf16 v[144:159], a[64:67], a[180:183], v[144:159]
ds_read_b64_tr_b16 a[84:85], v19 offset:61440
s_waitcnt lgkmcnt(7)
v_mfma_f32_32x32x16_bf16 v[160:175], a[68:71], a[176:179], v[160:175]
buffer_load_dwordx4 a[168:171], v26, s[40:43], s87 offen offset:1024 sc1
ds_read_b64_tr_b16 a[86:87], v19 offset:62464
v_mfma_f32_32x32x16_bf16 v[176:191], a[68:71], a[180:183], v[176:191]
ds_read_b64_tr_b16 a[88:89], v20 offset:61440
s_waitcnt lgkmcnt(7)
v_mfma_f32_32x32x16_bf16 v[192:207], a[72:75], a[176:179], v[192:207]
ds_read_b64_tr_b16 a[90:91], v20 offset:62464
ds_read_b64_tr_b16 a[92:93], v21 offset:61440
v_mfma_f32_32x32x16_bf16 v[208:223], a[72:75], a[180:183], v[208:223]
buffer_load_dwordx4 a[172:175], v26, s[40:43], s89 offen offset:1024 sc1
ds_read_b64_tr_b16 a[94:95], v21 offset:62464
s_waitcnt lgkmcnt(8)
v_mfma_f32_32x32x16_bf16 v[224:239], a[76:79], a[176:179], v[224:239]
s_cmp_lt_u32 s21, 2
s_cbranch_scc1 Lpf_22
buffer_store_dwordx4 v[56:59], v26, s[4:7], s69 offen offset:2048
s_branch Lpn_21
Lpf_22:
s_add_u32 s69, s67, 12288
buffer_store_dwordx4 v[80:83], v26, s[4:7], s69 offen offset:0
buffer_store_dwordx4 v[84:87], v26, s[4:7], s69 offen offset:1024
Lpn_21:
v_mfma_f32_32x32x16_bf16 v[240:255], a[76:79], a[180:183], v[240:255]
s_waitcnt vmcnt(22) lgkmcnt(0)
s_barrier
v_mfma_f32_32x32x16_bf16 v[128:143], a[80:83], a[184:187], v[128:143]
ds_read_b64_tr_b16 a[64:65], v18 offset:0
s_add_u32 m0, s84, 49152
s_add_u32 s66, s85, 2621440
buffer_load_dwordx4 v6, s[36:39], s66 offen offset:0 lds
ds_read_b64_tr_b16 a[66:67], v18 offset:1024
v_mfma_f32_32x32x16_bf16 v[144:159], a[80:83], a[188:191], v[144:159]
ds_read_b64_tr_b16 a[68:69], v19 offset:0
v_mfma_f32_32x32x16_bf16 v[160:175], a[84:87], a[184:187], v[160:175]
buffer_load_dwordx4 v7, s[36:39], s66 offen offset:1024 lds
buffer_load_dwordx4 a[176:179], v26, s[40:43], s87 offen offset:2048 sc1
ds_read_b64_tr_b16 a[70:71], v19 offset:1024
v_mfma_f32_32x32x16_bf16 v[176:191], a[84:87], a[188:191], v[176:191]
ds_read_b64_tr_b16 a[72:73], v20 offset:0
v_mfma_f32_32x32x16_bf16 v[192:207], a[88:91], a[184:187], v[192:207]
ds_read_b64_tr_b16 a[74:75], v20 offset:1024
buffer_load_dwordx4 v8, s[36:39], s66 offen offset:2048 lds
ds_read_b64_tr_b16 a[76:77], v21 offset:0
v_mfma_f32_32x32x16_bf16 v[208:223], a[88:91], a[188:191], v[208:223]
buffer_load_dwordx4 a[180:183], v26, s[40:43], s89 offen offset:2048 sc1
ds_read_b64_tr_b16 a[78:79], v21 offset:1024
v_mfma_f32_32x32x16_bf16 v[224:239], a[92:95], a[184:187], v[224:239]
buffer_load_dwordx4 v9, s[36:39], s66 offen offset:3072 lds
s_cmp_lt_u32 s21, 2
s_cbranch_scc1 Lpf_24
buffer_store_dwordx4 v[60:63], v26, s[4:7], s69 offen offset:3072
s_branch Lpn_23
Lpf_24:
buffer_store_dwordx4 v[88:91], v26, s[4:7], s69 offen offset:2048
buffer_store_dwordx4 v[92:95], v26, s[4:7], s69 offen offset:3072
Lpn_23:
v_mfma_f32_32x32x16_bf16 v[240:255], a[92:95], a[188:191], v[240:255]
s_waitcnt lgkmcnt(6)
v_mfma_f32_32x32x16_bf16 v[128:143], a[64:67], a[192:195], v[128:143]
ds_read_b64_tr_b16 a[80:81], v18 offset:4096
ds_read_b64_tr_b16 a[82:83], v18 offset:5120
v_mfma_f32_32x32x16_bf16 v[144:159], a[64:67], a[196:199], v[144:159]
ds_read_b64_tr_b16 a[84:85], v19 offset:4096
s_waitcnt lgkmcnt(7)
v_mfma_f32_32x32x16_bf16 v[160:175], a[68:71], a[192:195], v[160:175]
buffer_load_dwordx4 a[184:187], v26, s[40:43], s87 offen offset:3072 sc1
ds_read_b64_tr_b16 a[86:87], v19 offset:5120
v_mfma_f32_32x32x16_bf16 v[176:191], a[68:71], a[196:199], v[176:191]
ds_read_b64_tr_b16 a[88:89], v20 offset:4096
s_waitcnt lgkmcnt(7)
v_mfma_f32_32x32x16_bf16 v[192:207], a[72:75], a[192:195], v[192:207]
ds_read_b64_tr_b16 a[90:91], v20 offset:5120
ds_read_b64_tr_b16 a[92:93], v21 offset:4096
v_mfma_f32_32x32x16_bf16 v[208:223], a[72:75], a[196:199], v[208:223]
buffer_load_dwordx4 a[188:191], v26, s[40:43], s89 offen offset:3072 sc1
ds_read_b64_tr_b16 a[94:95], v21 offset:5120
s_waitcnt lgkmcnt(8)
v_mfma_f32_32x32x16_bf16 v[224:239], a[76:79], a[192:195], v[224:239]
s_cmp_lt_u32 s21, 2
s_cbranch_scc1 Lpf_26
s_add_u32 s69, s67, 8192
buffer_store_dwordx4 v[64:67], v26, s[4:7], s69 offen offset:0
s_branch Lpn_25
Lpf_26:
s_add_u32 s69, s67, 16384
buffer_store_dwordx4 v[96:99], v26, s[4:7], s69 offen offset:0
buffer_store_dwordx4 v[100:103], v26, s[4:7], s69 offen offset:1024
Lpn_25:
v_mfma_f32_32x32x16_bf16 v[240:255], a[76:79], a[196:199], v[240:255]
s_waitcnt lgkmcnt(6)
v_mfma_f32_32x32x16_bf16 v[128:143], a[80:83], a[200:203], v[128:143]
ds_read_b64_tr_b16 a[64:65], v18 offset:8192
ds_read_b64_tr_b16 a[66:67], v18 offset:9216
v_mfma_f32_32x32x16_bf16 v[144:159], a[80:83], a[204:207], v[144:159]
ds_read_b64_tr_b16 a[68:69], v19 offset:8192
s_waitcnt lgkmcnt(7)
v_mfma_f32_32x32x16_bf16 v[160:175], a[84:87], a[200:203], v[160:175]
s_add_u32 s86, s72, 24576
s_add_u32 s88, s73, 24576
buffer_load_dwordx4 a[192:195], v26, s[40:43], s86 offen offset:0 sc1
ds_read_b64_tr_b16 a[70:71], v19 offset:9216
v_mfma_f32_32x32x16_bf16 v[176:191], a[84:87], a[204:207], v[176:191]
ds_read_b64_tr_b16 a[72:73], v20 offset:8192
s_waitcnt lgkmcnt(7)
v_mfma_f32_32x32x16_bf16 v[192:207], a[88:91], a[200:203], v[192:207]
ds_read_b64_tr_b16 a[74:75], v20 offset:9216
ds_read_b64_tr_b16 a[76:77], v21 offset:8192
v_mfma_f32_32x32x16_bf16 v[208:223], a[88:91], a[204:207], v[208:223]
buffer_load_dwordx4 a[196:199], v26, s[40:43], s88 offen offset:0 sc1
ds_read_b64_tr_b16 a[78:79], v21 offset:9216
s_waitcnt lgkmcnt(8)
v_mfma_f32_32x32x16_bf16 v[224:239], a[92:95], a[200:203], v[224:239]
s_cmp_lt_u32 s21, 2
s_cbranch_scc1 Lpf_28
buffer_store_dwordx4 v[68:71], v26, s[4:7], s69 offen offset:1024
s_branch Lpn_27
Lpf_28:
buffer_store_dwordx4 v[104:107], v26, s[4:7], s69 offen offset:2048
buffer_store_dwordx4 v[108:111], v26, s[4:7], s69 offen offset:3072
Lpn_27:
v_mfma_f32_32x32x16_bf16 v[240:255], a[92:95], a[204:207], v[240:255]
s_waitcnt lgkmcnt(6)
v_mfma_f32_32x32x16_bf16 v[128:143], a[64:67], a[208:211], v[128:143]
ds_read_b64_tr_b16 a[80:81], v18 offset:12288
ds_read_b64_tr_b16 a[82:83], v18 offset:13312
v_mfma_f32_32x32x16_bf16 v[144:159], a[64:67], a[212:215], v[144:159]
ds_read_b64_tr_b16 a[84:85], v19 offset:12288
s_waitcnt lgkmcnt(7)
v_mfma_f32_32x32x16_bf16 v[160:175], a[68:71], a[208:211], v[160:175]
buffer_load_dwordx4 a[200:203], v26, s[40:43], s86 offen offset:1024 sc1
ds_read_b64_tr_b16 a[86:87], v19 offset:13312
v_mfma_f32_32x32x16_bf16 v[176:191], a[68:71], a[212:215], v[176:191]
ds_read_b64_tr_b16 a[88:89], v20 offset:12288
s_waitcnt lgkmcnt(7)
v_mfma_f32_32x32x16_bf16 v[192:207], a[72:75], a[208:211], v[192:207]
ds_read_b64_tr_b16 a[90:91], v20 offset:13312
ds_read_b64_tr_b16 a[92:93], v21 offset:12288
v_mfma_f32_32x32x16_bf16 v[208:223], a[72:75], a[212:215], v[208:223]
buffer_load_dwordx4 a[204:207], v26, s[40:43], s88 offen offset:1024 sc1
ds_read_b64_tr_b16 a[94:95], v21 offset:13312
s_waitcnt lgkmcnt(8)
v_mfma_f32_32x32x16_bf16 v[224:239], a[76:79], a[208:211], v[224:239]
s_cmp_lt_u32 s21, 2
s_cbranch_scc1 Lpf_30
buffer_store_dwordx4 v[72:75], v26, s[4:7], s69 offen offset:2048
s_branch Lpn_29
Lpf_30:
s_add_u32 s69, s67, 20480
buffer_store_dwordx4 v[112:115], v26, s[4:7], s69 offen offset:0
buffer_store_dwordx4 v[116:119], v26, s[4:7], s69 offen offset:1024
Lpn_29:
v_mfma_f32_32x32x16_bf16 v[240:255], a[76:79], a[212:215], v[240:255]
s_waitcnt vmcnt(30) lgkmcnt(0)
s_barrier
v_mfma_f32_32x32x16_bf16 v[128:143], a[80:83], a[216:219], v[128:143]
ds_read_b64_tr_b16 a[64:65], v18 offset:16384
s_add_u32 m0, s84, 0
s_add_u32 s66, s85, 3145728
buffer_load_dwordx4 v6, s[36:39], s66 offen offset:0 lds
ds_read_b64_tr_b16 a[66:67], v18 offset:17408
v_mfma_f32_32x32x16_bf16 v[144:159], a[80:83], a[220:223], v[144:159]
ds_read_b64_tr_b16 a[68:69], v19 offset:16384
v_mfma_f32_32x32x16_bf16 v[160:175], a[84:87], a[216:219], v[160:175]
buffer_load_dwordx4 v7, s[36:39], s66 offen offset:1024 lds
buffer_load_dwordx4 a[208:211], v26, s[40:43], s86 offen offset:2048 sc1
ds_read_b64_tr_b16 a[70:71], v19 offset:17408
v_mfma_f32_32x32x16_bf16 v[176:191], a[84:87], a[220:223], v[176:191]
ds_read_b64_tr_b16 a[72:73], v20 offset:16384
v_mfma_f32_32x32x16_bf16 v[192:207], a[88:91], a[216:219], v[192:207]
ds_read_b64_tr_b16 a[74:75], v20 offset:17408
buffer_load_dwordx4 v8, s[36:39], s66 offen offset:2048 lds
ds_read_b64_tr_b16 a[76:77], v21 offset:16384
v_mfma_f32_32x32x16_bf16 v[208:223], a[88:91], a[220:223], v[208:223]
buffer_load_dwordx4 a[212:215], v26, s[40:43], s88 offen offset:2048 sc1
ds_read_b64_tr_b16 a[78:79], v21 offset:17408
v_mfma_f32_32x32x16_bf16 v[224:239], a[92:95], a[216:219], v[224:239]
buffer_load_dwordx4 v9, s[36:39], s66 offen offset:3072 lds
s_cmp_lt_u32 s21, 2
s_cbranch_scc1 Lpf_32
buffer_store_dwordx4 v[76:79], v26, s[4:7], s69 offen offset:3072
s_branch Lpn_31
Lpf_32:
buffer_store_dwordx4 v[120:123], v26, s[4:7], s69 offen offset:2048
buffer_store_dwordx4 v[124:127], v26, s[4:7], s69 offen offset:3072
Lpn_31:
v_mfma_f32_32x32x16_bf16 v[240:255], a[92:95], a[220:223], v[240:255]
s_waitcnt lgkmcnt(6)
v_mfma_f32_32x32x16_bf16 v[128:143], a[64:67], a[224:227], v[128:143]
ds_read_b64_tr_b16 a[80:81], v18 offset:20480
ds_read_b64_tr_b16 a[82:83], v18 offset:21504
v_mfma_f32_32x32x16_bf16 v[144:159], a[64:67], a[228:231], v[144:159]
ds_read_b64_tr_b16 a[84:85], v19 offset:20480
s_waitcnt lgkmcnt(7)
v_mfma_f32_32x32x16_bf16 v[160:175], a[68:71], a[224:227], v[160:175]
buffer_load_dwordx4 a[216:219], v26, s[40:43], s86 offen offset:3072 sc1
ds_read_b64_tr_b16 a[86:87], v19 offset:21504
v_mfma_f32_32x32x16_bf16 v[176:191], a[68:71], a[228:231], v[176:191]
ds_read_b64_tr_b16 a[88:89], v20 offset:20480
s_waitcnt lgkmcnt(7)
v_mfma_f32_32x32x16_bf16 v[192:207], a[72:75], a[224:227], v[192:207]
ds_read_b64_tr_b16 a[90:91], v20 offset:21504
ds_read_b64_tr_b16 a[92:93], v21 offset:20480
v_mfma_f32_32x32x16_bf16 v[208:223], a[72:75], a[228:231], v[208:223]
buffer_load_dwordx4 a[220:223], v26, s[40:43], s88 offen offset:3072 sc1
ds_read_b64_tr_b16 a[94:95], v21 offset:21504
s_waitcnt lgkmcnt(8)
v_mfma_f32_32x32x16_bf16 v[224:239], a[76:79], a[224:227], v[224:239]
s_cmp_lt_u32 s21, 2
s_cbranch_scc1 Lpf_34
s_add_u32 s69, s67, 12288
buffer_store_dwordx4 v[80:83], v26, s[4:7], s69 offen offset:0
s_branch Lpn_33
Lpf_34:
s_add_u32 s69, s67, 24576
buffer_store_dwordx4 a[96:99], v26, s[4:7], s69 offen offset:0
buffer_store_dwordx4 a[100:103], v26, s[4:7], s69 offen offset:1024
Lpn_33:
v_mfma_f32_32x32x16_bf16 v[240:255], a[76:79], a[228:231], v[240:255]
s_waitcnt lgkmcnt(6)
v_mfma_f32_32x32x16_bf16 v[128:143], a[80:83], a[232:235], v[128:143]
ds_read_b64_tr_b16 a[64:65], v18 offset:24576
ds_read_b64_tr_b16 a[66:67], v18 offset:25600
v_mfma_f32_32x32x16_bf16 v[144:159], a[80:83], a[236:239], v[144:159]
ds_read_b64_tr_b16 a[68:69], v19 offset:24576
s_waitcnt lgkmcnt(7)
v_mfma_f32_32x32x16_bf16 v[160:175], a[84:87], a[232:235], v[160:175]
s_add_u32 s87, s72, 28672
s_add_u32 s89, s73, 28672
buffer_load_dwordx4 a[224:227], v26, s[40:43], s87 offen offset:0 sc1
ds_read_b64_tr_b16 a[70:71], v19 offset:25600
v_mfma_f32_32x32x16_bf16 v[176:191], a[84:87], a[236:239], v[176:191]
ds_read_b64_tr_b16 a[72:73], v20 offset:24576
s_waitcnt lgkmcnt(7)
v_mfma_f32_32x32x16_bf16 v[192:207], a[88:91], a[232:235], v[192:207]
ds_read_b64_tr_b16 a[74:75], v20 offset:25600
ds_read_b64_tr_b16 a[76:77], v21 offset:24576
v_mfma_f32_32x32x16_bf16 v[208:223], a[88:91], a[236:239], v[208:223]
buffer_load_dwordx4 a[228:231], v26, s[40:43], s89 offen offset:0 sc1
ds_read_b64_tr_b16 a[78:79], v21 offset:25600
s_waitcnt lgkmcnt(8)
v_mfma_f32_32x32x16_bf16 v[224:239], a[92:95], a[232:235], v[224:239]
s_cmp_lt_u32 s21, 2
s_cbranch_scc1 Lpf_36
buffer_store_dwordx4 v[84:87], v26, s[4:7], s69 offen offset:1024
s_branch Lpn_35
Lpf_36:
buffer_store_dwordx4 a[104:107], v26, s[4:7], s69 offen offset:2048
buffer_store_dwordx4 a[108:111], v26, s[4:7], s69 offen offset:3072
Lpn_35:
v_mfma_f32_32x32x16_bf16 v[240:255], a[92:95], a[236:239], v[240:255]
s_waitcnt lgkmcnt(6)
v_mfma_f32_32x32x16_bf16 v[128:143], a[64:67], a[240:243], v[128:143]
ds_read_b64_tr_b16 a[80:81], v18 offset:28672
ds_read_b64_tr_b16 a[82:83], v18 offset:29696
v_mfma_f32_32x32x16_bf16 v[144:159], a[64:67], a[244:247], v[144:159]
ds_read_b64_tr_b16 a[84:85], v19 offset:28672
s_waitcnt lgkmcnt(7)
v_mfma_f32_32x32x16_bf16 v[160:175], a[68:71], a[240:243], v[160:175]
buffer_load_dwordx4 a[232:235], v26, s[40:43], s87 offen offset:1024 sc1
ds_read_b64_tr_b16 a[86:87], v19 offset:29696
v_mfma_f32_32x32x16_bf16 v[176:191], a[68:71], a[244:247], v[176:191]
ds_read_b64_tr_b16 a[88:89], v20 offset:28672
s_waitcnt lgkmcnt(7)
v_mfma_f32_32x32x16_bf16 v[192:207], a[72:75], a[240:243], v[192:207]
ds_read_b64_tr_b16 a[90:91], v20 offset:29696
ds_read_b64_tr_b16 a[92:93], v21 offset:28672
v_mfma_f32_32x32x16_bf16 v[208:223], a[72:75], a[244:247], v[208:223]
buffer_load_dwordx4 a[236:239], v26, s[40:43], s89 offen offset:1024 sc1
ds_read_b64_tr_b16 a[94:95], v21 offset:29696
s_waitcnt lgkmcnt(8)
v_mfma_f32_32x32x16_bf16 v[224:239], a[76:79], a[240:243], v[224:239]
s_cmp_lt_u32 s21, 2
s_cbranch_scc1 Lpf_38
buffer_store_dwordx4 v[88:91], v26, s[4:7], s69 offen offset:2048
s_branch Lpn_37
Lpf_38:
s_add_u32 s69, s67, 28672
buffer_store_dwordx4 a[112:115], v26, s[4:7], s69 offen offset:0
buffer_store_dwordx4 a[116:119], v26, s[4:7], s69 offen offset:1024
Lpn_37:
v_mfma_f32_32x32x16_bf16 v[240:255], a[76:79], a[244:247], v[240:255]
s_waitcnt vmcnt(30) lgkmcnt(0)
s_barrier
v_mfma_f32_32x32x16_bf16 v[128:143], a[80:83], a[248:251], v[128:143]
ds_read_b64_tr_b16 a[64:65], v18 offset:32768
s_add_u32 m0, s84, 16384
s_add_u32 s66, s85, 3670016
buffer_load_dwordx4 v6, s[36:39], s66 offen offset:0 lds
ds_read_b64_tr_b16 a[66:67], v18 offset:33792
v_mfma_f32_32x32x16_bf16 v[144:159], a[80:83], a[252:255], v[144:159]
ds_read_b64_tr_b16 a[68:69], v19 offset:32768
v_mfma_f32_32x32x16_bf16 v[160:175], a[84:87], a[248:251], v[160:175]
buffer_load_dwordx4 v7, s[36:39], s66 offen offset:1024 lds
buffer_load_dwordx4 a[240:243], v26, s[40:43], s87 offen offset:2048 sc1
ds_read_b64_tr_b16 a[70:71], v19 offset:33792
v_mfma_f32_32x32x16_bf16 v[176:191], a[84:87], a[252:255], v[176:191]
ds_read_b64_tr_b16 a[72:73], v20 offset:32768
v_mfma_f32_32x32x16_bf16 v[192:207], a[88:91], a[248:251], v[192:207]
ds_read_b64_tr_b16 a[74:75], v20 offset:33792
buffer_load_dwordx4 v8, s[36:39], s66 offen offset:2048 lds
ds_read_b64_tr_b16 a[76:77], v21 offset:32768
v_mfma_f32_32x32x16_bf16 v[208:223], a[88:91], a[252:255], v[208:223]
buffer_load_dwordx4 a[244:247], v26, s[40:43], s89 offen offset:2048 sc1
ds_read_b64_tr_b16 a[78:79], v21 offset:33792
v_mfma_f32_32x32x16_bf16 v[224:239], a[92:95], a[248:251], v[224:239]
buffer_load_dwordx4 v9, s[36:39], s66 offen offset:3072 lds
s_cmp_lt_u32 s21, 2
s_cbranch_scc1 Lpf_40
buffer_store_dwordx4 v[92:95], v26, s[4:7], s69 offen offset:3072
s_branch Lpn_39
Lpf_40:
buffer_store_dwordx4 a[120:123], v26, s[4:7], s69 offen offset:2048
buffer_store_dwordx4 a[124:127], v26, s[4:7], s69 offen offset:3072
Lpn_39:
v_mfma_f32_32x32x16_bf16 v[240:255], a[92:95], a[252:255], v[240:255]
s_waitcnt lgkmcnt(6)
v_mfma_f32_32x32x16_bf16 v[128:143], a[64:67], a[128:131], v[128:143]
ds_read_b64_tr_b16 a[80:81], v18 offset:36864
ds_read_b64_tr_b16 a[82:83], v18 offset:37888
v_mfma_f32_32x32x16_bf16 v[144:159], a[64:67], a[132:135], v[144:159]
ds_read_b64_tr_b16 a[84:85], v19 offset:36864
s_waitcnt lgkmcnt(7)
v_mfma_f32_32x32x16_bf16 v[160:175], a[68:71], a[128:131], v[160:175]
buffer_load_dwordx4 a[248:251], v26, s[40:43], s87 offen offset:3072 sc1
ds_read_b64_tr_b16 a[86:87], v19 offset:37888
v_mfma_f32_32x32x16_bf16 v[176:191], a[68:71], a[132:135], v[176:191]
ds_read_b64_tr_b16 a[88:89], v20 offset:36864
s_waitcnt lgkmcnt(7)
v_mfma_f32_32x32x16_bf16 v[192:207], a[72:75], a[128:131], v[192:207]
ds_read_b64_tr_b16 a[90:91], v20 offset:37888
ds_read_b64_tr_b16 a[92:93], v21 offset:36864
v_mfma_f32_32x32x16_bf16 v[208:223], a[72:75], a[132:135], v[208:223]
buffer_load_dwordx4 a[252:255], v26, s[40:43], s89 offen offset:3072 sc1
ds_read_b64_tr_b16 a[94:95], v21 offset:37888
s_waitcnt lgkmcnt(8)
v_mfma_f32_32x32x16_bf16 v[224:239], a[76:79], a[128:131], v[224:239]
s_cmp_lt_u32 s21, 2
s_cbranch_scc1 Lpn_41
s_add_u32 s69, s67, 16384
buffer_store_dwordx4 v[96:99], v26, s[4:7], s69 offen offset:0
Lpn_41:
v_mfma_f32_32x32x16_bf16 v[240:255], a[76:79], a[132:135], v[240:255]
s_waitcnt lgkmcnt(6)
v_mfma_f32_32x32x16_bf16 v[128:143], a[80:83], a[136:139], v[128:143]
ds_read_b64_tr_b16 a[64:65], v18 offset:40960
ds_read_b64_tr_b16 a[66:67], v18 offset:41984
v_mfma_f32_32x32x16_bf16 v[144:159], a[80:83], a[140:143], v[144:159]
ds_read_b64_tr_b16 a[68:69], v19 offset:40960
s_waitcnt lgkmcnt(7)
v_mfma_f32_32x32x16_bf16 v[160:175], a[84:87], a[136:139], v[160:175]
s_add_u32 s86, s72, 32768
s_add_u32 s88, s73, 32768
buffer_load_dwordx4 a[128:131], v26, s[40:43], s86 offen offset:0 sc1
ds_read_b64_tr_b16 a[70:71], v19 offset:41984
v_mfma_f32_32x32x16_bf16 v[176:191], a[84:87], a[140:143], v[176:191]
ds_read_b64_tr_b16 a[72:73], v20 offset:40960
s_waitcnt lgkmcnt(7)
v_mfma_f32_32x32x16_bf16 v[192:207], a[88:91], a[136:139], v[192:207]
ds_read_b64_tr_b16 a[74:75], v20 offset:41984
ds_read_b64_tr_b16 a[76:77], v21 offset:40960
v_mfma_f32_32x32x16_bf16 v[208:223], a[88:91], a[140:143], v[208:223]
buffer_load_dwordx4 a[132:135], v26, s[40:43], s88 offen offset:0 sc1
ds_read_b64_tr_b16 a[78:79], v21 offset:41984
s_waitcnt lgkmcnt(8)
v_mfma_f32_32x32x16_bf16 v[224:239], a[92:95], a[136:139], v[224:239]
s_cmp_lt_u32 s21, 2
s_cbranch_scc1 Lpn_43
buffer_store_dwordx4 v[100:103], v26, s[4:7], s69 offen offset:1024
Lpn_43:
v_mfma_f32_32x32x16_bf16 v[240:255], a[92:95], a[140:143], v[240:255]
s_waitcnt lgkmcnt(6)
v_mfma_f32_32x32x16_bf16 v[128:143], a[64:67], a[144:147], v[128:143]
ds_read_b64_tr_b16 a[80:81], v18 offset:45056
ds_read_b64_tr_b16 a[82:83], v18 offset:46080
v_mfma_f32_32x32x16_bf16 v[144:159], a[64:67], a[148:151], v[144:159]
ds_read_b64_tr_b16 a[84:85], v19 offset:45056
s_waitcnt lgkmcnt(7)
v_mfma_f32_32x32x16_bf16 v[160:175], a[68:71], a[144:147], v[160:175]
buffer_load_dwordx4 a[136:139], v26, s[40:43], s86 offen offset:1024 sc1
ds_read_b64_tr_b16 a[86:87], v19 offset:46080
v_mfma_f32_32x32x16_bf16 v[176:191], a[68:71], a[148:151], v[176:191]
ds_read_b64_tr_b16 a[88:89], v20 offset:45056
s_waitcnt lgkmcnt(7)
v_mfma_f32_32x32x16_bf16 v[192:207], a[72:75], a[144:147], v[192:207]
ds_read_b64_tr_b16 a[90:91], v20 offset:46080
ds_read_b64_tr_b16 a[92:93], v21 offset:45056
v_mfma_f32_32x32x16_bf16 v[208:223], a[72:75], a[148:151], v[208:223]
buffer_load_dwordx4 a[140:143], v26, s[40:43], s88 offen offset:1024 sc1
ds_read_b64_tr_b16 a[94:95], v21 offset:46080
s_waitcnt lgkmcnt(8)
v_mfma_f32_32x32x16_bf16 v[224:239], a[76:79], a[144:147], v[224:239]
s_cmp_lt_u32 s21, 2
s_cbranch_scc1 Lpn_45
buffer_store_dwordx4 v[104:107], v26, s[4:7], s69 offen offset:2048
Lpn_45:
v_mfma_f32_32x32x16_bf16 v[240:255], a[76:79], a[148:151], v[240:255]
s_waitcnt vmcnt(30) lgkmcnt(0)
s_cmp_lt_u32 s21, 2
s_cbranch_scc0 Lpw_47
s_waitcnt vmcnt(6)
Lpw_47:
s_barrier
s_cmp_lt_u32 s21, 2
s_cbranch_scc0 Lsg_48
s_cmp_lg_u32 s22, 0
s_cbranch_scc1 Lsg_48
s_cmp_eq_u32 s23, 1
s_cbranch_scc1 Lrel_49
buffer_wbl2 sc1
s_waitcnt vmcnt(0)
Lrel_49:
s_lshl_b32 s60, s20, 7
s_lshl_b32 s61, s21, 2
s_add_u32 s60, s60, s61
s_add_u32 s60, s60, 0x5800000
v_mov_b32 v28, s60
v_mov_b32 v29, 1
s_mov_b64 s[60:61], exec
s_mov_b64 exec, 1
global_store_dword v28, v29, s[18:19] sc1
s_mov_b64 exec, s[60:61]
Lsg_48:
v_mfma_f32_32x32x16_bf16 v[128:143], a[80:83], a[152:155], v[128:143]
ds_read_b64_tr_b16 a[64:65], v18 offset:49152
s_add_u32 m0, s84, 32768
s_add_u32 s66, s85, 4194304
buffer_load_dwordx4 v6, s[36:39], s66 offen offset:0 lds
ds_read_b64_tr_b16 a[66:67], v18 offset:50176
v_mfma_f32_32x32x16_bf16 v[144:159], a[80:83], a[156:159], v[144:159]
ds_read_b64_tr_b16 a[68:69], v19 offset:49152
v_mfma_f32_32x32x16_bf16 v[160:175], a[84:87], a[152:155], v[160:175]
buffer_load_dwordx4 v7, s[36:39], s66 offen offset:1024 lds
buffer_load_dwordx4 a[144:147], v26, s[40:43], s86 offen offset:2048 sc1
ds_read_b64_tr_b16 a[70:71], v19 offset:50176
v_mfma_f32_32x32x16_bf16 v[176:191], a[84:87], a[156:159], v[176:191]
ds_read_b64_tr_b16 a[72:73], v20 offset:49152
v_mfma_f32_32x32x16_bf16 v[192:207], a[88:91], a[152:155], v[192:207]
ds_read_b64_tr_b16 a[74:75], v20 offset:50176
buffer_load_dwordx4 v8, s[36:39], s66 offen offset:2048 lds
ds_read_b64_tr_b16 a[76:77], v21 offset:49152
v_mfma_f32_32x32x16_bf16 v[208:223], a[88:91], a[156:159], v[208:223]
buffer_load_dwordx4 a[148:151], v26, s[40:43], s88 offen offset:2048 sc1
ds_read_b64_tr_b16 a[78:79], v21 offset:50176
v_mfma_f32_32x32x16_bf16 v[224:239], a[92:95], a[152:155], v[224:239]
buffer_load_dwordx4 v9, s[36:39], s66 offen offset:3072 lds
s_cmp_lt_u32 s21, 2
s_cbranch_scc1 Lpn_50
buffer_store_dwordx4 v[108:111], v26, s[4:7], s69 offen offset:3072
Lpn_50:
v_mfma_f32_32x32x16_bf16 v[240:255], a[92:95], a[156:159], v[240:255]
s_waitcnt lgkmcnt(6)
v_mfma_f32_32x32x16_bf16 v[128:143], a[64:67], a[160:163], v[128:143]
ds_read_b64_tr_b16 a[80:81], v18 offset:53248
ds_read_b64_tr_b16 a[82:83], v18 offset:54272
v_mfma_f32_32x32x16_bf16 v[144:159], a[64:67], a[164:167], v[144:159]
ds_read_b64_tr_b16 a[84:85], v19 offset:53248
s_waitcnt lgkmcnt(7)
v_mfma_f32_32x32x16_bf16 v[160:175], a[68:71], a[160:163], v[160:175]
buffer_load_dwordx4 a[152:155], v26, s[40:43], s86 offen offset:3072 sc1
ds_read_b64_tr_b16 a[86:87], v19 offset:54272
v_mfma_f32_32x32x16_bf16 v[176:191], a[68:71], a[164:167], v[176:191]
ds_read_b64_tr_b16 a[88:89], v20 offset:53248
s_waitcnt lgkmcnt(7)
v_mfma_f32_32x32x16_bf16 v[192:207], a[72:75], a[160:163], v[192:207]
ds_read_b64_tr_b16 a[90:91], v20 offset:54272
ds_read_b64_tr_b16 a[92:93], v21 offset:53248
v_mfma_f32_32x32x16_bf16 v[208:223], a[72:75], a[164:167], v[208:223]
buffer_load_dwordx4 a[156:159], v26, s[40:43], s88 offen offset:3072 sc1
ds_read_b64_tr_b16 a[94:95], v21 offset:54272
s_waitcnt lgkmcnt(8)
v_mfma_f32_32x32x16_bf16 v[224:239], a[76:79], a[160:163], v[224:239]
s_cmp_lt_u32 s21, 2
s_cbranch_scc1 Lpn_52
s_add_u32 s69, s67, 20480
buffer_store_dwordx4 v[112:115], v26, s[4:7], s69 offen offset:0
Lpn_52:
v_mfma_f32_32x32x16_bf16 v[240:255], a[76:79], a[164:167], v[240:255]
s_waitcnt lgkmcnt(6)
v_mfma_f32_32x32x16_bf16 v[128:143], a[80:83], a[168:171], v[128:143]
ds_read_b64_tr_b16 a[64:65], v18 offset:57344
ds_read_b64_tr_b16 a[66:67], v18 offset:58368
v_mfma_f32_32x32x16_bf16 v[144:159], a[80:83], a[172:175], v[144:159]
ds_read_b64_tr_b16 a[68:69], v19 offset:57344
s_waitcnt lgkmcnt(7)
v_mfma_f32_32x32x16_bf16 v[160:175], a[84:87], a[168:171], v[160:175]
s_add_u32 s87, s72, 36864
s_add_u32 s89, s73, 36864
buffer_load_dwordx4 a[160:163], v26, s[40:43], s87 offen offset:0 sc1
ds_read_b64_tr_b16 a[70:71], v19 offset:58368
v_mfma_f32_32x32x16_bf16 v[176:191], a[84:87], a[172:175], v[176:191]
ds_read_b64_tr_b16 a[72:73], v20 offset:57344
s_waitcnt lgkmcnt(7)
v_mfma_f32_32x32x16_bf16 v[192:207], a[88:91], a[168:171], v[192:207]
ds_read_b64_tr_b16 a[74:75], v20 offset:58368
ds_read_b64_tr_b16 a[76:77], v21 offset:57344
v_mfma_f32_32x32x16_bf16 v[208:223], a[88:91], a[172:175], v[208:223]
buffer_load_dwordx4 a[164:167], v26, s[40:43], s89 offen offset:0 sc1
ds_read_b64_tr_b16 a[78:79], v21 offset:58368
s_waitcnt lgkmcnt(8)
v_mfma_f32_32x32x16_bf16 v[224:239], a[92:95], a[168:171], v[224:239]
s_cmp_lt_u32 s21, 2
s_cbranch_scc1 Lpn_54
buffer_store_dwordx4 v[116:119], v26, s[4:7], s69 offen offset:1024
Lpn_54:
v_mfma_f32_32x32x16_bf16 v[240:255], a[92:95], a[172:175], v[240:255]
s_waitcnt lgkmcnt(6)
v_mfma_f32_32x32x16_bf16 v[128:143], a[64:67], a[176:179], v[128:143]
ds_read_b64_tr_b16 a[80:81], v18 offset:61440
ds_read_b64_tr_b16 a[82:83], v18 offset:62464
v_mfma_f32_32x32x16_bf16 v[144:159], a[64:67], a[180:183], v[144:159]
ds_read_b64_tr_b16 a[84:85], v19 offset:61440
s_waitcnt lgkmcnt(7)
v_mfma_f32_32x32x16_bf16 v[160:175], a[68:71], a[176:179], v[160:175]
buffer_load_dwordx4 a[168:171], v26, s[40:43], s87 offen offset:1024 sc1
ds_read_b64_tr_b16 a[86:87], v19 offset:62464
v_mfma_f32_32x32x16_bf16 v[176:191], a[68:71], a[180:183], v[176:191]
ds_read_b64_tr_b16 a[88:89], v20 offset:61440
s_waitcnt lgkmcnt(7)
v_mfma_f32_32x32x16_bf16 v[192:207], a[72:75], a[176:179], v[192:207]
ds_read_b64_tr_b16 a[90:91], v20 offset:62464
ds_read_b64_tr_b16 a[92:93], v21 offset:61440
v_mfma_f32_32x32x16_bf16 v[208:223], a[72:75], a[180:183], v[208:223]
buffer_load_dwordx4 a[172:175], v26, s[40:43], s89 offen offset:1024 sc1
ds_read_b64_tr_b16 a[94:95], v21 offset:62464
s_waitcnt lgkmcnt(8)
v_mfma_f32_32x32x16_bf16 v[224:239], a[76:79], a[176:179], v[224:239]
s_cmp_lt_u32 s21, 2
s_cbranch_scc1 Lpn_56
buffer_store_dwordx4 v[120:123], v26, s[4:7], s69 offen offset:2048
Lpn_56:
v_mfma_f32_32x32x16_bf16 v[240:255], a[76:79], a[180:183], v[240:255]
s_waitcnt vmcnt(30) lgkmcnt(0)
s_barrier
v_mfma_f32_32x32x16_bf16 v[128:143], a[80:83], a[184:187], v[128:143]
ds_read_b64_tr_b16 a[64:65], v18 offset:0
s_add_u32 m0, s84, 49152
s_add_u32 s66, s85, 4718592
buffer_load_dwordx4 v6, s[36:39], s66 offen offset:0 lds
ds_read_b64_tr_b16 a[66:67], v18 offset:1024
v_mfma_f32_32x32x16_bf16 v[144:159], a[80:83], a[188:191], v[144:159]
ds_read_b64_tr_b16 a[68:69], v19 offset:0
v_mfma_f32_32x32x16_bf16 v[160:175], a[84:87], a[184:187], v[160:175]
buffer_load_dwordx4 v7, s[36:39], s66 offen offset:1024 lds
buffer_load_dwordx4 a[176:179], v26, s[40:43], s87 offen offset:2048 sc1
ds_read_b64_tr_b16 a[70:71], v19 offset:1024
v_mfma_f32_32x32x16_bf16 v[176:191], a[84:87], a[188:191], v[176:191]
ds_read_b64_tr_b16 a[72:73], v20 offset:0
v_mfma_f32_32x32x16_bf16 v[192:207], a[88:91], a[184:187], v[192:207]
ds_read_b64_tr_b16 a[74:75], v20 offset:1024
buffer_load_dwordx4 v8, s[36:39], s66 offen offset:2048 lds
ds_read_b64_tr_b16 a[76:77], v21 offset:0
v_mfma_f32_32x32x16_bf16 v[208:223], a[88:91], a[188:191], v[208:223]
buffer_load_dwordx4 a[180:183], v26, s[40:43], s89 offen offset:2048 sc1
ds_read_b64_tr_b16 a[78:79], v21 offset:1024
v_mfma_f32_32x32x16_bf16 v[224:239], a[92:95], a[184:187], v[224:239]
buffer_load_dwordx4 v9, s[36:39], s66 offen offset:3072 lds
s_cmp_lt_u32 s21, 2
s_cbranch_scc1 Lpn_58
buffer_store_dwordx4 v[124:127], v26, s[4:7], s69 offen offset:3072
Lpn_58:
v_mfma_f32_32x32x16_bf16 v[240:255], a[92:95], a[188:191], v[240:255]
s_waitcnt lgkmcnt(6)
v_mfma_f32_32x32x16_bf16 v[128:143], a[64:67], a[192:195], v[128:143]
ds_read_b64_tr_b16 a[80:81], v18 offset:4096
ds_read_b64_tr_b16 a[82:83], v18 offset:5120
v_mfma_f32_32x32x16_bf16 v[144:159], a[64:67], a[196:199], v[144:159]
ds_read_b64_tr_b16 a[84:85], v19 offset:4096
s_waitcnt lgkmcnt(7)
v_mfma_f32_32x32x16_bf16 v[160:175], a[68:71], a[192:195], v[160:175]
buffer_load_dwordx4 a[184:187], v26, s[40:43], s87 offen offset:3072 sc1
ds_read_b64_tr_b16 a[86:87], v19 offset:5120
v_mfma_f32_32x32x16_bf16 v[176:191], a[68:71], a[196:199], v[176:191]
ds_read_b64_tr_b16 a[88:89], v20 offset:4096
s_waitcnt lgkmcnt(7)
v_mfma_f32_32x32x16_bf16 v[192:207], a[72:75], a[192:195], v[192:207]
ds_read_b64_tr_b16 a[90:91], v20 offset:5120
ds_read_b64_tr_b16 a[92:93], v21 offset:4096
v_mfma_f32_32x32x16_bf16 v[208:223], a[72:75], a[196:199], v[208:223]
buffer_load_dwordx4 a[188:191], v26, s[40:43], s89 offen offset:3072 sc1
ds_read_b64_tr_b16 a[94:95], v21 offset:5120
s_waitcnt lgkmcnt(8)
v_mfma_f32_32x32x16_bf16 v[224:239], a[76:79], a[192:195], v[224:239]
s_cmp_lt_u32 s21, 2
s_cbranch_scc1 Lpn_60
s_add_u32 s69, s67, 24576
buffer_store_dwordx4 a[96:99], v26, s[4:7], s69 offen offset:0
Lpn_60:
v_mfma_f32_32x32x16_bf16 v[240:255], a[76:79], a[196:199], v[240:255]
s_waitcnt lgkmcnt(6)
v_mfma_f32_32x32x16_bf16 v[128:143], a[80:83], a[200:203], v[128:143]
ds_read_b64_tr_b16 a[64:65], v18 offset:8192
ds_read_b64_tr_b16 a[66:67], v18 offset:9216
v_mfma_f32_32x32x16_bf16 v[144:159], a[80:83], a[204:207], v[144:159]
ds_read_b64_tr_b16 a[68:69], v19 offset:8192
s_waitcnt lgkmcnt(7)
v_mfma_f32_32x32x16_bf16 v[160:175], a[84:87], a[200:203], v[160:175]
ds_read_b64_tr_b16 a[70:71], v19 offset:9216
v_mfma_f32_32x32x16_bf16 v[176:191], a[84:87], a[204:207], v[176:191]
ds_read_b64_tr_b16 a[72:73], v20 offset:8192
s_waitcnt lgkmcnt(7)
v_mfma_f32_32x32x16_bf16 v[192:207], a[88:91], a[200:203], v[192:207]
ds_read_b64_tr_b16 a[74:75], v20 offset:9216
ds_read_b64_tr_b16 a[76:77], v21 offset:8192
v_mfma_f32_32x32x16_bf16 v[208:223], a[88:91], a[204:207], v[208:223]
ds_read_b64_tr_b16 a[78:79], v21 offset:9216
s_waitcnt lgkmcnt(8)
v_mfma_f32_32x32x16_bf16 v[224:239], a[92:95], a[200:203], v[224:239]
s_cmp_lt_u32 s21, 2
s_cbranch_scc1 Lpn_62
buffer_store_dwordx4 a[100:103], v26, s[4:7], s69 offen offset:1024
Lpn_62:
v_mfma_f32_32x32x16_bf16 v[240:255], a[92:95], a[204:207], v[240:255]
s_waitcnt lgkmcnt(6)
v_mfma_f32_32x32x16_bf16 v[128:143], a[64:67], a[208:211], v[128:143]
ds_read_b64_tr_b16 a[80:81], v18 offset:12288
ds_read_b64_tr_b16 a[82:83], v18 offset:13312
v_mfma_f32_32x32x16_bf16 v[144:159], a[64:67], a[212:215], v[144:159]
ds_read_b64_tr_b16 a[84:85], v19 offset:12288
s_waitcnt lgkmcnt(7)
v_mfma_f32_32x32x16_bf16 v[160:175], a[68:71], a[208:211], v[160:175]
ds_read_b64_tr_b16 a[86:87], v19 offset:13312
v_mfma_f32_32x32x16_bf16 v[176:191], a[68:71], a[212:215], v[176:191]
ds_read_b64_tr_b16 a[88:89], v20 offset:12288
s_waitcnt lgkmcnt(7)
v_mfma_f32_32x32x16_bf16 v[192:207], a[72:75], a[208:211], v[192:207]
ds_read_b64_tr_b16 a[90:91], v20 offset:13312
ds_read_b64_tr_b16 a[92:93], v21 offset:12288
v_mfma_f32_32x32x16_bf16 v[208:223], a[72:75], a[212:215], v[208:223]
ds_read_b64_tr_b16 a[94:95], v21 offset:13312
s_waitcnt lgkmcnt(8)
v_mfma_f32_32x32x16_bf16 v[224:239], a[76:79], a[208:211], v[224:239]
s_cmp_lt_u32 s21, 2
s_cbranch_scc1 Lpn_64
buffer_store_dwordx4 a[104:107], v26, s[4:7], s69 offen offset:2048
Lpn_64:
v_mfma_f32_32x32x16_bf16 v[240:255], a[76:79], a[212:215], v[240:255]
s_waitcnt vmcnt(26) lgkmcnt(0)
s_barrier
v_mfma_f32_32x32x16_bf16 v[128:143], a[80:83], a[216:219], v[128:143]
ds_read_b64_tr_b16 a[64:65], v18 offset:16384
ds_read_b64_tr_b16 a[66:67], v18 offset:17408
v_mfma_f32_32x32x16_bf16 v[144:159], a[80:83], a[220:223], v[144:159]
ds_read_b64_tr_b16 a[68:69], v19 offset:16384
v_mfma_f32_32x32x16_bf16 v[160:175], a[84:87], a[216:219], v[160:175]
ds_read_b64_tr_b16 a[70:71], v19 offset:17408
v_mfma_f32_32x32x16_bf16 v[176:191], a[84:87], a[220:223], v[176:191]
ds_read_b64_tr_b16 a[72:73], v20 offset:16384
v_mfma_f32_32x32x16_bf16 v[192:207], a[88:91], a[216:219], v[192:207]
ds_read_b64_tr_b16 a[74:75], v20 offset:17408
ds_read_b64_tr_b16 a[76:77], v21 offset:16384
v_mfma_f32_32x32x16_bf16 v[208:223], a[88:91], a[220:223], v[208:223]
ds_read_b64_tr_b16 a[78:79], v21 offset:17408
v_mfma_f32_32x32x16_bf16 v[224:239], a[92:95], a[216:219], v[224:239]
s_cmp_lt_u32 s21, 2
s_cbranch_scc1 Lpn_66
buffer_store_dwordx4 a[108:111], v26, s[4:7], s69 offen offset:3072
Lpn_66:
v_mfma_f32_32x32x16_bf16 v[240:255], a[92:95], a[220:223], v[240:255]
s_waitcnt lgkmcnt(6)
v_mfma_f32_32x32x16_bf16 v[128:143], a[64:67], a[224:227], v[128:143]
ds_read_b64_tr_b16 a[80:81], v18 offset:20480
ds_read_b64_tr_b16 a[82:83], v18 offset:21504
v_mfma_f32_32x32x16_bf16 v[144:159], a[64:67], a[228:231], v[144:159]
ds_read_b64_tr_b16 a[84:85], v19 offset:20480
s_waitcnt lgkmcnt(7)
v_mfma_f32_32x32x16_bf16 v[160:175], a[68:71], a[224:227], v[160:175]
ds_read_b64_tr_b16 a[86:87], v19 offset:21504
v_mfma_f32_32x32x16_bf16 v[176:191], a[68:71], a[228:231], v[176:191]
ds_read_b64_tr_b16 a[88:89], v20 offset:20480
s_waitcnt lgkmcnt(7)
v_mfma_f32_32x32x16_bf16 v[192:207], a[72:75], a[224:227], v[192:207]
ds_read_b64_tr_b16 a[90:91], v20 offset:21504
ds_read_b64_tr_b16 a[92:93], v21 offset:20480
v_mfma_f32_32x32x16_bf16 v[208:223], a[72:75], a[228:231], v[208:223]
ds_read_b64_tr_b16 a[94:95], v21 offset:21504
s_waitcnt lgkmcnt(8)
v_mfma_f32_32x32x16_bf16 v[224:239], a[76:79], a[224:227], v[224:239]
s_cmp_lt_u32 s21, 2
s_cbranch_scc1 Lpn_68
s_add_u32 s69, s67, 28672
buffer_store_dwordx4 a[112:115], v26, s[4:7], s69 offen offset:0
Lpn_68:
v_mfma_f32_32x32x16_bf16 v[240:255], a[76:79], a[228:231], v[240:255]
s_waitcnt lgkmcnt(6)
v_mfma_f32_32x32x16_bf16 v[128:143], a[80:83], a[232:235], v[128:143]
ds_read_b64_tr_b16 a[64:65], v18 offset:24576
ds_read_b64_tr_b16 a[66:67], v18 offset:25600
v_mfma_f32_32x32x16_bf16 v[144:159], a[80:83], a[236:239], v[144:159]
ds_read_b64_tr_b16 a[68:69], v19 offset:24576
s_waitcnt lgkmcnt(7)
v_mfma_f32_32x32x16_bf16 v[160:175], a[84:87], a[232:235], v[160:175]
ds_read_b64_tr_b16 a[70:71], v19 offset:25600
v_mfma_f32_32x32x16_bf16 v[176:191], a[84:87], a[236:239], v[176:191]
ds_read_b64_tr_b16 a[72:73], v20 offset:24576
s_waitcnt lgkmcnt(7)
v_mfma_f32_32x32x16_bf16 v[192:207], a[88:91], a[232:235], v[192:207]
ds_read_b64_tr_b16 a[74:75], v20 offset:25600
ds_read_b64_tr_b16 a[76:77], v21 offset:24576
v_mfma_f32_32x32x16_bf16 v[208:223], a[88:91], a[236:239], v[208:223]
ds_read_b64_tr_b16 a[78:79], v21 offset:25600
s_waitcnt lgkmcnt(8)
v_mfma_f32_32x32x16_bf16 v[224:239], a[92:95], a[232:235], v[224:239]
s_cmp_lt_u32 s21, 2
s_cbranch_scc1 Lpn_70
buffer_store_dwordx4 a[116:119], v26, s[4:7], s69 offen offset:1024
Lpn_70:
v_mfma_f32_32x32x16_bf16 v[240:255], a[92:95], a[236:239], v[240:255]
s_waitcnt lgkmcnt(6)
v_mfma_f32_32x32x16_bf16 v[128:143], a[64:67], a[240:243], v[128:143]
ds_read_b64_tr_b16 a[80:81], v18 offset:28672
ds_read_b64_tr_b16 a[82:83], v18 offset:29696
v_mfma_f32_32x32x16_bf16 v[144:159], a[64:67], a[244:247], v[144:159]
ds_read_b64_tr_b16 a[84:85], v19 offset:28672
s_waitcnt lgkmcnt(7)
v_mfma_f32_32x32x16_bf16 v[160:175], a[68:71], a[240:243], v[160:175]
ds_read_b64_tr_b16 a[86:87], v19 offset:29696
v_mfma_f32_32x32x16_bf16 v[176:191], a[68:71], a[244:247], v[176:191]
ds_read_b64_tr_b16 a[88:89], v20 offset:28672
s_waitcnt lgkmcnt(7)
v_mfma_f32_32x32x16_bf16 v[192:207], a[72:75], a[240:243], v[192:207]
ds_read_b64_tr_b16 a[90:91], v20 offset:29696
ds_read_b64_tr_b16 a[92:93], v21 offset:28672
v_mfma_f32_32x32x16_bf16 v[208:223], a[72:75], a[244:247], v[208:223]
ds_read_b64_tr_b16 a[94:95], v21 offset:29696
s_waitcnt lgkmcnt(8)
v_mfma_f32_32x32x16_bf16 v[224:239], a[76:79], a[240:243], v[224:239]
s_cmp_lt_u32 s21, 2
s_cbranch_scc1 Lpn_72
buffer_store_dwordx4 a[120:123], v26, s[4:7], s69 offen offset:2048
Lpn_72:
v_mfma_f32_32x32x16_bf16 v[240:255], a[76:79], a[244:247], v[240:255]
s_waitcnt vmcnt(14) lgkmcnt(0)
s_barrier
v_mfma_f32_32x32x16_bf16 v[128:143], a[80:83], a[248:251], v[128:143]
ds_read_b64_tr_b16 a[64:65], v18 offset:32768
ds_read_b64_tr_b16 a[66:67], v18 offset:33792
v_mfma_f32_32x32x16_bf16 v[144:159], a[80:83], a[252:255], v[144:159]
ds_read_b64_tr_b16 a[68:69], v19 offset:32768
v_mfma_f32_32x32x16_bf16 v[160:175], a[84:87], a[248:251], v[160:175]
ds_read_b64_tr_b16 a[70:71], v19 offset:33792
v_mfma_f32_32x32x16_bf16 v[176:191], a[84:87], a[252:255], v[176:191]
ds_read_b64_tr_b16 a[72:73], v20 offset:32768
v_mfma_f32_32x32x16_bf16 v[192:207], a[88:91], a[248:251], v[192:207]
ds_read_b64_tr_b16 a[74:75], v20 offset:33792
ds_read_b64_tr_b16 a[76:77], v21 offset:32768
v_mfma_f32_32x32x16_bf16 v[208:223], a[88:91], a[252:255], v[208:223]
ds_read_b64_tr_b16 a[78:79], v21 offset:33792
v_mfma_f32_32x32x16_bf16 v[224:239], a[92:95], a[248:251], v[224:239]
s_cmp_lt_u32 s21, 2
s_cbranch_scc1 Lpn_74
buffer_store_dwordx4 a[124:127], v26, s[4:7], s69 offen offset:3072
Lpn_74:
v_mfma_f32_32x32x16_bf16 v[240:255], a[92:95], a[252:255], v[240:255]
v_and_b32 v31, 7, v1
v_lshlrev_b32 v31, 2, v31
s_lshl_b32 s60, s20, 7
s_add_u32 s60, s60, 0x5800000
v_add_u32 v31, s60, v31
s_waitcnt lgkmcnt(6)
v_mfma_f32_32x32x16_bf16 v[128:143], a[64:67], a[128:131], v[128:143]
ds_read_b64_tr_b16 a[80:81], v18 offset:36864
ds_read_b64_tr_b16 a[82:83], v18 offset:37888
v_mfma_f32_32x32x16_bf16 v[144:159], a[64:67], a[132:135], v[144:159]
ds_read_b64_tr_b16 a[84:85], v19 offset:36864
s_waitcnt lgkmcnt(7)
v_mfma_f32_32x32x16_bf16 v[160:175], a[68:71], a[128:131], v[160:175]
ds_read_b64_tr_b16 a[86:87], v19 offset:37888
v_mfma_f32_32x32x16_bf16 v[176:191], a[68:71], a[132:135], v[176:191]
ds_read_b64_tr_b16 a[88:89], v20 offset:36864
s_waitcnt lgkmcnt(7)
v_mfma_f32_32x32x16_bf16 v[192:207], a[72:75], a[128:131], v[192:207]
ds_read_b64_tr_b16 a[90:91], v20 offset:37888
ds_read_b64_tr_b16 a[92:93], v21 offset:36864
v_mfma_f32_32x32x16_bf16 v[208:223], a[72:75], a[132:135], v[208:223]
ds_read_b64_tr_b16 a[94:95], v21 offset:37888
s_waitcnt lgkmcnt(8)
v_mfma_f32_32x32x16_bf16 v[224:239], a[76:79], a[128:131], v[224:239]
global_load_dword v30, v31, s[18:19] sc1
v_mfma_f32_32x32x16_bf16 v[240:255], a[76:79], a[132:135], v[240:255]
s_waitcnt lgkmcnt(6)
v_mfma_f32_32x32x16_bf16 v[128:143], a[80:83], a[136:139], v[128:143]
ds_read_b64_tr_b16 a[64:65], v18 offset:40960
ds_read_b64_tr_b16 a[66:67], v18 offset:41984
v_mfma_f32_32x32x16_bf16 v[144:159], a[80:83], a[140:143], v[144:159]
ds_read_b64_tr_b16 a[68:69], v19 offset:40960
s_waitcnt lgkmcnt(7)
v_mfma_f32_32x32x16_bf16 v[160:175], a[84:87], a[136:139], v[160:175]
ds_read_b64_tr_b16 a[70:71], v19 offset:41984
v_mfma_f32_32x32x16_bf16 v[176:191], a[84:87], a[140:143], v[176:191]
ds_read_b64_tr_b16 a[72:73], v20 offset:40960
s_waitcnt lgkmcnt(7)
v_mfma_f32_32x32x16_bf16 v[192:207], a[88:91], a[136:139], v[192:207]
ds_read_b64_tr_b16 a[74:75], v20 offset:41984
ds_read_b64_tr_b16 a[76:77], v21 offset:40960
v_mfma_f32_32x32x16_bf16 v[208:223], a[88:91], a[140:143], v[208:223]
ds_read_b64_tr_b16 a[78:79], v21 offset:41984
s_waitcnt lgkmcnt(8)
v_mfma_f32_32x32x16_bf16 v[224:239], a[92:95], a[136:139], v[224:239]
v_mfma_f32_32x32x16_bf16 v[240:255], a[92:95], a[140:143], v[240:255]
s_waitcnt lgkmcnt(6)
v_mfma_f32_32x32x16_bf16 v[128:143], a[64:67], a[144:147], v[128:143]
ds_read_b64_tr_b16 a[80:81], v18 offset:45056
ds_read_b64_tr_b16 a[82:83], v18 offset:46080
v_mfma_f32_32x32x16_bf16 v[144:159], a[64:67], a[148:151], v[144:159]
ds_read_b64_tr_b16 a[84:85], v19 offset:45056
s_waitcnt lgkmcnt(7)
v_mfma_f32_32x32x16_bf16 v[160:175], a[68:71], a[144:147], v[160:175]
ds_read_b64_tr_b16 a[86:87], v19 offset:46080
v_mfma_f32_32x32x16_bf16 v[176:191], a[68:71], a[148:151], v[176:191]
ds_read_b64_tr_b16 a[88:89], v20 offset:45056
s_waitcnt lgkmcnt(7)
v_mfma_f32_32x32x16_bf16 v[192:207], a[72:75], a[144:147], v[192:207]
ds_read_b64_tr_b16 a[90:91], v20 offset:46080
ds_read_b64_tr_b16 a[92:93], v21 offset:45056
v_mfma_f32_32x32x16_bf16 v[208:223], a[72:75], a[148:151], v[208:223]
ds_read_b64_tr_b16 a[94:95], v21 offset:46080
s_waitcnt lgkmcnt(8)
v_mfma_f32_32x32x16_bf16 v[224:239], a[76:79], a[144:147], v[224:239]
v_mfma_f32_32x32x16_bf16 v[240:255], a[76:79], a[148:151], v[240:255]
s_waitcnt vmcnt(0) lgkmcnt(0)
s_cmp_lg_u32 s22, 0
s_cbranch_scc1 Lkv_76
v_cmp_ne_u32 vcc, 0, v30
s_nop 1
s_and_b32 s60, vcc_lo, 0x3
s_cmp_eq_u32 s60, 0x3
s_cbranch_scc1 Lkv_77
s_mov_b32 s61, 0
Lsf_78:
global_load_dword v30, v31, s[18:19] sc1
s_waitcnt vmcnt(0)
v_cmp_ne_u32 vcc, 0, v30
s_nop 1
s_and_b32 s60, vcc_lo, 0x3
s_cmp_eq_u32 s60, 0x3
s_cbranch_scc1 Lsfd_79
s_add_u32 s61, s61, 1
s_cmp_lt_u32 s61, 0x40000
s_sleep 2
s_cbranch_scc1 Lsf_78
Lsfd_79:
Lkv_77:
s_cmp_eq_u32 s23, 1
s_cbranch_scc1 Lkv_76
buffer_inv sc1
s_waitcnt vmcnt(0)
Lkv_76:
s_barrier
s_cmp_lt_u32 s21, 2
s_cbranch_scc1 Lsg_80
s_cmp_lg_u32 s22, 0
s_cbranch_scc1 Lsg_80
s_cmp_eq_u32 s23, 1
s_cbranch_scc1 Lrel_81
buffer_wbl2 sc1
s_waitcnt vmcnt(0)
Lrel_81:
s_lshl_b32 s60, s20, 7
s_lshl_b32 s61, s21, 2
s_add_u32 s60, s60, s61
s_add_u32 s60, s60, 0x5800000
v_mov_b32 v28, s60
v_mov_b32 v29, 1
s_mov_b64 s[60:61], exec
s_mov_b64 exec, 1
global_store_dword v28, v29, s[18:19] sc1
s_mov_b64 exec, s[60:61]
Lsg_80:
v_mfma_f32_32x32x16_bf16 v[128:143], a[80:83], a[152:155], v[128:143]
ds_read_b64_tr_b16 a[64:65], v18 offset:49152
ds_read_b64_tr_b16 a[66:67], v18 offset:50176
v_mfma_f32_32x32x16_bf16 v[144:159], a[80:83], a[156:159], v[144:159]
ds_read_b64_tr_b16 a[68:69], v19 offset:49152
v_mfma_f32_32x32x16_bf16 v[160:175], a[84:87], a[152:155], v[160:175]
ds_read_b64_tr_b16 a[70:71], v19 offset:50176
v_mfma_f32_32x32x16_bf16 v[176:191], a[84:87], a[156:159], v[176:191]
ds_read_b64_tr_b16 a[72:73], v20 offset:49152
v_mfma_f32_32x32x16_bf16 v[192:207], a[88:91], a[152:155], v[192:207]
ds_read_b64_tr_b16 a[74:75], v20 offset:50176
ds_read_b64_tr_b16 a[76:77], v21 offset:49152
v_mfma_f32_32x32x16_bf16 v[208:223], a[88:91], a[156:159], v[208:223]
ds_read_b64_tr_b16 a[78:79], v21 offset:50176
v_mfma_f32_32x32x16_bf16 v[224:239], a[92:95], a[152:155], v[224:239]
v_mfma_f32_32x32x16_bf16 v[240:255], a[92:95], a[156:159], v[240:255]
s_lshl_b32 s62, s22, 13
s_add_u32 s64, s62, 32768
s_waitcnt lgkmcnt(6)
v_mfma_f32_32x32x16_bf16 v[128:143], a[64:67], a[160:163], v[128:143]
ds_read_b64_tr_b16 a[80:81], v18 offset:53248
s_add_u32 m0, s62, 0
s_add_u32 s66, s62, 0
buffer_load_dwordx4 v26, s[44:47], s66 offen offset:0 sc1 lds
ds_read_b64_tr_b16 a[82:83], v18 offset:54272
v_mfma_f32_32x32x16_bf16 v[144:159], a[64:67], a[164:167], v[144:159]
buffer_load_dwordx4 v26, s[44:47], s66 offen offset:1024 sc1 lds
ds_read_b64_tr_b16 a[84:85], v19 offset:53248
s_waitcnt lgkmcnt(7)
v_mfma_f32_32x32x16_bf16 v[160:175], a[68:71], a[160:163], v[160:175]
ds_read_b64_tr_b16 a[86:87], v19 offset:54272
buffer_load_dwordx4 v26, s[44:47], s66 offen offset:2048 sc1 lds
v_mfma_f32_32x32x16_bf16 v[176:191], a[68:71], a[164:167], v[176:191]
ds_read_b64_tr_b16 a[88:89], v20 offset:53248
s_waitcnt lgkmcnt(7)
v_mfma_f32_32x32x16_bf16 v[192:207], a[72:75], a[160:163], v[192:207]
buffer_load_dwordx4 v26, s[44:47], s66 offen offset:3072 sc1 lds
ds_read_b64_tr_b16 a[90:91], v20 offset:54272
ds_read_b64_tr_b16 a[92:93], v21 offset:53248
v_mfma_f32_32x32x16_bf16 v[208:223], a[72:75], a[164:167], v[208:223]
s_add_u32 m0, s62, 4096
s_add_u32 s66, s62, 4096
buffer_load_dwordx4 v26, s[44:47], s66 offen offset:0 sc1 lds
ds_read_b64_tr_b16 a[94:95], v21 offset:54272
s_waitcnt lgkmcnt(8)
v_mfma_f32_32x32x16_bf16 v[224:239], a[76:79], a[160:163], v[224:239]
buffer_load_dwordx4 v26, s[44:47], s66 offen offset:1024 sc1 lds
v_mfma_f32_32x32x16_bf16 v[240:255], a[76:79], a[164:167], v[240:255]
s_waitcnt lgkmcnt(6)
v_mfma_f32_32x32x16_bf16 v[128:143], a[80:83], a[168:171], v[128:143]
ds_read_b64_tr_b16 a[64:65], v18 offset:57344
buffer_load_dwordx4 v26, s[44:47], s66 offen offset:2048 sc1 lds
ds_read_b64_tr_b16 a[66:67], v18 offset:58368
v_mfma_f32_32x32x16_bf16 v[144:159], a[80:83], a[172:175], v[144:159]
buffer_load_dwordx4 v26, s[44:47], s66 offen offset:3072 sc1 lds
ds_read_b64_tr_b16 a[68:69], v19 offset:57344
s_waitcnt lgkmcnt(7)
v_mfma_f32_32x32x16_bf16 v[160:175], a[84:87], a[168:171], v[160:175]
ds_read_b64_tr_b16 a[70:71], v19 offset:58368
s_add_u32 m0, s62, 65536
s_add_u32 s66, s62, 0
buffer_load_dwordx4 v26, s[48:51], s66 offen offset:0 sc1 lds
v_mfma_f32_32x32x16_bf16 v[176:191], a[84:87], a[172:175], v[176:191]
ds_read_b64_tr_b16 a[72:73], v20 offset:57344
s_waitcnt lgkmcnt(7)
v_mfma_f32_32x32x16_bf16 v[192:207], a[88:91], a[168:171], v[192:207]
buffer_load_dwordx4 v26, s[48:51], s66 offen offset:1024 sc1 lds
ds_read_b64_tr_b16 a[74:75], v20 offset:58368
ds_read_b64_tr_b16 a[76:77], v21 offset:57344
v_mfma_f32_32x32x16_bf16 v[208:223], a[88:91], a[172:175], v[208:223]
buffer_load_dwordx4 v26, s[48:51], s66 offen offset:2048 sc1 lds
ds_read_b64_tr_b16 a[78:79], v21 offset:58368
s_waitcnt lgkmcnt(8)
v_mfma_f32_32x32x16_bf16 v[224:239], a[92:95], a[168:171], v[224:239]
buffer_load_dwordx4 v26, s[48:51], s66 offen offset:3072 sc1 lds
v_mfma_f32_32x32x16_bf16 v[240:255], a[92:95], a[172:175], v[240:255]
s_waitcnt lgkmcnt(6)
v_mfma_f32_32x32x16_bf16 v[128:143], a[64:67], a[176:179], v[128:143]
ds_read_b64_tr_b16 a[80:81], v18 offset:61440
s_add_u32 m0, s62, 69632
s_add_u32 s66, s62, 4096
buffer_load_dwordx4 v26, s[48:51], s66 offen offset:0 sc1 lds
ds_read_b64_tr_b16 a[82:83], v18 offset:62464
v_mfma_f32_32x32x16_bf16 v[144:159], a[64:67], a[180:183], v[144:159]
buffer_load_dwordx4 v26, s[48:51], s66 offen offset:1024 sc1 lds
ds_read_b64_tr_b16 a[84:85], v19 offset:61440
s_waitcnt lgkmcnt(7)
v_mfma_f32_32x32x16_bf16 v[160:175], a[68:71], a[176:179], v[160:175]
ds_read_b64_tr_b16 a[86:87], v19 offset:62464
buffer_load_dwordx4 v26, s[48:51], s66 offen offset:2048 sc1 lds
v_mfma_f32_32x32x16_bf16 v[176:191], a[68:71], a[180:183], v[176:191]
ds_read_b64_tr_b16 a[88:89], v20 offset:61440
s_waitcnt lgkmcnt(7)
v_mfma_f32_32x32x16_bf16 v[192:207], a[72:75], a[176:179], v[192:207]
buffer_load_dwordx4 v26, s[48:51], s66 offen offset:3072 sc1 lds
ds_read_b64_tr_b16 a[90:91], v20 offset:62464
ds_read_b64_tr_b16 a[92:93], v21 offset:61440
v_mfma_f32_32x32x16_bf16 v[208:223], a[72:75], a[180:183], v[208:223]
s_add_u32 m0, s62, 32768
s_add_u32 s66, s64, 0
buffer_load_dwordx4 v26, s[44:47], s66 offen offset:0 sc1 lds
ds_read_b64_tr_b16 a[94:95], v21 offset:62464
s_waitcnt lgkmcnt(8)
v_mfma_f32_32x32x16_bf16 v[224:239], a[76:79], a[176:179], v[224:239]
buffer_load_dwordx4 v26, s[44:47], s66 offen offset:1024 sc1 lds
v_mfma_f32_32x32x16_bf16 v[240:255], a[76:79], a[180:183], v[240:255]
s_waitcnt lgkmcnt(6)
v_mfma_f32_32x32x16_bf16 v[128:143], a[80:83], a[184:187], v[128:143]
buffer_load_dwordx4 v26, s[44:47], s66 offen offset:2048 sc1 lds
v_mfma_f32_32x32x16_bf16 v[144:159], a[80:83], a[188:191], v[144:159]
buffer_load_dwordx4 v26, s[44:47], s66 offen offset:3072 sc1 lds
s_waitcnt lgkmcnt(4)
v_mfma_f32_32x32x16_bf16 v[160:175], a[84:87], a[184:187], v[160:175]
s_add_u32 m0, s62, 36864
s_add_u32 s66, s64, 4096
buffer_load_dwordx4 v26, s[44:47], s66 offen offset:0 sc1 lds
v_mfma_f32_32x32x16_bf16 v[176:191], a[84:87], a[188:191], v[176:191]
s_waitcnt lgkmcnt(2)
v_mfma_f32_32x32x16_bf16 v[192:207], a[88:91], a[184:187], v[192:207]
buffer_load_dwordx4 v26, s[44:47], s66 offen offset:1024 sc1 lds
v_mfma_f32_32x32x16_bf16 v[208:223], a[88:91], a[188:191], v[208:223]
buffer_load_dwordx4 v26, s[44:47], s66 offen offset:2048 sc1 lds
s_waitcnt lgkmcnt(0)
v_mfma_f32_32x32x16_bf16 v[224:239], a[92:95], a[184:187], v[224:239]
buffer_load_dwordx4 v26, s[44:47], s66 offen offset:3072 sc1 lds
v_mfma_f32_32x32x16_bf16 v[240:255], a[92:95], a[188:191], v[240:255]
s_nop 15
s_barrier
s_lshl_b32 s60, s22, 14
s_add_u32 s60, s60, 98304
v_add_u32 v27, s60, v26
v_cvt_pk_bf16_f32 v32, v128, v129
v_cvt_pk_bf16_f32 v33, v130, v131
v_cvt_pk_bf16_f32 v34, v132, v133
v_cvt_pk_bf16_f32 v35, v134, v135
ds_write_b128 v27, v[32:35] offset:0
v_cvt_pk_bf16_f32 v36, v136, v137
v_cvt_pk_bf16_f32 v37, v138, v139
v_cvt_pk_bf16_f32 v38, v140, v141
v_cvt_pk_bf16_f32 v39, v142, v143
ds_write_b128 v27, v[36:39] offset:1024
v_cvt_pk_bf16_f32 v40, v160, v161
v_cvt_pk_bf16_f32 v41, v162, v163
v_cvt_pk_bf16_f32 v42, v164, v165
v_cvt_pk_bf16_f32 v43, v166, v167
ds_write_b128 v27, v[40:43] offset:2048
v_cvt_pk_bf16_f32 v44, v168, v169
v_cvt_pk_bf16_f32 v45, v170, v171
v_cvt_pk_bf16_f32 v46, v172, v173
v_cvt_pk_bf16_f32 v47, v174, v175
ds_write_b128 v27, v[44:47] offset:3072
v_cvt_pk_bf16_f32 v32, v192, v193
v_cvt_pk_bf16_f32 v33, v194, v195
v_cvt_pk_bf16_f32 v34, v196, v197
v_cvt_pk_bf16_f32 v35, v198, v199
ds_write_b128 v27, v[32:35] offset:4096
v_cvt_pk_bf16_f32 v36, v200, v201
v_cvt_pk_bf16_f32 v37, v202, v203
v_cvt_pk_bf16_f32 v38, v204, v205
v_cvt_pk_bf16_f32 v39, v206, v207
ds_write_b128 v27, v[36:39] offset:5120
v_cvt_pk_bf16_f32 v40, v224, v225
v_cvt_pk_bf16_f32 v41, v226, v227
v_cvt_pk_bf16_f32 v42, v228, v229
v_cvt_pk_bf16_f32 v43, v230, v231
ds_write_b128 v27, v[40:43] offset:6144
v_cvt_pk_bf16_f32 v44, v232, v233
v_cvt_pk_bf16_f32 v45, v234, v235
v_cvt_pk_bf16_f32 v46, v236, v237
v_cvt_pk_bf16_f32 v47, v238, v239
ds_write_b128 v27, v[44:47] offset:7168
v_cvt_pk_bf16_f32 v32, v144, v145
v_cvt_pk_bf16_f32 v33, v146, v147
v_cvt_pk_bf16_f32 v34, v148, v149
v_cvt_pk_bf16_f32 v35, v150, v151
ds_write_b128 v27, v[32:35] offset:8192
v_cvt_pk_bf16_f32 v36, v152, v153
v_cvt_pk_bf16_f32 v37, v154, v155
v_cvt_pk_bf16_f32 v38, v156, v157
v_cvt_pk_bf16_f32 v39, v158, v159
ds_write_b128 v27, v[36:39] offset:9216
v_cvt_pk_bf16_f32 v40, v176, v177
v_cvt_pk_bf16_f32 v41, v178, v179
v_cvt_pk_bf16_f32 v42, v180, v181
v_cvt_pk_bf16_f32 v43, v182, v183
ds_write_b128 v27, v[40:43] offset:10240
v_cvt_pk_bf16_f32 v44, v184, v185
v_cvt_pk_bf16_f32 v45, v186, v187
v_cvt_pk_bf16_f32 v46, v188, v189
v_cvt_pk_bf16_f32 v47, v190, v191
ds_write_b128 v27, v[44:47] offset:11264
v_cvt_pk_bf16_f32 v32, v208, v209
v_cvt_pk_bf16_f32 v33, v210, v211
v_cvt_pk_bf16_f32 v34, v212, v213
v_cvt_pk_bf16_f32 v35, v214, v215
ds_write_b128 v27, v[32:35] offset:12288
v_cvt_pk_bf16_f32 v36, v216, v217
v_cvt_pk_bf16_f32 v37, v218, v219
v_cvt_pk_bf16_f32 v38, v220, v221
v_cvt_pk_bf16_f32 v39, v222, v223
ds_write_b128 v27, v[36:39] offset:13312
v_cvt_pk_bf16_f32 v40, v240, v241
v_cvt_pk_bf16_f32 v41, v242, v243
v_cvt_pk_bf16_f32 v42, v244, v245
v_cvt_pk_bf16_f32 v43, v246, v247
ds_write_b128 v27, v[40:43] offset:14336
v_cvt_pk_bf16_f32 v44, v248, v249
v_cvt_pk_bf16_f32 v45, v250, v251
v_cvt_pk_bf16_f32 v46, v252, v253
v_cvt_pk_bf16_f32 v47, v254, v255
ds_write_b128 v27, v[44:47] offset:15360
s_waitcnt lgkmcnt(0)
s_barrier
s_lshr_b32 s60, s22, 1
s_lshl_b32 s60, s60, 14
v_add_u32 v2, s60, v26
v_add_u32 v3, 0x10000, v2
s_mov_b32 s74, 0
s_and_b32 s60, s22, 1
s_lshl_b32 s60, s60, 14
s_add_u32 s60, s60, 98304
v_add_u32 v27, s60, v26
ds_read_b128 a[128:131], v27 offset:0
ds_read_b128 a[132:135], v27 offset:1024
ds_read_b128 a[136:139], v27 offset:2048
ds_read_b128 a[140:143], v27 offset:3072
ds_read_b128 a[144:147], v27 offset:4096
ds_read_b128 a[148:151], v27 offset:5120
ds_read_b128 a[152:155], v27 offset:6144
ds_read_b128 a[156:159], v27 offset:7168
ds_read_b128 a[160:163], v27 offset:8192
ds_read_b128 a[164:167], v27 offset:9216
ds_read_b128 a[168:171], v27 offset:10240
ds_read_b128 a[172:175], v27 offset:11264
ds_read_b128 a[176:179], v27 offset:12288
ds_read_b128 a[180:183], v27 offset:13312
ds_read_b128 a[184:187], v27 offset:14336
s_waitcnt lgkmcnt(8)
ds_read_b128 a[188:191], v27 offset:15360
s_waitcnt lgkmcnt(8)
ds_read_b128 v[192:195], v27 offset:32768
ds_read_b128 v[196:199], v27 offset:33792
ds_read_b128 v[200:203], v27 offset:34816
ds_read_b128 v[204:207], v27 offset:35840
ds_read_b128 v[208:211], v27 offset:36864
ds_read_b128 v[212:215], v27 offset:37888
ds_read_b128 v[216:219], v27 offset:38912
s_waitcnt lgkmcnt(4)
ds_read_b128 v[220:223], v27 offset:39936
ds_read_b128 v[224:227], v27 offset:40960
ds_read_b128 v[228:231], v27 offset:41984
ds_read_b128 v[232:235], v27 offset:43008
ds_read_b128 v[236:239], v27 offset:44032
ds_read_b128 v[240:243], v27 offset:45056
ds_read_b128 v[244:247], v27 offset:46080
ds_read_b128 v[248:251], v27 offset:47104
s_waitcnt lgkmcnt(4)
ds_read_b128 v[252:255], v27 offset:48128
v_and_b32 v8, 31, v1
v_lshrrev_b32 v9, 5, v1
v_lshlrev_b32 v9, 2, v9
v_sub_u32 v8, v8, v9
v_cmp_le_i32 s[24:25], 0, v8
v_cmp_le_i32 s[26:27], 1, v8
v_cmp_le_i32 s[28:29], 2, v8
v_cmp_le_i32 s[30:31], 3, v8
v_cmp_le_i32 s[32:33], 8, v8
v_cmp_le_i32 s[34:35], 9, v8
v_cmp_le_i32 s[36:37], 10, v8
v_cmp_le_i32 s[38:39], 11, v8
v_cmp_le_i32 s[40:41], 16, v8
v_cmp_le_i32 s[42:43], 17, v8
v_cmp_le_i32 s[56:57], 18, v8
v_cmp_le_i32 s[58:59], 19, v8
v_cmp_le_i32 s[4:5], 24, v8
v_cmp_le_i32 s[6:7], 25, v8
v_cmp_le_i32 s[8:9], 26, v8
v_cmp_le_i32 s[10:11], 27, v8
v_mov_b32 v10, 0xf149f2ca
s_cmp_lg_u32 s83, 0
s_cbranch_scc1 LA_safe
s_add_u32 s68, s62, 32768
s_add_u32 s67, s62, 98304
s_mov_b32 s69, s62
s_mov_b32 s70, s62
s_sub_u32 s60, s75, 3
s_lshl_b32 s71, 29, s60
s_or_b32 s71, s71, 0xa001
v_mov_b32 v20, 0
v_mov_b32 v21, 0
v_mov_b32 v22, 0
v_mov_b32 v23, 0
s_nop 1
v_mfma_f32_32x32x16_bf16 a[0:15], v[20:23], v[20:23], 0
v_mfma_f32_32x32x16_bf16 a[16:31], v[20:23], v[20:23], 0
v_mfma_f32_32x32x16_bf16 a[32:47], v[20:23], v[20:23], 0
v_mfma_f32_32x32x16_bf16 a[48:63], v[20:23], v[20:23], 0
v_mfma_f32_32x32x16_bf16 a[64:79], v[20:23], v[20:23], 0
v_mfma_f32_32x32x16_bf16 a[80:95], v[20:23], v[20:23], 0
v_mfma_f32_32x32x16_bf16 a[96:111], v[20:23], v[20:23], 0
v_mfma_f32_32x32x16_bf16 a[112:127], v[20:23], v[20:23], 0
v_mov_b32 v4, 0
v_mov_b32 v5, 0
v_mov_b32 v6, 0
v_mov_b32 v7, 0
s_waitcnt vmcnt(0) lgkmcnt(0)
s_barrier
v_and_b32 v24, 7, v1
v_lshlrev_b32 v24, 2, v24
s_lshl_b32 s60, s20, 7
s_add_u32 s60, s60, 0x5800000
v_add_u32 v24, s60, v24
global_load_dword v23, v24, s[18:19] sc1
ds_read_b128 a[192:195], v2 offset:0
ds_read_b128 a[196:199], v2 offset:1024
ds_read_b128 a[200:203], v2 offset:2048
ds_read_b128 a[204:207], v2 offset:3072
ds_read_b128 a[208:211], v2 offset:4096
ds_read_b128 a[212:215], v2 offset:5120
s_waitcnt lgkmcnt(4)
v_mfma_f32_32x32x16_bf16 v[64:79], a[192:195], a[128:131], 0
ds_read_b128 a[216:219], v2 offset:6144
v_mfma_f32_32x32x16_bf16 v[80:95], a[192:195], a[160:163], 0
v_mfma_f32_32x32x16_bf16 v[64:79], a[196:199], a[132:135], v[64:79]
ds_read_b128 a[220:223], v2 offset:7168
v_mfma_f32_32x32x16_bf16 v[80:95], a[196:199], a[164:167], v[80:95]
s_waitcnt lgkmcnt(4)
v_mfma_f32_32x32x16_bf16 v[64:79], a[200:203], a[136:139], v[64:79]
ds_read_b128 a[224:227], v2 offset:8192
v_mfma_f32_32x32x16_bf16 v[80:95], a[200:203], a[168:171], v[80:95]
v_mfma_f32_32x32x16_bf16 v[64:79], a[204:207], a[140:143], v[64:79]
ds_read_b128 a[228:231], v2 offset:9216
v_mfma_f32_32x32x16_bf16 v[80:95], a[204:207], a[172:175], v[80:95]
s_waitcnt lgkmcnt(4)
v_mfma_f32_32x32x16_bf16 v[64:79], a[208:211], a[144:147], v[64:79]
ds_read_b128 a[232:235], v2 offset:10240
v_mfma_f32_32x32x16_bf16 v[80:95], a[208:211], a[176:179], v[80:95]
v_mfma_f32_32x32x16_bf16 v[64:79], a[212:215], a[148:151], v[64:79]
ds_read_b128 a[236:239], v2 offset:11264
v_mfma_f32_32x32x16_bf16 v[80:95], a[212:215], a[180:183], v[80:95]
s_waitcnt lgkmcnt(4)
v_mfma_f32_32x32x16_bf16 v[64:79], a[216:219], a[152:155], v[64:79]
ds_read_b128 a[240:243], v2 offset:12288
v_mfma_f32_32x32x16_bf16 v[80:95], a[216:219], a[184:187], v[80:95]
v_mfma_f32_32x32x16_bf16 v[64:79], a[220:223], a[156:159], v[64:79]
ds_read_b128 a[244:247], v2 offset:13312
v_mfma_f32_32x32x16_bf16 v[80:95], a[220:223], a[188:191], v[80:95]
s_waitcnt lgkmcnt(4)
v_mfma_f32_32x32x16_bf16 v[96:111], a[224:227], a[128:131], 0
ds_read_b128 a[248:251], v2 offset:14336
v_mfma_f32_32x32x16_bf16 v[112:127], a[224:227], a[160:163], 0
v_mfma_f32_32x32x16_bf16 v[96:111], a[228:231], a[132:135], v[96:111]
ds_read_b128 a[252:255], v2 offset:15360
v_mfma_f32_32x32x16_bf16 v[112:127], a[228:231], a[164:167], v[112:127]
s_waitcnt lgkmcnt(4)
v_mfma_f32_32x32x16_bf16 v[96:111], a[232:235], a[136:139], v[96:111]
v_mfma_f32_32x32x16_bf16 v[112:127], a[232:235], a[168:171], v[112:127]
v_mfma_f32_32x32x16_bf16 v[96:111], a[236:239], a[140:143], v[96:111]
v_mfma_f32_32x32x16_bf16 v[112:127], a[236:239], a[172:175], v[112:127]
s_waitcnt lgkmcnt(2)
v_mfma_f32_32x32x16_bf16 v[96:111], a[240:243], a[144:147], v[96:111]
v_mfma_f32_32x32x16_bf16 v[112:127], a[240:243], a[176:179], v[112:127]
v_mfma_f32_32x32x16_bf16 v[96:111], a[244:247], a[148:151], v[96:111]
v_mfma_f32_32x32x16_bf16 v[112:127], a[244:247], a[180:183], v[112:127]
s_waitcnt lgkmcnt(0)
v_mfma_f32_32x32x16_bf16 v[96:111], a[248:251], a[152:155], v[96:111]
v_mfma_f32_32x32x16_bf16 v[112:127], a[248:251], a[184:187], v[112:127]
v_mfma_f32_32x32x16_bf16 v[96:111], a[252:255], a[156:159], v[96:111]
v_mfma_f32_32x32x16_bf16 v[112:127], a[252:255], a[188:191], v[112:127]
s_waitcnt vmcnt(0)
v_cmp_ne_u32 vcc, 0, v23
s_nop 1
s_and_b32 s60, vcc_lo, 0xff
s_cmp_lg_u32 s60, 0xff
s_cbranch_scc1 Lkvf_82
s_cmp_lg_u32 s23, 1
s_cbranch_scc1 Lkvf_82
s_and_b32 s71, s71, 0xfffffffe
Lkvf_82:
s_barrier
s_add_u32 s64, s62, 65536
s_add_u32 m0, s62, 0
s_add_u32 s66, s64, 0
buffer_load_dwordx4 v26, s[44:47], s66 offen offset:0 sc1 lds
buffer_load_dwordx4 v26, s[44:47], s66 offen offset:1024 sc1 lds
buffer_load_dwordx4 v26, s[44:47], s66 offen offset:2048 sc1 lds
buffer_load_dwordx4 v26, s[44:47], s66 offen offset:3072 sc1 lds
s_add_u32 m0, s62, 4096
s_add_u32 s66, s64, 4096
buffer_load_dwordx4 v26, s[44:47], s66 offen offset:0 sc1 lds
buffer_load_dwordx4 v26, s[44:47], s66 offen offset:1024 sc1 lds
buffer_load_dwordx4 v26, s[44:47], s66 offen offset:2048 sc1 lds
buffer_load_dwordx4 v26, s[44:47], s66 offen offset:3072 sc1 lds
ds_read_b128 a[192:195], v2 offset:32768
ds_read_b128 a[196:199], v2 offset:33792
ds_read_b128 a[200:203], v2 offset:34816
ds_read_b128 a[204:207], v2 offset:35840
ds_read_b128 a[208:211], v2 offset:36864
ds_read_b128 a[212:215], v2 offset:37888
.p2align 6
LA_loop_e:
s_waitcnt vmcnt(8)
s_barrier
s_waitcnt lgkmcnt(4)
v_mfma_f32_32x32x16_bf16 v[128:143], a[192:195], a[128:131], 0
v_exp_f32 v64, v64
ds_read_b128 a[216:219], v2 offset:38912
v_exp_f32 v65, v65
v_mfma_f32_32x32x16_bf16 v[144:159], a[192:195], a[160:163], 0
v_exp_f32 v66, v66
v_exp_f32 v67, v67
v_add_f32 v4, v4, v64
v_add_f32 v5, v5, v65
v_mfma_f32_32x32x16_bf16 v[128:143], a[196:199], a[132:135], v[128:143]
s_add_u32 m0, s70, 98304
s_add_u32 s66, s68, 0
buffer_load_dwordx4 v26, s[48:51], s66 offen offset:0 sc1 lds
v_cvt_pk_bf16_f32 v32, v64, v65
v_mfma_f32_32x32x16_bf16 v[144:159], a[196:199], a[164:167], v[144:159]
ds_read_b128 a[220:223], v2 offset:39936
v_exp_f32 v68, v68
v_exp_f32 v69, v69
v_add_f32 v4, v4, v66
s_waitcnt lgkmcnt(4)
v_mfma_f32_32x32x16_bf16 v[128:143], a[200:203], a[136:139], v[128:143]
v_add_f32 v5, v5, v67
v_cvt_pk_bf16_f32 v33, v66, v67
v_exp_f32 v70, v70
ds_read_b128 a[224:227], v2 offset:40960
v_mfma_f32_32x32x16_bf16 v[144:159], a[200:203], a[168:171], v[144:159]
v_exp_f32 v71, v71
v_add_f32 v4, v4, v68
v_add_f32 v5, v5, v69
v_cvt_pk_bf16_f32 v34, v68, v69
ds_read_b128 a[228:231], v2 offset:41984
v_mfma_f32_32x32x16_bf16 v[128:143], a[204:207], a[140:143], v[128:143]
buffer_load_dwordx4 v26, s[48:51], s66 offen offset:1024 sc1 lds
ds_read_b128 a[232:235], v2 offset:43008
v_mfma_f32_32x32x16_bf16 v[144:159], a[204:207], a[172:175], v[144:159]
v_exp_f32 v80, v80
v_exp_f32 v81, v81
v_add_f32 v4, v4, v70
v_add_f32 v5, v5, v71
s_waitcnt lgkmcnt(5)
v_mfma_f32_32x32x16_bf16 v[128:143], a[208:211], a[144:147], v[128:143]
v_cvt_pk_bf16_f32 v35, v70, v71
v_exp_f32 v82, v82
v_exp_f32 v83, v83
v_mfma_f32_32x32x16_bf16 v[144:159], a[208:211], a[176:179], v[144:159]
v_add_f32 v6, v6, v80
buffer_load_dwordx4 v26, s[48:51], s66 offen offset:2048 sc1 lds
v_mfma_f32_32x32x16_bf16 v[128:143], a[212:215], a[148:151], v[128:143]
v_add_f32 v7, v7, v81
v_cvt_pk_bf16_f32 v48, v80, v81
v_exp_f32 v84, v84
v_exp_f32 v85, v85
v_mfma_f32_32x32x16_bf16 v[144:159], a[212:215], a[180:183], v[144:159]
v_add_f32 v6, v6, v82
v_add_f32 v7, v7, v83
v_cvt_pk_bf16_f32 v49, v82, v83
ds_read_b128 a[236:239], v2 offset:44032
v_exp_f32 v86, v86
s_waitcnt lgkmcnt(4)
v_mfma_f32_32x32x16_bf16 v[128:143], a[216:219], a[152:155], v[128:143]
v_exp_f32 v87, v87
v_add_f32 v6, v6, v84
v_add_f32 v7, v7, v85
v_cvt_pk_bf16_f32 v50, v84, v85
v_mfma_f32_32x32x16_bf16 v[144:159], a[216:219], a[184:187], v[144:159]
buffer_load_dwordx4 v26, s[48:51], s66 offen offset:3072 sc1 lds
ds_read_b128 a[240:243], v2 offset:45056
v_mfma_f32_32x32x16_bf16 v[128:143], a[220:223], a[156:159], v[128:143]
v_exp_f32 v72, v72
v_exp_f32 v73, v73
v_add_f32 v6, v6, v86
v_add_f32 v7, v7, v87
v_mfma_f32_32x32x16_bf16 v[144:159], a[220:223], a[188:191], v[144:159]
v_cvt_pk_bf16_f32 v51, v86, v87
v_exp_f32 v74, v74
v_exp_f32 v75, v75
ds_read_b128 a[244:247], v2 offset:46080
s_waitcnt lgkmcnt(4)
v_mfma_f32_32x32x16_bf16 v[160:175], a[224:227], a[128:131], 0
v_add_f32 v4, v4, v72
v_add_f32 v5, v5, v73
v_cvt_pk_bf16_f32 v36, v72, v73
v_exp_f32 v76, v76
v_mfma_f32_32x32x16_bf16 v[176:191], a[224:227], a[160:163], 0
s_add_u32 m0, s70, 102400
s_add_u32 s66, s68, 4096
buffer_load_dwordx4 v26, s[48:51], s66 offen offset:0 sc1 lds
ds_read_b128 a[248:251], v2 offset:47104
v_mfma_f32_32x32x16_bf16 v[160:175], a[228:231], a[132:135], v[160:175]
v_exp_f32 v77, v77
v_add_f32 v4, v4, v74
v_add_f32 v5, v5, v75
v_cvt_pk_bf16_f32 v37, v74, v75
ds_read_b128 a[252:255], v2 offset:48128
v_mfma_f32_32x32x16_bf16 v[176:191], a[228:231], a[164:167], v[176:191]
v_exp_f32 v78, v78
v_exp_f32 v79, v79
v_add_f32 v4, v4, v76
v_add_f32 v5, v5, v77
s_waitcnt lgkmcnt(4)
v_mfma_f32_32x32x16_bf16 v[160:175], a[232:235], a[136:139], v[160:175]
v_cvt_pk_bf16_f32 v38, v76, v77
v_exp_f32 v88, v88
v_exp_f32 v89, v89
v_mfma_f32_32x32x16_bf16 v[176:191], a[232:235], a[168:171], v[176:191]
buffer_load_dwordx4 v26, s[48:51], s66 offen offset:1024 sc1 lds
v_add_f32 v4, v4, v78
v_mfma_f32_32x32x16_bf16 v[160:175], a[236:239], a[140:143], v[160:175]
v_add_f32 v5, v5, v79
v_cvt_pk_bf16_f32 v39, v78, v79
v_exp_f32 v90, v90
ds_read_b128 a[192:195], v3 offset:0
v_mfma_f32_32x32x16_bf16 v[176:191], a[236:239], a[172:175], v[176:191]
v_exp_f32 v91, v91
v_add_f32 v6, v6, v88
v_add_f32 v7, v7, v89
v_cvt_pk_bf16_f32 v52, v88, v89
ds_read_b128 a[196:199], v3 offset:1024
s_waitcnt lgkmcnt(4)
v_mfma_f32_32x32x16_bf16 v[160:175], a[240:243], a[144:147], v[160:175]
v_exp_f32 v92, v92
v_exp_f32 v93, v93
v_add_f32 v6, v6, v90
v_mfma_f32_32x32x16_bf16 v[176:191], a[240:243], a[176:179], v[176:191]
buffer_load_dwordx4 v26, s[48:51], s66 offen offset:2048 sc1 lds
v_add_f32 v7, v7, v91
v_mfma_f32_32x32x16_bf16 v[160:175], a[244:247], a[148:151], v[160:175]
v_cvt_pk_bf16_f32 v53, v90, v91
v_exp_f32 v94, v94
v_exp_f32 v95, v95
v_add_f32 v6, v6, v92
v_mfma_f32_32x32x16_bf16 v[176:191], a[244:247], a[180:183], v[176:191]
ds_read_b128 a[200:203], v3 offset:2048
v_add_f32 v7, v7, v93
v_cvt_pk_bf16_f32 v54, v92, v93
v_exp_f32 v96, v96
s_waitcnt lgkmcnt(3)
v_mfma_f32_32x32x16_bf16 v[160:175], a[248:251], a[152:155], v[160:175]
v_exp_f32 v97, v97
v_add_f32 v6, v6, v94
v_add_f32 v7, v7, v95
v_cvt_pk_bf16_f32 v55, v94, v95
v_mfma_f32_32x32x16_bf16 v[176:191], a[248:251], a[184:187], v[176:191]
buffer_load_dwordx4 v26, s[48:51], s66 offen offset:3072 sc1 lds
ds_read_b128 a[204:207], v3 offset:3072
s_add_u32 s68, s68, 32768
v_mfma_f32_32x32x16_bf16 v[160:175], a[252:255], a[156:159], v[160:175]
v_exp_f32 v98, v98
v_exp_f32 v99, v99
v_add_f32 v4, v4, v96
v_add_f32 v5, v5, v97
v_mfma_f32_32x32x16_bf16 v[176:191], a[252:255], a[188:191], v[176:191]
s_waitcnt vmcnt(8)
s_barrier
v_cvt_pk_bf16_f32 v40, v96, v97
v_exp_f32 v100, v100
ds_read_b128 a[208:211], v3 offset:4096
s_waitcnt lgkmcnt(3)
v_mfma_f32_32x32x16_bf16 a[0:15], a[192:195], v[32:35], a[0:15]
v_exp_f32 v101, v101
v_add_f32 v4, v4, v98
v_add_f32 v5, v5, v99
v_cvt_pk_bf16_f32 v41, v98, v99
v_mfma_f32_32x32x16_bf16 a[64:79], a[192:195], v[48:51], a[64:79]
v_exp_f32 v102, v102
v_exp_f32 v103, v103
ds_read_b128 a[212:215], v3 offset:5120
v_add_f32 v4, v4, v100
v_mfma_f32_32x32x16_bf16 a[16:31], a[196:199], v[32:35], a[16:31]
v_add_f32 v5, v5, v101
v_cvt_pk_bf16_f32 v42, v100, v101
v_exp_f32 v112, v112
v_exp_f32 v113, v113
v_mfma_f32_32x32x16_bf16 a[80:95], a[196:199], v[48:51], a[80:95]
v_add_f32 v4, v4, v102
v_add_f32 v5, v5, v103
ds_read_b128 a[216:219], v3 offset:6144
v_cvt_pk_bf16_f32 v43, v102, v103
ds_read_b128 a[220:223], v3 offset:7168
s_waitcnt lgkmcnt(4)
v_mfma_f32_32x32x16_bf16 a[32:47], a[200:203], v[32:35], a[32:47]
v_exp_f32 v114, v114
v_exp_f32 v115, v115
v_add_f32 v6, v6, v112
v_mfma_f32_32x32x16_bf16 a[96:111], a[200:203], v[48:51], a[96:111]
v_add_f32 v7, v7, v113
v_cvt_pk_bf16_f32 v56, v112, v113
v_exp_f32 v116, v116
v_exp_f32 v117, v117
v_mfma_f32_32x32x16_bf16 a[48:63], a[204:207], v[32:35], a[48:63]
v_add_f32 v6, v6, v114
v_add_f32 v7, v7, v115
v_cvt_pk_bf16_f32 v57, v114, v115
v_exp_f32 v118, v118
ds_read_b128 a[224:227], v3 offset:8192
v_mfma_f32_32x32x16_bf16 a[112:127], a[204:207], v[48:51], a[112:127]
v_exp_f32 v119, v119
v_add_f32 v6, v6, v116
v_add_f32 v7, v7, v117
v_cvt_pk_bf16_f32 v58, v116, v117
s_waitcnt lgkmcnt(3)
v_mfma_f32_32x32x16_bf16 a[0:15], a[208:211], v[36:39], a[0:15]
v_exp_f32 v104, v104
v_exp_f32 v105, v105
ds_read_b128 a[228:231], v3 offset:9216
v_mfma_f32_32x32x16_bf16 a[64:79], a[208:211], v[52:55], a[64:79]
s_add_u32 m0, s69, 32768
s_add_u32 s66, s67, 0
buffer_load_dwordx4 v26, s[44:47], s66 offen offset:0 sc1 lds
v_add_f32 v6, v6, v118
v_mfma_f32_32x32x16_bf16 a[16:31], a[212:215], v[36:39], a[16:31]
v_add_f32 v7, v7, v119
v_cvt_pk_bf16_f32 v59, v118, v119
v_exp_f32 v106, v106
v_exp_f32 v107, v107
v_mfma_f32_32x32x16_bf16 a[80:95], a[212:215], v[52:55], a[80:95]
v_add_f32 v4, v4, v104
v_add_f32 v5, v5, v105
ds_read_b128 a[232:235], v3 offset:10240
v_cvt_pk_bf16_f32 v44, v104, v105
v_exp_f32 v108, v108
s_waitcnt lgkmcnt(3)
v_mfma_f32_32x32x16_bf16 a[32:47], a[216:219], v[36:39], a[32:47]
v_exp_f32 v109, v109
v_add_f32 v4, v4, v106
v_add_f32 v5, v5, v107
v_cvt_pk_bf16_f32 v45, v106, v107
v_mfma_f32_32x32x16_bf16 a[96:111], a[216:219], v[52:55], a[96:111]
buffer_load_dwordx4 v26, s[44:47], s66 offen offset:1024 sc1 lds
ds_read_b128 a[236:239], v3 offset:11264
v_mfma_f32_32x32x16_bf16 a[48:63], a[220:223], v[36:39], a[48:63]
v_exp_f32 v110, v110
v_exp_f32 v111, v111
v_add_f32 v4, v4, v108
v_add_f32 v5, v5, v109
v_mfma_f32_32x32x16_bf16 a[112:127], a[220:223], v[52:55], a[112:127]
v_cvt_pk_bf16_f32 v46, v108, v109
v_exp_f32 v120, v120
ds_read_b128 a[240:243], v3 offset:12288
v_exp_f32 v121, v121
s_waitcnt lgkmcnt(3)
v_mfma_f32_32x32x16_bf16 a[0:15], a[224:227], v[40:43], a[0:15]
buffer_load_dwordx4 v26, s[44:47], s66 offen offset:2048 sc1 lds
v_add_f32 v4, v4, v110
v_mfma_f32_32x32x16_bf16 a[64:79], a[224:227], v[56:59], a[64:79]
v_add_f32 v5, v5, v111
v_cvt_pk_bf16_f32 v47, v110, v111
v_exp_f32 v122, v122
v_exp_f32 v123, v123
v_mfma_f32_32x32x16_bf16 a[16:31], a[228:231], v[40:43], a[16:31]
ds_read_b128 a[244:247], v3 offset:13312
v_add_f32 v6, v6, v120
v_add_f32 v7, v7, v121
v_cvt_pk_bf16_f32 v60, v120, v121
ds_read_b128 a[248:251], v3 offset:14336
v_mfma_f32_32x32x16_bf16 a[80:95], a[228:231], v[56:59], a[80:95]
v_exp_f32 v124, v124
v_exp_f32 v125, v125
v_add_f32 v6, v6, v122
v_add_f32 v7, v7, v123
s_waitcnt lgkmcnt(3)
v_mfma_f32_32x32x16_bf16 a[32:47], a[232:235], v[40:43], a[32:47]
buffer_load_dwordx4 v26, s[44:47], s66 offen offset:3072 sc1 lds
v_cvt_pk_bf16_f32 v61, v122, v123
v_mfma_f32_32x32x16_bf16 a[96:111], a[232:235], v[56:59], a[96:111]
v_exp_f32 v126, v126
v_exp_f32 v127, v127
v_add_f32 v6, v6, v124
v_add_f32 v7, v7, v125
v_mfma_f32_32x32x16_bf16 a[48:63], a[236:239], v[40:43], a[48:63]
v_cvt_pk_bf16_f32 v62, v124, v125
s_nop 0
v_add_f32 v6, v6, v126
v_add_f32 v7, v7, v127
v_cvt_pk_bf16_f32 v63, v126, v127
ds_read_b128 a[252:255], v3 offset:15360
v_mfma_f32_32x32x16_bf16 a[112:127], a[236:239], v[56:59], a[112:127]
s_add_u32 m0, s69, 36864
s_add_u32 s66, s67, 4096
buffer_load_dwordx4 v26, s[44:47], s66 offen offset:0 sc1 lds
ds_read_b128 a[192:195], v2 offset:0
s_waitcnt lgkmcnt(3)
v_mfma_f32_32x32x16_bf16 a[0:15], a[240:243], v[44:47], a[0:15]
ds_read_b128 a[196:199], v2 offset:1024
buffer_load_dwordx4 v26, s[44:47], s66 offen offset:1024 sc1 lds
v_mfma_f32_32x32x16_bf16 a[64:79], a[240:243], v[60:63], a[64:79]
ds_read_b128 a[200:203], v2 offset:2048
buffer_load_dwordx4 v26, s[44:47], s66 offen offset:2048 sc1 lds
v_mfma_f32_32x32x16_bf16 a[16:31], a[244:247], v[44:47], a[16:31]
ds_read_b128 a[204:207], v2 offset:3072
ds_read_b128 a[208:211], v2 offset:4096
v_mfma_f32_32x32x16_bf16 a[80:95], a[244:247], v[60:63], a[80:95]
buffer_load_dwordx4 v26, s[44:47], s66 offen offset:3072 sc1 lds
s_waitcnt lgkmcnt(5)
v_mfma_f32_32x32x16_bf16 a[32:47], a[248:251], v[44:47], a[32:47]
s_add_u32 s67, s67, 32768
ds_read_b128 a[212:215], v2 offset:5120
v_mfma_f32_32x32x16_bf16 a[96:111], a[248:251], v[60:63], a[96:111]
v_mfma_f32_32x32x16_bf16 a[48:63], a[252:255], v[44:47], a[48:63]
v_mfma_f32_32x32x16_bf16 a[112:127], a[252:255], v[60:63], a[112:127]
s_bitcmp1_b32 s71, s74
s_cbranch_scc1 LA_ev_e
LA_cont_e:
s_add_u32 s74, s74, 1
s_waitcnt vmcnt(8)
s_barrier
s_waitcnt lgkmcnt(4)
v_mfma_f32_32x32x16_bf16 v[64:79], a[192:195], a[128:131], 0
v_exp_f32 v128, v128
ds_read_b128 a[216:219], v2 offset:6144
v_exp_f32 v129, v129
v_mfma_f32_32x32x16_bf16 v[80:95], a[192:195], a[160:163], 0
v_exp_f32 v130, v130
v_exp_f32 v131, v131
v_add_f32 v4, v4, v128
v_add_f32 v5, v5, v129
v_mfma_f32_32x32x16_bf16 v[64:79], a[196:199], a[132:135], v[64:79]
s_add_u32 m0, s70, 65536
s_add_u32 s66, s68, 0
buffer_load_dwordx4 v26, s[48:51], s66 offen offset:0 sc1 lds
v_cvt_pk_bf16_f32 v32, v128, v129
v_mfma_f32_32x32x16_bf16 v[80:95], a[196:199], a[164:167], v[80:95]
ds_read_b128 a[220:223], v2 offset:7168
v_exp_f32 v132, v132
v_exp_f32 v133, v133
v_add_f32 v4, v4, v130
s_waitcnt lgkmcnt(4)
v_mfma_f32_32x32x16_bf16 v[64:79], a[200:203], a[136:139], v[64:79]
v_add_f32 v5, v5, v131
v_cvt_pk_bf16_f32 v33, v130, v131
v_exp_f32 v134, v134
ds_read_b128 a[224:227], v2 offset:8192
v_mfma_f32_32x32x16_bf16 v[80:95], a[200:203], a[168:171], v[80:95]
v_exp_f32 v135, v135
v_add_f32 v4, v4, v132
v_add_f32 v5, v5, v133
v_cvt_pk_bf16_f32 v34, v132, v133
ds_read_b128 a[228:231], v2 offset:9216
v_mfma_f32_32x32x16_bf16 v[64:79], a[204:207], a[140:143], v[64:79]
buffer_load_dwordx4 v26, s[48:51], s66 offen offset:1024 sc1 lds
ds_read_b128 a[232:235], v2 offset:10240
v_mfma_f32_32x32x16_bf16 v[80:95], a[204:207], a[172:175], v[80:95]
v_exp_f32 v144, v144
v_exp_f32 v145, v145
v_add_f32 v4, v4, v134
v_add_f32 v5, v5, v135
s_waitcnt lgkmcnt(5)
v_mfma_f32_32x32x16_bf16 v[64:79], a[208:211], a[144:147], v[64:79]
v_cvt_pk_bf16_f32 v35, v134, v135
v_exp_f32 v146, v146
v_exp_f32 v147, v147
v_mfma_f32_32x32x16_bf16 v[80:95], a[208:211], a[176:179], v[80:95]
v_add_f32 v6, v6, v144
buffer_load_dwordx4 v26, s[48:51], s66 offen offset:2048 sc1 lds
v_mfma_f32_32x32x16_bf16 v[64:79], a[212:215], a[148:151], v[64:79]
v_add_f32 v7, v7, v145
v_cvt_pk_bf16_f32 v48, v144, v145
v_exp_f32 v148, v148
v_exp_f32 v149, v149
v_mfma_f32_32x32x16_bf16 v[80:95], a[212:215], a[180:183], v[80:95]
v_add_f32 v6, v6, v146
v_add_f32 v7, v7, v147
v_cvt_pk_bf16_f32 v49, v146, v147
ds_read_b128 a[236:239], v2 offset:11264
v_exp_f32 v150, v150
s_waitcnt lgkmcnt(4)
v_mfma_f32_32x32x16_bf16 v[64:79], a[216:219], a[152:155], v[64:79]
v_exp_f32 v151, v151
v_add_f32 v6, v6, v148
v_add_f32 v7, v7, v149
v_cvt_pk_bf16_f32 v50, v148, v149
v_mfma_f32_32x32x16_bf16 v[80:95], a[216:219], a[184:187], v[80:95]
buffer_load_dwordx4 v26, s[48:51], s66 offen offset:3072 sc1 lds
ds_read_b128 a[240:243], v2 offset:12288
v_mfma_f32_32x32x16_bf16 v[64:79], a[220:223], a[156:159], v[64:79]
v_exp_f32 v136, v136
v_exp_f32 v137, v137
v_add_f32 v6, v6, v150
v_add_f32 v7, v7, v151
v_mfma_f32_32x32x16_bf16 v[80:95], a[220:223], a[188:191], v[80:95]
v_cvt_pk_bf16_f32 v51, v150, v151
v_exp_f32 v138, v138
v_exp_f32 v139, v139
ds_read_b128 a[244:247], v2 offset:13312
s_waitcnt lgkmcnt(4)
v_mfma_f32_32x32x16_bf16 v[96:111], a[224:227], a[128:131], 0
v_add_f32 v4, v4, v136
v_add_f32 v5, v5, v137
v_cvt_pk_bf16_f32 v36, v136, v137
v_exp_f32 v140, v140
v_mfma_f32_32x32x16_bf16 v[112:127], a[224:227], a[160:163], 0
s_add_u32 m0, s70, 69632
s_add_u32 s66, s68, 4096
buffer_load_dwordx4 v26, s[48:51], s66 offen offset:0 sc1 lds
ds_read_b128 a[248:251], v2 offset:14336
v_mfma_f32_32x32x16_bf16 v[96:111], a[228:231], a[132:135], v[96:111]
v_exp_f32 v141, v141
v_add_f32 v4, v4, v138
v_add_f32 v5, v5, v139
v_cvt_pk_bf16_f32 v37, v138, v139
ds_read_b128 a[252:255], v2 offset:15360
v_mfma_f32_32x32x16_bf16 v[112:127], a[228:231], a[164:167], v[112:127]
v_exp_f32 v142, v142
v_exp_f32 v143, v143
v_add_f32 v4, v4, v140
v_add_f32 v5, v5, v141
s_waitcnt lgkmcnt(4)
v_mfma_f32_32x32x16_bf16 v[96:111], a[232:235], a[136:139], v[96:111]
v_cvt_pk_bf16_f32 v38, v140, v141
v_exp_f32 v152, v152
v_exp_f32 v153, v153
v_mfma_f32_32x32x16_bf16 v[112:127], a[232:235], a[168:171], v[112:127]
buffer_load_dwordx4 v26, s[48:51], s66 offen offset:1024 sc1 lds
v_add_f32 v4, v4, v142
v_mfma_f32_32x32x16_bf16 v[96:111], a[236:239], a[140:143], v[96:111]
v_add_f32 v5, v5, v143
v_cvt_pk_bf16_f32 v39, v142, v143
v_exp_f32 v154, v154
ds_read_b128 a[192:195], v3 offset:32768
v_mfma_f32_32x32x16_bf16 v[112:127], a[236:239], a[172:175], v[112:127]
v_exp_f32 v155, v155
v_add_f32 v6, v6, v152
v_add_f32 v7, v7, v153
v_cvt_pk_bf16_f32 v52, v152, v153
ds_read_b128 a[196:199], v3 offset:33792
s_waitcnt lgkmcnt(4)
v_mfma_f32_32x32x16_bf16 v[96:111], a[240:243], a[144:147], v[96:111]
v_exp_f32 v156, v156
v_exp_f32 v157, v157
v_add_f32 v6, v6, v154
v_mfma_f32_32x32x16_bf16 v[112:127], a[240:243], a[176:179], v[112:127]
buffer_load_dwordx4 v26, s[48:51], s66 offen offset:2048 sc1 lds
v_add_f32 v7, v7, v155
v_mfma_f32_32x32x16_bf16 v[96:111], a[244:247], a[148:151], v[96:111]
v_cvt_pk_bf16_f32 v53, v154, v155
v_exp_f32 v158, v158
v_exp_f32 v159, v159
v_add_f32 v6, v6, v156
v_mfma_f32_32x32x16_bf16 v[112:127], a[244:247], a[180:183], v[112:127]
ds_read_b128 a[200:203], v3 offset:34816
v_add_f32 v7, v7, v157
v_cvt_pk_bf16_f32 v54, v156, v157
v_exp_f32 v160, v160
s_waitcnt lgkmcnt(3)
v_mfma_f32_32x32x16_bf16 v[96:111], a[248:251], a[152:155], v[96:111]
v_exp_f32 v161, v161
v_add_f32 v6, v6, v158
v_add_f32 v7, v7, v159
v_cvt_pk_bf16_f32 v55, v158, v159
v_mfma_f32_32x32x16_bf16 v[112:127], a[248:251], a[184:187], v[112:127]
buffer_load_dwordx4 v26, s[48:51], s66 offen offset:3072 sc1 lds
ds_read_b128 a[204:207], v3 offset:35840
s_add_u32 s68, s68, 32768
v_mfma_f32_32x32x16_bf16 v[96:111], a[252:255], a[156:159], v[96:111]
v_exp_f32 v162, v162
v_exp_f32 v163, v163
v_add_f32 v4, v4, v160
v_add_f32 v5, v5, v161
v_mfma_f32_32x32x16_bf16 v[112:127], a[252:255], a[188:191], v[112:127]
s_waitcnt vmcnt(8)
s_barrier
v_cvt_pk_bf16_f32 v40, v160, v161
v_exp_f32 v164, v164
ds_read_b128 a[208:211], v3 offset:36864
s_waitcnt lgkmcnt(3)
v_mfma_f32_32x32x16_bf16 a[0:15], a[192:195], v[32:35], a[0:15]
v_exp_f32 v165, v165
v_add_f32 v4, v4, v162
v_add_f32 v5, v5, v163
v_cvt_pk_bf16_f32 v41, v162, v163
v_mfma_f32_32x32x16_bf16 a[64:79], a[192:195], v[48:51], a[64:79]
v_exp_f32 v166, v166
v_exp_f32 v167, v167
ds_read_b128 a[212:215], v3 offset:37888
v_add_f32 v4, v4, v164
v_mfma_f32_32x32x16_bf16 a[16:31], a[196:199], v[32:35], a[16:31]
v_add_f32 v5, v5, v165
v_cvt_pk_bf16_f32 v42, v164, v165
v_exp_f32 v176, v176
v_exp_f32 v177, v177
v_mfma_f32_32x32x16_bf16 a[80:95], a[196:199], v[48:51], a[80:95]
v_add_f32 v4, v4, v166
v_add_f32 v5, v5, v167
ds_read_b128 a[216:219], v3 offset:38912
v_cvt_pk_bf16_f32 v43, v166, v167
ds_read_b128 a[220:223], v3 offset:39936
s_waitcnt lgkmcnt(4)
v_mfma_f32_32x32x16_bf16 a[32:47], a[200:203], v[32:35], a[32:47]
v_exp_f32 v178, v178
v_exp_f32 v179, v179
v_add_f32 v6, v6, v176
v_mfma_f32_32x32x16_bf16 a[96:111], a[200:203], v[48:51], a[96:111]
v_add_f32 v7, v7, v177
v_cvt_pk_bf16_f32 v56, v176, v177
v_exp_f32 v180, v180
v_exp_f32 v181, v181
v_mfma_f32_32x32x16_bf16 a[48:63], a[204:207], v[32:35], a[48:63]
v_add_f32 v6, v6, v178
v_add_f32 v7, v7, v179
v_cvt_pk_bf16_f32 v57, v178, v179
v_exp_f32 v182, v182
ds_read_b128 a[224:227], v3 offset:40960
v_mfma_f32_32x32x16_bf16 a[112:127], a[204:207], v[48:51], a[112:127]
v_exp_f32 v183, v183
v_add_f32 v6, v6, v180
v_add_f32 v7, v7, v181
v_cvt_pk_bf16_f32 v58, v180, v181
s_waitcnt lgkmcnt(3)
v_mfma_f32_32x32x16_bf16 a[0:15], a[208:211], v[36:39], a[0:15]
v_exp_f32 v168, v168
v_exp_f32 v169, v169
ds_read_b128 a[228:231], v3 offset:41984
v_mfma_f32_32x32x16_bf16 a[64:79], a[208:211], v[52:55], a[64:79]
s_add_u32 m0, s69, 0
s_add_u32 s66, s67, 0
buffer_load_dwordx4 v26, s[44:47], s66 offen offset:0 sc1 lds
v_add_f32 v6, v6, v182
v_mfma_f32_32x32x16_bf16 a[16:31], a[212:215], v[36:39], a[16:31]
v_add_f32 v7, v7, v183
v_cvt_pk_bf16_f32 v59, v182, v183
v_exp_f32 v170, v170
v_exp_f32 v171, v171
v_mfma_f32_32x32x16_bf16 a[80:95], a[212:215], v[52:55], a[80:95]
v_add_f32 v4, v4, v168
v_add_f32 v5, v5, v169
ds_read_b128 a[232:235], v3 offset:43008
v_cvt_pk_bf16_f32 v44, v168, v169
v_exp_f32 v172, v172
s_waitcnt lgkmcnt(3)
v_mfma_f32_32x32x16_bf16 a[32:47], a[216:219], v[36:39], a[32:47]
v_exp_f32 v173, v173
v_add_f32 v4, v4, v170
v_add_f32 v5, v5, v171
v_cvt_pk_bf16_f32 v45, v170, v171
v_mfma_f32_32x32x16_bf16 a[96:111], a[216:219], v[52:55], a[96:111]
buffer_load_dwordx4 v26, s[44:47], s66 offen offset:1024 sc1 lds
ds_read_b128 a[236:239], v3 offset:44032
v_mfma_f32_32x32x16_bf16 a[48:63], a[220:223], v[36:39], a[48:63]
v_exp_f32 v174, v174
v_exp_f32 v175, v175
v_add_f32 v4, v4, v172
v_add_f32 v5, v5, v173
v_mfma_f32_32x32x16_bf16 a[112:127], a[220:223], v[52:55], a[112:127]
v_cvt_pk_bf16_f32 v46, v172, v173
v_exp_f32 v184, v184
ds_read_b128 a[240:243], v3 offset:45056
v_exp_f32 v185, v185
s_waitcnt lgkmcnt(3)
v_mfma_f32_32x32x16_bf16 a[0:15], a[224:227], v[40:43], a[0:15]
buffer_load_dwordx4 v26, s[44:47], s66 offen offset:2048 sc1 lds
v_add_f32 v4, v4, v174
v_mfma_f32_32x32x16_bf16 a[64:79], a[224:227], v[56:59], a[64:79]
v_add_f32 v5, v5, v175
v_cvt_pk_bf16_f32 v47, v174, v175
v_exp_f32 v186, v186
v_exp_f32 v187, v187
v_mfma_f32_32x32x16_bf16 a[16:31], a[228:231], v[40:43], a[16:31]
ds_read_b128 a[244:247], v3 offset:46080
v_add_f32 v6, v6, v184
v_add_f32 v7, v7, v185
v_cvt_pk_bf16_f32 v60, v184, v185
ds_read_b128 a[248:251], v3 offset:47104
v_mfma_f32_32x32x16_bf16 a[80:95], a[228:231], v[56:59], a[80:95]
v_exp_f32 v188, v188
v_exp_f32 v189, v189
v_add_f32 v6, v6, v186
v_add_f32 v7, v7, v187
s_waitcnt lgkmcnt(3)
v_mfma_f32_32x32x16_bf16 a[32:47], a[232:235], v[40:43], a[32:47]
buffer_load_dwordx4 v26, s[44:47], s66 offen offset:3072 sc1 lds
v_cvt_pk_bf16_f32 v61, v186, v187
v_mfma_f32_32x32x16_bf16 a[96:111], a[232:235], v[56:59], a[96:111]
v_exp_f32 v190, v190
v_exp_f32 v191, v191
v_add_f32 v6, v6, v188
v_add_f32 v7, v7, v189
v_mfma_f32_32x32x16_bf16 a[48:63], a[236:239], v[40:43], a[48:63]
v_cvt_pk_bf16_f32 v62, v188, v189
s_nop 0
v_add_f32 v6, v6, v190
v_add_f32 v7, v7, v191
v_cvt_pk_bf16_f32 v63, v190, v191
ds_read_b128 a[252:255], v3 offset:48128
v_mfma_f32_32x32x16_bf16 a[112:127], a[236:239], v[56:59], a[112:127]
s_add_u32 m0, s69, 4096
s_add_u32 s66, s67, 4096
buffer_load_dwordx4 v26, s[44:47], s66 offen offset:0 sc1 lds
ds_read_b128 a[192:195], v2 offset:32768
s_waitcnt lgkmcnt(3)
v_mfma_f32_32x32x16_bf16 a[0:15], a[240:243], v[44:47], a[0:15]
ds_read_b128 a[196:199], v2 offset:33792
buffer_load_dwordx4 v26, s[44:47], s66 offen offset:1024 sc1 lds
v_mfma_f32_32x32x16_bf16 a[64:79], a[240:243], v[60:63], a[64:79]
ds_read_b128 a[200:203], v2 offset:34816
buffer_load_dwordx4 v26, s[44:47], s66 offen offset:2048 sc1 lds
v_mfma_f32_32x32x16_bf16 a[16:31], a[244:247], v[44:47], a[16:31]
ds_read_b128 a[204:207], v2 offset:35840
ds_read_b128 a[208:211], v2 offset:36864
v_mfma_f32_32x32x16_bf16 a[80:95], a[244:247], v[60:63], a[80:95]
buffer_load_dwordx4 v26, s[44:47], s66 offen offset:3072 sc1 lds
s_waitcnt lgkmcnt(5)
v_mfma_f32_32x32x16_bf16 a[32:47], a[248:251], v[44:47], a[32:47]
s_add_u32 s67, s67, 32768
ds_read_b128 a[212:215], v2 offset:37888
v_mfma_f32_32x32x16_bf16 a[96:111], a[248:251], v[60:63], a[96:111]
v_mfma_f32_32x32x16_bf16 a[48:63], a[252:255], v[44:47], a[48:63]
v_mfma_f32_32x32x16_bf16 a[112:127], a[252:255], v[60:63], a[112:127]
s_bitcmp1_b32 s71, s74
s_cbranch_scc1 LA_ev_o
LA_cont_o:
s_add_u32 s74, s74, 1
s_cmp_lt_u32 s74, 16
s_cbranch_scc1 LA_loop_e
s_waitcnt lgkmcnt(0)
s_waitcnt vmcnt(8)
s_barrier
ds_read_b128 a[192:195], v3 offset:0
ds_read_b128 a[196:199], v3 offset:1024
v_exp_f32 v64, v64
v_exp_f32 v65, v65
v_exp_f32 v66, v66
v_exp_f32 v67, v67
v_add_f32 v4, v4, v64
v_add_f32 v5, v5, v65
v_cvt_pk_bf16_f32 v32, v64, v65
v_exp_f32 v68, v68
v_exp_f32 v69, v69
v_add_f32 v4, v4, v66
v_add_f32 v5, v5, v67
v_cvt_pk_bf16_f32 v33, v66, v67
v_exp_f32 v70, v70
v_exp_f32 v71, v71
v_add_f32 v4, v4, v68
v_add_f32 v5, v5, v69
v_cvt_pk_bf16_f32 v34, v68, v69
v_exp_f32 v80, v80
v_exp_f32 v81, v81
v_add_f32 v4, v4, v70
v_add_f32 v5, v5, v71
v_cvt_pk_bf16_f32 v35, v70, v71
v_exp_f32 v82, v82
v_exp_f32 v83, v83
v_add_f32 v6, v6, v80
v_add_f32 v7, v7, v81
v_cvt_pk_bf16_f32 v48, v80, v81
v_exp_f32 v84, v84
v_exp_f32 v85, v85
v_add_f32 v6, v6, v82
v_add_f32 v7, v7, v83
v_cvt_pk_bf16_f32 v49, v82, v83
v_exp_f32 v86, v86
v_exp_f32 v87, v87
v_add_f32 v6, v6, v84
v_add_f32 v7, v7, v85
v_cvt_pk_bf16_f32 v50, v84, v85
v_exp_f32 v72, v72
v_exp_f32 v73, v73
v_add_f32 v6, v6, v86
v_add_f32 v7, v7, v87
v_cvt_pk_bf16_f32 v51, v86, v87
s_nop 0
s_waitcnt lgkmcnt(0)
v_mfma_f32_32x32x16_bf16 a[0:15], a[192:195], v[32:35], a[0:15]
ds_read_b128 a[200:203], v3 offset:2048
ds_read_b128 a[204:207], v3 offset:3072
ds_read_b128 a[208:211], v3 offset:4096
ds_read_b128 a[212:215], v3 offset:5120
v_exp_f32 v74, v74
ds_read_b128 a[216:219], v3 offset:6144
ds_read_b128 a[220:223], v3 offset:7168
v_mfma_f32_32x32x16_bf16 a[64:79], a[192:195], v[48:51], a[64:79]
v_exp_f32 v75, v75
v_add_f32 v4, v4, v72
v_add_f32 v5, v5, v73
v_cvt_pk_bf16_f32 v36, v72, v73
v_exp_f32 v76, v76
v_exp_f32 v77, v77
v_add_f32 v4, v4, v74
v_mfma_f32_32x32x16_bf16 a[16:31], a[196:199], v[32:35], a[16:31]
v_add_f32 v5, v5, v75
v_cvt_pk_bf16_f32 v37, v74, v75
v_exp_f32 v78, v78
v_exp_f32 v79, v79
v_add_f32 v4, v4, v76
v_add_f32 v5, v5, v77
v_cvt_pk_bf16_f32 v38, v76, v77
ds_read_b128 a[224:227], v3 offset:8192
v_mfma_f32_32x32x16_bf16 a[80:95], a[196:199], v[48:51], a[80:95]
v_exp_f32 v88, v88
v_exp_f32 v89, v89
v_add_f32 v4, v4, v78
v_add_f32 v5, v5, v79
v_cvt_pk_bf16_f32 v39, v78, v79
v_exp_f32 v90, v90
s_waitcnt lgkmcnt(5)
v_mfma_f32_32x32x16_bf16 a[32:47], a[200:203], v[32:35], a[32:47]
v_exp_f32 v91, v91
v_add_f32 v6, v6, v88
v_add_f32 v7, v7, v89
v_cvt_pk_bf16_f32 v52, v88, v89
v_exp_f32 v92, v92
v_exp_f32 v93, v93
v_mfma_f32_32x32x16_bf16 a[96:111], a[200:203], v[48:51], a[96:111]
v_add_f32 v6, v6, v90
v_add_f32 v7, v7, v91
v_cvt_pk_bf16_f32 v53, v90, v91
v_exp_f32 v94, v94
v_exp_f32 v95, v95
v_add_f32 v6, v6, v92
v_add_f32 v7, v7, v93
v_cvt_pk_bf16_f32 v54, v92, v93
v_mfma_f32_32x32x16_bf16 a[48:63], a[204:207], v[32:35], a[48:63]
v_exp_f32 v96, v96
v_exp_f32 v97, v97
v_add_f32 v6, v6, v94
v_add_f32 v7, v7, v95
v_cvt_pk_bf16_f32 v55, v94, v95
v_exp_f32 v98, v98
ds_read_b128 a[228:231], v3 offset:9216
v_mfma_f32_32x32x16_bf16 a[112:127], a[204:207], v[48:51], a[112:127]
v_exp_f32 v99, v99
v_add_f32 v4, v4, v96
v_add_f32 v5, v5, v97
v_cvt_pk_bf16_f32 v40, v96, v97
v_exp_f32 v100, v100
v_exp_f32 v101, v101
v_add_f32 v4, v4, v98
s_waitcnt lgkmcnt(4)
v_mfma_f32_32x32x16_bf16 a[0:15], a[208:211], v[36:39], a[0:15]
v_add_f32 v5, v5, v99
v_cvt_pk_bf16_f32 v41, v98, v99
v_exp_f32 v102, v102
v_exp_f32 v103, v103
v_add_f32 v4, v4, v100
v_add_f32 v5, v5, v101
v_cvt_pk_bf16_f32 v42, v100, v101
v_mfma_f32_32x32x16_bf16 a[64:79], a[208:211], v[52:55], a[64:79]
v_exp_f32 v112, v112
v_exp_f32 v113, v113
v_add_f32 v4, v4, v102
v_add_f32 v5, v5, v103
ds_read_b128 a[232:235], v3 offset:10240
v_cvt_pk_bf16_f32 v43, v102, v103
v_exp_f32 v114, v114
v_mfma_f32_32x32x16_bf16 a[16:31], a[212:215], v[36:39], a[16:31]
v_exp_f32 v115, v115
v_add_f32 v6, v6, v112
v_add_f32 v7, v7, v113
v_cvt_pk_bf16_f32 v56, v112, v113
v_exp_f32 v116, v116
v_exp_f32 v117, v117
v_add_f32 v6, v6, v114
v_mfma_f32_32x32x16_bf16 a[80:95], a[212:215], v[52:55], a[80:95]
v_add_f32 v7, v7, v115
v_cvt_pk_bf16_f32 v57, v114, v115
v_exp_f32 v118, v118
v_exp_f32 v119, v119
v_add_f32 v6, v6, v116
v_add_f32 v7, v7, v117
ds_read_b128 a[236:239], v3 offset:11264
s_waitcnt lgkmcnt(4)
v_mfma_f32_32x32x16_bf16 a[32:47], a[216:219], v[36:39], a[32:47]
v_cvt_pk_bf16_f32 v58, v116, v117
v_exp_f32 v104, v104
v_exp_f32 v105, v105
v_add_f32 v6, v6, v118
v_add_f32 v7, v7, v119
v_cvt_pk_bf16_f32 v59, v118, v119
ds_read_b128 a[240:243], v3 offset:12288
v_mfma_f32_32x32x16_bf16 a[96:111], a[216:219], v[52:55], a[96:111]
v_exp_f32 v106, v106
v_exp_f32 v107, v107
v_add_f32 v4, v4, v104
v_add_f32 v5, v5, v105
v_cvt_pk_bf16_f32 v44, v104, v105
v_exp_f32 v108, v108
ds_read_b128 a[244:247], v3 offset:13312
v_mfma_f32_32x32x16_bf16 a[48:63], a[220:223], v[36:39], a[48:63]
v_exp_f32 v109, v109
v_add_f32 v4, v4, v106
v_add_f32 v5, v5, v107
v_cvt_pk_bf16_f32 v45, v106, v107
v_exp_f32 v110, v110
v_exp_f32 v111, v111
v_add_f32 v4, v4, v108
v_mfma_f32_32x32x16_bf16 a[112:127], a[220:223], v[52:55], a[112:127]
v_add_f32 v5, v5, v109
v_cvt_pk_bf16_f32 v46, v108, v109
v_exp_f32 v120, v120
v_exp_f32 v121, v121
v_add_f32 v4, v4, v110
v_add_f32 v5, v5, v111
v_cvt_pk_bf16_f32 v47, v110, v111
s_waitcnt lgkmcnt(4)
v_mfma_f32_32x32x16_bf16 a[0:15], a[224:227], v[40:43], a[0:15]
v_exp_f32 v122, v122
v_exp_f32 v123, v123
v_add_f32 v6, v6, v120
v_add_f32 v7, v7, v121
v_cvt_pk_bf16_f32 v60, v120, v121
v_exp_f32 v124, v124
v_mfma_f32_32x32x16_bf16 a[64:79], a[224:227], v[56:59], a[64:79]
v_exp_f32 v125, v125
v_add_f32 v6, v6, v122
v_add_f32 v7, v7, v123
v_cvt_pk_bf16_f32 v61, v122, v123
v_exp_f32 v126, v126
v_exp_f32 v127, v127
v_add_f32 v6, v6, v124
v_mfma_f32_32x32x16_bf16 a[16:31], a[228:231], v[40:43], a[16:31]
v_add_f32 v7, v7, v125
v_cvt_pk_bf16_f32 v62, v124, v125
s_nop 0
v_add_f32 v6, v6, v126
v_add_f32 v7, v7, v127
v_cvt_pk_bf16_f32 v63, v126, v127
ds_read_b128 a[248:251], v3 offset:14336
ds_read_b128 a[252:255], v3 offset:15360
v_mfma_f32_32x32x16_bf16 a[80:95], a[228:231], v[56:59], a[80:95]
s_waitcnt lgkmcnt(4)
v_mfma_f32_32x32x16_bf16 a[32:47], a[232:235], v[40:43], a[32:47]
v_mfma_f32_32x32x16_bf16 a[96:111], a[232:235], v[56:59], a[96:111]
v_mfma_f32_32x32x16_bf16 a[48:63], a[236:239], v[40:43], a[48:63]
v_mfma_f32_32x32x16_bf16 a[112:127], a[236:239], v[56:59], a[112:127]
s_waitcnt lgkmcnt(2)
v_mfma_f32_32x32x16_bf16 a[0:15], a[240:243], v[44:47], a[0:15]
v_mfma_f32_32x32x16_bf16 a[64:79], a[240:243], v[60:63], a[64:79]
v_mfma_f32_32x32x16_bf16 a[16:31], a[244:247], v[44:47], a[16:31]
v_mfma_f32_32x32x16_bf16 a[80:95], a[244:247], v[60:63], a[80:95]
s_waitcnt lgkmcnt(0)
v_mfma_f32_32x32x16_bf16 a[32:47], a[248:251], v[44:47], a[32:47]
v_mfma_f32_32x32x16_bf16 a[96:111], a[248:251], v[60:63], a[96:111]
v_mfma_f32_32x32x16_bf16 a[48:63], a[252:255], v[44:47], a[48:63]
v_mfma_f32_32x32x16_bf16 a[112:127], a[252:255], v[60:63], a[112:127]
s_mov_b32 s78, 2
s_branch LA_fin
LA_ev_e:
s_cmp_lg_u32 s74, 0
s_cbranch_scc1 Lev_83
s_mov_b32 s61, 0
Lsf_84:
global_load_dword v23, v24, s[18:19] sc1
s_waitcnt vmcnt(0)
v_cmp_ne_u32 vcc, 0, v23
s_nop 1
s_and_b32 s60, vcc_lo, 0xff
s_cmp_eq_u32 s60, 0xff
s_cbranch_scc1 Lsfd_85
s_add_u32 s61, s61, 1
s_cmp_lt_u32 s61, 0x40000
s_sleep 2
s_cbranch_scc1 Lsf_84
Lsfd_85:
s_cmp_eq_u32 s23, 1
s_cbranch_scc1 Lev_83
buffer_inv sc1
s_waitcnt vmcnt(0)
Lev_83:
s_add_u32 s60, s75, 1
s_cmp_lg_u32 s60, s74
s_cbranch_scc1 Lev_86
s_bitcmp1_b32 s82, 0
s_cbranch_scc1 Lev_86
s_cmp_lg_u32 s22, 0
s_cbranch_scc1 Lcs_87
s_lshl_b32 s60, s75, 2
s_lshr_b32 s61, s20, 3
s_add_u32 s60, s60, s61
s_lshl_b32 s60, s60, 7
s_and_b32 s61, s20, 7
s_lshl_b32 s61, s61, 2
s_add_u32 s60, s60, s61
s_add_u32 s60, s60, 4096
s_add_u32 s60, s60, 0x5800000
v_mov_b32 v22, s60
v_mov_b32 v23, 1
s_mov_b64 s[60:61], exec
s_mov_b64 exec, 1
global_store_dword v22, v23, s[18:19] sc1
s_mov_b64 exec, s[60:61]
Lcs_87:
Lev_86:
s_add_u32 s60, s74, 3
s_cmp_lg_u32 s60, s75
s_cbranch_scc1 Lev_88
s_mov_b32 s67, s62
Lev_88:
s_cmp_lg_u32 s74, 13
s_cbranch_scc1 Lev_89
s_mov_b32 s69, 0x30000
s_mov_b32 s67, 0x200000
Lev_89:
s_cmp_lg_u32 s74, 15
s_cbranch_scc1 Lev_90
s_mov_b32 s70, 0x30000
s_mov_b32 s68, 0x200000
s_and_b32 s12, s2, 3
s_bfe_u32 s13, s2, 0x10002
s_lshr_b32 s15, s2, 3
s_and_b32 s60, s15, 7
s_lshl_b32 s13, s13, 3
s_add_u32 s13, s13, s60
s_lshr_b32 s15, s15, 3
s_load_dwordx2 s[84:85], s[0:1], 40
s_waitcnt lgkmcnt(0)
s_and_b32 s85, s85, 0xffff
s_mov_b32 s86, 5242880
s_mov_b32 s87, 0x20000
s_lshl_b32 s60, s12, 10
s_and_b32 s61, s13, 7
s_lshl_b32 s61, s61, 7
s_add_u32 s60, s60, s61
s_lshl_b32 s61, s22, 5
s_add_u32 s60, s60, s61
s_mul_i32 s61, s15, 320
v_lshrrev_b32 v22, 1, v1
v_add_u32 v22, s60, v22
v_mul_u32_u24 v22, 1280, v22
v_add_u32 v22, s61, v22
v_and_b32 v23, 1, v1
v_lshlrev_b32 v23, 7, v23
v_add_u32 v23, v22, v23
buffer_load_dword v24, v23, s[84:87], 0 offen
buffer_load_dword v24, v22, s[84:87], 0 offen offset:300
s_cmp_eq_u32 s22, 1
s_cbranch_scc1 Lme_93
s_cmp_eq_u32 s22, 2
s_cbranch_scc1 Lm2_92
v_cndmask_b32 v128, v10, v128, s[24:25]
v_cndmask_b32 v129, v10, v129, s[26:27]
v_cndmask_b32 v130, v10, v130, s[28:29]
v_cndmask_b32 v131, v10, v131, s[30:31]
v_cndmask_b32 v132, v10, v132, s[32:33]
v_cndmask_b32 v133, v10, v133, s[34:35]
v_cndmask_b32 v134, v10, v134, s[36:37]
v_cndmask_b32 v135, v10, v135, s[38:39]
v_cndmask_b32 v136, v10, v136, s[40:41]
v_cndmask_b32 v137, v10, v137, s[42:43]
v_cndmask_b32 v138, v10, v138, s[56:57]
v_cndmask_b32 v139, v10, v139, s[58:59]
v_cndmask_b32 v140, v10, v140, s[4:5]
v_cndmask_b32 v141, v10, v141, s[6:7]
v_cndmask_b32 v142, v10, v142, s[8:9]
v_cndmask_b32 v143, v10, v143, s[10:11]
v_cndmask_b32 v176, v10, v176, s[24:25]
v_cndmask_b32 v177, v10, v177, s[26:27]
v_cndmask_b32 v178, v10, v178, s[28:29]
v_cndmask_b32 v179, v10, v179, s[30:31]
v_cndmask_b32 v180, v10, v180, s[32:33]
v_cndmask_b32 v181, v10, v181, s[34:35]
v_cndmask_b32 v182, v10, v182, s[36:37]
v_cndmask_b32 v183, v10, v183, s[38:39]
v_cndmask_b32 v184, v10, v184, s[40:41]
v_cndmask_b32 v185, v10, v185, s[42:43]
v_cndmask_b32 v186, v10, v186, s[56:57]
v_cndmask_b32 v187, v10, v187, s[58:59]
v_cndmask_b32 v188, v10, v188, s[4:5]
v_cndmask_b32 v189, v10, v189, s[6:7]
v_cndmask_b32 v190, v10, v190, s[8:9]
v_cndmask_b32 v191, v10, v191, s[10:11]
v_mov_b32 v160, v10
v_mov_b32 v161, v10
v_mov_b32 v162, v10
v_mov_b32 v163, v10
v_mov_b32 v164, v10
v_mov_b32 v165, v10
v_mov_b32 v166, v10
v_mov_b32 v167, v10
v_mov_b32 v168, v10
v_mov_b32 v169, v10
v_mov_b32 v170, v10
v_mov_b32 v171, v10
v_mov_b32 v172, v10
v_mov_b32 v173, v10
v_mov_b32 v174, v10
v_mov_b32 v175, v10
s_branch Lme_93
Lm2_92:
v_mov_b32 v128, v10
v_mov_b32 v129, v10
v_mov_b32 v130, v10
v_mov_b32 v131, v10
v_mov_b32 v132, v10
v_mov_b32 v133, v10
v_mov_b32 v134, v10
v_mov_b32 v135, v10
v_mov_b32 v136, v10
v_mov_b32 v137, v10
v_mov_b32 v138, v10
v_mov_b32 v139, v10
v_mov_b32 v140, v10
v_mov_b32 v141, v10
v_mov_b32 v142, v10
v_mov_b32 v143, v10
v_mov_b32 v144, v10
v_mov_b32 v145, v10
v_mov_b32 v146, v10
v_mov_b32 v147, v10
v_mov_b32 v148, v10
v_mov_b32 v149, v10
v_mov_b32 v150, v10
v_mov_b32 v151, v10
v_mov_b32 v152, v10
v_mov_b32 v153, v10
v_mov_b32 v154, v10
v_mov_b32 v155, v10
v_mov_b32 v156, v10
v_mov_b32 v157, v10
v_mov_b32 v158, v10
v_mov_b32 v159, v10
v_mov_b32 v160, v10
v_mov_b32 v161, v10
v_mov_b32 v162, v10
v_mov_b32 v163, v10
v_mov_b32 v164, v10
v_mov_b32 v165, v10
v_mov_b32 v166, v10
v_mov_b32 v167, v10
v_mov_b32 v168, v10
v_mov_b32 v169, v10
v_mov_b32 v170, v10
v_mov_b32 v171, v10
v_mov_b32 v172, v10
v_mov_b32 v173, v10
v_mov_b32 v174, v10
v_mov_b32 v175, v10
v_mov_b32 v176, v10
v_mov_b32 v177, v10
v_mov_b32 v178, v10
v_mov_b32 v179, v10
v_mov_b32 v180, v10
v_mov_b32 v181, v10
v_mov_b32 v182, v10
v_mov_b32 v183, v10
v_mov_b32 v184, v10
v_mov_b32 v185, v10
v_mov_b32 v186, v10
v_mov_b32 v187, v10
v_mov_b32 v188, v10
v_mov_b32 v189, v10
v_mov_b32 v190, v10
v_mov_b32 v191, v10
Lme_93:
Lev_90:
s_add_u32 s60, s74, 1
s_cmp_lg_u32 s60, s75
s_cbranch_scc1 Lev_94
s_cmp_eq_u32 s22, 1
s_cbranch_scc1 Lme_97
s_cmp_eq_u32 s22, 2
s_cbranch_scc1 Lm2_96
v_cndmask_b32 v128, v10, v128, s[24:25]
v_cndmask_b32 v129, v10, v129, s[26:27]
v_cndmask_b32 v130, v10, v130, s[28:29]
v_cndmask_b32 v131, v10, v131, s[30:31]
v_cndmask_b32 v132, v10, v132, s[32:33]
v_cndmask_b32 v133, v10, v133, s[34:35]
v_cndmask_b32 v134, v10, v134, s[36:37]
v_cndmask_b32 v135, v10, v135, s[38:39]
v_cndmask_b32 v136, v10, v136, s[40:41]
v_cndmask_b32 v137, v10, v137, s[42:43]
v_cndmask_b32 v138, v10, v138, s[56:57]
v_cndmask_b32 v139, v10, v139, s[58:59]
v_cndmask_b32 v140, v10, v140, s[4:5]
v_cndmask_b32 v141, v10, v141, s[6:7]
v_cndmask_b32 v142, v10, v142, s[8:9]
v_cndmask_b32 v143, v10, v143, s[10:11]
v_cndmask_b32 v176, v10, v176, s[24:25]
v_cndmask_b32 v177, v10, v177, s[26:27]
v_cndmask_b32 v178, v10, v178, s[28:29]
v_cndmask_b32 v179, v10, v179, s[30:31]
v_cndmask_b32 v180, v10, v180, s[32:33]
v_cndmask_b32 v181, v10, v181, s[34:35]
v_cndmask_b32 v182, v10, v182, s[36:37]
v_cndmask_b32 v183, v10, v183, s[38:39]
v_cndmask_b32 v184, v10, v184, s[40:41]
v_cndmask_b32 v185, v10, v185, s[42:43]
v_cndmask_b32 v186, v10, v186, s[56:57]
v_cndmask_b32 v187, v10, v187, s[58:59]
v_cndmask_b32 v188, v10, v188, s[4:5]
v_cndmask_b32 v189, v10, v189, s[6:7]
v_cndmask_b32 v190, v10, v190, s[8:9]
v_cndmask_b32 v191, v10, v191, s[10:11]
v_mov_b32 v160, v10
v_mov_b32 v161, v10
v_mov_b32 v162, v10
v_mov_b32 v163, v10
v_mov_b32 v164, v10
v_mov_b32 v165, v10
v_mov_b32 v166, v10
v_mov_b32 v167, v10
v_mov_b32 v168, v10
v_mov_b32 v169, v10
v_mov_b32 v170, v10
v_mov_b32 v171, v10
v_mov_b32 v172, v10
v_mov_b32 v173, v10
v_mov_b32 v174, v10
v_mov_b32 v175, v10
s_branch Lme_97
Lm2_96:
v_mov_b32 v128, v10
v_mov_b32 v129, v10
v_mov_b32 v130, v10
v_mov_b32 v131, v10
v_mov_b32 v132, v10
v_mov_b32 v133, v10
v_mov_b32 v134, v10
v_mov_b32 v135, v10
v_mov_b32 v136, v10
v_mov_b32 v137, v10
v_mov_b32 v138, v10
v_mov_b32 v139, v10
v_mov_b32 v140, v10
v_mov_b32 v141, v10
v_mov_b32 v142, v10
v_mov_b32 v143, v10
v_mov_b32 v144, v10
v_mov_b32 v145, v10
v_mov_b32 v146, v10
v_mov_b32 v147, v10
v_mov_b32 v148, v10
v_mov_b32 v149, v10
v_mov_b32 v150, v10
v_mov_b32 v151, v10
v_mov_b32 v152, v10
v_mov_b32 v153, v10
v_mov_b32 v154, v10
v_mov_b32 v155, v10
v_mov_b32 v156, v10
v_mov_b32 v157, v10
v_mov_b32 v158, v10
v_mov_b32 v159, v10
v_mov_b32 v160, v10
v_mov_b32 v161, v10
v_mov_b32 v162, v10
v_mov_b32 v163, v10
v_mov_b32 v164, v10
v_mov_b32 v165, v10
v_mov_b32 v166, v10
v_mov_b32 v167, v10
v_mov_b32 v168, v10
v_mov_b32 v169, v10
v_mov_b32 v170, v10
v_mov_b32 v171, v10
v_mov_b32 v172, v10
v_mov_b32 v173, v10
v_mov_b32 v174, v10
v_mov_b32 v175, v10
v_mov_b32 v176, v10
v_mov_b32 v177, v10
v_mov_b32 v178, v10
v_mov_b32 v179, v10
v_mov_b32 v180, v10
v_mov_b32 v181, v10
v_mov_b32 v182, v10
v_mov_b32 v183, v10
v_mov_b32 v184, v10
v_mov_b32 v185, v10
v_mov_b32 v186, v10
v_mov_b32 v187, v10
v_mov_b32 v188, v10
v_mov_b32 v189, v10
v_mov_b32 v190, v10
v_mov_b32 v191, v10
Lme_97:
v_accvgpr_write_b32 a128, v192
v_accvgpr_write_b32 a129, v193
v_accvgpr_write_b32 a130, v194
v_accvgpr_write_b32 a131, v195
v_accvgpr_write_b32 a132, v196
v_accvgpr_write_b32 a133, v197
v_accvgpr_write_b32 a134, v198
v_accvgpr_write_b32 a135, v199
v_accvgpr_write_b32 a136, v200
v_accvgpr_write_b32 a137, v201
v_accvgpr_write_b32 a138, v202
v_accvgpr_write_b32 a139, v203
v_accvgpr_write_b32 a140, v204
v_accvgpr_write_b32 a141, v205
v_accvgpr_write_b32 a142, v206
v_accvgpr_write_b32 a143, v207
v_accvgpr_write_b32 a144, v208
v_accvgpr_write_b32 a145, v209
v_accvgpr_write_b32 a146, v210
v_accvgpr_write_b32 a147, v211
v_accvgpr_write_b32 a148, v212
v_accvgpr_write_b32 a149, v213
v_accvgpr_write_b32 a150, v214
v_accvgpr_write_b32 a151, v215
v_accvgpr_write_b32 a152, v216
v_accvgpr_write_b32 a153, v217
v_accvgpr_write_b32 a154, v218
v_accvgpr_write_b32 a155, v219
v_accvgpr_write_b32 a156, v220
v_accvgpr_write_b32 a157, v221
v_accvgpr_write_b32 a158, v222
v_accvgpr_write_b32 a159, v223
v_accvgpr_write_b32 a160, v224
v_accvgpr_write_b32 a161, v225
v_accvgpr_write_b32 a162, v226
v_accvgpr_write_b32 a163, v227
v_accvgpr_write_b32 a164, v228
v_accvgpr_write_b32 a165, v229
v_accvgpr_write_b32 a166, v230
v_accvgpr_write_b32 a167, v231
v_accvgpr_write_b32 a168, v232
v_accvgpr_write_b32 a169, v233
v_accvgpr_write_b32 a170, v234
v_accvgpr_write_b32 a171, v235
v_accvgpr_write_b32 a172, v236
v_accvgpr_write_b32 a173, v237
v_accvgpr_write_b32 a174, v238
v_accvgpr_write_b32 a175, v239
v_accvgpr_write_b32 a176, v240
v_accvgpr_write_b32 a177, v241
v_accvgpr_write_b32 a178, v242
v_accvgpr_write_b32 a179, v243
v_accvgpr_write_b32 a180, v244
v_accvgpr_write_b32 a181, v245
v_accvgpr_write_b32 a182, v246
v_accvgpr_write_b32 a183, v247
v_accvgpr_write_b32 a184, v248
v_accvgpr_write_b32 a185, v249
v_accvgpr_write_b32 a186, v250
v_accvgpr_write_b32 a187, v251
v_accvgpr_write_b32 a188, v252
v_accvgpr_write_b32 a189, v253
v_accvgpr_write_b32 a190, v254
v_accvgpr_write_b32 a191, v255
s_mov_b32 s68, s62
s_mov_b32 s69, 0x30000
s_mov_b32 s81, s67
s_mov_b32 s67, 0x200000
Lev_94:
s_cmp_lg_u32 s74, s75
s_cbranch_scc1 LA_cont_e
s_mov_b32 s78, 0
s_branch LA_fin
LA_ev_o:
s_add_u32 s60, s75, 1
s_cmp_lg_u32 s60, s74
s_cbranch_scc1 Lev_98
s_bitcmp1_b32 s82, 0
s_cbranch_scc1 Lev_98
s_cmp_lg_u32 s22, 0
s_cbranch_scc1 Lcs_99
s_lshl_b32 s60, s75, 2
s_lshr_b32 s61, s20, 3
s_add_u32 s60, s60, s61
s_lshl_b32 s60, s60, 7
s_and_b32 s61, s20, 7
s_lshl_b32 s61, s61, 2
s_add_u32 s60, s60, s61
s_add_u32 s60, s60, 4096
s_add_u32 s60, s60, 0x5800000
v_mov_b32 v22, s60
v_mov_b32 v23, 1
s_mov_b64 s[60:61], exec
s_mov_b64 exec, 1
global_store_dword v22, v23, s[18:19] sc1
s_mov_b64 exec, s[60:61]
Lcs_99:
Lev_98:
s_add_u32 s60, s74, 3
s_cmp_lg_u32 s60, s75
s_cbranch_scc1 Lev_100
s_mov_b32 s67, s62
Lev_100:
s_cmp_lg_u32 s74, 13
s_cbranch_scc1 Lev_101
s_mov_b32 s69, 0x30000
s_mov_b32 s67, 0x200000
Lev_101:
s_cmp_lg_u32 s74, 15
s_cbranch_scc1 Lev_102
s_mov_b32 s70, 0x30000
s_mov_b32 s68, 0x200000
s_and_b32 s12, s2, 3
s_bfe_u32 s13, s2, 0x10002
s_lshr_b32 s15, s2, 3
s_and_b32 s60, s15, 7
s_lshl_b32 s13, s13, 3
s_add_u32 s13, s13, s60
s_lshr_b32 s15, s15, 3
s_load_dwordx2 s[84:85], s[0:1], 40
s_waitcnt lgkmcnt(0)
s_and_b32 s85, s85, 0xffff
s_mov_b32 s86, 5242880
s_mov_b32 s87, 0x20000
s_lshl_b32 s60, s12, 10
s_and_b32 s61, s13, 7
s_lshl_b32 s61, s61, 7
s_add_u32 s60, s60, s61
s_lshl_b32 s61, s22, 5
s_add_u32 s60, s60, s61
s_mul_i32 s61, s15, 320
v_lshrrev_b32 v22, 1, v1
v_add_u32 v22, s60, v22
v_mul_u32_u24 v22, 1280, v22
v_add_u32 v22, s61, v22
v_and_b32 v23, 1, v1
v_lshlrev_b32 v23, 7, v23
v_add_u32 v23, v22, v23
buffer_load_dword v24, v23, s[84:87], 0 offen
buffer_load_dword v24, v22, s[84:87], 0 offen offset:300
s_cmp_eq_u32 s22, 1
s_cbranch_scc1 Lme_105
s_cmp_eq_u32 s22, 2
s_cbranch_scc1 Lm2_104
v_cndmask_b32 v64, v10, v64, s[24:25]
v_cndmask_b32 v65, v10, v65, s[26:27]
v_cndmask_b32 v66, v10, v66, s[28:29]
v_cndmask_b32 v67, v10, v67, s[30:31]
v_cndmask_b32 v68, v10, v68, s[32:33]
v_cndmask_b32 v69, v10, v69, s[34:35]
v_cndmask_b32 v70, v10, v70, s[36:37]
v_cndmask_b32 v71, v10, v71, s[38:39]
v_cndmask_b32 v72, v10, v72, s[40:41]
v_cndmask_b32 v73, v10, v73, s[42:43]
v_cndmask_b32 v74, v10, v74, s[56:57]
v_cndmask_b32 v75, v10, v75, s[58:59]
v_cndmask_b32 v76, v10, v76, s[4:5]
v_cndmask_b32 v77, v10, v77, s[6:7]
v_cndmask_b32 v78, v10, v78, s[8:9]
v_cndmask_b32 v79, v10, v79, s[10:11]
v_cndmask_b32 v112, v10, v112, s[24:25]
v_cndmask_b32 v113, v10, v113, s[26:27]
v_cndmask_b32 v114, v10, v114, s[28:29]
v_cndmask_b32 v115, v10, v115, s[30:31]
v_cndmask_b32 v116, v10, v116, s[32:33]
v_cndmask_b32 v117, v10, v117, s[34:35]
v_cndmask_b32 v118, v10, v118, s[36:37]
v_cndmask_b32 v119, v10, v119, s[38:39]
v_cndmask_b32 v120, v10, v120, s[40:41]
v_cndmask_b32 v121, v10, v121, s[42:43]
v_cndmask_b32 v122, v10, v122, s[56:57]
v_cndmask_b32 v123, v10, v123, s[58:59]
v_cndmask_b32 v124, v10, v124, s[4:5]
v_cndmask_b32 v125, v10, v125, s[6:7]
v_cndmask_b32 v126, v10, v126, s[8:9]
v_cndmask_b32 v127, v10, v127, s[10:11]
v_mov_b32 v96, v10
v_mov_b32 v97, v10
v_mov_b32 v98, v10
v_mov_b32 v99, v10
v_mov_b32 v100, v10
v_mov_b32 v101, v10
v_mov_b32 v102, v10
v_mov_b32 v103, v10
v_mov_b32 v104, v10
v_mov_b32 v105, v10
v_mov_b32 v106, v10
v_mov_b32 v107, v10
v_mov_b32 v108, v10
v_mov_b32 v109, v10
v_mov_b32 v110, v10
v_mov_b32 v111, v10
s_branch Lme_105
Lm2_104:
v_mov_b32 v64, v10
v_mov_b32 v65, v10
v_mov_b32 v66, v10
v_mov_b32 v67, v10
v_mov_b32 v68, v10
v_mov_b32 v69, v10
v_mov_b32 v70, v10
v_mov_b32 v71, v10
v_mov_b32 v72, v10
v_mov_b32 v73, v10
v_mov_b32 v74, v10
v_mov_b32 v75, v10
v_mov_b32 v76, v10
v_mov_b32 v77, v10
v_mov_b32 v78, v10
v_mov_b32 v79, v10
v_mov_b32 v80, v10
v_mov_b32 v81, v10
v_mov_b32 v82, v10
v_mov_b32 v83, v10
v_mov_b32 v84, v10
v_mov_b32 v85, v10
v_mov_b32 v86, v10
v_mov_b32 v87, v10
v_mov_b32 v88, v10
v_mov_b32 v89, v10
v_mov_b32 v90, v10
v_mov_b32 v91, v10
v_mov_b32 v92, v10
v_mov_b32 v93, v10
v_mov_b32 v94, v10
v_mov_b32 v95, v10
v_mov_b32 v96, v10
v_mov_b32 v97, v10
v_mov_b32 v98, v10
v_mov_b32 v99, v10
v_mov_b32 v100, v10
v_mov_b32 v101, v10
v_mov_b32 v102, v10
v_mov_b32 v103, v10
v_mov_b32 v104, v10
v_mov_b32 v105, v10
v_mov_b32 v106, v10
v_mov_b32 v107, v10
v_mov_b32 v108, v10
v_mov_b32 v109, v10
v_mov_b32 v110, v10
v_mov_b32 v111, v10
v_mov_b32 v112, v10
v_mov_b32 v113, v10
v_mov_b32 v114, v10
v_mov_b32 v115, v10
v_mov_b32 v116, v10
v_mov_b32 v117, v10
v_mov_b32 v118, v10
v_mov_b32 v119, v10
v_mov_b32 v120, v10
v_mov_b32 v121, v10
v_mov_b32 v122, v10
v_mov_b32 v123, v10
v_mov_b32 v124, v10
v_mov_b32 v125, v10
v_mov_b32 v126, v10
v_mov_b32 v127, v10
Lme_105:
Lev_102:
s_add_u32 s60, s74, 1
s_cmp_lg_u32 s60, s75
s_cbranch_scc1 Lev_106
s_cmp_eq_u32 s22, 1
s_cbranch_scc1 Lme_109
s_cmp_eq_u32 s22, 2
s_cbranch_scc1 Lm2_108
v_cndmask_b32 v64, v10, v64, s[24:25]
v_cndmask_b32 v65, v10, v65, s[26:27]
v_cndmask_b32 v66, v10, v66, s[28:29]
v_cndmask_b32 v67, v10, v67, s[30:31]
v_cndmask_b32 v68, v10, v68, s[32:33]
v_cndmask_b32 v69, v10, v69, s[34:35]
v_cndmask_b32 v70, v10, v70, s[36:37]
v_cndmask_b32 v71, v10, v71, s[38:39]
v_cndmask_b32 v72, v10, v72, s[40:41]
v_cndmask_b32 v73, v10, v73, s[42:43]
v_cndmask_b32 v74, v10, v74, s[56:57]
v_cndmask_b32 v75, v10, v75, s[58:59]
v_cndmask_b32 v76, v10, v76, s[4:5]
v_cndmask_b32 v77, v10, v77, s[6:7]
v_cndmask_b32 v78, v10, v78, s[8:9]
v_cndmask_b32 v79, v10, v79, s[10:11]
v_cndmask_b32 v112, v10, v112, s[24:25]
v_cndmask_b32 v113, v10, v113, s[26:27]
v_cndmask_b32 v114, v10, v114, s[28:29]
v_cndmask_b32 v115, v10, v115, s[30:31]
v_cndmask_b32 v116, v10, v116, s[32:33]
v_cndmask_b32 v117, v10, v117, s[34:35]
v_cndmask_b32 v118, v10, v118, s[36:37]
v_cndmask_b32 v119, v10, v119, s[38:39]
v_cndmask_b32 v120, v10, v120, s[40:41]
v_cndmask_b32 v121, v10, v121, s[42:43]
v_cndmask_b32 v122, v10, v122, s[56:57]
v_cndmask_b32 v123, v10, v123, s[58:59]
v_cndmask_b32 v124, v10, v124, s[4:5]
v_cndmask_b32 v125, v10, v125, s[6:7]
v_cndmask_b32 v126, v10, v126, s[8:9]
v_cndmask_b32 v127, v10, v127, s[10:11]
v_mov_b32 v96, v10
v_mov_b32 v97, v10
v_mov_b32 v98, v10
v_mov_b32 v99, v10
v_mov_b32 v100, v10
v_mov_b32 v101, v10
v_mov_b32 v102, v10
v_mov_b32 v103, v10
v_mov_b32 v104, v10
v_mov_b32 v105, v10
v_mov_b32 v106, v10
v_mov_b32 v107, v10
v_mov_b32 v108, v10
v_mov_b32 v109, v10
v_mov_b32 v110, v10
v_mov_b32 v111, v10
s_branch Lme_109
Lm2_108:
v_mov_b32 v64, v10
v_mov_b32 v65, v10
v_mov_b32 v66, v10
v_mov_b32 v67, v10
v_mov_b32 v68, v10
v_mov_b32 v69, v10
v_mov_b32 v70, v10
v_mov_b32 v71, v10
v_mov_b32 v72, v10
v_mov_b32 v73, v10
v_mov_b32 v74, v10
v_mov_b32 v75, v10
v_mov_b32 v76, v10
v_mov_b32 v77, v10
v_mov_b32 v78, v10
v_mov_b32 v79, v10
v_mov_b32 v80, v10
v_mov_b32 v81, v10
v_mov_b32 v82, v10
v_mov_b32 v83, v10
v_mov_b32 v84, v10
v_mov_b32 v85, v10
v_mov_b32 v86, v10
v_mov_b32 v87, v10
v_mov_b32 v88, v10
v_mov_b32 v89, v10
v_mov_b32 v90, v10
v_mov_b32 v91, v10
v_mov_b32 v92, v10
v_mov_b32 v93, v10
v_mov_b32 v94, v10
v_mov_b32 v95, v10
v_mov_b32 v96, v10
v_mov_b32 v97, v10
v_mov_b32 v98, v10
v_mov_b32 v99, v10
v_mov_b32 v100, v10
v_mov_b32 v101, v10
v_mov_b32 v102, v10
v_mov_b32 v103, v10
v_mov_b32 v104, v10
v_mov_b32 v105, v10
v_mov_b32 v106, v10
v_mov_b32 v107, v10
v_mov_b32 v108, v10
v_mov_b32 v109, v10
v_mov_b32 v110, v10
v_mov_b32 v111, v10
v_mov_b32 v112, v10
v_mov_b32 v113, v10
v_mov_b32 v114, v10
v_mov_b32 v115, v10
v_mov_b32 v116, v10
v_mov_b32 v117, v10
v_mov_b32 v118, v10
v_mov_b32 v119, v10
v_mov_b32 v120, v10
v_mov_b32 v121, v10
v_mov_b32 v122, v10
v_mov_b32 v123, v10
v_mov_b32 v124, v10
v_mov_b32 v125, v10
v_mov_b32 v126, v10
v_mov_b32 v127, v10
Lme_109:
v_accvgpr_write_b32 a128, v192
v_accvgpr_write_b32 a129, v193
v_accvgpr_write_b32 a130, v194
v_accvgpr_write_b32 a131, v195
v_accvgpr_write_b32 a132, v196
v_accvgpr_write_b32 a133, v197
v_accvgpr_write_b32 a134, v198
v_accvgpr_write_b32 a135, v199
v_accvgpr_write_b32 a136, v200
v_accvgpr_write_b32 a137, v201
v_accvgpr_write_b32 a138, v202
v_accvgpr_write_b32 a139, v203
v_accvgpr_write_b32 a140, v204
v_accvgpr_write_b32 a141, v205
v_accvgpr_write_b32 a142, v206
v_accvgpr_write_b32 a143, v207
v_accvgpr_write_b32 a144, v208
v_accvgpr_write_b32 a145, v209
v_accvgpr_write_b32 a146, v210
v_accvgpr_write_b32 a147, v211
v_accvgpr_write_b32 a148, v212
v_accvgpr_write_b32 a149, v213
v_accvgpr_write_b32 a150, v214
v_accvgpr_write_b32 a151, v215
v_accvgpr_write_b32 a152, v216
v_accvgpr_write_b32 a153, v217
v_accvgpr_write_b32 a154, v218
v_accvgpr_write_b32 a155, v219
v_accvgpr_write_b32 a156, v220
v_accvgpr_write_b32 a157, v221
v_accvgpr_write_b32 a158, v222
v_accvgpr_write_b32 a159, v223
v_accvgpr_write_b32 a160, v224
v_accvgpr_write_b32 a161, v225
v_accvgpr_write_b32 a162, v226
v_accvgpr_write_b32 a163, v227
v_accvgpr_write_b32 a164, v228
v_accvgpr_write_b32 a165, v229
v_accvgpr_write_b32 a166, v230
v_accvgpr_write_b32 a167, v231
v_accvgpr_write_b32 a168, v232
v_accvgpr_write_b32 a169, v233
v_accvgpr_write_b32 a170, v234
v_accvgpr_write_b32 a171, v235
v_accvgpr_write_b32 a172, v236
v_accvgpr_write_b32 a173, v237
v_accvgpr_write_b32 a174, v238
v_accvgpr_write_b32 a175, v239
v_accvgpr_write_b32 a176, v240
v_accvgpr_write_b32 a177, v241
v_accvgpr_write_b32 a178, v242
v_accvgpr_write_b32 a179, v243
v_accvgpr_write_b32 a180, v244
v_accvgpr_write_b32 a181, v245
v_accvgpr_write_b32 a182, v246
v_accvgpr_write_b32 a183, v247
v_accvgpr_write_b32 a184, v248
v_accvgpr_write_b32 a185, v249
v_accvgpr_write_b32 a186, v250
v_accvgpr_write_b32 a187, v251
v_accvgpr_write_b32 a188, v252
v_accvgpr_write_b32 a189, v253
v_accvgpr_write_b32 a190, v254
v_accvgpr_write_b32 a191, v255
s_mov_b32 s68, s62
s_mov_b32 s69, 0x30000
s_mov_b32 s81, s67
s_mov_b32 s67, 0x200000
Lev_106:
s_cmp_lg_u32 s74, s75
s_cbranch_scc1 LA_cont_o
s_mov_b32 s78, 1
s_branch LA_fin
LA_fin:
s_mov_b64 s[76:77], 0
s_cmp_eq_u32 s74, s75
s_cselect_b32 s79, s75, s21
s_nop 7
v_add_f32 v16, v4, v5
v_mov_b32 v18, v16
v_add_f32 v17, v6, v7
v_mov_b32 v19, v17
s_and_b32 s63, s74, 1
s_xor_b32 s60, s63, 1
s_lshl_b32 s60, s60, 15
v_permlane32_swap_b32 v16, v18
v_permlane32_swap_b32 v17, v19
s_and_b32 s61, s22, 1
s_lshl_b32 s61, s61, 14
s_add_u32 s64, s60, s61
s_add_u32 s65, s61, 0x20000
v_add_f32 v16, v16, v18
v_add_f32 v17, v17, v19
s_cmp_ge_u32 s22, 2
s_cselect_b32 s60, s64, s65
s_cselect_b32 s61, s65, s64
v_add_u32 v11, s60, v26
v_add_u32 v12, s61, v26
s_lshl_b32 s60, s63, 15
s_add_u32 s60, s60, 65536
v_lshlrev_b32 v13, 3, v1
v_add_u32 v13, s60, v13
s_lshl_b32 s61, s22, 9
s_xor_b32 s60, s61, 1024
v_add_u32 v14, s60, v13
v_add_u32 v13, s61, v13
s_waitcnt lgkmcnt(0)
s_barrier
s_cmp_ge_u32 s22, 2
s_cbranch_scc1 LA_finB
v_mov_b32 v20, 0
v_mov_b32 v21, 0
v_mov_b32 v22, 0
v_mov_b32 v23, 0
ds_write_b64 v13, v[16:17]
ds_write_b128 v11, a[32:35] offset:0
v_accvgpr_read_b32 v192, a0
v_accvgpr_read_b32 v193, a1
v_accvgpr_read_b32 v194, a2
v_accvgpr_read_b32 v195, a3
ds_write_b128 v11, a[36:39] offset:1024
v_accvgpr_read_b32 v196, a4
v_accvgpr_read_b32 v197, a5
v_accvgpr_read_b32 v198, a6
v_accvgpr_read_b32 v199, a7
ds_write_b128 v11, a[40:43] offset:2048
v_accvgpr_read_b32 v200, a8
v_accvgpr_read_b32 v201, a9
v_accvgpr_read_b32 v202, a10
v_accvgpr_read_b32 v203, a11
ds_write_b128 v11, a[44:47] offset:3072
v_accvgpr_read_b32 v204, a12
v_accvgpr_read_b32 v205, a13
v_accvgpr_read_b32 v206, a14
v_accvgpr_read_b32 v207, a15
v_mfma_f32_32x32x16_bf16 a[0:15], v[20:23], v[20:23], 0
ds_write_b128 v11, a[48:51] offset:4096
v_accvgpr_read_b32 v208, a16
v_accvgpr_read_b32 v209, a17
v_accvgpr_read_b32 v210, a18
v_accvgpr_read_b32 v211, a19
ds_write_b128 v11, a[52:55] offset:5120
v_accvgpr_read_b32 v212, a20
v_accvgpr_read_b32 v213, a21
v_accvgpr_read_b32 v214, a22
v_accvgpr_read_b32 v215, a23
ds_write_b128 v11, a[56:59] offset:6144
v_accvgpr_read_b32 v216, a24
v_accvgpr_read_b32 v217, a25
v_accvgpr_read_b32 v218, a26
v_accvgpr_read_b32 v219, a27
ds_write_b128 v11, a[60:63] offset:7168
v_accvgpr_read_b32 v220, a28
v_accvgpr_read_b32 v221, a29
v_accvgpr_read_b32 v222, a30
v_accvgpr_read_b32 v223, a31
v_mfma_f32_32x32x16_bf16 a[16:31], v[20:23], v[20:23], 0
ds_write_b128 v11, a[96:99] offset:8192
v_accvgpr_read_b32 v224, a64
v_accvgpr_read_b32 v225, a65
v_accvgpr_read_b32 v226, a66
v_accvgpr_read_b32 v227, a67
ds_write_b128 v11, a[100:103] offset:9216
v_accvgpr_read_b32 v228, a68
v_accvgpr_read_b32 v229, a69
v_accvgpr_read_b32 v230, a70
v_accvgpr_read_b32 v231, a71
ds_write_b128 v11, a[104:107] offset:10240
v_accvgpr_read_b32 v232, a72
v_accvgpr_read_b32 v233, a73
v_accvgpr_read_b32 v234, a74
v_accvgpr_read_b32 v235, a75
ds_write_b128 v11, a[108:111] offset:11264
v_accvgpr_read_b32 v236, a76
v_accvgpr_read_b32 v237, a77
v_accvgpr_read_b32 v238, a78
v_accvgpr_read_b32 v239, a79
v_mfma_f32_32x32x16_bf16 a[64:79], v[20:23], v[20:23], 0
ds_write_b128 v11, a[112:115] offset:12288
v_accvgpr_read_b32 v240, a80
v_accvgpr_read_b32 v241, a81
v_accvgpr_read_b32 v242, a82
v_accvgpr_read_b32 v243, a83
ds_write_b128 v11, a[116:119] offset:13312
v_accvgpr_read_b32 v244, a84
v_accvgpr_read_b32 v245, a85
v_accvgpr_read_b32 v246, a86
v_accvgpr_read_b32 v247, a87
ds_write_b128 v11, a[120:123] offset:14336
v_accvgpr_read_b32 v248, a88
v_accvgpr_read_b32 v249, a89
v_accvgpr_read_b32 v250, a90
v_accvgpr_read_b32 v251, a91
ds_write_b128 v11, a[124:127] offset:15360
v_accvgpr_read_b32 v252, a92
v_accvgpr_read_b32 v253, a93
v_accvgpr_read_b32 v254, a94
v_accvgpr_read_b32 v255, a95
v_mfma_f32_32x32x16_bf16 a[80:95], v[20:23], v[20:23], 0
s_lshl_b32 s60, s79, 2
s_and_b32 s61, s22, 1
s_lshl_b32 s61, s61, 1
s_add_u32 s60, s60, s61
s_lshl_b32 s60, s60, 18
s_lshl_b32 s61, s20, 13
s_add_u32 s60, s60, s61
s_add_u32 s60, s60, 0
s_add_u32 s61, s60, 0x40000
s_waitcnt lgkmcnt(0)
v_mfma_f32_32x32x16_bf16 a[32:47], v[20:23], v[20:23], 0
v_mfma_f32_32x32x16_bf16 a[48:63], v[20:23], v[20:23], 0
v_mfma_f32_32x32x16_bf16 a[96:111], v[20:23], v[20:23], 0
v_mfma_f32_32x32x16_bf16 a[112:127], v[20:23], v[20:23], 0
s_barrier
ds_read_b64 v[18:19], v14
ds_read_b128 v[32:35], v12 offset:0
ds_read_b128 v[36:39], v12 offset:1024
ds_read_b128 v[40:43], v12 offset:2048
ds_read_b128 v[44:47], v12 offset:3072
ds_read_b128 v[48:51], v12 offset:4096
ds_read_b128 v[52:55], v12 offset:5120
ds_read_b128 v[56:59], v12 offset:6144
ds_read_b128 v[60:63], v12 offset:7168
s_waitcnt lgkmcnt(8)
v_add_f32 v16, v16, v18
v_add_f32 v17, v17, v19
v_mov_b32 v18, 0x21800000
v_mov_b32 v19, 0x5d800000
v_cmp_nge_f32 vcc, v16, v18
s_or_b64 s[76:77], s[76:77], vcc
v_cmp_nle_f32 vcc, v16, v19
s_or_b64 s[76:77], s[76:77], vcc
v_cmp_nge_f32 vcc, v17, v18
s_or_b64 s[76:77], s[76:77], vcc
v_cmp_nle_f32 vcc, v17, v19
s_or_b64 s[76:77], s[76:77], vcc
v_rcp_f32 v14, v16
v_rcp_f32 v18, v17
s_nop 0
v_mov_b32 v15, v14
v_mov_b32 v19, v18
s_waitcnt lgkmcnt(4)
v_pk_add_f32 v[192:193], v[192:193], v[32:33]
v_pk_add_f32 v[194:195], v[194:195], v[34:35]
v_pk_add_f32 v[196:197], v[196:197], v[36:37]
v_pk_add_f32 v[198:199], v[198:199], v[38:39]
v_pk_add_f32 v[200:201], v[200:201], v[40:41]
v_pk_add_f32 v[202:203], v[202:203], v[42:43]
v_pk_add_f32 v[204:205], v[204:205], v[44:45]
v_pk_add_f32 v[206:207], v[206:207], v[46:47]
ds_read_b128 v[32:35], v12 offset:8192
ds_read_b128 v[36:39], v12 offset:9216
ds_read_b128 v[40:43], v12 offset:10240
ds_read_b128 v[44:47], v12 offset:11264
v_pk_mul_f32 v[192:193], v[192:193], v[14:15]
v_pk_mul_f32 v[194:195], v[194:195], v[14:15]
v_pk_mul_f32 v[196:197], v[196:197], v[14:15]
v_pk_mul_f32 v[198:199], v[198:199], v[14:15]
v_pk_mul_f32 v[200:201], v[200:201], v[14:15]
v_pk_mul_f32 v[202:203], v[202:203], v[14:15]
v_pk_mul_f32 v[204:205], v[204:205], v[14:15]
v_pk_mul_f32 v[206:207], v[206:207], v[14:15]
v_cvt_pk_bf16_f32 v28, v192, v193
v_cvt_pk_bf16_f32 v29, v194, v195
v_cvt_pk_bf16_f32 v30, v196, v197
v_cvt_pk_bf16_f32 v31, v198, v199
buffer_store_dwordx4 v[28:31], v26, s[52:55], s60 offen offset:0 sc1
v_cvt_pk_bf16_f32 v4, v200, v201
v_cvt_pk_bf16_f32 v5, v202, v203
v_cvt_pk_bf16_f32 v6, v204, v205
v_cvt_pk_bf16_f32 v7, v206, v207
buffer_store_dwordx4 v[4:7], v26, s[52:55], s60 offen offset:1024 sc1
s_waitcnt lgkmcnt(4)
v_pk_add_f32 v[208:209], v[208:209], v[48:49]
v_pk_add_f32 v[210:211], v[210:211], v[50:51]
v_pk_add_f32 v[212:213], v[212:213], v[52:53]
v_pk_add_f32 v[214:215], v[214:215], v[54:55]
v_pk_add_f32 v[216:217], v[216:217], v[56:57]
v_pk_add_f32 v[218:219], v[218:219], v[58:59]
v_pk_add_f32 v[220:221], v[220:221], v[60:61]
v_pk_add_f32 v[222:223], v[222:223], v[62:63]
ds_read_b128 v[48:51], v12 offset:12288
ds_read_b128 v[52:55], v12 offset:13312
ds_read_b128 v[56:59], v12 offset:14336
ds_read_b128 v[60:63], v12 offset:15360
v_pk_mul_f32 v[208:209], v[208:209], v[14:15]
v_pk_mul_f32 v[210:211], v[210:211], v[14:15]
v_pk_mul_f32 v[212:213], v[212:213], v[14:15]
v_pk_mul_f32 v[214:215], v[214:215], v[14:15]
v_pk_mul_f32 v[216:217], v[216:217], v[14:15]
v_pk_mul_f32 v[218:219], v[218:219], v[14:15]
v_pk_mul_f32 v[220:221], v[220:221], v[14:15]
v_pk_mul_f32 v[222:223], v[222:223], v[14:15]
v_cvt_pk_bf16_f32 v28, v208, v209
v_cvt_pk_bf16_f32 v29, v210, v211
v_cvt_pk_bf16_f32 v30, v212, v213
v_cvt_pk_bf16_f32 v31, v214, v215
buffer_store_dwordx4 v[28:31], v26, s[52:55], s60 offen offset:2048 sc1
v_cvt_pk_bf16_f32 v4, v216, v217
v_cvt_pk_bf16_f32 v5, v218, v219
v_cvt_pk_bf16_f32 v6, v220, v221
v_cvt_pk_bf16_f32 v7, v222, v223
buffer_store_dwordx4 v[4:7], v26, s[52:55], s60 offen offset:3072 sc1
s_waitcnt lgkmcnt(4)
v_pk_add_f32 v[224:225], v[224:225], v[32:33]
v_pk_add_f32 v[226:227], v[226:227], v[34:35]
v_pk_add_f32 v[228:229], v[228:229], v[36:37]
v_pk_add_f32 v[230:231], v[230:231], v[38:39]
v_pk_add_f32 v[232:233], v[232:233], v[40:41]
v_pk_add_f32 v[234:235], v[234:235], v[42:43]
v_pk_add_f32 v[236:237], v[236:237], v[44:45]
v_pk_add_f32 v[238:239], v[238:239], v[46:47]
v_pk_mul_f32 v[224:225], v[224:225], v[18:19]
v_pk_mul_f32 v[226:227], v[226:227], v[18:19]
v_pk_mul_f32 v[228:229], v[228:229], v[18:19]
v_pk_mul_f32 v[230:231], v[230:231], v[18:19]
v_pk_mul_f32 v[232:233], v[232:233], v[18:19]
v_pk_mul_f32 v[234:235], v[234:235], v[18:19]
v_pk_mul_f32 v[236:237], v[236:237], v[18:19]
v_pk_mul_f32 v[238:239], v[238:239], v[18:19]
v_cvt_pk_bf16_f32 v28, v224, v225
v_cvt_pk_bf16_f32 v29, v226, v227
v_cvt_pk_bf16_f32 v30, v228, v229
v_cvt_pk_bf16_f32 v31, v230, v231
buffer_store_dwordx4 v[28:31], v26, s[52:55], s61 offen offset:0 sc1
v_cvt_pk_bf16_f32 v4, v232, v233
v_cvt_pk_bf16_f32 v5, v234, v235
v_cvt_pk_bf16_f32 v6, v236, v237
v_cvt_pk_bf16_f32 v7, v238, v239
buffer_store_dwordx4 v[4:7], v26, s[52:55], s61 offen offset:1024 sc1
s_waitcnt lgkmcnt(0)
v_pk_add_f32 v[240:241], v[240:241], v[48:49]
v_pk_add_f32 v[242:243], v[242:243], v[50:51]
v_pk_add_f32 v[244:245], v[244:245], v[52:53]
v_pk_add_f32 v[246:247], v[246:247], v[54:55]
v_pk_add_f32 v[248:249], v[248:249], v[56:57]
v_pk_add_f32 v[250:251], v[250:251], v[58:59]
v_pk_add_f32 v[252:253], v[252:253], v[60:61]
v_pk_add_f32 v[254:255], v[254:255], v[62:63]
v_pk_mul_f32 v[240:241], v[240:241], v[18:19]
v_pk_mul_f32 v[242:243], v[242:243], v[18:19]
v_pk_mul_f32 v[244:245], v[244:245], v[18:19]
v_pk_mul_f32 v[246:247], v[246:247], v[18:19]
v_pk_mul_f32 v[248:249], v[248:249], v[18:19]
v_pk_mul_f32 v[250:251], v[250:251], v[18:19]
v_pk_mul_f32 v[252:253], v[252:253], v[18:19]
v_pk_mul_f32 v[254:255], v[254:255], v[18:19]
v_cvt_pk_bf16_f32 v28, v240, v241
v_cvt_pk_bf16_f32 v29, v242, v243
v_cvt_pk_bf16_f32 v30, v244, v245
v_cvt_pk_bf16_f32 v31, v246, v247
buffer_store_dwordx4 v[28:31], v26, s[52:55], s61 offen offset:2048 sc1
v_cvt_pk_bf16_f32 v4, v248, v249
v_cvt_pk_bf16_f32 v5, v250, v251
v_cvt_pk_bf16_f32 v6, v252, v253
v_cvt_pk_bf16_f32 v7, v254, v255
buffer_store_dwordx4 v[4:7], v26, s[52:55], s61 offen offset:3072 sc1
s_nop 1
v_mov_b32 v4, 0
v_mov_b32 v5, 0
v_mov_b32 v6, 0
v_mov_b32 v7, 0
s_branch LA_finJ
LA_finB:
v_mov_b32 v20, 0
v_mov_b32 v21, 0
v_mov_b32 v22, 0
v_mov_b32 v23, 0
ds_write_b64 v13, v[16:17]
ds_write_b128 v11, a[0:3] offset:0
v_accvgpr_read_b32 v192, a32
v_accvgpr_read_b32 v193, a33
v_accvgpr_read_b32 v194, a34
v_accvgpr_read_b32 v195, a35
ds_write_b128 v11, a[4:7] offset:1024
v_accvgpr_read_b32 v196, a36
v_accvgpr_read_b32 v197, a37
v_accvgpr_read_b32 v198, a38
v_accvgpr_read_b32 v199, a39
ds_write_b128 v11, a[8:11] offset:2048
v_accvgpr_read_b32 v200, a40
v_accvgpr_read_b32 v201, a41
v_accvgpr_read_b32 v202, a42
v_accvgpr_read_b32 v203, a43
ds_write_b128 v11, a[12:15] offset:3072
v_accvgpr_read_b32 v204, a44
v_accvgpr_read_b32 v205, a45
v_accvgpr_read_b32 v206, a46
v_accvgpr_read_b32 v207, a47
v_mfma_f32_32x32x16_bf16 a[32:47], v[20:23], v[20:23], 0
ds_write_b128 v11, a[16:19] offset:4096
v_accvgpr_read_b32 v208, a48
v_accvgpr_read_b32 v209, a49
v_accvgpr_read_b32 v210, a50
v_accvgpr_read_b32 v211, a51
ds_write_b128 v11, a[20:23] offset:5120
v_accvgpr_read_b32 v212, a52
v_accvgpr_read_b32 v213, a53
v_accvgpr_read_b32 v214, a54
v_accvgpr_read_b32 v215, a55
ds_write_b128 v11, a[24:27] offset:6144
v_accvgpr_read_b32 v216, a56
v_accvgpr_read_b32 v217, a57
v_accvgpr_read_b32 v218, a58
v_accvgpr_read_b32 v219, a59
ds_write_b128 v11, a[28:31] offset:7168
v_accvgpr_read_b32 v220, a60
v_accvgpr_read_b32 v221, a61
v_accvgpr_read_b32 v222, a62
v_accvgpr_read_b32 v223, a63
v_mfma_f32_32x32x16_bf16 a[48:63], v[20:23], v[20:23], 0
ds_write_b128 v11, a[64:67] offset:8192
v_accvgpr_read_b32 v224, a96
v_accvgpr_read_b32 v225, a97
v_accvgpr_read_b32 v226, a98
v_accvgpr_read_b32 v227, a99
ds_write_b128 v11, a[68:71] offset:9216
v_accvgpr_read_b32 v228, a100
v_accvgpr_read_b32 v229, a101
v_accvgpr_read_b32 v230, a102
v_accvgpr_read_b32 v231, a103
ds_write_b128 v11, a[72:75] offset:10240
v_accvgpr_read_b32 v232, a104
v_accvgpr_read_b32 v233, a105
v_accvgpr_read_b32 v234, a106
v_accvgpr_read_b32 v235, a107
ds_write_b128 v11, a[76:79] offset:11264
v_accvgpr_read_b32 v236, a108
v_accvgpr_read_b32 v237, a109
v_accvgpr_read_b32 v238, a110
v_accvgpr_read_b32 v239, a111
v_mfma_f32_32x32x16_bf16 a[96:111], v[20:23], v[20:23], 0
ds_write_b128 v11, a[80:83] offset:12288
v_accvgpr_read_b32 v240, a112
v_accvgpr_read_b32 v241, a113
v_accvgpr_read_b32 v242, a114
v_accvgpr_read_b32 v243, a115
ds_write_b128 v11, a[84:87] offset:13312
v_accvgpr_read_b32 v244, a116
v_accvgpr_read_b32 v245, a117
v_accvgpr_read_b32 v246, a118
v_accvgpr_read_b32 v247, a119
ds_write_b128 v11, a[88:91] offset:14336
v_accvgpr_read_b32 v248, a120
v_accvgpr_read_b32 v249, a121
v_accvgpr_read_b32 v250, a122
v_accvgpr_read_b32 v251, a123
ds_write_b128 v11, a[92:95] offset:15360
v_accvgpr_read_b32 v252, a124
v_accvgpr_read_b32 v253, a125
v_accvgpr_read_b32 v254, a126
v_accvgpr_read_b32 v255, a127
v_mfma_f32_32x32x16_bf16 a[112:127], v[20:23], v[20:23], 0
s_lshl_b32 s60, s79, 2
s_and_b32 s61, s22, 1
s_lshl_b32 s61, s61, 1
s_add_u32 s60, s60, s61
s_lshl_b32 s60, s60, 18
s_lshl_b32 s61, s20, 13
s_add_u32 s60, s60, s61
s_add_u32 s60, s60, 4096
s_add_u32 s61, s60, 0x40000
s_waitcnt lgkmcnt(0)
v_mfma_f32_32x32x16_bf16 a[0:15], v[20:23], v[20:23], 0
v_mfma_f32_32x32x16_bf16 a[16:31], v[20:23], v[20:23], 0
v_mfma_f32_32x32x16_bf16 a[64:79], v[20:23], v[20:23], 0
v_mfma_f32_32x32x16_bf16 a[80:95], v[20:23], v[20:23], 0
s_barrier
ds_read_b64 v[18:19], v14
ds_read_b128 v[32:35], v12 offset:0
ds_read_b128 v[36:39], v12 offset:1024
ds_read_b128 v[40:43], v12 offset:2048
ds_read_b128 v[44:47], v12 offset:3072
ds_read_b128 v[48:51], v12 offset:4096
ds_read_b128 v[52:55], v12 offset:5120
ds_read_b128 v[56:59], v12 offset:6144
ds_read_b128 v[60:63], v12 offset:7168
s_waitcnt lgkmcnt(8)
v_add_f32 v16, v16, v18
v_add_f32 v17, v17, v19
v_mov_b32 v18, 0x21800000
v_mov_b32 v19, 0x5d800000
v_cmp_nge_f32 vcc, v16, v18
s_or_b64 s[76:77], s[76:77], vcc
v_cmp_nle_f32 vcc, v16, v19
s_or_b64 s[76:77], s[76:77], vcc
v_cmp_nge_f32 vcc, v17, v18
s_or_b64 s[76:77], s[76:77], vcc
v_cmp_nle_f32 vcc, v17, v19
s_or_b64 s[76:77], s[76:77], vcc
v_rcp_f32 v14, v16
v_rcp_f32 v18, v17
s_nop 0
v_mov_b32 v15, v14
v_mov_b32 v19, v18
s_waitcnt lgkmcnt(4)
v_pk_add_f32 v[192:193], v[192:193], v[32:33]
v_pk_add_f32 v[194:195], v[194:195], v[34:35]
v_pk_add_f32 v[196:197], v[196:197], v[36:37]
v_pk_add_f32 v[198:199], v[198:199], v[38:39]
v_pk_add_f32 v[200:201], v[200:201], v[40:41]
v_pk_add_f32 v[202:203], v[202:203], v[42:43]
v_pk_add_f32 v[204:205], v[204:205], v[44:45]
v_pk_add_f32 v[206:207], v[206:207], v[46:47]
ds_read_b128 v[32:35], v12 offset:8192
ds_read_b128 v[36:39], v12 offset:9216
ds_read_b128 v[40:43], v12 offset:10240
ds_read_b128 v[44:47], v12 offset:11264
v_pk_mul_f32 v[192:193], v[192:193], v[14:15]
v_pk_mul_f32 v[194:195], v[194:195], v[14:15]
v_pk_mul_f32 v[196:197], v[196:197], v[14:15]
v_pk_mul_f32 v[198:199], v[198:199], v[14:15]
v_pk_mul_f32 v[200:201], v[200:201], v[14:15]
v_pk_mul_f32 v[202:203], v[202:203], v[14:15]
v_pk_mul_f32 v[204:205], v[204:205], v[14:15]
v_pk_mul_f32 v[206:207], v[206:207], v[14:15]
v_cvt_pk_bf16_f32 v28, v192, v193
v_cvt_pk_bf16_f32 v29, v194, v195
v_cvt_pk_bf16_f32 v30, v196, v197
v_cvt_pk_bf16_f32 v31, v198, v199
buffer_store_dwordx4 v[28:31], v26, s[52:55], s60 offen offset:0 sc1
v_cvt_pk_bf16_f32 v4, v200, v201
v_cvt_pk_bf16_f32 v5, v202, v203
v_cvt_pk_bf16_f32 v6, v204, v205
v_cvt_pk_bf16_f32 v7, v206, v207
buffer_store_dwordx4 v[4:7], v26, s[52:55], s60 offen offset:1024 sc1
s_waitcnt lgkmcnt(4)
v_pk_add_f32 v[208:209], v[208:209], v[48:49]
v_pk_add_f32 v[210:211], v[210:211], v[50:51]
v_pk_add_f32 v[212:213], v[212:213], v[52:53]
v_pk_add_f32 v[214:215], v[214:215], v[54:55]
v_pk_add_f32 v[216:217], v[216:217], v[56:57]
v_pk_add_f32 v[218:219], v[218:219], v[58:59]
v_pk_add_f32 v[220:221], v[220:221], v[60:61]
v_pk_add_f32 v[222:223], v[222:223], v[62:63]
ds_read_b128 v[48:51], v12 offset:12288
ds_read_b128 v[52:55], v12 offset:13312
ds_read_b128 v[56:59], v12 offset:14336
ds_read_b128 v[60:63], v12 offset:15360
v_pk_mul_f32 v[208:209], v[208:209], v[14:15]
v_pk_mul_f32 v[210:211], v[210:211], v[14:15]
v_pk_mul_f32 v[212:213], v[212:213], v[14:15]
v_pk_mul_f32 v[214:215], v[214:215], v[14:15]
v_pk_mul_f32 v[216:217], v[216:217], v[14:15]
v_pk_mul_f32 v[218:219], v[218:219], v[14:15]
v_pk_mul_f32 v[220:221], v[220:221], v[14:15]
v_pk_mul_f32 v[222:223], v[222:223], v[14:15]
v_cvt_pk_bf16_f32 v28, v208, v209
v_cvt_pk_bf16_f32 v29, v210, v211
v_cvt_pk_bf16_f32 v30, v212, v213
v_cvt_pk_bf16_f32 v31, v214, v215
buffer_store_dwordx4 v[28:31], v26, s[52:55], s60 offen offset:2048 sc1
v_cvt_pk_bf16_f32 v4, v216, v217
v_cvt_pk_bf16_f32 v5, v218, v219
v_cvt_pk_bf16_f32 v6, v220, v221
v_cvt_pk_bf16_f32 v7, v222, v223
buffer_store_dwordx4 v[4:7], v26, s[52:55], s60 offen offset:3072 sc1
s_waitcnt lgkmcnt(4)
v_pk_add_f32 v[224:225], v[224:225], v[32:33]
v_pk_add_f32 v[226:227], v[226:227], v[34:35]
v_pk_add_f32 v[228:229], v[228:229], v[36:37]
v_pk_add_f32 v[230:231], v[230:231], v[38:39]
v_pk_add_f32 v[232:233], v[232:233], v[40:41]
v_pk_add_f32 v[234:235], v[234:235], v[42:43]
v_pk_add_f32 v[236:237], v[236:237], v[44:45]
v_pk_add_f32 v[238:239], v[238:239], v[46:47]
v_pk_mul_f32 v[224:225], v[224:225], v[18:19]
v_pk_mul_f32 v[226:227], v[226:227], v[18:19]
v_pk_mul_f32 v[228:229], v[228:229], v[18:19]
v_pk_mul_f32 v[230:231], v[230:231], v[18:19]
v_pk_mul_f32 v[232:233], v[232:233], v[18:19]
v_pk_mul_f32 v[234:235], v[234:235], v[18:19]
v_pk_mul_f32 v[236:237], v[236:237], v[18:19]
v_pk_mul_f32 v[238:239], v[238:239], v[18:19]
v_cvt_pk_bf16_f32 v28, v224, v225
v_cvt_pk_bf16_f32 v29, v226, v227
v_cvt_pk_bf16_f32 v30, v228, v229
v_cvt_pk_bf16_f32 v31, v230, v231
buffer_store_dwordx4 v[28:31], v26, s[52:55], s61 offen offset:0 sc1
v_cvt_pk_bf16_f32 v4, v232, v233
v_cvt_pk_bf16_f32 v5, v234, v235
v_cvt_pk_bf16_f32 v6, v236, v237
v_cvt_pk_bf16_f32 v7, v238, v239
buffer_store_dwordx4 v[4:7], v26, s[52:55], s61 offen offset:1024 sc1
s_waitcnt lgkmcnt(0)
v_pk_add_f32 v[240:241], v[240:241], v[48:49]
v_pk_add_f32 v[242:243], v[242:243], v[50:51]
v_pk_add_f32 v[244:245], v[244:245], v[52:53]
v_pk_add_f32 v[246:247], v[246:247], v[54:55]
v_pk_add_f32 v[248:249], v[248:249], v[56:57]
v_pk_add_f32 v[250:251], v[250:251], v[58:59]
v_pk_add_f32 v[252:253], v[252:253], v[60:61]
v_pk_add_f32 v[254:255], v[254:255], v[62:63]
v_pk_mul_f32 v[240:241], v[240:241], v[18:19]
v_pk_mul_f32 v[242:243], v[242:243], v[18:19]
v_pk_mul_f32 v[244:245], v[244:245], v[18:19]
v_pk_mul_f32 v[246:247], v[246:247], v[18:19]
v_pk_mul_f32 v[248:249], v[248:249], v[18:19]
v_pk_mul_f32 v[250:251], v[250:251], v[18:19]
v_pk_mul_f32 v[252:253], v[252:253], v[18:19]
v_pk_mul_f32 v[254:255], v[254:255], v[18:19]
v_cvt_pk_bf16_f32 v28, v240, v241
v_cvt_pk_bf16_f32 v29, v242, v243
v_cvt_pk_bf16_f32 v30, v244, v245
v_cvt_pk_bf16_f32 v31, v246, v247
buffer_store_dwordx4 v[28:31], v26, s[52:55], s61 offen offset:2048 sc1
v_cvt_pk_bf16_f32 v4, v248, v249
v_cvt_pk_bf16_f32 v5, v250, v251
v_cvt_pk_bf16_f32 v6, v252, v253
v_cvt_pk_bf16_f32 v7, v254, v255
buffer_store_dwordx4 v[4:7], v26, s[52:55], s61 offen offset:3072 sc1
s_nop 1
v_mov_b32 v4, 0
v_mov_b32 v5, 0
v_mov_b32 v6, 0
v_mov_b32 v7, 0
LA_finJ:
s_cmp_lg_u64 s[76:77], 0
s_cselect_b32 s60, 1, 0
v_mov_b32 v23, s60
s_lshl_b32 s60, s63, 15
s_add_u32 s60, s60, 69632
s_lshl_b32 s61, s22, 2
s_add_u32 s61, s61, s60
v_mov_b32 v24, s61
v_mov_b32 v22, s60
ds_write_b32 v24, v23
s_waitcnt lgkmcnt(0)
s_barrier
ds_read_b128 v[20:23], v22
s_cmp_lt_u32 s78, 2
s_cbranch_scc1 Lfo_110
s_cmp_eq_u32 s74, s75
s_cselect_b32 s61, 1, 2
s_waitcnt lgkmcnt(0)
v_or_b32 v20, v20, v21
v_or_b32 v22, v22, v23
v_or_b32 v20, v20, v22
s_nop 0
v_readfirstlane_b32 s60, v20
s_nop 3
s_mul_i32 s60, s60, s61
s_or_b32 s82, s82, s60
s_cmp_eq_u32 s78, 2
s_cbranch_scc1 LA_att_done
s_cmp_eq_u32 s78, 3
s_cbranch_scc1 LA_safe_b2
s_branch LA_safe_done
Lfo_110:
s_cmp_gt_u32 s74, 13
s_cbranch_scc1 Lnok_111
s_mov_b32 s64, s81
s_add_u32 s67, s81, 32768
s_xor_b32 s65, s63, 1
s_lshl_b32 s65, s65, 15
s_add_u32 s65, s65, s62
s_add_u32 m0, s65, 0
s_add_u32 s66, s64, 0
buffer_load_dwordx4 v26, s[44:47], s66 offen offset:0 sc1 lds
buffer_load_dwordx4 v26, s[44:47], s66 offen offset:1024 sc1 lds
buffer_load_dwordx4 v26, s[44:47], s66 offen offset:2048 sc1 lds
buffer_load_dwordx4 v26, s[44:47], s66 offen offset:3072 sc1 lds
s_add_u32 m0, s65, 4096
s_add_u32 s66, s64, 4096
buffer_load_dwordx4 v26, s[44:47], s66 offen offset:0 sc1 lds
buffer_load_dwordx4 v26, s[44:47], s66 offen offset:1024 sc1 lds
buffer_load_dwordx4 v26, s[44:47], s66 offen offset:2048 sc1 lds
buffer_load_dwordx4 v26, s[44:47], s66 offen offset:3072 sc1 lds
s_cmp_ge_u32 s74, 13
s_cselect_b32 s69, s69, s62
s_cselect_b32 s67, 0x200000, s67
Lnok_111:
s_cmp_eq_u32 s74, s75
s_cselect_b32 s61, 1, 2
s_waitcnt lgkmcnt(0)
v_or_b32 v20, v20, v21
v_or_b32 v22, v22, v23
v_or_b32 v20, v20, v22
s_nop 0
v_readfirstlane_b32 s60, v20
s_nop 3
s_mul_i32 s60, s60, s61
s_or_b32 s82, s82, s60
s_cmp_eq_u32 s78, 0
s_cbranch_scc1 LA_cont_e
s_branch LA_cont_o
LA_redo:
s_mov_b32 s83, 1
s_waitcnt vmcnt(0) lgkmcnt(0)
s_barrier
s_load_dwordx2 s[8:9], s[0:1], 16
s_waitcnt lgkmcnt(0)
s_lshl_b32 s60, s20, 8
s_add_u32 s36, s8, s60
s_addc_u32 s37, s9, 0
s_mov_b32 s38, 0x0
s_mov_b32 s39, 0x20000
s_sub_u32 s38, 0x500000, s60
s_mov_b32 s40, s18
s_mov_b32 s41, s19
s_mov_b32 s42, 0x280000
s_mov_b32 s43, 0x20000
s_mov_b32 s4, s18
s_mov_b32 s5, s19
s_mov_b32 s6, 0x0
s_mov_b32 s7, 0x20000
s_mov_b32 s67, 0
v_lshlrev_b32 v26, 4, v1
v_lshrrev_b32 v27, 4, v1
v_and_b32 v28, 15, v1
v_lshlrev_b32 v29, 2, v27
v_xor_b32 v28, v28, v29
v_lshlrev_b32 v28, 4, v28
v_lshlrev_b32 v27, 13, v27
v_add_u32 v27, v27, v28
v_add_u32 v6, 0, v27
v_add_u32 v7, 31744, v27
v_add_u32 v8, 63488, v27
v_add_u32 v9, 95232, v27
s_lshl_b32 s85, s22, 17
s_lshl_b32 s84, s22, 12
s_add_u32 s84, s84, 98304
s_sub_u32 s75, 15, s21
s_cmp_ge_u32 s22, 2
s_cselect_b32 s60, s21, s75
s_lshl_b32 s60, s60, 2
s_and_b32 s61, s22, 1
s_lshl_b32 s61, s61, 1
s_add_u32 s60, s60, s61
s_mul_i32 s72, s60, 40960
s_add_u32 s73, s72, 40960
s_add_u32 m0, s84, 32768
s_add_u32 s66, s85, 0
buffer_load_dwordx4 v6, s[36:39], s66 offen offset:0 lds
buffer_load_dwordx4 v7, s[36:39], s66 offen offset:1024 lds
buffer_load_dwordx4 v8, s[36:39], s66 offen offset:2048 lds
buffer_load_dwordx4 v9, s[36:39], s66 offen offset:3072 lds
s_add_u32 m0, s84, 49152
s_add_u32 s66, s85, 524288
buffer_load_dwordx4 v6, s[36:39], s66 offen offset:0 lds
buffer_load_dwordx4 v7, s[36:39], s66 offen offset:1024 lds
buffer_load_dwordx4 v8, s[36:39], s66 offen offset:2048 lds
buffer_load_dwordx4 v9, s[36:39], s66 offen offset:3072 lds
s_waitcnt vmcnt(0)
s_add_u32 s86, s72, 0
s_add_u32 s88, s73, 0
buffer_load_dwordx4 a[128:131], v26, s[40:43], s86 offen offset:0 sc1
buffer_load_dwordx4 a[132:135], v26, s[40:43], s88 offen offset:0 sc1
buffer_load_dwordx4 a[136:139], v26, s[40:43], s86 offen offset:1024 sc1
buffer_load_dwordx4 a[140:143], v26, s[40:43], s88 offen offset:1024 sc1
buffer_load_dwordx4 a[144:147], v26, s[40:43], s86 offen offset:2048 sc1
buffer_load_dwordx4 a[148:151], v26, s[40:43], s88 offen offset:2048 sc1
buffer_load_dwordx4 a[152:155], v26, s[40:43], s86 offen offset:3072 sc1
buffer_load_dwordx4 a[156:159], v26, s[40:43], s88 offen offset:3072 sc1
s_add_u32 s87, s72, 4096
s_add_u32 s89, s73, 4096
buffer_load_dwordx4 a[160:163], v26, s[40:43], s87 offen offset:0 sc1
buffer_load_dwordx4 a[164:167], v26, s[40:43], s89 offen offset:0 sc1
buffer_load_dwordx4 a[168:171], v26, s[40:43], s87 offen offset:1024 sc1
buffer_load_dwordx4 a[172:175], v26, s[40:43], s89 offen offset:1024 sc1
buffer_load_dwordx4 a[176:179], v26, s[40:43], s87 offen offset:2048 sc1
buffer_load_dwordx4 a[180:183], v26, s[40:43], s89 offen offset:2048 sc1
buffer_load_dwordx4 a[184:187], v26, s[40:43], s87 offen offset:3072 sc1
buffer_load_dwordx4 a[188:191], v26, s[40:43], s89 offen offset:3072 sc1
s_add_u32 s86, s72, 8192
s_add_u32 s88, s73, 8192
buffer_load_dwordx4 a[192:195], v26, s[40:43], s86 offen offset:0 sc1
buffer_load_dwordx4 a[196:199], v26, s[40:43], s88 offen offset:0 sc1
buffer_load_dwordx4 a[200:203], v26, s[40:43], s86 offen offset:1024 sc1
buffer_load_dwordx4 a[204:207], v26, s[40:43], s88 offen offset:1024 sc1
buffer_load_dwordx4 a[208:211], v26, s[40:43], s86 offen offset:2048 sc1
buffer_load_dwordx4 a[212:215], v26, s[40:43], s88 offen offset:2048 sc1
buffer_load_dwordx4 a[216:219], v26, s[40:43], s86 offen offset:3072 sc1
buffer_load_dwordx4 a[220:223], v26, s[40:43], s88 offen offset:3072 sc1
s_add_u32 s87, s72, 12288
s_add_u32 s89, s73, 12288
buffer_load_dwordx4 a[224:227], v26, s[40:43], s87 offen offset:0 sc1
buffer_load_dwordx4 a[228:231], v26, s[40:43], s89 offen offset:0 sc1
buffer_load_dwordx4 a[232:235], v26, s[40:43], s87 offen offset:1024 sc1
buffer_load_dwordx4 a[236:239], v26, s[40:43], s89 offen offset:1024 sc1
buffer_load_dwordx4 a[240:243], v26, s[40:43], s87 offen offset:2048 sc1
buffer_load_dwordx4 a[244:247], v26, s[40:43], s89 offen offset:2048 sc1
s_add_u32 m0, s84, 0
s_add_u32 s66, s85, 1048576
buffer_load_dwordx4 v6, s[36:39], s66 offen offset:0 lds
buffer_load_dwordx4 v7, s[36:39], s66 offen offset:1024 lds
buffer_load_dwordx4 v8, s[36:39], s66 offen offset:2048 lds
buffer_load_dwordx4 v9, s[36:39], s66 offen offset:3072 lds
s_add_u32 m0, s84, 16384
s_add_u32 s66, s85, 1572864
buffer_load_dwordx4 v6, s[36:39], s66 offen offset:0 lds
buffer_load_dwordx4 v7, s[36:39], s66 offen offset:1024 lds
buffer_load_dwordx4 v8, s[36:39], s66 offen offset:2048 lds
buffer_load_dwordx4 v9, s[36:39], s66 offen offset:3072 lds
s_branch LA_p2
LA_safe:
s_lshl_b32 s62, s22, 13
s_waitcnt vmcnt(0) lgkmcnt(0)
s_bitcmp1_b32 s82, 0
s_cbranch_scc0 LA_safe_b2
s_mov_b32 s64, s75
v_mov_b32 v20, 0
v_mov_b32 v21, 0
v_mov_b32 v22, 0
v_mov_b32 v23, 0
s_nop 1
v_mfma_f32_32x32x16_bf16 a[0:15], v[20:23], v[20:23], 0
v_mfma_f32_32x32x16_bf16 a[16:31], v[20:23], v[20:23], 0
v_mfma_f32_32x32x16_bf16 a[32:47], v[20:23], v[20:23], 0
v_mfma_f32_32x32x16_bf16 a[48:63], v[20:23], v[20:23], 0
v_mfma_f32_32x32x16_bf16 a[64:79], v[20:23], v[20:23], 0
v_mfma_f32_32x32x16_bf16 a[80:95], v[20:23], v[20:23], 0
v_mfma_f32_32x32x16_bf16 a[96:111], v[20:23], v[20:23], 0
v_mfma_f32_32x32x16_bf16 a[112:127], v[20:23], v[20:23], 0
v_mov_b32 v4, 0
v_mov_b32 v5, 0
v_mov_b32 v6, 0
v_mov_b32 v7, 0
v_mov_b32 v28, 0xff7fffff
v_mov_b32 v29, 0xff7fffff
s_mov_b32 s65, 0
LA_sf_loop_a:
s_barrier
s_lshl_b32 s60, s65, 15
s_add_u32 s81, s60, s62
s_add_u32 m0, s62, 0
s_add_u32 s66, s81, 0
buffer_load_dwordx4 v26, s[44:47], s66 offen offset:0 sc1 lds
buffer_load_dwordx4 v26, s[44:47], s66 offen offset:1024 sc1 lds
buffer_load_dwordx4 v26, s[44:47], s66 offen offset:2048 sc1 lds
buffer_load_dwordx4 v26, s[44:47], s66 offen offset:3072 sc1 lds
s_add_u32 m0, s62, 4096
s_add_u32 s66, s81, 4096
buffer_load_dwordx4 v26, s[44:47], s66 offen offset:0 sc1 lds
buffer_load_dwordx4 v26, s[44:47], s66 offen offset:1024 sc1 lds
buffer_load_dwordx4 v26, s[44:47], s66 offen offset:2048 sc1 lds
buffer_load_dwordx4 v26, s[44:47], s66 offen offset:3072 sc1 lds
s_add_u32 m0, s62, 65536
s_add_u32 s66, s81, 0
buffer_load_dwordx4 v26, s[48:51], s66 offen offset:0 sc1 lds
buffer_load_dwordx4 v26, s[48:51], s66 offen offset:1024 sc1 lds
buffer_load_dwordx4 v26, s[48:51], s66 offen offset:2048 sc1 lds
buffer_load_dwordx4 v26, s[48:51], s66 offen offset:3072 sc1 lds
s_add_u32 m0, s62, 69632
s_add_u32 s66, s81, 4096
buffer_load_dwordx4 v26, s[48:51], s66 offen offset:0 sc1 lds
buffer_load_dwordx4 v26, s[48:51], s66 offen offset:1024 sc1 lds
buffer_load_dwordx4 v26, s[48:51], s66 offen offset:2048 sc1 lds
buffer_load_dwordx4 v26, s[48:51], s66 offen offset:3072 sc1 lds
s_waitcnt vmcnt(0)
s_barrier
ds_read_b128 a[192:195], v2 offset:0
ds_read_b128 a[196:199], v2 offset:1024
ds_read_b128 a[200:203], v2 offset:2048
ds_read_b128 a[204:207], v2 offset:3072
ds_read_b128 a[208:211], v2 offset:4096
ds_read_b128 a[212:215], v2 offset:5120
s_waitcnt lgkmcnt(4)
v_mfma_f32_32x32x16_bf16 v[64:79], a[192:195], a[128:131], 0
ds_read_b128 a[216:219], v2 offset:6144
v_mfma_f32_32x32x16_bf16 v[80:95], a[192:195], a[160:163], 0
v_mfma_f32_32x32x16_bf16 v[64:79], a[196:199], a[132:135], v[64:79]
ds_read_b128 a[220:223], v2 offset:7168
v_mfma_f32_32x32x16_bf16 v[80:95], a[196:199], a[164:167], v[80:95]
s_waitcnt lgkmcnt(4)
v_mfma_f32_32x32x16_bf16 v[64:79], a[200:203], a[136:139], v[64:79]
ds_read_b128 a[224:227], v2 offset:8192
v_mfma_f32_32x32x16_bf16 v[80:95], a[200:203], a[168:171], v[80:95]
v_mfma_f32_32x32x16_bf16 v[64:79], a[204:207], a[140:143], v[64:79]
ds_read_b128 a[228:231], v2 offset:9216
v_mfma_f32_32x32x16_bf16 v[80:95], a[204:207], a[172:175], v[80:95]
s_waitcnt lgkmcnt(4)
v_mfma_f32_32x32x16_bf16 v[64:79], a[208:211], a[144:147], v[64:79]
ds_read_b128 a[232:235], v2 offset:10240
v_mfma_f32_32x32x16_bf16 v[80:95], a[208:211], a[176:179], v[80:95]
v_mfma_f32_32x32x16_bf16 v[64:79], a[212:215], a[148:151], v[64:79]
ds_read_b128 a[236:239], v2 offset:11264
v_mfma_f32_32x32x16_bf16 v[80:95], a[212:215], a[180:183], v[80:95]
s_waitcnt lgkmcnt(4)
v_mfma_f32_32x32x16_bf16 v[64:79], a[216:219], a[152:155], v[64:79]
ds_read_b128 a[240:243], v2 offset:12288
v_mfma_f32_32x32x16_bf16 v[80:95], a[216:219], a[184:187], v[80:95]
v_mfma_f32_32x32x16_bf16 v[64:79], a[220:223], a[156:159], v[64:79]
ds_read_b128 a[244:247], v2 offset:13312
v_mfma_f32_32x32x16_bf16 v[80:95], a[220:223], a[188:191], v[80:95]
s_waitcnt lgkmcnt(4)
v_mfma_f32_32x32x16_bf16 v[96:111], a[224:227], a[128:131], 0
ds_read_b128 a[248:251], v2 offset:14336
v_mfma_f32_32x32x16_bf16 v[112:127], a[224:227], a[160:163], 0
v_mfma_f32_32x32x16_bf16 v[96:111], a[228:231], a[132:135], v[96:111]
ds_read_b128 a[252:255], v2 offset:15360
v_mfma_f32_32x32x16_bf16 v[112:127], a[228:231], a[164:167], v[112:127]
s_waitcnt lgkmcnt(4)
v_mfma_f32_32x32x16_bf16 v[96:111], a[232:235], a[136:139], v[96:111]
v_mfma_f32_32x32x16_bf16 v[112:127], a[232:235], a[168:171], v[112:127]
v_mfma_f32_32x32x16_bf16 v[96:111], a[236:239], a[140:143], v[96:111]
v_mfma_f32_32x32x16_bf16 v[112:127], a[236:239], a[172:175], v[112:127]
s_waitcnt lgkmcnt(2)
v_mfma_f32_32x32x16_bf16 v[96:111], a[240:243], a[144:147], v[96:111]
v_mfma_f32_32x32x16_bf16 v[112:127], a[240:243], a[176:179], v[112:127]
v_mfma_f32_32x32x16_bf16 v[96:111], a[244:247], a[148:151], v[96:111]
v_mfma_f32_32x32x16_bf16 v[112:127], a[244:247], a[180:183], v[112:127]
s_waitcnt lgkmcnt(0)
v_mfma_f32_32x32x16_bf16 v[96:111], a[248:251], a[152:155], v[96:111]
v_mfma_f32_32x32x16_bf16 v[112:127], a[248:251], a[184:187], v[112:127]
v_mfma_f32_32x32x16_bf16 v[96:111], a[252:255], a[156:159], v[96:111]
v_mfma_f32_32x32x16_bf16 v[112:127], a[252:255], a[188:191], v[112:127]
s_nop 15
s_cmp_lg_u32 s65, s64
s_cbranch_scc1 Lsfm_113
s_cmp_eq_u32 s22, 1
s_cbranch_scc1 Lme_116
s_cmp_eq_u32 s22, 2
s_cbranch_scc1 Lm2_115
v_cndmask_b32 v64, v10, v64, s[24:25]
v_cndmask_b32 v65, v10, v65, s[26:27]
v_cndmask_b32 v66, v10, v66, s[28:29]
v_cndmask_b32 v67, v10, v67, s[30:31]
v_cndmask_b32 v68, v10, v68, s[32:33]
v_cndmask_b32 v69, v10, v69, s[34:35]
v_cndmask_b32 v70, v10, v70, s[36:37]
v_cndmask_b32 v71, v10, v71, s[38:39]
v_cndmask_b32 v72, v10, v72, s[40:41]
v_cndmask_b32 v73, v10, v73, s[42:43]
v_cndmask_b32 v74, v10, v74, s[56:57]
v_cndmask_b32 v75, v10, v75, s[58:59]
v_cndmask_b32 v76, v10, v76, s[4:5]
v_cndmask_b32 v77, v10, v77, s[6:7]
v_cndmask_b32 v78, v10, v78, s[8:9]
v_cndmask_b32 v79, v10, v79, s[10:11]
v_cndmask_b32 v112, v10, v112, s[24:25]
v_cndmask_b32 v113, v10, v113, s[26:27]
v_cndmask_b32 v114, v10, v114, s[28:29]
v_cndmask_b32 v115, v10, v115, s[30:31]
v_cndmask_b32 v116, v10, v116, s[32:33]
v_cndmask_b32 v117, v10, v117, s[34:35]
v_cndmask_b32 v118, v10, v118, s[36:37]
v_cndmask_b32 v119, v10, v119, s[38:39]
v_cndmask_b32 v120, v10, v120, s[40:41]
v_cndmask_b32 v121, v10, v121, s[42:43]
v_cndmask_b32 v122, v10, v122, s[56:57]
v_cndmask_b32 v123, v10, v123, s[58:59]
v_cndmask_b32 v124, v10, v124, s[4:5]
v_cndmask_b32 v125, v10, v125, s[6:7]
v_cndmask_b32 v126, v10, v126, s[8:9]
v_cndmask_b32 v127, v10, v127, s[10:11]
v_mov_b32 v96, v10
v_mov_b32 v97, v10
v_mov_b32 v98, v10
v_mov_b32 v99, v10
v_mov_b32 v100, v10
v_mov_b32 v101, v10
v_mov_b32 v102, v10
v_mov_b32 v103, v10
v_mov_b32 v104, v10
v_mov_b32 v105, v10
v_mov_b32 v106, v10
v_mov_b32 v107, v10
v_mov_b32 v108, v10
v_mov_b32 v109, v10
v_mov_b32 v110, v10
v_mov_b32 v111, v10
s_branch Lme_116
Lm2_115:
v_mov_b32 v64, v10
v_mov_b32 v65, v10
v_mov_b32 v66, v10
v_mov_b32 v67, v10
v_mov_b32 v68, v10
v_mov_b32 v69, v10
v_mov_b32 v70, v10
v_mov_b32 v71, v10
v_mov_b32 v72, v10
v_mov_b32 v73, v10
v_mov_b32 v74, v10
v_mov_b32 v75, v10
v_mov_b32 v76, v10
v_mov_b32 v77, v10
v_mov_b32 v78, v10
v_mov_b32 v79, v10
v_mov_b32 v80, v10
v_mov_b32 v81, v10
v_mov_b32 v82, v10
v_mov_b32 v83, v10
v_mov_b32 v84, v10
v_mov_b32 v85, v10
v_mov_b32 v86, v10
v_mov_b32 v87, v10
v_mov_b32 v88, v10
v_mov_b32 v89, v10
v_mov_b32 v90, v10
v_mov_b32 v91, v10
v_mov_b32 v92, v10
v_mov_b32 v93, v10
v_mov_b32 v94, v10
v_mov_b32 v95, v10
v_mov_b32 v96, v10
v_mov_b32 v97, v10
v_mov_b32 v98, v10
v_mov_b32 v99, v10
v_mov_b32 v100, v10
v_mov_b32 v101, v10
v_mov_b32 v102, v10
v_mov_b32 v103, v10
v_mov_b32 v104, v10
v_mov_b32 v105, v10
v_mov_b32 v106, v10
v_mov_b32 v107, v10
v_mov_b32 v108, v10
v_mov_b32 v109, v10
v_mov_b32 v110, v10
v_mov_b32 v111, v10
v_mov_b32 v112, v10
v_mov_b32 v113, v10
v_mov_b32 v114, v10
v_mov_b32 v115, v10
v_mov_b32 v116, v10
v_mov_b32 v117, v10
v_mov_b32 v118, v10
v_mov_b32 v119, v10
v_mov_b32 v120, v10
v_mov_b32 v121, v10
v_mov_b32 v122, v10
v_mov_b32 v123, v10
v_mov_b32 v124, v10
v_mov_b32 v125, v10
v_mov_b32 v126, v10
v_mov_b32 v127, v10
Lme_116:
Lsfm_113:
v_max_f32 v12, v64, v65
v_max3_f32 v12, v12, v66, v67
v_max3_f32 v12, v12, v68, v69
v_max3_f32 v12, v12, v70, v71
v_max3_f32 v12, v12, v72, v73
v_max3_f32 v12, v12, v74, v75
v_max3_f32 v12, v12, v76, v77
v_max3_f32 v12, v12, v78, v79
v_max3_f32 v12, v12, v96, v97
v_max3_f32 v12, v12, v98, v99
v_max3_f32 v12, v12, v100, v101
v_max3_f32 v12, v12, v102, v103
v_max3_f32 v12, v12, v104, v105
v_max3_f32 v12, v12, v106, v107
v_max3_f32 v12, v12, v108, v109
v_max3_f32 v12, v12, v110, v111
v_mov_b32 v13, v12
s_nop 1
v_permlane32_swap_b32 v12, v13
s_nop 1
v_max_f32 v12, v12, v13
v_max_f32 v12, v12, v28
v_sub_f32 v13, v28, v12
v_exp_f32 v13, v13
v_mov_b32 v28, v12
v_mul_f32 v4, v4, v13
v_mul_f32 v5, v5, v13
v_accvgpr_read_b32 v14, a0
v_mul_f32 v14, v14, v13
v_accvgpr_write_b32 a0, v14
v_accvgpr_read_b32 v14, a1
v_mul_f32 v14, v14, v13
v_accvgpr_write_b32 a1, v14
v_accvgpr_read_b32 v14, a2
v_mul_f32 v14, v14, v13
v_accvgpr_write_b32 a2, v14
v_accvgpr_read_b32 v14, a3
v_mul_f32 v14, v14, v13
v_accvgpr_write_b32 a3, v14
v_accvgpr_read_b32 v14, a4
v_mul_f32 v14, v14, v13
v_accvgpr_write_b32 a4, v14
v_accvgpr_read_b32 v14, a5
v_mul_f32 v14, v14, v13
v_accvgpr_write_b32 a5, v14
v_accvgpr_read_b32 v14, a6
v_mul_f32 v14, v14, v13
v_accvgpr_write_b32 a6, v14
v_accvgpr_read_b32 v14, a7
v_mul_f32 v14, v14, v13
v_accvgpr_write_b32 a7, v14
v_accvgpr_read_b32 v14, a8
v_mul_f32 v14, v14, v13
v_accvgpr_write_b32 a8, v14
v_accvgpr_read_b32 v14, a9
v_mul_f32 v14, v14, v13
v_accvgpr_write_b32 a9, v14
v_accvgpr_read_b32 v14, a10
v_mul_f32 v14, v14, v13
v_accvgpr_write_b32 a10, v14
v_accvgpr_read_b32 v14, a11
v_mul_f32 v14, v14, v13
v_accvgpr_write_b32 a11, v14
v_accvgpr_read_b32 v14, a12
v_mul_f32 v14, v14, v13
v_accvgpr_write_b32 a12, v14
v_accvgpr_read_b32 v14, a13
v_mul_f32 v14, v14, v13
v_accvgpr_write_b32 a13, v14
v_accvgpr_read_b32 v14, a14
v_mul_f32 v14, v14, v13
v_accvgpr_write_b32 a14, v14
v_accvgpr_read_b32 v14, a15
v_mul_f32 v14, v14, v13
v_accvgpr_write_b32 a15, v14
v_accvgpr_read_b32 v14, a16
v_mul_f32 v14, v14, v13
v_accvgpr_write_b32 a16, v14
v_accvgpr_read_b32 v14, a17
v_mul_f32 v14, v14, v13
v_accvgpr_write_b32 a17, v14
v_accvgpr_read_b32 v14, a18
v_mul_f32 v14, v14, v13
v_accvgpr_write_b32 a18, v14
v_accvgpr_read_b32 v14, a19
v_mul_f32 v14, v14, v13
v_accvgpr_write_b32 a19, v14
v_accvgpr_read_b32 v14, a20
v_mul_f32 v14, v14, v13
v_accvgpr_write_b32 a20, v14
v_accvgpr_read_b32 v14, a21
v_mul_f32 v14, v14, v13
v_accvgpr_write_b32 a21, v14
v_accvgpr_read_b32 v14, a22
v_mul_f32 v14, v14, v13
v_accvgpr_write_b32 a22, v14
v_accvgpr_read_b32 v14, a23
v_mul_f32 v14, v14, v13
v_accvgpr_write_b32 a23, v14
v_accvgpr_read_b32 v14, a24
v_mul_f32 v14, v14, v13
v_accvgpr_write_b32 a24, v14
v_accvgpr_read_b32 v14, a25
v_mul_f32 v14, v14, v13
v_accvgpr_write_b32 a25, v14
v_accvgpr_read_b32 v14, a26
v_mul_f32 v14, v14, v13
v_accvgpr_write_b32 a26, v14
v_accvgpr_read_b32 v14, a27
v_mul_f32 v14, v14, v13
v_accvgpr_write_b32 a27, v14
v_accvgpr_read_b32 v14, a28
v_mul_f32 v14, v14, v13
v_accvgpr_write_b32 a28, v14
v_accvgpr_read_b32 v14, a29
v_mul_f32 v14, v14, v13
v_accvgpr_write_b32 a29, v14
v_accvgpr_read_b32 v14, a30
v_mul_f32 v14, v14, v13
v_accvgpr_write_b32 a30, v14
v_accvgpr_read_b32 v14, a31
v_mul_f32 v14, v14, v13
v_accvgpr_write_b32 a31, v14
v_accvgpr_read_b32 v14, a32
v_mul_f32 v14, v14, v13
v_accvgpr_write_b32 a32, v14
v_accvgpr_read_b32 v14, a33
v_mul_f32 v14, v14, v13
v_accvgpr_write_b32 a33, v14
v_accvgpr_read_b32 v14, a34
v_mul_f32 v14, v14, v13
v_accvgpr_write_b32 a34, v14
v_accvgpr_read_b32 v14, a35
v_mul_f32 v14, v14, v13
v_accvgpr_write_b32 a35, v14
v_accvgpr_read_b32 v14, a36
v_mul_f32 v14, v14, v13
v_accvgpr_write_b32 a36, v14
v_accvgpr_read_b32 v14, a37
v_mul_f32 v14, v14, v13
v_accvgpr_write_b32 a37, v14
v_accvgpr_read_b32 v14, a38
v_mul_f32 v14, v14, v13
v_accvgpr_write_b32 a38, v14
v_accvgpr_read_b32 v14, a39
v_mul_f32 v14, v14, v13
v_accvgpr_write_b32 a39, v14
v_accvgpr_read_b32 v14, a40
v_mul_f32 v14, v14, v13
v_accvgpr_write_b32 a40, v14
v_accvgpr_read_b32 v14, a41
v_mul_f32 v14, v14, v13
v_accvgpr_write_b32 a41, v14
v_accvgpr_read_b32 v14, a42
v_mul_f32 v14, v14, v13
v_accvgpr_write_b32 a42, v14
v_accvgpr_read_b32 v14, a43
v_mul_f32 v14, v14, v13
v_accvgpr_write_b32 a43, v14
v_accvgpr_read_b32 v14, a44
v_mul_f32 v14, v14, v13
v_accvgpr_write_b32 a44, v14
v_accvgpr_read_b32 v14, a45
v_mul_f32 v14, v14, v13
v_accvgpr_write_b32 a45, v14
v_accvgpr_read_b32 v14, a46
v_mul_f32 v14, v14, v13
v_accvgpr_write_b32 a46, v14
v_accvgpr_read_b32 v14, a47
v_mul_f32 v14, v14, v13
v_accvgpr_write_b32 a47, v14
v_accvgpr_read_b32 v14, a48
v_mul_f32 v14, v14, v13
v_accvgpr_write_b32 a48, v14
v_accvgpr_read_b32 v14, a49
v_mul_f32 v14, v14, v13
v_accvgpr_write_b32 a49, v14
v_accvgpr_read_b32 v14, a50
v_mul_f32 v14, v14, v13
v_accvgpr_write_b32 a50, v14
v_accvgpr_read_b32 v14, a51
v_mul_f32 v14, v14, v13
v_accvgpr_write_b32 a51, v14
v_accvgpr_read_b32 v14, a52
v_mul_f32 v14, v14, v13
v_accvgpr_write_b32 a52, v14
v_accvgpr_read_b32 v14, a53
v_mul_f32 v14, v14, v13
v_accvgpr_write_b32 a53, v14
v_accvgpr_read_b32 v14, a54
v_mul_f32 v14, v14, v13
v_accvgpr_write_b32 a54, v14
v_accvgpr_read_b32 v14, a55
v_mul_f32 v14, v14, v13
v_accvgpr_write_b32 a55, v14
v_accvgpr_read_b32 v14, a56
v_mul_f32 v14, v14, v13
v_accvgpr_write_b32 a56, v14
v_accvgpr_read_b32 v14, a57
v_mul_f32 v14, v14, v13
v_accvgpr_write_b32 a57, v14
v_accvgpr_read_b32 v14, a58
v_mul_f32 v14, v14, v13
v_accvgpr_write_b32 a58, v14
v_accvgpr_read_b32 v14, a59
v_mul_f32 v14, v14, v13
v_accvgpr_write_b32 a59, v14
v_accvgpr_read_b32 v14, a60
v_mul_f32 v14, v14, v13
v_accvgpr_write_b32 a60, v14
v_accvgpr_read_b32 v14, a61
v_mul_f32 v14, v14, v13
v_accvgpr_write_b32 a61, v14
v_accvgpr_read_b32 v14, a62
v_mul_f32 v14, v14, v13
v_accvgpr_write_b32 a62, v14
v_accvgpr_read_b32 v14, a63
v_mul_f32 v14, v14, v13
v_accvgpr_write_b32 a63, v14
v_sub_f32 v64, v64, v12
v_sub_f32 v65, v65, v12
v_sub_f32 v66, v66, v12
v_sub_f32 v67, v67, v12
v_sub_f32 v68, v68, v12
v_sub_f32 v69, v69, v12
v_sub_f32 v70, v70, v12
v_sub_f32 v71, v71, v12
v_sub_f32 v72, v72, v12
v_sub_f32 v73, v73, v12
v_sub_f32 v74, v74, v12
v_sub_f32 v75, v75, v12
v_sub_f32 v76, v76, v12
v_sub_f32 v77, v77, v12
v_sub_f32 v78, v78, v12
v_sub_f32 v79, v79, v12
v_sub_f32 v96, v96, v12
v_sub_f32 v97, v97, v12
v_sub_f32 v98, v98, v12
v_sub_f32 v99, v99, v12
v_sub_f32 v100, v100, v12
v_sub_f32 v101, v101, v12
v_sub_f32 v102, v102, v12
v_sub_f32 v103, v103, v12
v_sub_f32 v104, v104, v12
v_sub_f32 v105, v105, v12
v_sub_f32 v106, v106, v12
v_sub_f32 v107, v107, v12
v_sub_f32 v108, v108, v12
v_sub_f32 v109, v109, v12
v_sub_f32 v110, v110, v12
v_sub_f32 v111, v111, v12
v_max_f32 v12, v80, v81
v_max3_f32 v12, v12, v82, v83
v_max3_f32 v12, v12, v84, v85
v_max3_f32 v12, v12, v86, v87
v_max3_f32 v12, v12, v88, v89
v_max3_f32 v12, v12, v90, v91
v_max3_f32 v12, v12, v92, v93
v_max3_f32 v12, v12, v94, v95
v_max3_f32 v12, v12, v112, v113
v_max3_f32 v12, v12, v114, v115
v_max3_f32 v12, v12, v116, v117
v_max3_f32 v12, v12, v118, v119
v_max3_f32 v12, v12, v120, v121
v_max3_f32 v12, v12, v122, v123
v_max3_f32 v12, v12, v124, v125
v_max3_f32 v12, v12, v126, v127
v_mov_b32 v13, v12
s_nop 1
v_permlane32_swap_b32 v12, v13
s_nop 1
v_max_f32 v12, v12, v13
v_max_f32 v12, v12, v29
v_sub_f32 v13, v29, v12
v_exp_f32 v13, v13
v_mov_b32 v29, v12
v_mul_f32 v6, v6, v13
v_mul_f32 v7, v7, v13
v_accvgpr_read_b32 v14, a64
v_mul_f32 v14, v14, v13
v_accvgpr_write_b32 a64, v14
v_accvgpr_read_b32 v14, a65
v_mul_f32 v14, v14, v13
v_accvgpr_write_b32 a65, v14
v_accvgpr_read_b32 v14, a66
v_mul_f32 v14, v14, v13
v_accvgpr_write_b32 a66, v14
v_accvgpr_read_b32 v14, a67
v_mul_f32 v14, v14, v13
v_accvgpr_write_b32 a67, v14
v_accvgpr_read_b32 v14, a68
v_mul_f32 v14, v14, v13
v_accvgpr_write_b32 a68, v14
v_accvgpr_read_b32 v14, a69
v_mul_f32 v14, v14, v13
v_accvgpr_write_b32 a69, v14
v_accvgpr_read_b32 v14, a70
v_mul_f32 v14, v14, v13
v_accvgpr_write_b32 a70, v14
v_accvgpr_read_b32 v14, a71
v_mul_f32 v14, v14, v13
v_accvgpr_write_b32 a71, v14
v_accvgpr_read_b32 v14, a72
v_mul_f32 v14, v14, v13
v_accvgpr_write_b32 a72, v14
v_accvgpr_read_b32 v14, a73
v_mul_f32 v14, v14, v13
v_accvgpr_write_b32 a73, v14
v_accvgpr_read_b32 v14, a74
v_mul_f32 v14, v14, v13
v_accvgpr_write_b32 a74, v14
v_accvgpr_read_b32 v14, a75
v_mul_f32 v14, v14, v13
v_accvgpr_write_b32 a75, v14
v_accvgpr_read_b32 v14, a76
v_mul_f32 v14, v14, v13
v_accvgpr_write_b32 a76, v14
v_accvgpr_read_b32 v14, a77
v_mul_f32 v14, v14, v13
v_accvgpr_write_b32 a77, v14
v_accvgpr_read_b32 v14, a78
v_mul_f32 v14, v14, v13
v_accvgpr_write_b32 a78, v14
v_accvgpr_read_b32 v14, a79
v_mul_f32 v14, v14, v13
v_accvgpr_write_b32 a79, v14
v_accvgpr_read_b32 v14, a80
v_mul_f32 v14, v14, v13
v_accvgpr_write_b32 a80, v14
v_accvgpr_read_b32 v14, a81
v_mul_f32 v14, v14, v13
v_accvgpr_write_b32 a81, v14
v_accvgpr_read_b32 v14, a82
v_mul_f32 v14, v14, v13
v_accvgpr_write_b32 a82, v14
v_accvgpr_read_b32 v14, a83
v_mul_f32 v14, v14, v13
v_accvgpr_write_b32 a83, v14
v_accvgpr_read_b32 v14, a84
v_mul_f32 v14, v14, v13
v_accvgpr_write_b32 a84, v14
v_accvgpr_read_b32 v14, a85
v_mul_f32 v14, v14, v13
v_accvgpr_write_b32 a85, v14
v_accvgpr_read_b32 v14, a86
v_mul_f32 v14, v14, v13
v_accvgpr_write_b32 a86, v14
v_accvgpr_read_b32 v14, a87
v_mul_f32 v14, v14, v13
v_accvgpr_write_b32 a87, v14
v_accvgpr_read_b32 v14, a88
v_mul_f32 v14, v14, v13
v_accvgpr_write_b32 a88, v14
v_accvgpr_read_b32 v14, a89
v_mul_f32 v14, v14, v13
v_accvgpr_write_b32 a89, v14
v_accvgpr_read_b32 v14, a90
v_mul_f32 v14, v14, v13
v_accvgpr_write_b32 a90, v14
v_accvgpr_read_b32 v14, a91
v_mul_f32 v14, v14, v13
v_accvgpr_write_b32 a91, v14
v_accvgpr_read_b32 v14, a92
v_mul_f32 v14, v14, v13
v_accvgpr_write_b32 a92, v14
v_accvgpr_read_b32 v14, a93
v_mul_f32 v14, v14, v13
v_accvgpr_write_b32 a93, v14
v_accvgpr_read_b32 v14, a94
v_mul_f32 v14, v14, v13
v_accvgpr_write_b32 a94, v14
v_accvgpr_read_b32 v14, a95
v_mul_f32 v14, v14, v13
v_accvgpr_write_b32 a95, v14
v_accvgpr_read_b32 v14, a96
v_mul_f32 v14, v14, v13
v_accvgpr_write_b32 a96, v14
v_accvgpr_read_b32 v14, a97
v_mul_f32 v14, v14, v13
v_accvgpr_write_b32 a97, v14
v_accvgpr_read_b32 v14, a98
v_mul_f32 v14, v14, v13
v_accvgpr_write_b32 a98, v14
v_accvgpr_read_b32 v14, a99
v_mul_f32 v14, v14, v13
v_accvgpr_write_b32 a99, v14
v_accvgpr_read_b32 v14, a100
v_mul_f32 v14, v14, v13
v_accvgpr_write_b32 a100, v14
v_accvgpr_read_b32 v14, a101
v_mul_f32 v14, v14, v13
v_accvgpr_write_b32 a101, v14
v_accvgpr_read_b32 v14, a102
v_mul_f32 v14, v14, v13
v_accvgpr_write_b32 a102, v14
v_accvgpr_read_b32 v14, a103
v_mul_f32 v14, v14, v13
v_accvgpr_write_b32 a103, v14
v_accvgpr_read_b32 v14, a104
v_mul_f32 v14, v14, v13
v_accvgpr_write_b32 a104, v14
v_accvgpr_read_b32 v14, a105
v_mul_f32 v14, v14, v13
v_accvgpr_write_b32 a105, v14
v_accvgpr_read_b32 v14, a106
v_mul_f32 v14, v14, v13
v_accvgpr_write_b32 a106, v14
v_accvgpr_read_b32 v14, a107
v_mul_f32 v14, v14, v13
v_accvgpr_write_b32 a107, v14
v_accvgpr_read_b32 v14, a108
v_mul_f32 v14, v14, v13
v_accvgpr_write_b32 a108, v14
v_accvgpr_read_b32 v14, a109
v_mul_f32 v14, v14, v13
v_accvgpr_write_b32 a109, v14
v_accvgpr_read_b32 v14, a110
v_mul_f32 v14, v14, v13
v_accvgpr_write_b32 a110, v14
v_accvgpr_read_b32 v14, a111
v_mul_f32 v14, v14, v13
v_accvgpr_write_b32 a111, v14
v_accvgpr_read_b32 v14, a112
v_mul_f32 v14, v14, v13
v_accvgpr_write_b32 a112, v14
v_accvgpr_read_b32 v14, a113
v_mul_f32 v14, v14, v13
v_accvgpr_write_b32 a113, v14
v_accvgpr_read_b32 v14, a114
v_mul_f32 v14, v14, v13
v_accvgpr_write_b32 a114, v14
v_accvgpr_read_b32 v14, a115
v_mul_f32 v14, v14, v13
v_accvgpr_write_b32 a115, v14
v_accvgpr_read_b32 v14, a116
v_mul_f32 v14, v14, v13
v_accvgpr_write_b32 a116, v14
v_accvgpr_read_b32 v14, a117
v_mul_f32 v14, v14, v13
v_accvgpr_write_b32 a117, v14
v_accvgpr_read_b32 v14, a118
v_mul_f32 v14, v14, v13
v_accvgpr_write_b32 a118, v14
v_accvgpr_read_b32 v14, a119
v_mul_f32 v14, v14, v13
v_accvgpr_write_b32 a119, v14
v_accvgpr_read_b32 v14, a120
v_mul_f32 v14, v14, v13
v_accvgpr_write_b32 a120, v14
v_accvgpr_read_b32 v14, a121
v_mul_f32 v14, v14, v13
v_accvgpr_write_b32 a121, v14
v_accvgpr_read_b32 v14, a122
v_mul_f32 v14, v14, v13
v_accvgpr_write_b32 a122, v14
v_accvgpr_read_b32 v14, a123
v_mul_f32 v14, v14, v13
v_accvgpr_write_b32 a123, v14
v_accvgpr_read_b32 v14, a124
v_mul_f32 v14, v14, v13
v_accvgpr_write_b32 a124, v14
v_accvgpr_read_b32 v14, a125
v_mul_f32 v14, v14, v13
v_accvgpr_write_b32 a125, v14
v_accvgpr_read_b32 v14, a126
v_mul_f32 v14, v14, v13
v_accvgpr_write_b32 a126, v14
v_accvgpr_read_b32 v14, a127
v_mul_f32 v14, v14, v13
v_accvgpr_write_b32 a127, v14
v_sub_f32 v80, v80, v12
v_sub_f32 v81, v81, v12
v_sub_f32 v82, v82, v12
v_sub_f32 v83, v83, v12
v_sub_f32 v84, v84, v12
v_sub_f32 v85, v85, v12
v_sub_f32 v86, v86, v12
v_sub_f32 v87, v87, v12
v_sub_f32 v88, v88, v12
v_sub_f32 v89, v89, v12
v_sub_f32 v90, v90, v12
v_sub_f32 v91, v91, v12
v_sub_f32 v92, v92, v12
v_sub_f32 v93, v93, v12
v_sub_f32 v94, v94, v12
v_sub_f32 v95, v95, v12
v_sub_f32 v112, v112, v12
v_sub_f32 v113, v113, v12
v_sub_f32 v114, v114, v12
v_sub_f32 v115, v115, v12
v_sub_f32 v116, v116, v12
v_sub_f32 v117, v117, v12
v_sub_f32 v118, v118, v12
v_sub_f32 v119, v119, v12
v_sub_f32 v120, v120, v12
v_sub_f32 v121, v121, v12
v_sub_f32 v122, v122, v12
v_sub_f32 v123, v123, v12
v_sub_f32 v124, v124, v12
v_sub_f32 v125, v125, v12
v_sub_f32 v126, v126, v12
v_sub_f32 v127, v127, v12
v_exp_f32 v64, v64
v_exp_f32 v65, v65
v_exp_f32 v66, v66
v_exp_f32 v67, v67
v_add_f32 v4, v4, v64
v_add_f32 v5, v5, v65
v_cvt_pk_bf16_f32 v32, v64, v65
v_exp_f32 v68, v68
v_exp_f32 v69, v69
v_add_f32 v4, v4, v66
v_add_f32 v5, v5, v67
v_cvt_pk_bf16_f32 v33, v66, v67
v_exp_f32 v70, v70
v_exp_f32 v71, v71
v_add_f32 v4, v4, v68
v_add_f32 v5, v5, v69
v_cvt_pk_bf16_f32 v34, v68, v69
v_exp_f32 v80, v80
v_exp_f32 v81, v81
v_add_f32 v4, v4, v70
v_add_f32 v5, v5, v71
v_cvt_pk_bf16_f32 v35, v70, v71
v_exp_f32 v82, v82
v_exp_f32 v83, v83
v_add_f32 v6, v6, v80
v_add_f32 v7, v7, v81
v_cvt_pk_bf16_f32 v48, v80, v81
v_exp_f32 v84, v84
v_exp_f32 v85, v85
v_add_f32 v6, v6, v82
v_add_f32 v7, v7, v83
v_cvt_pk_bf16_f32 v49, v82, v83
v_exp_f32 v86, v86
v_exp_f32 v87, v87
v_add_f32 v6, v6, v84
v_add_f32 v7, v7, v85
v_cvt_pk_bf16_f32 v50, v84, v85
v_exp_f32 v72, v72
v_exp_f32 v73, v73
v_add_f32 v6, v6, v86
v_add_f32 v7, v7, v87
v_cvt_pk_bf16_f32 v51, v86, v87
v_exp_f32 v74, v74
v_exp_f32 v75, v75
v_add_f32 v4, v4, v72
v_add_f32 v5, v5, v73
v_cvt_pk_bf16_f32 v36, v72, v73
v_exp_f32 v76, v76
v_exp_f32 v77, v77
v_add_f32 v4, v4, v74
v_add_f32 v5, v5, v75
v_cvt_pk_bf16_f32 v37, v74, v75
v_exp_f32 v78, v78
v_exp_f32 v79, v79
v_add_f32 v4, v4, v76
v_add_f32 v5, v5, v77
v_cvt_pk_bf16_f32 v38, v76, v77
v_exp_f32 v88, v88
v_exp_f32 v89, v89
v_add_f32 v4, v4, v78
v_add_f32 v5, v5, v79
v_cvt_pk_bf16_f32 v39, v78, v79
v_exp_f32 v90, v90
v_exp_f32 v91, v91
v_add_f32 v6, v6, v88
v_add_f32 v7, v7, v89
v_cvt_pk_bf16_f32 v52, v88, v89
v_exp_f32 v92, v92
v_exp_f32 v93, v93
v_add_f32 v6, v6, v90
v_add_f32 v7, v7, v91
v_cvt_pk_bf16_f32 v53, v90, v91
v_exp_f32 v94, v94
v_exp_f32 v95, v95
v_add_f32 v6, v6, v92
v_add_f32 v7, v7, v93
v_cvt_pk_bf16_f32 v54, v92, v93
v_exp_f32 v96, v96
v_exp_f32 v97, v97
v_add_f32 v6, v6, v94
v_add_f32 v7, v7, v95
v_cvt_pk_bf16_f32 v55, v94, v95
v_exp_f32 v98, v98
v_exp_f32 v99, v99
v_add_f32 v4, v4, v96
v_add_f32 v5, v5, v97
v_cvt_pk_bf16_f32 v40, v96, v97
v_exp_f32 v100, v100
v_exp_f32 v101, v101
v_add_f32 v4, v4, v98
v_add_f32 v5, v5, v99
v_cvt_pk_bf16_f32 v41, v98, v99
v_exp_f32 v102, v102
v_exp_f32 v103, v103
v_add_f32 v4, v4, v100
v_add_f32 v5, v5, v101
v_cvt_pk_bf16_f32 v42, v100, v101
v_exp_f32 v112, v112
v_exp_f32 v113, v113
v_add_f32 v4, v4, v102
v_add_f32 v5, v5, v103
v_cvt_pk_bf16_f32 v43, v102, v103
v_exp_f32 v114, v114
v_exp_f32 v115, v115
v_add_f32 v6, v6, v112
v_add_f32 v7, v7, v113
v_cvt_pk_bf16_f32 v56, v112, v113
v_exp_f32 v116, v116
v_exp_f32 v117, v117
v_add_f32 v6, v6, v114
v_add_f32 v7, v7, v115
v_cvt_pk_bf16_f32 v57, v114, v115
v_exp_f32 v118, v118
v_exp_f32 v119, v119
v_add_f32 v6, v6, v116
v_add_f32 v7, v7, v117
v_cvt_pk_bf16_f32 v58, v116, v117
v_exp_f32 v104, v104
v_exp_f32 v105, v105
v_add_f32 v6, v6, v118
v_add_f32 v7, v7, v119
v_cvt_pk_bf16_f32 v59, v118, v119
v_exp_f32 v106, v106
v_exp_f32 v107, v107
v_add_f32 v4, v4, v104
v_add_f32 v5, v5, v105
v_cvt_pk_bf16_f32 v44, v104, v105
v_exp_f32 v108, v108
v_exp_f32 v109, v109
v_add_f32 v4, v4, v106
v_add_f32 v5, v5, v107
v_cvt_pk_bf16_f32 v45, v106, v107
v_exp_f32 v110, v110
v_exp_f32 v111, v111
v_add_f32 v4, v4, v108
v_add_f32 v5, v5, v109
v_cvt_pk_bf16_f32 v46, v108, v109
v_exp_f32 v120, v120
v_exp_f32 v121, v121
v_add_f32 v4, v4, v110
v_add_f32 v5, v5, v111
v_cvt_pk_bf16_f32 v47, v110, v111
v_exp_f32 v122, v122
v_exp_f32 v123, v123
v_add_f32 v6, v6, v120
v_add_f32 v7, v7, v121
v_cvt_pk_bf16_f32 v60, v120, v121
v_exp_f32 v124, v124
v_exp_f32 v125, v125
v_add_f32 v6, v6, v122
v_add_f32 v7, v7, v123
v_cvt_pk_bf16_f32 v61, v122, v123
v_exp_f32 v126, v126
v_exp_f32 v127, v127
v_add_f32 v6, v6, v124
v_add_f32 v7, v7, v125
v_cvt_pk_bf16_f32 v62, v124, v125
s_nop 0
v_add_f32 v6, v6, v126
v_add_f32 v7, v7, v127
v_cvt_pk_bf16_f32 v63, v126, v127
s_nop 1
ds_read_b128 a[192:195], v3 offset:0
ds_read_b128 a[196:199], v3 offset:1024
ds_read_b128 a[200:203], v3 offset:2048
ds_read_b128 a[204:207], v3 offset:3072
ds_read_b128 a[208:211], v3 offset:4096
ds_read_b128 a[212:215], v3 offset:5120
s_waitcnt lgkmcnt(4)
v_mfma_f32_32x32x16_bf16 a[0:15], a[192:195], v[32:35], a[0:15]
ds_read_b128 a[216:219], v3 offset:6144
v_mfma_f32_32x32x16_bf16 a[64:79], a[192:195], v[48:51], a[64:79]
v_mfma_f32_32x32x16_bf16 a[16:31], a[196:199], v[32:35], a[16:31]
ds_read_b128 a[220:223], v3 offset:7168
v_mfma_f32_32x32x16_bf16 a[80:95], a[196:199], v[48:51], a[80:95]
s_waitcnt lgkmcnt(4)
v_mfma_f32_32x32x16_bf16 a[32:47], a[200:203], v[32:35], a[32:47]
ds_read_b128 a[224:227], v3 offset:8192
v_mfma_f32_32x32x16_bf16 a[96:111], a[200:203], v[48:51], a[96:111]
v_mfma_f32_32x32x16_bf16 a[48:63], a[204:207], v[32:35], a[48:63]
ds_read_b128 a[228:231], v3 offset:9216
v_mfma_f32_32x32x16_bf16 a[112:127], a[204:207], v[48:51], a[112:127]
s_waitcnt lgkmcnt(4)
v_mfma_f32_32x32x16_bf16 a[0:15], a[208:211], v[36:39], a[0:15]
ds_read_b128 a[232:235], v3 offset:10240
v_mfma_f32_32x32x16_bf16 a[64:79], a[208:211], v[52:55], a[64:79]
v_mfma_f32_32x32x16_bf16 a[16:31], a[212:215], v[36:39], a[16:31]
ds_read_b128 a[236:239], v3 offset:11264
v_mfma_f32_32x32x16_bf16 a[80:95], a[212:215], v[52:55], a[80:95]
s_waitcnt lgkmcnt(4)
v_mfma_f32_32x32x16_bf16 a[32:47], a[216:219], v[36:39], a[32:47]
ds_read_b128 a[240:243], v3 offset:12288
v_mfma_f32_32x32x16_bf16 a[96:111], a[216:219], v[52:55], a[96:111]
v_mfma_f32_32x32x16_bf16 a[48:63], a[220:223], v[36:39], a[48:63]
ds_read_b128 a[244:247], v3 offset:13312
v_mfma_f32_32x32x16_bf16 a[112:127], a[220:223], v[52:55], a[112:127]
s_waitcnt lgkmcnt(4)
v_mfma_f32_32x32x16_bf16 a[0:15], a[224:227], v[40:43], a[0:15]
ds_read_b128 a[248:251], v3 offset:14336
v_mfma_f32_32x32x16_bf16 a[64:79], a[224:227], v[56:59], a[64:79]
v_mfma_f32_32x32x16_bf16 a[16:31], a[228:231], v[40:43], a[16:31]
ds_read_b128 a[252:255], v3 offset:15360
v_mfma_f32_32x32x16_bf16 a[80:95], a[228:231], v[56:59], a[80:95]
s_waitcnt lgkmcnt(4)
v_mfma_f32_32x32x16_bf16 a[32:47], a[232:235], v[40:43], a[32:47]
v_mfma_f32_32x32x16_bf16 a[96:111], a[232:235], v[56:59], a[96:111]
v_mfma_f32_32x32x16_bf16 a[48:63], a[236:239], v[40:43], a[48:63]
v_mfma_f32_32x32x16_bf16 a[112:127], a[236:239], v[56:59], a[112:127]
s_waitcnt lgkmcnt(2)
v_mfma_f32_32x32x16_bf16 a[0:15], a[240:243], v[44:47], a[0:15]
v_mfma_f32_32x32x16_bf16 a[64:79], a[240:243], v[60:63], a[64:79]
v_mfma_f32_32x32x16_bf16 a[16:31], a[244:247], v[44:47], a[16:31]
v_mfma_f32_32x32x16_bf16 a[80:95], a[244:247], v[60:63], a[80:95]
s_waitcnt lgkmcnt(0)
v_mfma_f32_32x32x16_bf16 a[32:47], a[248:251], v[44:47], a[32:47]
v_mfma_f32_32x32x16_bf16 a[96:111], a[248:251], v[60:63], a[96:111]
v_mfma_f32_32x32x16_bf16 a[48:63], a[252:255], v[44:47], a[48:63]
v_mfma_f32_32x32x16_bf16 a[112:127], a[252:255], v[60:63], a[112:127]
s_add_u32 s65, s65, 1
s_cmp_le_u32 s65, s64
s_cbranch_scc1 LA_sf_loop_a
s_nop 15
s_barrier
v_lshlrev_b32 v12, 3, v1
v_add_u32 v12, 0x20000, v12
s_lshl_b32 s60, s22, 9
v_add_u32 v13, s60, v12
s_xor_b32 s60, s60, 1024
v_add_u32 v12, s60, v12
ds_write_b64 v13, v[28:29]
s_waitcnt lgkmcnt(0)
s_barrier
ds_read_b64 v[14:15], v12
s_waitcnt lgkmcnt(0)
s_barrier
v_max_f32 v12, v28, v14
v_sub_f32 v13, v28, v12
v_exp_f32 v13, v13
s_nop 0
v_mul_f32 v4, v4, v13
v_mul_f32 v5, v5, v13
v_accvgpr_read_b32 v11, a0
v_mul_f32 v11, v11, v13
v_accvgpr_write_b32 a0, v11
v_accvgpr_read_b32 v11, a1
v_mul_f32 v11, v11, v13
v_accvgpr_write_b32 a1, v11
v_accvgpr_read_b32 v11, a2
v_mul_f32 v11, v11, v13
v_accvgpr_write_b32 a2, v11
v_accvgpr_read_b32 v11, a3
v_mul_f32 v11, v11, v13
v_accvgpr_write_b32 a3, v11
v_accvgpr_read_b32 v11, a4
v_mul_f32 v11, v11, v13
v_accvgpr_write_b32 a4, v11
v_accvgpr_read_b32 v11, a5
v_mul_f32 v11, v11, v13
v_accvgpr_write_b32 a5, v11
v_accvgpr_read_b32 v11, a6
v_mul_f32 v11, v11, v13
v_accvgpr_write_b32 a6, v11
v_accvgpr_read_b32 v11, a7
v_mul_f32 v11, v11, v13
v_accvgpr_write_b32 a7, v11
v_accvgpr_read_b32 v11, a8
v_mul_f32 v11, v11, v13
v_accvgpr_write_b32 a8, v11
v_accvgpr_read_b32 v11, a9
v_mul_f32 v11, v11, v13
v_accvgpr_write_b32 a9, v11
v_accvgpr_read_b32 v11, a10
v_mul_f32 v11, v11, v13
v_accvgpr_write_b32 a10, v11
v_accvgpr_read_b32 v11, a11
v_mul_f32 v11, v11, v13
v_accvgpr_write_b32 a11, v11
v_accvgpr_read_b32 v11, a12
v_mul_f32 v11, v11, v13
v_accvgpr_write_b32 a12, v11
v_accvgpr_read_b32 v11, a13
v_mul_f32 v11, v11, v13
v_accvgpr_write_b32 a13, v11
v_accvgpr_read_b32 v11, a14
v_mul_f32 v11, v11, v13
v_accvgpr_write_b32 a14, v11
v_accvgpr_read_b32 v11, a15
v_mul_f32 v11, v11, v13
v_accvgpr_write_b32 a15, v11
v_accvgpr_read_b32 v11, a16
v_mul_f32 v11, v11, v13
v_accvgpr_write_b32 a16, v11
v_accvgpr_read_b32 v11, a17
v_mul_f32 v11, v11, v13
v_accvgpr_write_b32 a17, v11
v_accvgpr_read_b32 v11, a18
v_mul_f32 v11, v11, v13
v_accvgpr_write_b32 a18, v11
v_accvgpr_read_b32 v11, a19
v_mul_f32 v11, v11, v13
v_accvgpr_write_b32 a19, v11
v_accvgpr_read_b32 v11, a20
v_mul_f32 v11, v11, v13
v_accvgpr_write_b32 a20, v11
v_accvgpr_read_b32 v11, a21
v_mul_f32 v11, v11, v13
v_accvgpr_write_b32 a21, v11
v_accvgpr_read_b32 v11, a22
v_mul_f32 v11, v11, v13
v_accvgpr_write_b32 a22, v11
v_accvgpr_read_b32 v11, a23
v_mul_f32 v11, v11, v13
v_accvgpr_write_b32 a23, v11
v_accvgpr_read_b32 v11, a24
v_mul_f32 v11, v11, v13
v_accvgpr_write_b32 a24, v11
v_accvgpr_read_b32 v11, a25
v_mul_f32 v11, v11, v13
v_accvgpr_write_b32 a25, v11
v_accvgpr_read_b32 v11, a26
v_mul_f32 v11, v11, v13
v_accvgpr_write_b32 a26, v11
v_accvgpr_read_b32 v11, a27
v_mul_f32 v11, v11, v13
v_accvgpr_write_b32 a27, v11
v_accvgpr_read_b32 v11, a28
v_mul_f32 v11, v11, v13
v_accvgpr_write_b32 a28, v11
v_accvgpr_read_b32 v11, a29
v_mul_f32 v11, v11, v13
v_accvgpr_write_b32 a29, v11
v_accvgpr_read_b32 v11, a30
v_mul_f32 v11, v11, v13
v_accvgpr_write_b32 a30, v11
v_accvgpr_read_b32 v11, a31
v_mul_f32 v11, v11, v13
v_accvgpr_write_b32 a31, v11
v_accvgpr_read_b32 v11, a32
v_mul_f32 v11, v11, v13
v_accvgpr_write_b32 a32, v11
v_accvgpr_read_b32 v11, a33
v_mul_f32 v11, v11, v13
v_accvgpr_write_b32 a33, v11
v_accvgpr_read_b32 v11, a34
v_mul_f32 v11, v11, v13
v_accvgpr_write_b32 a34, v11
v_accvgpr_read_b32 v11, a35
v_mul_f32 v11, v11, v13
v_accvgpr_write_b32 a35, v11
v_accvgpr_read_b32 v11, a36
v_mul_f32 v11, v11, v13
v_accvgpr_write_b32 a36, v11
v_accvgpr_read_b32 v11, a37
v_mul_f32 v11, v11, v13
v_accvgpr_write_b32 a37, v11
v_accvgpr_read_b32 v11, a38
v_mul_f32 v11, v11, v13
v_accvgpr_write_b32 a38, v11
v_accvgpr_read_b32 v11, a39
v_mul_f32 v11, v11, v13
v_accvgpr_write_b32 a39, v11
v_accvgpr_read_b32 v11, a40
v_mul_f32 v11, v11, v13
v_accvgpr_write_b32 a40, v11
v_accvgpr_read_b32 v11, a41
v_mul_f32 v11, v11, v13
v_accvgpr_write_b32 a41, v11
v_accvgpr_read_b32 v11, a42
v_mul_f32 v11, v11, v13
v_accvgpr_write_b32 a42, v11
v_accvgpr_read_b32 v11, a43
v_mul_f32 v11, v11, v13
v_accvgpr_write_b32 a43, v11
v_accvgpr_read_b32 v11, a44
v_mul_f32 v11, v11, v13
v_accvgpr_write_b32 a44, v11
v_accvgpr_read_b32 v11, a45
v_mul_f32 v11, v11, v13
v_accvgpr_write_b32 a45, v11
v_accvgpr_read_b32 v11, a46
v_mul_f32 v11, v11, v13
v_accvgpr_write_b32 a46, v11
v_accvgpr_read_b32 v11, a47
v_mul_f32 v11, v11, v13
v_accvgpr_write_b32 a47, v11
v_accvgpr_read_b32 v11, a48
v_mul_f32 v11, v11, v13
v_accvgpr_write_b32 a48, v11
v_accvgpr_read_b32 v11, a49
v_mul_f32 v11, v11, v13
v_accvgpr_write_b32 a49, v11
v_accvgpr_read_b32 v11, a50
v_mul_f32 v11, v11, v13
v_accvgpr_write_b32 a50, v11
v_accvgpr_read_b32 v11, a51
v_mul_f32 v11, v11, v13
v_accvgpr_write_b32 a51, v11
v_accvgpr_read_b32 v11, a52
v_mul_f32 v11, v11, v13
v_accvgpr_write_b32 a52, v11
v_accvgpr_read_b32 v11, a53
v_mul_f32 v11, v11, v13
v_accvgpr_write_b32 a53, v11
v_accvgpr_read_b32 v11, a54
v_mul_f32 v11, v11, v13
v_accvgpr_write_b32 a54, v11
v_accvgpr_read_b32 v11, a55
v_mul_f32 v11, v11, v13
v_accvgpr_write_b32 a55, v11
v_accvgpr_read_b32 v11, a56
v_mul_f32 v11, v11, v13
v_accvgpr_write_b32 a56, v11
v_accvgpr_read_b32 v11, a57
v_mul_f32 v11, v11, v13
v_accvgpr_write_b32 a57, v11
v_accvgpr_read_b32 v11, a58
v_mul_f32 v11, v11, v13
v_accvgpr_write_b32 a58, v11
v_accvgpr_read_b32 v11, a59
v_mul_f32 v11, v11, v13
v_accvgpr_write_b32 a59, v11
v_accvgpr_read_b32 v11, a60
v_mul_f32 v11, v11, v13
v_accvgpr_write_b32 a60, v11
v_accvgpr_read_b32 v11, a61
v_mul_f32 v11, v11, v13
v_accvgpr_write_b32 a61, v11
v_accvgpr_read_b32 v11, a62
v_mul_f32 v11, v11, v13
v_accvgpr_write_b32 a62, v11
v_accvgpr_read_b32 v11, a63
v_mul_f32 v11, v11, v13
v_accvgpr_write_b32 a63, v11
v_max_f32 v12, v29, v15
v_sub_f32 v13, v29, v12
v_exp_f32 v13, v13
s_nop 0
v_mul_f32 v6, v6, v13
v_mul_f32 v7, v7, v13
v_accvgpr_read_b32 v11, a64
v_mul_f32 v11, v11, v13
v_accvgpr_write_b32 a64, v11
v_accvgpr_read_b32 v11, a65
v_mul_f32 v11, v11, v13
v_accvgpr_write_b32 a65, v11
v_accvgpr_read_b32 v11, a66
v_mul_f32 v11, v11, v13
v_accvgpr_write_b32 a66, v11
v_accvgpr_read_b32 v11, a67
v_mul_f32 v11, v11, v13
v_accvgpr_write_b32 a67, v11
v_accvgpr_read_b32 v11, a68
v_mul_f32 v11, v11, v13
v_accvgpr_write_b32 a68, v11
v_accvgpr_read_b32 v11, a69
v_mul_f32 v11, v11, v13
v_accvgpr_write_b32 a69, v11
v_accvgpr_read_b32 v11, a70
v_mul_f32 v11, v11, v13
v_accvgpr_write_b32 a70, v11
v_accvgpr_read_b32 v11, a71
v_mul_f32 v11, v11, v13
v_accvgpr_write_b32 a71, v11
v_accvgpr_read_b32 v11, a72
v_mul_f32 v11, v11, v13
v_accvgpr_write_b32 a72, v11
v_accvgpr_read_b32 v11, a73
v_mul_f32 v11, v11, v13
v_accvgpr_write_b32 a73, v11
v_accvgpr_read_b32 v11, a74
v_mul_f32 v11, v11, v13
v_accvgpr_write_b32 a74, v11
v_accvgpr_read_b32 v11, a75
v_mul_f32 v11, v11, v13
v_accvgpr_write_b32 a75, v11
v_accvgpr_read_b32 v11, a76
v_mul_f32 v11, v11, v13
v_accvgpr_write_b32 a76, v11
v_accvgpr_read_b32 v11, a77
v_mul_f32 v11, v11, v13
v_accvgpr_write_b32 a77, v11
v_accvgpr_read_b32 v11, a78
v_mul_f32 v11, v11, v13
v_accvgpr_write_b32 a78, v11
v_accvgpr_read_b32 v11, a79
v_mul_f32 v11, v11, v13
v_accvgpr_write_b32 a79, v11
v_accvgpr_read_b32 v11, a80
v_mul_f32 v11, v11, v13
v_accvgpr_write_b32 a80, v11
v_accvgpr_read_b32 v11, a81
v_mul_f32 v11, v11, v13
v_accvgpr_write_b32 a81, v11
v_accvgpr_read_b32 v11, a82
v_mul_f32 v11, v11, v13
v_accvgpr_write_b32 a82, v11
v_accvgpr_read_b32 v11, a83
v_mul_f32 v11, v11, v13
v_accvgpr_write_b32 a83, v11
v_accvgpr_read_b32 v11, a84
v_mul_f32 v11, v11, v13
v_accvgpr_write_b32 a84, v11
v_accvgpr_read_b32 v11, a85
v_mul_f32 v11, v11, v13
v_accvgpr_write_b32 a85, v11
v_accvgpr_read_b32 v11, a86
v_mul_f32 v11, v11, v13
v_accvgpr_write_b32 a86, v11
v_accvgpr_read_b32 v11, a87
v_mul_f32 v11, v11, v13
v_accvgpr_write_b32 a87, v11
v_accvgpr_read_b32 v11, a88
v_mul_f32 v11, v11, v13
v_accvgpr_write_b32 a88, v11
v_accvgpr_read_b32 v11, a89
v_mul_f32 v11, v11, v13
v_accvgpr_write_b32 a89, v11
v_accvgpr_read_b32 v11, a90
v_mul_f32 v11, v11, v13
v_accvgpr_write_b32 a90, v11
v_accvgpr_read_b32 v11, a91
v_mul_f32 v11, v11, v13
v_accvgpr_write_b32 a91, v11
v_accvgpr_read_b32 v11, a92
v_mul_f32 v11, v11, v13
v_accvgpr_write_b32 a92, v11
v_accvgpr_read_b32 v11, a93
v_mul_f32 v11, v11, v13
v_accvgpr_write_b32 a93, v11
v_accvgpr_read_b32 v11, a94
v_mul_f32 v11, v11, v13
v_accvgpr_write_b32 a94, v11
v_accvgpr_read_b32 v11, a95
v_mul_f32 v11, v11, v13
v_accvgpr_write_b32 a95, v11
v_accvgpr_read_b32 v11, a96
v_mul_f32 v11, v11, v13
v_accvgpr_write_b32 a96, v11
v_accvgpr_read_b32 v11, a97
v_mul_f32 v11, v11, v13
v_accvgpr_write_b32 a97, v11
v_accvgpr_read_b32 v11, a98
v_mul_f32 v11, v11, v13
v_accvgpr_write_b32 a98, v11
v_accvgpr_read_b32 v11, a99
v_mul_f32 v11, v11, v13
v_accvgpr_write_b32 a99, v11
v_accvgpr_read_b32 v11, a100
v_mul_f32 v11, v11, v13
v_accvgpr_write_b32 a100, v11
v_accvgpr_read_b32 v11, a101
v_mul_f32 v11, v11, v13
v_accvgpr_write_b32 a101, v11
v_accvgpr_read_b32 v11, a102
v_mul_f32 v11, v11, v13
v_accvgpr_write_b32 a102, v11
v_accvgpr_read_b32 v11, a103
v_mul_f32 v11, v11, v13
v_accvgpr_write_b32 a103, v11
v_accvgpr_read_b32 v11, a104
v_mul_f32 v11, v11, v13
v_accvgpr_write_b32 a104, v11
v_accvgpr_read_b32 v11, a105
v_mul_f32 v11, v11, v13
v_accvgpr_write_b32 a105, v11
v_accvgpr_read_b32 v11, a106
v_mul_f32 v11, v11, v13
v_accvgpr_write_b32 a106, v11
v_accvgpr_read_b32 v11, a107
v_mul_f32 v11, v11, v13
v_accvgpr_write_b32 a107, v11
v_accvgpr_read_b32 v11, a108
v_mul_f32 v11, v11, v13
v_accvgpr_write_b32 a108, v11
v_accvgpr_read_b32 v11, a109
v_mul_f32 v11, v11, v13
v_accvgpr_write_b32 a109, v11
v_accvgpr_read_b32 v11, a110
v_mul_f32 v11, v11, v13
v_accvgpr_write_b32 a110, v11
v_accvgpr_read_b32 v11, a111
v_mul_f32 v11, v11, v13
v_accvgpr_write_b32 a111, v11
v_accvgpr_read_b32 v11, a112
v_mul_f32 v11, v11, v13
v_accvgpr_write_b32 a112, v11
v_accvgpr_read_b32 v11, a113
v_mul_f32 v11, v11, v13
v_accvgpr_write_b32 a113, v11
v_accvgpr_read_b32 v11, a114
v_mul_f32 v11, v11, v13
v_accvgpr_write_b32 a114, v11
v_accvgpr_read_b32 v11, a115
v_mul_f32 v11, v11, v13
v_accvgpr_write_b32 a115, v11
v_accvgpr_read_b32 v11, a116
v_mul_f32 v11, v11, v13
v_accvgpr_write_b32 a116, v11
v_accvgpr_read_b32 v11, a117
v_mul_f32 v11, v11, v13
v_accvgpr_write_b32 a117, v11
v_accvgpr_read_b32 v11, a118
v_mul_f32 v11, v11, v13
v_accvgpr_write_b32 a118, v11
v_accvgpr_read_b32 v11, a119
v_mul_f32 v11, v11, v13
v_accvgpr_write_b32 a119, v11
v_accvgpr_read_b32 v11, a120
v_mul_f32 v11, v11, v13
v_accvgpr_write_b32 a120, v11
v_accvgpr_read_b32 v11, a121
v_mul_f32 v11, v11, v13
v_accvgpr_write_b32 a121, v11
v_accvgpr_read_b32 v11, a122
v_mul_f32 v11, v11, v13
v_accvgpr_write_b32 a122, v11
v_accvgpr_read_b32 v11, a123
v_mul_f32 v11, v11, v13
v_accvgpr_write_b32 a123, v11
v_accvgpr_read_b32 v11, a124
v_mul_f32 v11, v11, v13
v_accvgpr_write_b32 a124, v11
v_accvgpr_read_b32 v11, a125
v_mul_f32 v11, v11, v13
v_accvgpr_write_b32 a125, v11
v_accvgpr_read_b32 v11, a126
v_mul_f32 v11, v11, v13
v_accvgpr_write_b32 a126, v11
v_accvgpr_read_b32 v11, a127
v_mul_f32 v11, v11, v13
v_accvgpr_write_b32 a127, v11
s_nop 3
v_accvgpr_write_b32 a128, v192
v_accvgpr_write_b32 a129, v193
v_accvgpr_write_b32 a130, v194
v_accvgpr_write_b32 a131, v195
v_accvgpr_write_b32 a132, v196
v_accvgpr_write_b32 a133, v197
v_accvgpr_write_b32 a134, v198
v_accvgpr_write_b32 a135, v199
v_accvgpr_write_b32 a136, v200
v_accvgpr_write_b32 a137, v201
v_accvgpr_write_b32 a138, v202
v_accvgpr_write_b32 a139, v203
v_accvgpr_write_b32 a140, v204
v_accvgpr_write_b32 a141, v205
v_accvgpr_write_b32 a142, v206
v_accvgpr_write_b32 a143, v207
v_accvgpr_write_b32 a144, v208
v_accvgpr_write_b32 a145, v209
v_accvgpr_write_b32 a146, v210
v_accvgpr_write_b32 a147, v211
v_accvgpr_write_b32 a148, v212
v_accvgpr_write_b32 a149, v213
v_accvgpr_write_b32 a150, v214
v_accvgpr_write_b32 a151, v215
v_accvgpr_write_b32 a152, v216
v_accvgpr_write_b32 a153, v217
v_accvgpr_write_b32 a154, v218
v_accvgpr_write_b32 a155, v219
v_accvgpr_write_b32 a156, v220
v_accvgpr_write_b32 a157, v221
v_accvgpr_write_b32 a158, v222
v_accvgpr_write_b32 a159, v223
v_accvgpr_write_b32 a160, v224
v_accvgpr_write_b32 a161, v225
v_accvgpr_write_b32 a162, v226
v_accvgpr_write_b32 a163, v227
v_accvgpr_write_b32 a164, v228
v_accvgpr_write_b32 a165, v229
v_accvgpr_write_b32 a166, v230
v_accvgpr_write_b32 a167, v231
v_accvgpr_write_b32 a168, v232
v_accvgpr_write_b32 a169, v233
v_accvgpr_write_b32 a170, v234
v_accvgpr_write_b32 a171, v235
v_accvgpr_write_b32 a172, v236
v_accvgpr_write_b32 a173, v237
v_accvgpr_write_b32 a174, v238
v_accvgpr_write_b32 a175, v239
v_accvgpr_write_b32 a176, v240
v_accvgpr_write_b32 a177, v241
v_accvgpr_write_b32 a178, v242
v_accvgpr_write_b32 a179, v243
v_accvgpr_write_b32 a180, v244
v_accvgpr_write_b32 a181, v245
v_accvgpr_write_b32 a182, v246
v_accvgpr_write_b32 a183, v247
v_accvgpr_write_b32 a184, v248
v_accvgpr_write_b32 a185, v249
v_accvgpr_write_b32 a186, v250
v_accvgpr_write_b32 a187, v251
v_accvgpr_write_b32 a188, v252
v_accvgpr_write_b32 a189, v253
v_accvgpr_write_b32 a190, v254
v_accvgpr_write_b32 a191, v255
s_or_b32 s82, s82, 4
s_mov_b32 s74, s75
s_mov_b32 s78, 3
s_branch LA_fin
LA_safe_b2:
s_bitcmp1_b32 s82, 1
s_cbranch_scc0 LA_safe_done
s_bitcmp1_b32 s82, 2
s_cbranch_scc1 Lsfq_117
v_accvgpr_write_b32 a128, v192
v_accvgpr_write_b32 a129, v193
v_accvgpr_write_b32 a130, v194
v_accvgpr_write_b32 a131, v195
v_accvgpr_write_b32 a132, v196
v_accvgpr_write_b32 a133, v197
v_accvgpr_write_b32 a134, v198
v_accvgpr_write_b32 a135, v199
v_accvgpr_write_b32 a136, v200
v_accvgpr_write_b32 a137, v201
v_accvgpr_write_b32 a138, v202
v_accvgpr_write_b32 a139, v203
v_accvgpr_write_b32 a140, v204
v_accvgpr_write_b32 a141, v205
v_accvgpr_write_b32 a142, v206
v_accvgpr_write_b32 a143, v207
v_accvgpr_write_b32 a144, v208
v_accvgpr_write_b32 a145, v209
v_accvgpr_write_b32 a146, v210
v_accvgpr_write_b32 a147, v211
v_accvgpr_write_b32 a148, v212
v_accvgpr_write_b32 a149, v213
v_accvgpr_write_b32 a150, v214
v_accvgpr_write_b32 a151, v215
v_accvgpr_write_b32 a152, v216
v_accvgpr_write_b32 a153, v217
v_accvgpr_write_b32 a154, v218
v_accvgpr_write_b32 a155, v219
v_accvgpr_write_b32 a156, v220
v_accvgpr_write_b32 a157, v221
v_accvgpr_write_b32 a158, v222
v_accvgpr_write_b32 a159, v223
v_accvgpr_write_b32 a160, v224
v_accvgpr_write_b32 a161, v225
v_accvgpr_write_b32 a162, v226
v_accvgpr_write_b32 a163, v227
v_accvgpr_write_b32 a164, v228
v_accvgpr_write_b32 a165, v229
v_accvgpr_write_b32 a166, v230
v_accvgpr_write_b32 a167, v231
v_accvgpr_write_b32 a168, v232
v_accvgpr_write_b32 a169, v233
v_accvgpr_write_b32 a170, v234
v_accvgpr_write_b32 a171, v235
v_accvgpr_write_b32 a172, v236
v_accvgpr_write_b32 a173, v237
v_accvgpr_write_b32 a174, v238
v_accvgpr_write_b32 a175, v239
v_accvgpr_write_b32 a176, v240
v_accvgpr_write_b32 a177, v241
v_accvgpr_write_b32 a178, v242
v_accvgpr_write_b32 a179, v243
v_accvgpr_write_b32 a180, v244
v_accvgpr_write_b32 a181, v245
v_accvgpr_write_b32 a182, v246
v_accvgpr_write_b32 a183, v247
v_accvgpr_write_b32 a184, v248
v_accvgpr_write_b32 a185, v249
v_accvgpr_write_b32 a186, v250
v_accvgpr_write_b32 a187, v251
v_accvgpr_write_b32 a188, v252
v_accvgpr_write_b32 a189, v253
v_accvgpr_write_b32 a190, v254
v_accvgpr_write_b32 a191, v255
Lsfq_117:
s_mov_b32 s64, s21
v_mov_b32 v20, 0
v_mov_b32 v21, 0
v_mov_b32 v22, 0
v_mov_b32 v23, 0
s_nop 1
v_mfma_f32_32x32x16_bf16 a[0:15], v[20:23], v[20:23], 0
v_mfma_f32_32x32x16_bf16 a[16:31], v[20:23], v[20:23], 0
v_mfma_f32_32x32x16_bf16 a[32:47], v[20:23], v[20:23], 0
v_mfma_f32_32x32x16_bf16 a[48:63], v[20:23], v[20:23], 0
v_mfma_f32_32x32x16_bf16 a[64:79], v[20:23], v[20:23], 0
v_mfma_f32_32x32x16_bf16 a[80:95], v[20:23], v[20:23], 0
v_mfma_f32_32x32x16_bf16 a[96:111], v[20:23], v[20:23], 0
v_mfma_f32_32x32x16_bf16 a[112:127], v[20:23], v[20:23], 0
v_mov_b32 v4, 0
v_mov_b32 v5, 0
v_mov_b32 v6, 0
v_mov_b32 v7, 0
v_mov_b32 v28, 0xff7fffff
v_mov_b32 v29, 0xff7fffff
s_mov_b32 s65, 0
LA_sf_loop_b:
s_barrier
s_lshl_b32 s60, s65, 15
s_add_u32 s81, s60, s62
s_add_u32 m0, s62, 0
s_add_u32 s66, s81, 0
buffer_load_dwordx4 v26, s[44:47], s66 offen offset:0 sc1 lds
buffer_load_dwordx4 v26, s[44:47], s66 offen offset:1024 sc1 lds
buffer_load_dwordx4 v26, s[44:47], s66 offen offset:2048 sc1 lds
buffer_load_dwordx4 v26, s[44:47], s66 offen offset:3072 sc1 lds
s_add_u32 m0, s62, 4096
s_add_u32 s66, s81, 4096
buffer_load_dwordx4 v26, s[44:47], s66 offen offset:0 sc1 lds
buffer_load_dwordx4 v26, s[44:47], s66 offen offset:1024 sc1 lds
buffer_load_dwordx4 v26, s[44:47], s66 offen offset:2048 sc1 lds
buffer_load_dwordx4 v26, s[44:47], s66 offen offset:3072 sc1 lds
s_add_u32 m0, s62, 65536
s_add_u32 s66, s81, 0
buffer_load_dwordx4 v26, s[48:51], s66 offen offset:0 sc1 lds
buffer_load_dwordx4 v26, s[48:51], s66 offen offset:1024 sc1 lds
buffer_load_dwordx4 v26, s[48:51], s66 offen offset:2048 sc1 lds
buffer_load_dwordx4 v26, s[48:51], s66 offen offset:3072 sc1 lds
s_add_u32 m0, s62, 69632
s_add_u32 s66, s81, 4096
buffer_load_dwordx4 v26, s[48:51], s66 offen offset:0 sc1 lds
buffer_load_dwordx4 v26, s[48:51], s66 offen offset:1024 sc1 lds
buffer_load_dwordx4 v26, s[48:51], s66 offen offset:2048 sc1 lds
buffer_load_dwordx4 v26, s[48:51], s66 offen offset:3072 sc1 lds
s_waitcnt vmcnt(0)
s_barrier
ds_read_b128 a[192:195], v2 offset:0
ds_read_b128 a[196:199], v2 offset:1024
ds_read_b128 a[200:203], v2 offset:2048
ds_read_b128 a[204:207], v2 offset:3072
ds_read_b128 a[208:211], v2 offset:4096
ds_read_b128 a[212:215], v2 offset:5120
s_waitcnt lgkmcnt(4)
v_mfma_f32_32x32x16_bf16 v[64:79], a[192:195], a[128:131], 0
ds_read_b128 a[216:219], v2 offset:6144
v_mfma_f32_32x32x16_bf16 v[80:95], a[192:195], a[160:163], 0
v_mfma_f32_32x32x16_bf16 v[64:79], a[196:199], a[132:135], v[64:79]
ds_read_b128 a[220:223], v2 offset:7168
v_mfma_f32_32x32x16_bf16 v[80:95], a[196:199], a[164:167], v[80:95]
s_waitcnt lgkmcnt(4)
v_mfma_f32_32x32x16_bf16 v[64:79], a[200:203], a[136:139], v[64:79]
ds_read_b128 a[224:227], v2 offset:8192
v_mfma_f32_32x32x16_bf16 v[80:95], a[200:203], a[168:171], v[80:95]
v_mfma_f32_32x32x16_bf16 v[64:79], a[204:207], a[140:143], v[64:79]
ds_read_b128 a[228:231], v2 offset:9216
v_mfma_f32_32x32x16_bf16 v[80:95], a[204:207], a[172:175], v[80:95]
s_waitcnt lgkmcnt(4)
v_mfma_f32_32x32x16_bf16 v[64:79], a[208:211], a[144:147], v[64:79]
ds_read_b128 a[232:235], v2 offset:10240
v_mfma_f32_32x32x16_bf16 v[80:95], a[208:211], a[176:179], v[80:95]
v_mfma_f32_32x32x16_bf16 v[64:79], a[212:215], a[148:151], v[64:79]
ds_read_b128 a[236:239], v2 offset:11264
v_mfma_f32_32x32x16_bf16 v[80:95], a[212:215], a[180:183], v[80:95]
s_waitcnt lgkmcnt(4)
v_mfma_f32_32x32x16_bf16 v[64:79], a[216:219], a[152:155], v[64:79]
ds_read_b128 a[240:243], v2 offset:12288
v_mfma_f32_32x32x16_bf16 v[80:95], a[216:219], a[184:187], v[80:95]
v_mfma_f32_32x32x16_bf16 v[64:79], a[220:223], a[156:159], v[64:79]
ds_read_b128 a[244:247], v2 offset:13312
v_mfma_f32_32x32x16_bf16 v[80:95], a[220:223], a[188:191], v[80:95]
s_waitcnt lgkmcnt(4)
v_mfma_f32_32x32x16_bf16 v[96:111], a[224:227], a[128:131], 0
ds_read_b128 a[248:251], v2 offset:14336
v_mfma_f32_32x32x16_bf16 v[112:127], a[224:227], a[160:163], 0
v_mfma_f32_32x32x16_bf16 v[96:111], a[228:231], a[132:135], v[96:111]
ds_read_b128 a[252:255], v2 offset:15360
v_mfma_f32_32x32x16_bf16 v[112:127], a[228:231], a[164:167], v[112:127]
s_waitcnt lgkmcnt(4)
v_mfma_f32_32x32x16_bf16 v[96:111], a[232:235], a[136:139], v[96:111]
v_mfma_f32_32x32x16_bf16 v[112:127], a[232:235], a[168:171], v[112:127]
v_mfma_f32_32x32x16_bf16 v[96:111], a[236:239], a[140:143], v[96:111]
v_mfma_f32_32x32x16_bf16 v[112:127], a[236:239], a[172:175], v[112:127]
s_waitcnt lgkmcnt(2)
v_mfma_f32_32x32x16_bf16 v[96:111], a[240:243], a[144:147], v[96:111]
v_mfma_f32_32x32x16_bf16 v[112:127], a[240:243], a[176:179], v[112:127]
v_mfma_f32_32x32x16_bf16 v[96:111], a[244:247], a[148:151], v[96:111]
v_mfma_f32_32x32x16_bf16 v[112:127], a[244:247], a[180:183], v[112:127]
s_waitcnt lgkmcnt(0)
v_mfma_f32_32x32x16_bf16 v[96:111], a[248:251], a[152:155], v[96:111]
v_mfma_f32_32x32x16_bf16 v[112:127], a[248:251], a[184:187], v[112:127]
v_mfma_f32_32x32x16_bf16 v[96:111], a[252:255], a[156:159], v[96:111]
v_mfma_f32_32x32x16_bf16 v[112:127], a[252:255], a[188:191], v[112:127]
s_nop 15
s_cmp_lg_u32 s65, s64
s_cbranch_scc1 Lsfm_118
s_cmp_eq_u32 s22, 1
s_cbranch_scc1 Lme_121
s_cmp_eq_u32 s22, 2
s_cbranch_scc1 Lm2_120
v_cndmask_b32 v64, v10, v64, s[24:25]
v_cndmask_b32 v65, v10, v65, s[26:27]
v_cndmask_b32 v66, v10, v66, s[28:29]
v_cndmask_b32 v67, v10, v67, s[30:31]
v_cndmask_b32 v68, v10, v68, s[32:33]
v_cndmask_b32 v69, v10, v69, s[34:35]
v_cndmask_b32 v70, v10, v70, s[36:37]
v_cndmask_b32 v71, v10, v71, s[38:39]
v_cndmask_b32 v72, v10, v72, s[40:41]
v_cndmask_b32 v73, v10, v73, s[42:43]
v_cndmask_b32 v74, v10, v74, s[56:57]
v_cndmask_b32 v75, v10, v75, s[58:59]
v_cndmask_b32 v76, v10, v76, s[4:5]
v_cndmask_b32 v77, v10, v77, s[6:7]
v_cndmask_b32 v78, v10, v78, s[8:9]
v_cndmask_b32 v79, v10, v79, s[10:11]
v_cndmask_b32 v112, v10, v112, s[24:25]
v_cndmask_b32 v113, v10, v113, s[26:27]
v_cndmask_b32 v114, v10, v114, s[28:29]
v_cndmask_b32 v115, v10, v115, s[30:31]
v_cndmask_b32 v116, v10, v116, s[32:33]
v_cndmask_b32 v117, v10, v117, s[34:35]
v_cndmask_b32 v118, v10, v118, s[36:37]
v_cndmask_b32 v119, v10, v119, s[38:39]
v_cndmask_b32 v120, v10, v120, s[40:41]
v_cndmask_b32 v121, v10, v121, s[42:43]
v_cndmask_b32 v122, v10, v122, s[56:57]
v_cndmask_b32 v123, v10, v123, s[58:59]
v_cndmask_b32 v124, v10, v124, s[4:5]
v_cndmask_b32 v125, v10, v125, s[6:7]
v_cndmask_b32 v126, v10, v126, s[8:9]
v_cndmask_b32 v127, v10, v127, s[10:11]
v_mov_b32 v96, v10
v_mov_b32 v97, v10
v_mov_b32 v98, v10
v_mov_b32 v99, v10
v_mov_b32 v100, v10
v_mov_b32 v101, v10
v_mov_b32 v102, v10
v_mov_b32 v103, v10
v_mov_b32 v104, v10
v_mov_b32 v105, v10
v_mov_b32 v106, v10
v_mov_b32 v107, v10
v_mov_b32 v108, v10
v_mov_b32 v109, v10
v_mov_b32 v110, v10
v_mov_b32 v111, v10
s_branch Lme_121
Lm2_120:
v_mov_b32 v64, v10
v_mov_b32 v65, v10
v_mov_b32 v66, v10
v_mov_b32 v67, v10
v_mov_b32 v68, v10
v_mov_b32 v69, v10
v_mov_b32 v70, v10
v_mov_b32 v71, v10
v_mov_b32 v72, v10
v_mov_b32 v73, v10
v_mov_b32 v74, v10
v_mov_b32 v75, v10
v_mov_b32 v76, v10
v_mov_b32 v77, v10
v_mov_b32 v78, v10
v_mov_b32 v79, v10
v_mov_b32 v80, v10
v_mov_b32 v81, v10
v_mov_b32 v82, v10
v_mov_b32 v83, v10
v_mov_b32 v84, v10
v_mov_b32 v85, v10
v_mov_b32 v86, v10
v_mov_b32 v87, v10
v_mov_b32 v88, v10
v_mov_b32 v89, v10
v_mov_b32 v90, v10
v_mov_b32 v91, v10
v_mov_b32 v92, v10
v_mov_b32 v93, v10
v_mov_b32 v94, v10
v_mov_b32 v95, v10
v_mov_b32 v96, v10
v_mov_b32 v97, v10
v_mov_b32 v98, v10
v_mov_b32 v99, v10
v_mov_b32 v100, v10
v_mov_b32 v101, v10
v_mov_b32 v102, v10
v_mov_b32 v103, v10
v_mov_b32 v104, v10
v_mov_b32 v105, v10
v_mov_b32 v106, v10
v_mov_b32 v107, v10
v_mov_b32 v108, v10
v_mov_b32 v109, v10
v_mov_b32 v110, v10
v_mov_b32 v111, v10
v_mov_b32 v112, v10
v_mov_b32 v113, v10
v_mov_b32 v114, v10
v_mov_b32 v115, v10
v_mov_b32 v116, v10
v_mov_b32 v117, v10
v_mov_b32 v118, v10
v_mov_b32 v119, v10
v_mov_b32 v120, v10
v_mov_b32 v121, v10
v_mov_b32 v122, v10
v_mov_b32 v123, v10
v_mov_b32 v124, v10
v_mov_b32 v125, v10
v_mov_b32 v126, v10
v_mov_b32 v127, v10
Lme_121:
Lsfm_118:
v_max_f32 v12, v64, v65
v_max3_f32 v12, v12, v66, v67
v_max3_f32 v12, v12, v68, v69
v_max3_f32 v12, v12, v70, v71
v_max3_f32 v12, v12, v72, v73
v_max3_f32 v12, v12, v74, v75
v_max3_f32 v12, v12, v76, v77
v_max3_f32 v12, v12, v78, v79
v_max3_f32 v12, v12, v96, v97
v_max3_f32 v12, v12, v98, v99
v_max3_f32 v12, v12, v100, v101
v_max3_f32 v12, v12, v102, v103
v_max3_f32 v12, v12, v104, v105
v_max3_f32 v12, v12, v106, v107
v_max3_f32 v12, v12, v108, v109
v_max3_f32 v12, v12, v110, v111
v_mov_b32 v13, v12
s_nop 1
v_permlane32_swap_b32 v12, v13
s_nop 1
v_max_f32 v12, v12, v13
v_max_f32 v12, v12, v28
v_sub_f32 v13, v28, v12
v_exp_f32 v13, v13
v_mov_b32 v28, v12
v_mul_f32 v4, v4, v13
v_mul_f32 v5, v5, v13
v_accvgpr_read_b32 v14, a0
v_mul_f32 v14, v14, v13
v_accvgpr_write_b32 a0, v14
v_accvgpr_read_b32 v14, a1
v_mul_f32 v14, v14, v13
v_accvgpr_write_b32 a1, v14
v_accvgpr_read_b32 v14, a2
v_mul_f32 v14, v14, v13
v_accvgpr_write_b32 a2, v14
v_accvgpr_read_b32 v14, a3
v_mul_f32 v14, v14, v13
v_accvgpr_write_b32 a3, v14
v_accvgpr_read_b32 v14, a4
v_mul_f32 v14, v14, v13
v_accvgpr_write_b32 a4, v14
v_accvgpr_read_b32 v14, a5
v_mul_f32 v14, v14, v13
v_accvgpr_write_b32 a5, v14
v_accvgpr_read_b32 v14, a6
v_mul_f32 v14, v14, v13
v_accvgpr_write_b32 a6, v14
v_accvgpr_read_b32 v14, a7
v_mul_f32 v14, v14, v13
v_accvgpr_write_b32 a7, v14
v_accvgpr_read_b32 v14, a8
v_mul_f32 v14, v14, v13
v_accvgpr_write_b32 a8, v14
v_accvgpr_read_b32 v14, a9
v_mul_f32 v14, v14, v13
v_accvgpr_write_b32 a9, v14
v_accvgpr_read_b32 v14, a10
v_mul_f32 v14, v14, v13
v_accvgpr_write_b32 a10, v14
v_accvgpr_read_b32 v14, a11
v_mul_f32 v14, v14, v13
v_accvgpr_write_b32 a11, v14
v_accvgpr_read_b32 v14, a12
v_mul_f32 v14, v14, v13
v_accvgpr_write_b32 a12, v14
v_accvgpr_read_b32 v14, a13
v_mul_f32 v14, v14, v13
v_accvgpr_write_b32 a13, v14
v_accvgpr_read_b32 v14, a14
v_mul_f32 v14, v14, v13
v_accvgpr_write_b32 a14, v14
v_accvgpr_read_b32 v14, a15
v_mul_f32 v14, v14, v13
v_accvgpr_write_b32 a15, v14
v_accvgpr_read_b32 v14, a16
v_mul_f32 v14, v14, v13
v_accvgpr_write_b32 a16, v14
v_accvgpr_read_b32 v14, a17
v_mul_f32 v14, v14, v13
v_accvgpr_write_b32 a17, v14
v_accvgpr_read_b32 v14, a18
v_mul_f32 v14, v14, v13
v_accvgpr_write_b32 a18, v14
v_accvgpr_read_b32 v14, a19
v_mul_f32 v14, v14, v13
v_accvgpr_write_b32 a19, v14
v_accvgpr_read_b32 v14, a20
v_mul_f32 v14, v14, v13
v_accvgpr_write_b32 a20, v14
v_accvgpr_read_b32 v14, a21
v_mul_f32 v14, v14, v13
v_accvgpr_write_b32 a21, v14
v_accvgpr_read_b32 v14, a22
v_mul_f32 v14, v14, v13
v_accvgpr_write_b32 a22, v14
v_accvgpr_read_b32 v14, a23
v_mul_f32 v14, v14, v13
v_accvgpr_write_b32 a23, v14
v_accvgpr_read_b32 v14, a24
v_mul_f32 v14, v14, v13
v_accvgpr_write_b32 a24, v14
v_accvgpr_read_b32 v14, a25
v_mul_f32 v14, v14, v13
v_accvgpr_write_b32 a25, v14
v_accvgpr_read_b32 v14, a26
v_mul_f32 v14, v14, v13
v_accvgpr_write_b32 a26, v14
v_accvgpr_read_b32 v14, a27
v_mul_f32 v14, v14, v13
v_accvgpr_write_b32 a27, v14
v_accvgpr_read_b32 v14, a28
v_mul_f32 v14, v14, v13
v_accvgpr_write_b32 a28, v14
v_accvgpr_read_b32 v14, a29
v_mul_f32 v14, v14, v13
v_accvgpr_write_b32 a29, v14
v_accvgpr_read_b32 v14, a30
v_mul_f32 v14, v14, v13
v_accvgpr_write_b32 a30, v14
v_accvgpr_read_b32 v14, a31
v_mul_f32 v14, v14, v13
v_accvgpr_write_b32 a31, v14
v_accvgpr_read_b32 v14, a32
v_mul_f32 v14, v14, v13
v_accvgpr_write_b32 a32, v14
v_accvgpr_read_b32 v14, a33
v_mul_f32 v14, v14, v13
v_accvgpr_write_b32 a33, v14
v_accvgpr_read_b32 v14, a34
v_mul_f32 v14, v14, v13
v_accvgpr_write_b32 a34, v14
v_accvgpr_read_b32 v14, a35
v_mul_f32 v14, v14, v13
v_accvgpr_write_b32 a35, v14
v_accvgpr_read_b32 v14, a36
v_mul_f32 v14, v14, v13
v_accvgpr_write_b32 a36, v14
v_accvgpr_read_b32 v14, a37
v_mul_f32 v14, v14, v13
v_accvgpr_write_b32 a37, v14
v_accvgpr_read_b32 v14, a38
v_mul_f32 v14, v14, v13
v_accvgpr_write_b32 a38, v14
v_accvgpr_read_b32 v14, a39
v_mul_f32 v14, v14, v13
v_accvgpr_write_b32 a39, v14
v_accvgpr_read_b32 v14, a40
v_mul_f32 v14, v14, v13
v_accvgpr_write_b32 a40, v14
v_accvgpr_read_b32 v14, a41
v_mul_f32 v14, v14, v13
v_accvgpr_write_b32 a41, v14
v_accvgpr_read_b32 v14, a42
v_mul_f32 v14, v14, v13
v_accvgpr_write_b32 a42, v14
v_accvgpr_read_b32 v14, a43
v_mul_f32 v14, v14, v13
v_accvgpr_write_b32 a43, v14
v_accvgpr_read_b32 v14, a44
v_mul_f32 v14, v14, v13
v_accvgpr_write_b32 a44, v14
v_accvgpr_read_b32 v14, a45
v_mul_f32 v14, v14, v13
v_accvgpr_write_b32 a45, v14
v_accvgpr_read_b32 v14, a46
v_mul_f32 v14, v14, v13
v_accvgpr_write_b32 a46, v14
v_accvgpr_read_b32 v14, a47
v_mul_f32 v14, v14, v13
v_accvgpr_write_b32 a47, v14
v_accvgpr_read_b32 v14, a48
v_mul_f32 v14, v14, v13
v_accvgpr_write_b32 a48, v14
v_accvgpr_read_b32 v14, a49
v_mul_f32 v14, v14, v13
v_accvgpr_write_b32 a49, v14
v_accvgpr_read_b32 v14, a50
v_mul_f32 v14, v14, v13
v_accvgpr_write_b32 a50, v14
v_accvgpr_read_b32 v14, a51
v_mul_f32 v14, v14, v13
v_accvgpr_write_b32 a51, v14
v_accvgpr_read_b32 v14, a52
v_mul_f32 v14, v14, v13
v_accvgpr_write_b32 a52, v14
v_accvgpr_read_b32 v14, a53
v_mul_f32 v14, v14, v13
v_accvgpr_write_b32 a53, v14
v_accvgpr_read_b32 v14, a54
v_mul_f32 v14, v14, v13
v_accvgpr_write_b32 a54, v14
v_accvgpr_read_b32 v14, a55
v_mul_f32 v14, v14, v13
v_accvgpr_write_b32 a55, v14
v_accvgpr_read_b32 v14, a56
v_mul_f32 v14, v14, v13
v_accvgpr_write_b32 a56, v14
v_accvgpr_read_b32 v14, a57
v_mul_f32 v14, v14, v13
v_accvgpr_write_b32 a57, v14
v_accvgpr_read_b32 v14, a58
v_mul_f32 v14, v14, v13
v_accvgpr_write_b32 a58, v14
v_accvgpr_read_b32 v14, a59
v_mul_f32 v14, v14, v13
v_accvgpr_write_b32 a59, v14
v_accvgpr_read_b32 v14, a60
v_mul_f32 v14, v14, v13
v_accvgpr_write_b32 a60, v14
v_accvgpr_read_b32 v14, a61
v_mul_f32 v14, v14, v13
v_accvgpr_write_b32 a61, v14
v_accvgpr_read_b32 v14, a62
v_mul_f32 v14, v14, v13
v_accvgpr_write_b32 a62, v14
v_accvgpr_read_b32 v14, a63
v_mul_f32 v14, v14, v13
v_accvgpr_write_b32 a63, v14
v_sub_f32 v64, v64, v12
v_sub_f32 v65, v65, v12
v_sub_f32 v66, v66, v12
v_sub_f32 v67, v67, v12
v_sub_f32 v68, v68, v12
v_sub_f32 v69, v69, v12
v_sub_f32 v70, v70, v12
v_sub_f32 v71, v71, v12
v_sub_f32 v72, v72, v12
v_sub_f32 v73, v73, v12
v_sub_f32 v74, v74, v12
v_sub_f32 v75, v75, v12
v_sub_f32 v76, v76, v12
v_sub_f32 v77, v77, v12
v_sub_f32 v78, v78, v12
v_sub_f32 v79, v79, v12
v_sub_f32 v96, v96, v12
v_sub_f32 v97, v97, v12
v_sub_f32 v98, v98, v12
v_sub_f32 v99, v99, v12
v_sub_f32 v100, v100, v12
v_sub_f32 v101, v101, v12
v_sub_f32 v102, v102, v12
v_sub_f32 v103, v103, v12
v_sub_f32 v104, v104, v12
v_sub_f32 v105, v105, v12
v_sub_f32 v106, v106, v12
v_sub_f32 v107, v107, v12
v_sub_f32 v108, v108, v12
v_sub_f32 v109, v109, v12
v_sub_f32 v110, v110, v12
v_sub_f32 v111, v111, v12
v_max_f32 v12, v80, v81
v_max3_f32 v12, v12, v82, v83
v_max3_f32 v12, v12, v84, v85
v_max3_f32 v12, v12, v86, v87
v_max3_f32 v12, v12, v88, v89
v_max3_f32 v12, v12, v90, v91
v_max3_f32 v12, v12, v92, v93
v_max3_f32 v12, v12, v94, v95
v_max3_f32 v12, v12, v112, v113
v_max3_f32 v12, v12, v114, v115
v_max3_f32 v12, v12, v116, v117
v_max3_f32 v12, v12, v118, v119
v_max3_f32 v12, v12, v120, v121
v_max3_f32 v12, v12, v122, v123
v_max3_f32 v12, v12, v124, v125
v_max3_f32 v12, v12, v126, v127
v_mov_b32 v13, v12
s_nop 1
v_permlane32_swap_b32 v12, v13
s_nop 1
v_max_f32 v12, v12, v13
v_max_f32 v12, v12, v29
v_sub_f32 v13, v29, v12
v_exp_f32 v13, v13
v_mov_b32 v29, v12
v_mul_f32 v6, v6, v13
v_mul_f32 v7, v7, v13
v_accvgpr_read_b32 v14, a64
v_mul_f32 v14, v14, v13
v_accvgpr_write_b32 a64, v14
v_accvgpr_read_b32 v14, a65
v_mul_f32 v14, v14, v13
v_accvgpr_write_b32 a65, v14
v_accvgpr_read_b32 v14, a66
v_mul_f32 v14, v14, v13
v_accvgpr_write_b32 a66, v14
v_accvgpr_read_b32 v14, a67
v_mul_f32 v14, v14, v13
v_accvgpr_write_b32 a67, v14
v_accvgpr_read_b32 v14, a68
v_mul_f32 v14, v14, v13
v_accvgpr_write_b32 a68, v14
v_accvgpr_read_b32 v14, a69
v_mul_f32 v14, v14, v13
v_accvgpr_write_b32 a69, v14
v_accvgpr_read_b32 v14, a70
v_mul_f32 v14, v14, v13
v_accvgpr_write_b32 a70, v14
v_accvgpr_read_b32 v14, a71
v_mul_f32 v14, v14, v13
v_accvgpr_write_b32 a71, v14
v_accvgpr_read_b32 v14, a72
v_mul_f32 v14, v14, v13
v_accvgpr_write_b32 a72, v14
v_accvgpr_read_b32 v14, a73
v_mul_f32 v14, v14, v13
v_accvgpr_write_b32 a73, v14
v_accvgpr_read_b32 v14, a74
v_mul_f32 v14, v14, v13
v_accvgpr_write_b32 a74, v14
v_accvgpr_read_b32 v14, a75
v_mul_f32 v14, v14, v13
v_accvgpr_write_b32 a75, v14
v_accvgpr_read_b32 v14, a76
v_mul_f32 v14, v14, v13
v_accvgpr_write_b32 a76, v14
v_accvgpr_read_b32 v14, a77
v_mul_f32 v14, v14, v13
v_accvgpr_write_b32 a77, v14
v_accvgpr_read_b32 v14, a78
v_mul_f32 v14, v14, v13
v_accvgpr_write_b32 a78, v14
v_accvgpr_read_b32 v14, a79
v_mul_f32 v14, v14, v13
v_accvgpr_write_b32 a79, v14
v_accvgpr_read_b32 v14, a80
v_mul_f32 v14, v14, v13
v_accvgpr_write_b32 a80, v14
v_accvgpr_read_b32 v14, a81
v_mul_f32 v14, v14, v13
v_accvgpr_write_b32 a81, v14
v_accvgpr_read_b32 v14, a82
v_mul_f32 v14, v14, v13
v_accvgpr_write_b32 a82, v14
v_accvgpr_read_b32 v14, a83
v_mul_f32 v14, v14, v13
v_accvgpr_write_b32 a83, v14
v_accvgpr_read_b32 v14, a84
v_mul_f32 v14, v14, v13
v_accvgpr_write_b32 a84, v14
v_accvgpr_read_b32 v14, a85
v_mul_f32 v14, v14, v13
v_accvgpr_write_b32 a85, v14
v_accvgpr_read_b32 v14, a86
v_mul_f32 v14, v14, v13
v_accvgpr_write_b32 a86, v14
v_accvgpr_read_b32 v14, a87
v_mul_f32 v14, v14, v13
v_accvgpr_write_b32 a87, v14
v_accvgpr_read_b32 v14, a88
v_mul_f32 v14, v14, v13
v_accvgpr_write_b32 a88, v14
v_accvgpr_read_b32 v14, a89
v_mul_f32 v14, v14, v13
v_accvgpr_write_b32 a89, v14
v_accvgpr_read_b32 v14, a90
v_mul_f32 v14, v14, v13
v_accvgpr_write_b32 a90, v14
v_accvgpr_read_b32 v14, a91
v_mul_f32 v14, v14, v13
v_accvgpr_write_b32 a91, v14
v_accvgpr_read_b32 v14, a92
v_mul_f32 v14, v14, v13
v_accvgpr_write_b32 a92, v14
v_accvgpr_read_b32 v14, a93
v_mul_f32 v14, v14, v13
v_accvgpr_write_b32 a93, v14
v_accvgpr_read_b32 v14, a94
v_mul_f32 v14, v14, v13
v_accvgpr_write_b32 a94, v14
v_accvgpr_read_b32 v14, a95
v_mul_f32 v14, v14, v13
v_accvgpr_write_b32 a95, v14
v_accvgpr_read_b32 v14, a96
v_mul_f32 v14, v14, v13
v_accvgpr_write_b32 a96, v14
v_accvgpr_read_b32 v14, a97
v_mul_f32 v14, v14, v13
v_accvgpr_write_b32 a97, v14
v_accvgpr_read_b32 v14, a98
v_mul_f32 v14, v14, v13
v_accvgpr_write_b32 a98, v14
v_accvgpr_read_b32 v14, a99
v_mul_f32 v14, v14, v13
v_accvgpr_write_b32 a99, v14
v_accvgpr_read_b32 v14, a100
v_mul_f32 v14, v14, v13
v_accvgpr_write_b32 a100, v14
v_accvgpr_read_b32 v14, a101
v_mul_f32 v14, v14, v13
v_accvgpr_write_b32 a101, v14
v_accvgpr_read_b32 v14, a102
v_mul_f32 v14, v14, v13
v_accvgpr_write_b32 a102, v14
v_accvgpr_read_b32 v14, a103
v_mul_f32 v14, v14, v13
v_accvgpr_write_b32 a103, v14
v_accvgpr_read_b32 v14, a104
v_mul_f32 v14, v14, v13
v_accvgpr_write_b32 a104, v14
v_accvgpr_read_b32 v14, a105
v_mul_f32 v14, v14, v13
v_accvgpr_write_b32 a105, v14
v_accvgpr_read_b32 v14, a106
v_mul_f32 v14, v14, v13
v_accvgpr_write_b32 a106, v14
v_accvgpr_read_b32 v14, a107
v_mul_f32 v14, v14, v13
v_accvgpr_write_b32 a107, v14
v_accvgpr_read_b32 v14, a108
v_mul_f32 v14, v14, v13
v_accvgpr_write_b32 a108, v14
v_accvgpr_read_b32 v14, a109
v_mul_f32 v14, v14, v13
v_accvgpr_write_b32 a109, v14
v_accvgpr_read_b32 v14, a110
v_mul_f32 v14, v14, v13
v_accvgpr_write_b32 a110, v14
v_accvgpr_read_b32 v14, a111
v_mul_f32 v14, v14, v13
v_accvgpr_write_b32 a111, v14
v_accvgpr_read_b32 v14, a112
v_mul_f32 v14, v14, v13
v_accvgpr_write_b32 a112, v14
v_accvgpr_read_b32 v14, a113
v_mul_f32 v14, v14, v13
v_accvgpr_write_b32 a113, v14
v_accvgpr_read_b32 v14, a114
v_mul_f32 v14, v14, v13
v_accvgpr_write_b32 a114, v14
v_accvgpr_read_b32 v14, a115
v_mul_f32 v14, v14, v13
v_accvgpr_write_b32 a115, v14
v_accvgpr_read_b32 v14, a116
v_mul_f32 v14, v14, v13
v_accvgpr_write_b32 a116, v14
v_accvgpr_read_b32 v14, a117
v_mul_f32 v14, v14, v13
v_accvgpr_write_b32 a117, v14
v_accvgpr_read_b32 v14, a118
v_mul_f32 v14, v14, v13
v_accvgpr_write_b32 a118, v14
v_accvgpr_read_b32 v14, a119
v_mul_f32 v14, v14, v13
v_accvgpr_write_b32 a119, v14
v_accvgpr_read_b32 v14, a120
v_mul_f32 v14, v14, v13
v_accvgpr_write_b32 a120, v14
v_accvgpr_read_b32 v14, a121
v_mul_f32 v14, v14, v13
v_accvgpr_write_b32 a121, v14
v_accvgpr_read_b32 v14, a122
v_mul_f32 v14, v14, v13
v_accvgpr_write_b32 a122, v14
v_accvgpr_read_b32 v14, a123
v_mul_f32 v14, v14, v13
v_accvgpr_write_b32 a123, v14
v_accvgpr_read_b32 v14, a124
v_mul_f32 v14, v14, v13
v_accvgpr_write_b32 a124, v14
v_accvgpr_read_b32 v14, a125
v_mul_f32 v14, v14, v13
v_accvgpr_write_b32 a125, v14
v_accvgpr_read_b32 v14, a126
v_mul_f32 v14, v14, v13
v_accvgpr_write_b32 a126, v14
v_accvgpr_read_b32 v14, a127
v_mul_f32 v14, v14, v13
v_accvgpr_write_b32 a127, v14
v_sub_f32 v80, v80, v12
v_sub_f32 v81, v81, v12
v_sub_f32 v82, v82, v12
v_sub_f32 v83, v83, v12
v_sub_f32 v84, v84, v12
v_sub_f32 v85, v85, v12
v_sub_f32 v86, v86, v12
v_sub_f32 v87, v87, v12
v_sub_f32 v88, v88, v12
v_sub_f32 v89, v89, v12
v_sub_f32 v90, v90, v12
v_sub_f32 v91, v91, v12
v_sub_f32 v92, v92, v12
v_sub_f32 v93, v93, v12
v_sub_f32 v94, v94, v12
v_sub_f32 v95, v95, v12
v_sub_f32 v112, v112, v12
v_sub_f32 v113, v113, v12
v_sub_f32 v114, v114, v12
v_sub_f32 v115, v115, v12
v_sub_f32 v116, v116, v12
v_sub_f32 v117, v117, v12
v_sub_f32 v118, v118, v12
v_sub_f32 v119, v119, v12
v_sub_f32 v120, v120, v12
v_sub_f32 v121, v121, v12
v_sub_f32 v122, v122, v12
v_sub_f32 v123, v123, v12
v_sub_f32 v124, v124, v12
v_sub_f32 v125, v125, v12
v_sub_f32 v126, v126, v12
v_sub_f32 v127, v127, v12
v_exp_f32 v64, v64
v_exp_f32 v65, v65
v_exp_f32 v66, v66
v_exp_f32 v67, v67
v_add_f32 v4, v4, v64
v_add_f32 v5, v5, v65
v_cvt_pk_bf16_f32 v32, v64, v65
v_exp_f32 v68, v68
v_exp_f32 v69, v69
v_add_f32 v4, v4, v66
v_add_f32 v5, v5, v67
v_cvt_pk_bf16_f32 v33, v66, v67
v_exp_f32 v70, v70
v_exp_f32 v71, v71
v_add_f32 v4, v4, v68
v_add_f32 v5, v5, v69
v_cvt_pk_bf16_f32 v34, v68, v69
v_exp_f32 v80, v80
v_exp_f32 v81, v81
v_add_f32 v4, v4, v70
v_add_f32 v5, v5, v71
v_cvt_pk_bf16_f32 v35, v70, v71
v_exp_f32 v82, v82
v_exp_f32 v83, v83
v_add_f32 v6, v6, v80
v_add_f32 v7, v7, v81
v_cvt_pk_bf16_f32 v48, v80, v81
v_exp_f32 v84, v84
v_exp_f32 v85, v85
v_add_f32 v6, v6, v82
v_add_f32 v7, v7, v83
v_cvt_pk_bf16_f32 v49, v82, v83
v_exp_f32 v86, v86
v_exp_f32 v87, v87
v_add_f32 v6, v6, v84
v_add_f32 v7, v7, v85
v_cvt_pk_bf16_f32 v50, v84, v85
v_exp_f32 v72, v72
v_exp_f32 v73, v73
v_add_f32 v6, v6, v86
v_add_f32 v7, v7, v87
v_cvt_pk_bf16_f32 v51, v86, v87
v_exp_f32 v74, v74
v_exp_f32 v75, v75
v_add_f32 v4, v4, v72
v_add_f32 v5, v5, v73
v_cvt_pk_bf16_f32 v36, v72, v73
v_exp_f32 v76, v76
v_exp_f32 v77, v77
v_add_f32 v4, v4, v74
v_add_f32 v5, v5, v75
v_cvt_pk_bf16_f32 v37, v74, v75
v_exp_f32 v78, v78
v_exp_f32 v79, v79
v_add_f32 v4, v4, v76
v_add_f32 v5, v5, v77
v_cvt_pk_bf16_f32 v38, v76, v77
v_exp_f32 v88, v88
v_exp_f32 v89, v89
v_add_f32 v4, v4, v78
v_add_f32 v5, v5, v79
v_cvt_pk_bf16_f32 v39, v78, v79
v_exp_f32 v90, v90
v_exp_f32 v91, v91
v_add_f32 v6, v6, v88
v_add_f32 v7, v7, v89
v_cvt_pk_bf16_f32 v52, v88, v89
v_exp_f32 v92, v92
v_exp_f32 v93, v93
v_add_f32 v6, v6, v90
v_add_f32 v7, v7, v91
v_cvt_pk_bf16_f32 v53, v90, v91
v_exp_f32 v94, v94
v_exp_f32 v95, v95
v_add_f32 v6, v6, v92
v_add_f32 v7, v7, v93
v_cvt_pk_bf16_f32 v54, v92, v93
v_exp_f32 v96, v96
v_exp_f32 v97, v97
v_add_f32 v6, v6, v94
v_add_f32 v7, v7, v95
v_cvt_pk_bf16_f32 v55, v94, v95
v_exp_f32 v98, v98
v_exp_f32 v99, v99
v_add_f32 v4, v4, v96
v_add_f32 v5, v5, v97
v_cvt_pk_bf16_f32 v40, v96, v97
v_exp_f32 v100, v100
v_exp_f32 v101, v101
v_add_f32 v4, v4, v98
v_add_f32 v5, v5, v99
v_cvt_pk_bf16_f32 v41, v98, v99
v_exp_f32 v102, v102
v_exp_f32 v103, v103
v_add_f32 v4, v4, v100
v_add_f32 v5, v5, v101
v_cvt_pk_bf16_f32 v42, v100, v101
v_exp_f32 v112, v112
v_exp_f32 v113, v113
v_add_f32 v4, v4, v102
v_add_f32 v5, v5, v103
v_cvt_pk_bf16_f32 v43, v102, v103
v_exp_f32 v114, v114
v_exp_f32 v115, v115
v_add_f32 v6, v6, v112
v_add_f32 v7, v7, v113
v_cvt_pk_bf16_f32 v56, v112, v113
v_exp_f32 v116, v116
v_exp_f32 v117, v117
v_add_f32 v6, v6, v114
v_add_f32 v7, v7, v115
v_cvt_pk_bf16_f32 v57, v114, v115
v_exp_f32 v118, v118
v_exp_f32 v119, v119
v_add_f32 v6, v6, v116
v_add_f32 v7, v7, v117
v_cvt_pk_bf16_f32 v58, v116, v117
v_exp_f32 v104, v104
v_exp_f32 v105, v105
v_add_f32 v6, v6, v118
v_add_f32 v7, v7, v119
v_cvt_pk_bf16_f32 v59, v118, v119
v_exp_f32 v106, v106
v_exp_f32 v107, v107
v_add_f32 v4, v4, v104
v_add_f32 v5, v5, v105
v_cvt_pk_bf16_f32 v44, v104, v105
v_exp_f32 v108, v108
v_exp_f32 v109, v109
v_add_f32 v4, v4, v106
v_add_f32 v5, v5, v107
v_cvt_pk_bf16_f32 v45, v106, v107
v_exp_f32 v110, v110
v_exp_f32 v111, v111
v_add_f32 v4, v4, v108
v_add_f32 v5, v5, v109
v_cvt_pk_bf16_f32 v46, v108, v109
v_exp_f32 v120, v120
v_exp_f32 v121, v121
v_add_f32 v4, v4, v110
v_add_f32 v5, v5, v111
v_cvt_pk_bf16_f32 v47, v110, v111
v_exp_f32 v122, v122
v_exp_f32 v123, v123
v_add_f32 v6, v6, v120
v_add_f32 v7, v7, v121
v_cvt_pk_bf16_f32 v60, v120, v121
v_exp_f32 v124, v124
v_exp_f32 v125, v125
v_add_f32 v6, v6, v122
v_add_f32 v7, v7, v123
v_cvt_pk_bf16_f32 v61, v122, v123
v_exp_f32 v126, v126
v_exp_f32 v127, v127
v_add_f32 v6, v6, v124
v_add_f32 v7, v7, v125
v_cvt_pk_bf16_f32 v62, v124, v125
s_nop 0
v_add_f32 v6, v6, v126
v_add_f32 v7, v7, v127
v_cvt_pk_bf16_f32 v63, v126, v127
s_nop 1
ds_read_b128 a[192:195], v3 offset:0
ds_read_b128 a[196:199], v3 offset:1024
ds_read_b128 a[200:203], v3 offset:2048
ds_read_b128 a[204:207], v3 offset:3072
ds_read_b128 a[208:211], v3 offset:4096
ds_read_b128 a[212:215], v3 offset:5120
s_waitcnt lgkmcnt(4)
v_mfma_f32_32x32x16_bf16 a[0:15], a[192:195], v[32:35], a[0:15]
ds_read_b128 a[216:219], v3 offset:6144
v_mfma_f32_32x32x16_bf16 a[64:79], a[192:195], v[48:51], a[64:79]
v_mfma_f32_32x32x16_bf16 a[16:31], a[196:199], v[32:35], a[16:31]
ds_read_b128 a[220:223], v3 offset:7168
v_mfma_f32_32x32x16_bf16 a[80:95], a[196:199], v[48:51], a[80:95]
s_waitcnt lgkmcnt(4)
v_mfma_f32_32x32x16_bf16 a[32:47], a[200:203], v[32:35], a[32:47]
ds_read_b128 a[224:227], v3 offset:8192
v_mfma_f32_32x32x16_bf16 a[96:111], a[200:203], v[48:51], a[96:111]
v_mfma_f32_32x32x16_bf16 a[48:63], a[204:207], v[32:35], a[48:63]
ds_read_b128 a[228:231], v3 offset:9216
v_mfma_f32_32x32x16_bf16 a[112:127], a[204:207], v[48:51], a[112:127]
s_waitcnt lgkmcnt(4)
v_mfma_f32_32x32x16_bf16 a[0:15], a[208:211], v[36:39], a[0:15]
ds_read_b128 a[232:235], v3 offset:10240
v_mfma_f32_32x32x16_bf16 a[64:79], a[208:211], v[52:55], a[64:79]
v_mfma_f32_32x32x16_bf16 a[16:31], a[212:215], v[36:39], a[16:31]
ds_read_b128 a[236:239], v3 offset:11264
v_mfma_f32_32x32x16_bf16 a[80:95], a[212:215], v[52:55], a[80:95]
s_waitcnt lgkmcnt(4)
v_mfma_f32_32x32x16_bf16 a[32:47], a[216:219], v[36:39], a[32:47]
ds_read_b128 a[240:243], v3 offset:12288
v_mfma_f32_32x32x16_bf16 a[96:111], a[216:219], v[52:55], a[96:111]
v_mfma_f32_32x32x16_bf16 a[48:63], a[220:223], v[36:39], a[48:63]
ds_read_b128 a[244:247], v3 offset:13312
v_mfma_f32_32x32x16_bf16 a[112:127], a[220:223], v[52:55], a[112:127]
s_waitcnt lgkmcnt(4)
v_mfma_f32_32x32x16_bf16 a[0:15], a[224:227], v[40:43], a[0:15]
ds_read_b128 a[248:251], v3 offset:14336
v_mfma_f32_32x32x16_bf16 a[64:79], a[224:227], v[56:59], a[64:79]
v_mfma_f32_32x32x16_bf16 a[16:31], a[228:231], v[40:43], a[16:31]
ds_read_b128 a[252:255], v3 offset:15360
v_mfma_f32_32x32x16_bf16 a[80:95], a[228:231], v[56:59], a[80:95]
s_waitcnt lgkmcnt(4)
v_mfma_f32_32x32x16_bf16 a[32:47], a[232:235], v[40:43], a[32:47]
v_mfma_f32_32x32x16_bf16 a[96:111], a[232:235], v[56:59], a[96:111]
v_mfma_f32_32x32x16_bf16 a[48:63], a[236:239], v[40:43], a[48:63]
v_mfma_f32_32x32x16_bf16 a[112:127], a[236:239], v[56:59], a[112:127]
s_waitcnt lgkmcnt(2)
v_mfma_f32_32x32x16_bf16 a[0:15], a[240:243], v[44:47], a[0:15]
v_mfma_f32_32x32x16_bf16 a[64:79], a[240:243], v[60:63], a[64:79]
v_mfma_f32_32x32x16_bf16 a[16:31], a[244:247], v[44:47], a[16:31]
v_mfma_f32_32x32x16_bf16 a[80:95], a[244:247], v[60:63], a[80:95]
s_waitcnt lgkmcnt(0)
v_mfma_f32_32x32x16_bf16 a[32:47], a[248:251], v[44:47], a[32:47]
v_mfma_f32_32x32x16_bf16 a[96:111], a[248:251], v[60:63], a[96:111]
v_mfma_f32_32x32x16_bf16 a[48:63], a[252:255], v[44:47], a[48:63]
v_mfma_f32_32x32x16_bf16 a[112:127], a[252:255], v[60:63], a[112:127]
s_add_u32 s65, s65, 1
s_cmp_le_u32 s65, s64
s_cbranch_scc1 LA_sf_loop_b
s_nop 15
s_barrier
v_lshlrev_b32 v12, 3, v1
v_add_u32 v12, 0x20000, v12
s_lshl_b32 s60, s22, 9
v_add_u32 v13, s60, v12
s_xor_b32 s60, s60, 1024
v_add_u32 v12, s60, v12
ds_write_b64 v13, v[28:29]
s_waitcnt lgkmcnt(0)
s_barrier
ds_read_b64 v[14:15], v12
s_waitcnt lgkmcnt(0)
s_barrier
v_max_f32 v12, v28, v14
v_sub_f32 v13, v28, v12
v_exp_f32 v13, v13
s_nop 0
v_mul_f32 v4, v4, v13
v_mul_f32 v5, v5, v13
v_accvgpr_read_b32 v11, a0
v_mul_f32 v11, v11, v13
v_accvgpr_write_b32 a0, v11
v_accvgpr_read_b32 v11, a1
v_mul_f32 v11, v11, v13
v_accvgpr_write_b32 a1, v11
v_accvgpr_read_b32 v11, a2
v_mul_f32 v11, v11, v13
v_accvgpr_write_b32 a2, v11
v_accvgpr_read_b32 v11, a3
v_mul_f32 v11, v11, v13
v_accvgpr_write_b32 a3, v11
v_accvgpr_read_b32 v11, a4
v_mul_f32 v11, v11, v13
v_accvgpr_write_b32 a4, v11
v_accvgpr_read_b32 v11, a5
v_mul_f32 v11, v11, v13
v_accvgpr_write_b32 a5, v11
v_accvgpr_read_b32 v11, a6
v_mul_f32 v11, v11, v13
v_accvgpr_write_b32 a6, v11
v_accvgpr_read_b32 v11, a7
v_mul_f32 v11, v11, v13
v_accvgpr_write_b32 a7, v11
v_accvgpr_read_b32 v11, a8
v_mul_f32 v11, v11, v13
v_accvgpr_write_b32 a8, v11
v_accvgpr_read_b32 v11, a9
v_mul_f32 v11, v11, v13
v_accvgpr_write_b32 a9, v11
v_accvgpr_read_b32 v11, a10
v_mul_f32 v11, v11, v13
v_accvgpr_write_b32 a10, v11
v_accvgpr_read_b32 v11, a11
v_mul_f32 v11, v11, v13
v_accvgpr_write_b32 a11, v11
v_accvgpr_read_b32 v11, a12
v_mul_f32 v11, v11, v13
v_accvgpr_write_b32 a12, v11
v_accvgpr_read_b32 v11, a13
v_mul_f32 v11, v11, v13
v_accvgpr_write_b32 a13, v11
v_accvgpr_read_b32 v11, a14
v_mul_f32 v11, v11, v13
v_accvgpr_write_b32 a14, v11
v_accvgpr_read_b32 v11, a15
v_mul_f32 v11, v11, v13
v_accvgpr_write_b32 a15, v11
v_accvgpr_read_b32 v11, a16
v_mul_f32 v11, v11, v13
v_accvgpr_write_b32 a16, v11
v_accvgpr_read_b32 v11, a17
v_mul_f32 v11, v11, v13
v_accvgpr_write_b32 a17, v11
v_accvgpr_read_b32 v11, a18
v_mul_f32 v11, v11, v13
v_accvgpr_write_b32 a18, v11
v_accvgpr_read_b32 v11, a19
v_mul_f32 v11, v11, v13
v_accvgpr_write_b32 a19, v11
v_accvgpr_read_b32 v11, a20
v_mul_f32 v11, v11, v13
v_accvgpr_write_b32 a20, v11
v_accvgpr_read_b32 v11, a21
v_mul_f32 v11, v11, v13
v_accvgpr_write_b32 a21, v11
v_accvgpr_read_b32 v11, a22
v_mul_f32 v11, v11, v13
v_accvgpr_write_b32 a22, v11
v_accvgpr_read_b32 v11, a23
v_mul_f32 v11, v11, v13
v_accvgpr_write_b32 a23, v11
v_accvgpr_read_b32 v11, a24
v_mul_f32 v11, v11, v13
v_accvgpr_write_b32 a24, v11
v_accvgpr_read_b32 v11, a25
v_mul_f32 v11, v11, v13
v_accvgpr_write_b32 a25, v11
v_accvgpr_read_b32 v11, a26
v_mul_f32 v11, v11, v13
v_accvgpr_write_b32 a26, v11
v_accvgpr_read_b32 v11, a27
v_mul_f32 v11, v11, v13
v_accvgpr_write_b32 a27, v11
v_accvgpr_read_b32 v11, a28
v_mul_f32 v11, v11, v13
v_accvgpr_write_b32 a28, v11
v_accvgpr_read_b32 v11, a29
v_mul_f32 v11, v11, v13
v_accvgpr_write_b32 a29, v11
v_accvgpr_read_b32 v11, a30
v_mul_f32 v11, v11, v13
v_accvgpr_write_b32 a30, v11
v_accvgpr_read_b32 v11, a31
v_mul_f32 v11, v11, v13
v_accvgpr_write_b32 a31, v11
v_accvgpr_read_b32 v11, a32
v_mul_f32 v11, v11, v13
v_accvgpr_write_b32 a32, v11
v_accvgpr_read_b32 v11, a33
v_mul_f32 v11, v11, v13
v_accvgpr_write_b32 a33, v11
v_accvgpr_read_b32 v11, a34
v_mul_f32 v11, v11, v13
v_accvgpr_write_b32 a34, v11
v_accvgpr_read_b32 v11, a35
v_mul_f32 v11, v11, v13
v_accvgpr_write_b32 a35, v11
v_accvgpr_read_b32 v11, a36
v_mul_f32 v11, v11, v13
v_accvgpr_write_b32 a36, v11
v_accvgpr_read_b32 v11, a37
v_mul_f32 v11, v11, v13
v_accvgpr_write_b32 a37, v11
v_accvgpr_read_b32 v11, a38
v_mul_f32 v11, v11, v13
v_accvgpr_write_b32 a38, v11
v_accvgpr_read_b32 v11, a39
v_mul_f32 v11, v11, v13
v_accvgpr_write_b32 a39, v11
v_accvgpr_read_b32 v11, a40
v_mul_f32 v11, v11, v13
v_accvgpr_write_b32 a40, v11
v_accvgpr_read_b32 v11, a41
v_mul_f32 v11, v11, v13
v_accvgpr_write_b32 a41, v11
v_accvgpr_read_b32 v11, a42
v_mul_f32 v11, v11, v13
v_accvgpr_write_b32 a42, v11
v_accvgpr_read_b32 v11, a43
v_mul_f32 v11, v11, v13
v_accvgpr_write_b32 a43, v11
v_accvgpr_read_b32 v11, a44
v_mul_f32 v11, v11, v13
v_accvgpr_write_b32 a44, v11
v_accvgpr_read_b32 v11, a45
v_mul_f32 v11, v11, v13
v_accvgpr_write_b32 a45, v11
v_accvgpr_read_b32 v11, a46
v_mul_f32 v11, v11, v13
v_accvgpr_write_b32 a46, v11
v_accvgpr_read_b32 v11, a47
v_mul_f32 v11, v11, v13
v_accvgpr_write_b32 a47, v11
v_accvgpr_read_b32 v11, a48
v_mul_f32 v11, v11, v13
v_accvgpr_write_b32 a48, v11
v_accvgpr_read_b32 v11, a49
v_mul_f32 v11, v11, v13
v_accvgpr_write_b32 a49, v11
v_accvgpr_read_b32 v11, a50
v_mul_f32 v11, v11, v13
v_accvgpr_write_b32 a50, v11
v_accvgpr_read_b32 v11, a51
v_mul_f32 v11, v11, v13
v_accvgpr_write_b32 a51, v11
v_accvgpr_read_b32 v11, a52
v_mul_f32 v11, v11, v13
v_accvgpr_write_b32 a52, v11
v_accvgpr_read_b32 v11, a53
v_mul_f32 v11, v11, v13
v_accvgpr_write_b32 a53, v11
v_accvgpr_read_b32 v11, a54
v_mul_f32 v11, v11, v13
v_accvgpr_write_b32 a54, v11
v_accvgpr_read_b32 v11, a55
v_mul_f32 v11, v11, v13
v_accvgpr_write_b32 a55, v11
v_accvgpr_read_b32 v11, a56
v_mul_f32 v11, v11, v13
v_accvgpr_write_b32 a56, v11
v_accvgpr_read_b32 v11, a57
v_mul_f32 v11, v11, v13
v_accvgpr_write_b32 a57, v11
v_accvgpr_read_b32 v11, a58
v_mul_f32 v11, v11, v13
v_accvgpr_write_b32 a58, v11
v_accvgpr_read_b32 v11, a59
v_mul_f32 v11, v11, v13
v_accvgpr_write_b32 a59, v11
v_accvgpr_read_b32 v11, a60
v_mul_f32 v11, v11, v13
v_accvgpr_write_b32 a60, v11
v_accvgpr_read_b32 v11, a61
v_mul_f32 v11, v11, v13
v_accvgpr_write_b32 a61, v11
v_accvgpr_read_b32 v11, a62
v_mul_f32 v11, v11, v13
v_accvgpr_write_b32 a62, v11
v_accvgpr_read_b32 v11, a63
v_mul_f32 v11, v11, v13
v_accvgpr_write_b32 a63, v11
v_max_f32 v12, v29, v15
v_sub_f32 v13, v29, v12
v_exp_f32 v13, v13
s_nop 0
v_mul_f32 v6, v6, v13
v_mul_f32 v7, v7, v13
v_accvgpr_read_b32 v11, a64
v_mul_f32 v11, v11, v13
v_accvgpr_write_b32 a64, v11
v_accvgpr_read_b32 v11, a65
v_mul_f32 v11, v11, v13
v_accvgpr_write_b32 a65, v11
v_accvgpr_read_b32 v11, a66
v_mul_f32 v11, v11, v13
v_accvgpr_write_b32 a66, v11
v_accvgpr_read_b32 v11, a67
v_mul_f32 v11, v11, v13
v_accvgpr_write_b32 a67, v11
v_accvgpr_read_b32 v11, a68
v_mul_f32 v11, v11, v13
v_accvgpr_write_b32 a68, v11
v_accvgpr_read_b32 v11, a69
v_mul_f32 v11, v11, v13
v_accvgpr_write_b32 a69, v11
v_accvgpr_read_b32 v11, a70
v_mul_f32 v11, v11, v13
v_accvgpr_write_b32 a70, v11
v_accvgpr_read_b32 v11, a71
v_mul_f32 v11, v11, v13
v_accvgpr_write_b32 a71, v11
v_accvgpr_read_b32 v11, a72
v_mul_f32 v11, v11, v13
v_accvgpr_write_b32 a72, v11
v_accvgpr_read_b32 v11, a73
v_mul_f32 v11, v11, v13
v_accvgpr_write_b32 a73, v11
v_accvgpr_read_b32 v11, a74
v_mul_f32 v11, v11, v13
v_accvgpr_write_b32 a74, v11
v_accvgpr_read_b32 v11, a75
v_mul_f32 v11, v11, v13
v_accvgpr_write_b32 a75, v11
v_accvgpr_read_b32 v11, a76
v_mul_f32 v11, v11, v13
v_accvgpr_write_b32 a76, v11
v_accvgpr_read_b32 v11, a77
v_mul_f32 v11, v11, v13
v_accvgpr_write_b32 a77, v11
v_accvgpr_read_b32 v11, a78
v_mul_f32 v11, v11, v13
v_accvgpr_write_b32 a78, v11
v_accvgpr_read_b32 v11, a79
v_mul_f32 v11, v11, v13
v_accvgpr_write_b32 a79, v11
v_accvgpr_read_b32 v11, a80
v_mul_f32 v11, v11, v13
v_accvgpr_write_b32 a80, v11
v_accvgpr_read_b32 v11, a81
v_mul_f32 v11, v11, v13
v_accvgpr_write_b32 a81, v11
v_accvgpr_read_b32 v11, a82
v_mul_f32 v11, v11, v13
v_accvgpr_write_b32 a82, v11
v_accvgpr_read_b32 v11, a83
v_mul_f32 v11, v11, v13
v_accvgpr_write_b32 a83, v11
v_accvgpr_read_b32 v11, a84
v_mul_f32 v11, v11, v13
v_accvgpr_write_b32 a84, v11
v_accvgpr_read_b32 v11, a85
v_mul_f32 v11, v11, v13
v_accvgpr_write_b32 a85, v11
v_accvgpr_read_b32 v11, a86
v_mul_f32 v11, v11, v13
v_accvgpr_write_b32 a86, v11
v_accvgpr_read_b32 v11, a87
v_mul_f32 v11, v11, v13
v_accvgpr_write_b32 a87, v11
v_accvgpr_read_b32 v11, a88
v_mul_f32 v11, v11, v13
v_accvgpr_write_b32 a88, v11
v_accvgpr_read_b32 v11, a89
v_mul_f32 v11, v11, v13
v_accvgpr_write_b32 a89, v11
v_accvgpr_read_b32 v11, a90
v_mul_f32 v11, v11, v13
v_accvgpr_write_b32 a90, v11
v_accvgpr_read_b32 v11, a91
v_mul_f32 v11, v11, v13
v_accvgpr_write_b32 a91, v11
v_accvgpr_read_b32 v11, a92
v_mul_f32 v11, v11, v13
v_accvgpr_write_b32 a92, v11
v_accvgpr_read_b32 v11, a93
v_mul_f32 v11, v11, v13
v_accvgpr_write_b32 a93, v11
v_accvgpr_read_b32 v11, a94
v_mul_f32 v11, v11, v13
v_accvgpr_write_b32 a94, v11
v_accvgpr_read_b32 v11, a95
v_mul_f32 v11, v11, v13
v_accvgpr_write_b32 a95, v11
v_accvgpr_read_b32 v11, a96
v_mul_f32 v11, v11, v13
v_accvgpr_write_b32 a96, v11
v_accvgpr_read_b32 v11, a97
v_mul_f32 v11, v11, v13
v_accvgpr_write_b32 a97, v11
v_accvgpr_read_b32 v11, a98
v_mul_f32 v11, v11, v13
v_accvgpr_write_b32 a98, v11
v_accvgpr_read_b32 v11, a99
v_mul_f32 v11, v11, v13
v_accvgpr_write_b32 a99, v11
v_accvgpr_read_b32 v11, a100
v_mul_f32 v11, v11, v13
v_accvgpr_write_b32 a100, v11
v_accvgpr_read_b32 v11, a101
v_mul_f32 v11, v11, v13
v_accvgpr_write_b32 a101, v11
v_accvgpr_read_b32 v11, a102
v_mul_f32 v11, v11, v13
v_accvgpr_write_b32 a102, v11
v_accvgpr_read_b32 v11, a103
v_mul_f32 v11, v11, v13
v_accvgpr_write_b32 a103, v11
v_accvgpr_read_b32 v11, a104
v_mul_f32 v11, v11, v13
v_accvgpr_write_b32 a104, v11
v_accvgpr_read_b32 v11, a105
v_mul_f32 v11, v11, v13
v_accvgpr_write_b32 a105, v11
v_accvgpr_read_b32 v11, a106
v_mul_f32 v11, v11, v13
v_accvgpr_write_b32 a106, v11
v_accvgpr_read_b32 v11, a107
v_mul_f32 v11, v11, v13
v_accvgpr_write_b32 a107, v11
v_accvgpr_read_b32 v11, a108
v_mul_f32 v11, v11, v13
v_accvgpr_write_b32 a108, v11
v_accvgpr_read_b32 v11, a109
v_mul_f32 v11, v11, v13
v_accvgpr_write_b32 a109, v11
v_accvgpr_read_b32 v11, a110
v_mul_f32 v11, v11, v13
v_accvgpr_write_b32 a110, v11
v_accvgpr_read_b32 v11, a111
v_mul_f32 v11, v11, v13
v_accvgpr_write_b32 a111, v11
v_accvgpr_read_b32 v11, a112
v_mul_f32 v11, v11, v13
v_accvgpr_write_b32 a112, v11
v_accvgpr_read_b32 v11, a113
v_mul_f32 v11, v11, v13
v_accvgpr_write_b32 a113, v11
v_accvgpr_read_b32 v11, a114
v_mul_f32 v11, v11, v13
v_accvgpr_write_b32 a114, v11
v_accvgpr_read_b32 v11, a115
v_mul_f32 v11, v11, v13
v_accvgpr_write_b32 a115, v11
v_accvgpr_read_b32 v11, a116
v_mul_f32 v11, v11, v13
v_accvgpr_write_b32 a116, v11
v_accvgpr_read_b32 v11, a117
v_mul_f32 v11, v11, v13
v_accvgpr_write_b32 a117, v11
v_accvgpr_read_b32 v11, a118
v_mul_f32 v11, v11, v13
v_accvgpr_write_b32 a118, v11
v_accvgpr_read_b32 v11, a119
v_mul_f32 v11, v11, v13
v_accvgpr_write_b32 a119, v11
v_accvgpr_read_b32 v11, a120
v_mul_f32 v11, v11, v13
v_accvgpr_write_b32 a120, v11
v_accvgpr_read_b32 v11, a121
v_mul_f32 v11, v11, v13
v_accvgpr_write_b32 a121, v11
v_accvgpr_read_b32 v11, a122
v_mul_f32 v11, v11, v13
v_accvgpr_write_b32 a122, v11
v_accvgpr_read_b32 v11, a123
v_mul_f32 v11, v11, v13
v_accvgpr_write_b32 a123, v11
v_accvgpr_read_b32 v11, a124
v_mul_f32 v11, v11, v13
v_accvgpr_write_b32 a124, v11
v_accvgpr_read_b32 v11, a125
v_mul_f32 v11, v11, v13
v_accvgpr_write_b32 a125, v11
v_accvgpr_read_b32 v11, a126
v_mul_f32 v11, v11, v13
v_accvgpr_write_b32 a126, v11
v_accvgpr_read_b32 v11, a127
v_mul_f32 v11, v11, v13
v_accvgpr_write_b32 a127, v11
s_nop 3
s_mov_b32 s74, 16
s_mov_b32 s78, 4
s_branch LA_fin
LA_att_done:
s_cmp_lg_u32 s82, 0
s_cbranch_scc1 LA_redo
LA_safe_done:
s_load_dwordx2 s[8:9], s[0:1], 40
s_and_b32 s12, s2, 3
s_bfe_u32 s13, s2, 0x10002
s_lshr_b32 s15, s2, 3
s_and_b32 s60, s15, 7
s_lshl_b32 s13, s13, 3
s_add_u32 s13, s13, s60
s_lshr_b32 s15, s15, 3
s_waitcnt lgkmcnt(0)
s_mul_i32 s60, s12, 1310720
s_mul_i32 s61, s15, 320
s_add_u32 s60, s60, s61
s_add_u32 s24, s8, s60
s_addc_u32 s25, s9, 0
s_mov_b32 s26, 0x0
s_mov_b32 s27, 0x20000
s_sub_u32 s26, 5242880, s60
s_lshl_b32 s60, s13, 2
s_add_u32 s60, s60, s22
s_lshl_b32 s60, s60, 8
s_lshl_b32 s61, s12, 6
s_add_u32 s60, s60, s61
s_lshl_b32 s60, s60, 10
s_add_u32 s60, s60, 0x2400000
s_add_u32 s28, s18, s60
s_addc_u32 s29, s19, 0
s_mov_b32 s30, 0x10000
s_mov_b32 s31, 0x20000
s_lshl_b32 s60, s12, 6
s_lshl_b32 s61, s13, 2
s_add_u32 s60, s60, s61
s_add_u32 s60, s60, s22
s_mul_i32 s60, s60, 20
s_mul_i32 s61, s15, 5
s_add_u32 s60, s60, s61
s_lshl_b32 s60, s60, 11
s_add_u32 s60, s60, 0x3400000
s_add_u32 s32, s18, s60
s_addc_u32 s33, s19, 0
s_mov_b32 s34, 0x2800
s_mov_b32 s35, 0x20000
v_lshlrev_b32 v3, 4, v1
s_mul_i32 s60, s22, 320
s_movk_i32 s61, 3277
v_add_u32 v10, s60, v1
v_add_u32 v10, 0, v10
v_mul_lo_u32 v11, v10, s61
v_lshrrev_b32 v11, 16, v11
v_mul_u32_u24 v12, 20, v11
v_sub_u32 v12, v10, v12
v_mul_u32_u24 v11, 1280, v11
v_lshlrev_b32 v12, 4, v12
v_add_u32 v11, v11, v12
v_mov_b32 v4, v11
v_add_u32 v10, s60, v1
v_add_u32 v10, 64, v10
v_mul_lo_u32 v11, v10, s61
v_lshrrev_b32 v11, 16, v11
v_mul_u32_u24 v12, 20, v11
v_sub_u32 v12, v10, v12
v_mul_u32_u24 v11, 1280, v11
v_lshlrev_b32 v12, 4, v12
v_add_u32 v11, v11, v12
v_subrev_u32 v11, 1024, v11
v_mov_b32 v5, v11
v_add_u32 v10, s60, v1
v_add_u32 v10, 128, v10
v_mul_lo_u32 v11, v10, s61
v_lshrrev_b32 v11, 16, v11
v_mul_u32_u24 v12, 20, v11
v_sub_u32 v12, v10, v12
v_mul_u32_u24 v11, 1280, v11
v_lshlrev_b32 v12, 4, v12
v_add_u32 v11, v11, v12
v_subrev_u32 v11, 2048, v11
v_mov_b32 v6, v11
v_add_u32 v10, s60, v1
v_add_u32 v10, 192, v10
v_mul_lo_u32 v11, v10, s61
v_lshrrev_b32 v11, 16, v11
v_mul_u32_u24 v12, 20, v11
v_sub_u32 v12, v10, v12
v_mul_u32_u24 v11, 1280, v11
v_lshlrev_b32 v12, 4, v12
v_add_u32 v11, v11, v12
v_subrev_u32 v11, 3072, v11
v_mov_b32 v7, v11
v_add_u32 v10, s60, v1
v_add_u32 v10, 256, v10
v_mul_lo_u32 v11, v10, s61
v_lshrrev_b32 v11, 16, v11
v_mul_u32_u24 v12, 20, v11
v_sub_u32 v12, v10, v12
v_mul_u32_u24 v11, 1280, v11
v_lshlrev_b32 v12, 4, v12
v_add_u32 v11, v11, v12
v_mov_b32 v8, v11
v_lshrrev_b32 v10, 5, v1
v_lshlrev_b32 v10, 2, v10
v_lshrrev_b32 v11, 2, v1
v_and_b32 v11, 3, v11
v_add_u32 v10, v10, v11
v_mul_u32_u24 v10, 320, v10
v_lshrrev_b32 v11, 4, v1
v_and_b32 v11, 1, v11
v_lshlrev_b32 v11, 5, v11
v_add_u32 v10, v10, v11
v_and_b32 v11, 3, v1
v_lshlrev_b32 v11, 3, v11
v_add_u32 v14, v10, v11
v_add_u32 v15, 40960, v14
s_mul_i32 s62, s22, 5120
s_load_dwordx4 s[4:7], s[0:1], 64
s_load_dwordx2 s[10:11], s[0:1], 80
s_waitcnt lgkmcnt(0)
s_min_u32 s61, s2, 53
s_lshl_b32 s60, s61, 6
s_add_u32 s44, s4, s60
s_addc_u32 s45, s5, 0
s_mov_b32 s46, 0x0
s_mov_b32 s47, 0x20000
s_sub_u32 s46, 2211840, s60
s_add_u32 s48, s6, s60
s_addc_u32 s49, s7, 0
s_mov_b32 s50, 0x0
s_mov_b32 s51, 0x20000
s_sub_u32 s50, 2211840, s60
v_lshrrev_b32 v16, 2, v1
v_mul_u32_u24 v16, 3456, v16
v_and_b32 v17, 3, v1
v_lshlrev_b32 v17, 4, v17
v_add_u32 v16, v16, v17
s_mul_i32 s66, s22, 552960
s_mul_i32 s67, s22, 10240
s_cmp_ge_u32 s2, 54
s_cselect_b32 s67, 90112, s67
s_cselect_b32 s46, 0, s46
s_cselect_b32 s50, 0, s50
s_barrier
s_add_u32 m0, s62, 0
s_mov_b32 s63, 0
buffer_load_dwordx4 v4, s[24:27], s63 offen offset:0 lds
buffer_load_dwordx4 v5, s[24:27], s63 offen offset:1024 lds
buffer_load_dwordx4 v6, s[24:27], s63 offen offset:2048 lds
buffer_load_dwordx4 v7, s[24:27], s63 offen offset:3072 lds
s_add_u32 m0, s62, 4096
s_nop 0
buffer_load_dwordx4 v8, s[24:27], s63 offen lds
s_add_u32 m0, s62, 20480
s_mov_b32 s63, 81920
buffer_load_dwordx4 v4, s[24:27], s63 offen offset:0 lds
buffer_load_dwordx4 v5, s[24:27], s63 offen offset:1024 lds
buffer_load_dwordx4 v6, s[24:27], s63 offen offset:2048 lds
buffer_load_dwordx4 v7, s[24:27], s63 offen offset:3072 lds
s_add_u32 m0, s62, 24576
s_nop 0
buffer_load_dwordx4 v8, s[24:27], s63 offen lds
s_add_u32 m0, s62, 40960
s_mov_b32 s63, 163840
buffer_load_dwordx4 v4, s[24:27], s63 offen offset:0 lds
buffer_load_dwordx4 v5, s[24:27], s63 offen offset:1024 lds
buffer_load_dwordx4 v6, s[24:27], s63 offen offset:2048 lds
buffer_load_dwordx4 v7, s[24:27], s63 offen offset:3072 lds
s_add_u32 m0, s62, 45056
s_nop 0
buffer_load_dwordx4 v8, s[24:27], s63 offen lds
s_waitcnt vmcnt(15)
s_barrier
s_cmp_lg_u32 s22, 0
s_cbranch_scc1 Lcs_122
s_lshl_b32 s60, s21, 2
s_lshr_b32 s61, s20, 3
s_add_u32 s60, s60, s61
s_lshl_b32 s60, s60, 7
s_and_b32 s61, s20, 7
s_lshl_b32 s61, s61, 2
s_add_u32 s60, s60, s61
s_add_u32 s60, s60, 4096
s_add_u32 s60, s60, 0x5800000
v_mov_b32 v22, s60
v_mov_b32 v23, 1
s_mov_b64 s[60:61], exec
s_mov_b64 exec, 1
global_store_dword v22, v23, s[18:19] sc1
s_mov_b64 exec, s[60:61]
Lcs_122:
s_bitcmp1_b32 s82, 0
s_cbranch_scc1 Lt16_124
s_cmp_lg_u32 s75, 15
s_cbranch_scc1 Lt15_123
Lt16_124:
s_cmp_lg_u32 s22, 0
s_cbranch_scc1 Lcs_125
s_lshl_b32 s60, s75, 2
s_lshr_b32 s61, s20, 3
s_add_u32 s60, s60, s61
s_lshl_b32 s60, s60, 7
s_and_b32 s61, s20, 7
s_lshl_b32 s61, s61, 2
s_add_u32 s60, s60, s61
s_add_u32 s60, s60, 4096
s_add_u32 s60, s60, 0x5800000
v_mov_b32 v22, s60
v_mov_b32 v23, 1
s_mov_b64 s[60:61], exec
s_mov_b64 exec, 1
global_store_dword v22, v23, s[18:19] sc1
s_mov_b64 exec, s[60:61]
Lcs_125:
Lt15_123:
v_and_b32 v10, 7, v1
v_lshlrev_b32 v10, 2, v10
s_lshl_b32 s60, s13, 2
s_add_u32 s60, s60, s12
s_lshl_b32 s60, s60, 7
s_add_u32 s60, s60, 0x5801000
v_add_u32 v10, s60, v10
s_mov_b32 s61, 0
Lsf_126:
global_load_dword v11, v10, s[18:19] sc1
s_waitcnt vmcnt(0)
v_cmp_ne_u32 vcc, 0, v11
s_nop 1
s_and_b32 s60, vcc_lo, 0xff
s_cmp_eq_u32 s60, 0xff
s_cbranch_scc1 Lsfd_127
s_add_u32 s61, s61, 1
s_cmp_lt_u32 s61, 0x40000
s_sleep 2
s_cbranch_scc1 Lsf_126
Lsfd_127:
s_mov_b32 s64, 0
buffer_load_dwordx4 v[128:131], v3, s[28:31], s64 offen offset:0 sc1
buffer_load_dwordx4 v[132:135], v3, s[28:31], s64 offen offset:1024 sc1
buffer_load_dwordx4 v[136:139], v3, s[28:31], s64 offen offset:2048 sc1
buffer_load_dwordx4 v[140:143], v3, s[28:31], s64 offen offset:3072 sc1
s_mov_b32 s65, 4096
buffer_load_dwordx4 v[144:147], v3, s[28:31], s65 offen offset:0 sc1
buffer_load_dwordx4 v[148:151], v3, s[28:31], s65 offen offset:1024 sc1
buffer_load_dwordx4 v[152:155], v3, s[28:31], s65 offen offset:2048 sc1
buffer_load_dwordx4 v[156:159], v3, s[28:31], s65 offen offset:3072 sc1
s_mov_b32 s64, 8192
buffer_load_dwordx4 v[160:163], v3, s[28:31], s64 offen offset:0 sc1
buffer_load_dwordx4 v[164:167], v3, s[28:31], s64 offen offset:1024 sc1
buffer_load_dwordx4 v[168:171], v3, s[28:31], s64 offen offset:2048 sc1
buffer_load_dwordx4 v[172:175], v3, s[28:31], s64 offen offset:3072 sc1
s_mov_b32 s65, 12288
buffer_load_dwordx4 v[176:179], v3, s[28:31], s65 offen offset:0 sc1
buffer_load_dwordx4 v[180:183], v3, s[28:31], s65 offen offset:1024 sc1
buffer_load_dwordx4 v[184:187], v3, s[28:31], s65 offen offset:2048 sc1
buffer_load_dwordx4 v[188:191], v3, s[28:31], s65 offen offset:3072 sc1
s_mov_b32 s64, 16384
buffer_load_dwordx4 v[192:195], v3, s[28:31], s64 offen offset:0 sc1
buffer_load_dwordx4 v[196:199], v3, s[28:31], s64 offen offset:1024 sc1
buffer_load_dwordx4 v[200:203], v3, s[28:31], s64 offen offset:2048 sc1
buffer_load_dwordx4 v[204:207], v3, s[28:31], s64 offen offset:3072 sc1
s_mov_b32 s65, 20480
buffer_load_dwordx4 v[208:211], v3, s[28:31], s65 offen offset:0 sc1
buffer_load_dwordx4 v[212:215], v3, s[28:31], s65 offen offset:1024 sc1
buffer_load_dwordx4 v[216:219], v3, s[28:31], s65 offen offset:2048 sc1
buffer_load_dwordx4 v[220:223], v3, s[28:31], s65 offen offset:3072 sc1
s_mov_b32 s64, 24576
buffer_load_dwordx4 v[224:227], v3, s[28:31], s64 offen offset:0 sc1
buffer_load_dwordx4 v[228:231], v3, s[28:31], s64 offen offset:1024 sc1
buffer_load_dwordx4 v[232:235], v3, s[28:31], s64 offen offset:2048 sc1
buffer_load_dwordx4 v[236:239], v3, s[28:31], s64 offen offset:3072 sc1
s_mov_b32 s65, 28672
buffer_load_dwordx4 v[240:243], v3, s[28:31], s65 offen offset:0 sc1
buffer_load_dwordx4 v[244:247], v3, s[28:31], s65 offen offset:1024 sc1
s_barrier
ds_read_b64_tr_b16 a[0:1], v14 offset:0
ds_read_b64_tr_b16 a[2:3], v14 offset:2560
ds_read_b64_tr_b16 a[4:5], v14 offset:64
ds_read_b64_tr_b16 a[6:7], v14 offset:2624
ds_read_b64_tr_b16 a[8:9], v14 offset:128
ds_read_b64_tr_b16 a[10:11], v14 offset:2688
ds_read_b64_tr_b16 a[12:13], v14 offset:192
ds_read_b64_tr_b16 a[14:15], v14 offset:2752
ds_read_b64_tr_b16 a[16:17], v14 offset:256
ds_read_b64_tr_b16 a[18:19], v14 offset:2816
ds_read_b64_tr_b16 a[20:21], v14 offset:5120
ds_read_b64_tr_b16 a[22:23], v14 offset:7680
ds_read_b64_tr_b16 a[24:25], v14 offset:5184
ds_read_b64_tr_b16 a[26:27], v14 offset:7744
ds_read_b64_tr_b16 a[28:29], v14 offset:5248
s_waitcnt lgkmcnt(10)
ds_read_b64_tr_b16 a[30:31], v14 offset:7808
ds_read_b64_tr_b16 a[32:33], v14 offset:5312
ds_read_b64_tr_b16 a[34:35], v14 offset:7872
ds_read_b64_tr_b16 a[36:37], v14 offset:5376
ds_read_b64_tr_b16 a[38:39], v14 offset:7936
s_waitcnt vmcnt(29) lgkmcnt(10)
v_mfma_f32_32x32x16_bf16 v[32:47], a[0:3], v[128:131], 0
ds_read_b64_tr_b16 a[40:41], v14 offset:10240
ds_read_b64_tr_b16 a[42:43], v14 offset:12800
ds_read_b64_tr_b16 a[44:45], v14 offset:10304
ds_read_b64_tr_b16 a[46:47], v14 offset:12864
v_mfma_f32_32x32x16_bf16 v[48:63], a[4:7], v[128:131], 0
ds_read_b64_tr_b16 a[48:49], v14 offset:10368
ds_read_b64_tr_b16 a[50:51], v14 offset:12928
ds_read_b64_tr_b16 a[52:53], v14 offset:10432
ds_read_b64_tr_b16 a[54:55], v14 offset:12992
ds_read_b64_tr_b16 a[56:57], v14 offset:10496
v_mfma_f32_32x32x16_bf16 v[64:79], a[8:11], v[128:131], 0
ds_read_b64_tr_b16 a[58:59], v14 offset:13056
v_mfma_f32_32x32x16_bf16 v[80:95], a[12:15], v[128:131], 0
v_mfma_f32_32x32x16_bf16 v[96:111], a[16:19], v[128:131], 0
ds_read_b64_tr_b16 a[0:1], v14 offset:15360
ds_read_b64_tr_b16 a[2:3], v14 offset:17920
ds_read_b64_tr_b16 a[4:5], v14 offset:15424
ds_read_b64_tr_b16 a[6:7], v14 offset:17984
ds_read_b64_tr_b16 a[8:9], v14 offset:15488
s_waitcnt vmcnt(28) lgkmcnt(15)
v_mfma_f32_32x32x16_bf16 v[32:47], a[20:23], v[132:135], v[32:47]
ds_read_b64_tr_b16 a[10:11], v14 offset:18048
ds_read_b64_tr_b16 a[12:13], v14 offset:15552
v_mfma_f32_32x32x16_bf16 v[48:63], a[24:27], v[132:135], v[48:63]
ds_read_b64_tr_b16 a[14:15], v14 offset:18112
ds_read_b64_tr_b16 a[16:17], v14 offset:15616
v_mfma_f32_32x32x16_bf16 v[64:79], a[28:31], v[132:135], v[64:79]
ds_read_b64_tr_b16 a[18:19], v14 offset:18176
v_mfma_f32_32x32x16_bf16 v[80:95], a[32:35], v[132:135], v[80:95]
v_mfma_f32_32x32x16_bf16 v[96:111], a[36:39], v[132:135], v[96:111]
s_barrier
s_waitcnt vmcnt(27) lgkmcnt(10)
v_mfma_f32_32x32x16_bf16 v[32:47], a[40:43], v[136:139], v[32:47]
ds_read_b64_tr_b16 a[20:21], v14 offset:20480
s_add_u32 m0, s62, 61440
s_mov_b32 s63, 245760
buffer_load_dwordx4 v4, s[24:27], s63 offen offset:0 lds
v_mfma_f32_32x32x16_bf16 v[48:63], a[44:47], v[136:139], v[48:63]
ds_read_b64_tr_b16 a[22:23], v14 offset:23040
ds_read_b64_tr_b16 a[24:25], v14 offset:20544
ds_read_b64_tr_b16 a[26:27], v14 offset:23104
ds_read_b64_tr_b16 a[28:29], v14 offset:20608
v_mfma_f32_32x32x16_bf16 v[64:79], a[48:51], v[136:139], v[64:79]
s_add_u32 m0, s62, 61440
s_nop 0
buffer_load_dwordx4 v5, s[24:27], s63 offen offset:1024 lds
ds_read_b64_tr_b16 a[30:31], v14 offset:23168
v_mfma_f32_32x32x16_bf16 v[80:95], a[52:55], v[136:139], v[80:95]
s_add_u32 m0, s62, 61440
s_nop 0
buffer_load_dwordx4 v6, s[24:27], s63 offen offset:2048 lds
ds_read_b64_tr_b16 a[32:33], v14 offset:20672
v_mfma_f32_32x32x16_bf16 v[96:111], a[56:59], v[136:139], v[96:111]
s_add_u32 m0, s62, 61440
s_nop 0
buffer_load_dwordx4 v7, s[24:27], s63 offen offset:3072 lds
ds_read_b64_tr_b16 a[34:35], v14 offset:23232
s_waitcnt vmcnt(30) lgkmcnt(8)
v_mfma_f32_32x32x16_bf16 v[32:47], a[0:3], v[140:143], v[32:47]
ds_read_b64_tr_b16 a[36:37], v14 offset:20736
ds_read_b64_tr_b16 a[38:39], v14 offset:23296
ds_read_b64_tr_b16 a[40:41], v14 offset:25600
ds_read_b64_tr_b16 a[42:43], v14 offset:28160
v_mfma_f32_32x32x16_bf16 v[48:63], a[4:7], v[140:143], v[48:63]
s_add_u32 m0, s62, 65536
s_nop 0
buffer_load_dwordx4 v8, s[24:27], s63 offen lds
ds_read_b64_tr_b16 a[44:45], v14 offset:25664
v_mfma_f32_32x32x16_bf16 v[64:79], a[8:11], v[140:143], v[64:79]
buffer_load_dwordx4 v[248:251], v3, s[28:31], s65 offen offset:2048 sc1
ds_read_b64_tr_b16 a[46:47], v14 offset:28224
v_mfma_f32_32x32x16_bf16 v[80:95], a[12:15], v[140:143], v[80:95]
buffer_load_dwordx4 v[252:255], v3, s[28:31], s65 offen offset:3072 sc1
ds_read_b64_tr_b16 a[48:49], v14 offset:25728
v_mfma_f32_32x32x16_bf16 v[96:111], a[16:19], v[140:143], v[96:111]
s_mov_b32 s64, 32768
buffer_load_dwordx4 v[128:131], v3, s[28:31], s64 offen offset:0 sc1
buffer_load_dwordx4 v[132:135], v3, s[28:31], s64 offen offset:1024 sc1
ds_read_b64_tr_b16 a[50:51], v14 offset:28288
ds_read_b64_tr_b16 a[52:53], v14 offset:25792
ds_read_b64_tr_b16 a[54:55], v14 offset:28352
ds_read_b64_tr_b16 a[56:57], v14 offset:25856
ds_read_b64_tr_b16 a[58:59], v14 offset:28416
s_waitcnt vmcnt(34) lgkmcnt(10)
v_mfma_f32_32x32x16_bf16 v[32:47], a[20:23], v[144:147], v[32:47]
ds_read_b64_tr_b16 a[0:1], v14 offset:30720
ds_read_b64_tr_b16 a[2:3], v14 offset:33280
ds_read_b64_tr_b16 a[4:5], v14 offset:30784
ds_read_b64_tr_b16 a[6:7], v14 offset:33344
v_mfma_f32_32x32x16_bf16 v[48:63], a[24:27], v[144:147], v[48:63]
s_add_u32 m0, s67, 81920
s_add_u32 s68, s66, 0
buffer_load_dwordx4 v16, s[44:47], s68 offen lds
ds_read_b64_tr_b16 a[8:9], v14 offset:30848
v_mfma_f32_32x32x16_bf16 v[64:79], a[28:31], v[144:147], v[64:79]
ds_read_b64_tr_b16 a[10:11], v14 offset:33408
ds_read_b64_tr_b16 a[12:13], v14 offset:30912
ds_read_b64_tr_b16 a[14:15], v14 offset:33472
ds_read_b64_tr_b16 a[16:17], v14 offset:30976
ds_read_b64_tr_b16 a[18:19], v14 offset:33536
v_mfma_f32_32x32x16_bf16 v[80:95], a[32:35], v[144:147], v[80:95]
v_mfma_f32_32x32x16_bf16 v[96:111], a[36:39], v[144:147], v[96:111]
ds_read_b64_tr_b16 a[20:21], v14 offset:35840
ds_read_b64_tr_b16 a[22:23], v14 offset:38400
ds_read_b64_tr_b16 a[24:25], v14 offset:35904
ds_read_b64_tr_b16 a[26:27], v14 offset:38464
ds_read_b64_tr_b16 a[28:29], v14 offset:35968
s_waitcnt vmcnt(34) lgkmcnt(15)
v_mfma_f32_32x32x16_bf16 v[32:47], a[40:43], v[148:151], v[32:47]
s_add_u32 m0, s67, 82944
s_add_u32 s68, s66, 55296
buffer_load_dwordx4 v16, s[44:47], s68 offen lds
v_mfma_f32_32x32x16_bf16 v[48:63], a[44:47], v[148:151], v[48:63]
ds_read_b64_tr_b16 a[30:31], v14 offset:38528
ds_read_b64_tr_b16 a[32:33], v14 offset:36032
ds_read_b64_tr_b16 a[34:35], v14 offset:38592
ds_read_b64_tr_b16 a[36:37], v14 offset:36096
v_mfma_f32_32x32x16_bf16 v[64:79], a[48:51], v[148:151], v[64:79]
ds_read_b64_tr_b16 a[38:39], v14 offset:38656
v_mfma_f32_32x32x16_bf16 v[80:95], a[52:55], v[148:151], v[80:95]
v_mfma_f32_32x32x16_bf16 v[96:111], a[56:59], v[148:151], v[96:111]
s_barrier
s_waitcnt vmcnt(34) lgkmcnt(10)
v_mfma_f32_32x32x16_bf16 v[32:47], a[0:3], v[152:155], v[32:47]
ds_read_b64_tr_b16 a[40:41], v15 offset:0
s_add_u32 m0, s62, 0
s_mov_b32 s63, 327680
buffer_load_dwordx4 v4, s[24:27], s63 offen offset:0 lds
v_mfma_f32_32x32x16_bf16 v[48:63], a[4:7], v[152:155], v[48:63]
ds_read_b64_tr_b16 a[42:43], v15 offset:2560
ds_read_b64_tr_b16 a[44:45], v15 offset:64
ds_read_b64_tr_b16 a[46:47], v15 offset:2624
ds_read_b64_tr_b16 a[48:49], v15 offset:128
v_mfma_f32_32x32x16_bf16 v[64:79], a[8:11], v[152:155], v[64:79]
s_add_u32 m0, s62, 0
s_nop 0
buffer_load_dwordx4 v5, s[24:27], s63 offen offset:1024 lds
ds_read_b64_tr_b16 a[50:51], v15 offset:2688
v_mfma_f32_32x32x16_bf16 v[80:95], a[12:15], v[152:155], v[80:95]
s_add_u32 m0, s62, 0
s_nop 0
buffer_load_dwordx4 v6, s[24:27], s63 offen offset:2048 lds
ds_read_b64_tr_b16 a[52:53], v15 offset:192
v_mfma_f32_32x32x16_bf16 v[96:111], a[16:19], v[152:155], v[96:111]
s_add_u32 m0, s62, 0
s_nop 0
buffer_load_dwordx4 v7, s[24:27], s63 offen offset:3072 lds
ds_read_b64_tr_b16 a[54:55], v15 offset:2752
s_waitcnt vmcnt(37) lgkmcnt(8)
v_mfma_f32_32x32x16_bf16 v[32:47], a[20:23], v[156:159], v[32:47]
ds_read_b64_tr_b16 a[56:57], v15 offset:256
ds_read_b64_tr_b16 a[58:59], v15 offset:2816
ds_read_b64_tr_b16 a[0:1], v15 offset:5120
ds_read_b64_tr_b16 a[2:3], v15 offset:7680
v_mfma_f32_32x32x16_bf16 v[48:63], a[24:27], v[156:159], v[48:63]
s_add_u32 m0, s62, 4096
s_nop 0
buffer_load_dwordx4 v8, s[24:27], s63 offen lds
ds_read_b64_tr_b16 a[4:5], v15 offset:5184
v_mfma_f32_32x32x16_bf16 v[64:79], a[28:31], v[156:159], v[64:79]
buffer_load_dwordx4 v[136:139], v3, s[28:31], s64 offen offset:2048 sc1
ds_read_b64_tr_b16 a[6:7], v15 offset:7744
v_mfma_f32_32x32x16_bf16 v[80:95], a[32:35], v[156:159], v[80:95]
buffer_load_dwordx4 v[140:143], v3, s[28:31], s64 offen offset:3072 sc1
ds_read_b64_tr_b16 a[8:9], v15 offset:5248
v_mfma_f32_32x32x16_bf16 v[96:111], a[36:39], v[156:159], v[96:111]
s_mov_b32 s65, 36864
buffer_load_dwordx4 v[144:147], v3, s[28:31], s65 offen offset:0 sc1
buffer_load_dwordx4 v[148:151], v3, s[28:31], s65 offen offset:1024 sc1
ds_read_b64_tr_b16 a[10:11], v15 offset:7808
ds_read_b64_tr_b16 a[12:13], v15 offset:5312
ds_read_b64_tr_b16 a[14:15], v15 offset:7872
ds_read_b64_tr_b16 a[16:17], v15 offset:5376
ds_read_b64_tr_b16 a[18:19], v15 offset:7936
s_waitcnt vmcnt(41) lgkmcnt(10)
v_mfma_f32_32x32x16_bf16 v[32:47], a[40:43], v[160:163], v[32:47]
ds_read_b64_tr_b16 a[20:21], v15 offset:10240
ds_read_b64_tr_b16 a[22:23], v15 offset:12800
ds_read_b64_tr_b16 a[24:25], v15 offset:10304
ds_read_b64_tr_b16 a[26:27], v15 offset:12864
v_mfma_f32_32x32x16_bf16 v[48:63], a[44:47], v[160:163], v[48:63]
s_add_u32 m0, s67, 83968
s_add_u32 s68, s66, 110592
buffer_load_dwordx4 v16, s[44:47], s68 offen lds
ds_read_b64_tr_b16 a[28:29], v15 offset:10368
v_mfma_f32_32x32x16_bf16 v[64:79], a[48:51], v[160:163], v[64:79]
ds_read_b64_tr_b16 a[30:31], v15 offset:12928
ds_read_b64_tr_b16 a[32:33], v15 offset:10432
ds_read_b64_tr_b16 a[34:35], v15 offset:12992
ds_read_b64_tr_b16 a[36:37], v15 offset:10496
ds_read_b64_tr_b16 a[38:39], v15 offset:13056
v_mfma_f32_32x32x16_bf16 v[80:95], a[52:55], v[160:163], v[80:95]
v_mfma_f32_32x32x16_bf16 v[96:111], a[56:59], v[160:163], v[96:111]
ds_read_b64_tr_b16 a[40:41], v15 offset:15360
ds_read_b64_tr_b16 a[42:43], v15 offset:17920
ds_read_b64_tr_b16 a[44:45], v15 offset:15424
ds_read_b64_tr_b16 a[46:47], v15 offset:17984
ds_read_b64_tr_b16 a[48:49], v15 offset:15488
s_waitcnt vmcnt(41) lgkmcnt(15)
v_mfma_f32_32x32x16_bf16 v[32:47], a[0:3], v[164:167], v[32:47]
s_add_u32 m0, s67, 84992
s_add_u32 s68, s66, 165888
buffer_load_dwordx4 v16, s[44:47], s68 offen lds
v_mfma_f32_32x32x16_bf16 v[48:63], a[4:7], v[164:167], v[48:63]
ds_read_b64_tr_b16 a[50:51], v15 offset:18048
ds_read_b64_tr_b16 a[52:53], v15 offset:15552
ds_read_b64_tr_b16 a[54:55], v15 offset:18112
ds_read_b64_tr_b16 a[56:57], v15 offset:15616
v_mfma_f32_32x32x16_bf16 v[64:79], a[8:11], v[164:167], v[64:79]
ds_read_b64_tr_b16 a[58:59], v15 offset:18176
v_mfma_f32_32x32x16_bf16 v[80:95], a[12:15], v[164:167], v[80:95]
v_mfma_f32_32x32x16_bf16 v[96:111], a[16:19], v[164:167], v[96:111]
s_waitcnt vmcnt(17)
s_barrier
s_waitcnt lgkmcnt(10)
v_mfma_f32_32x32x16_bf16 v[32:47], a[20:23], v[168:171], v[32:47]
ds_read_b64_tr_b16 a[0:1], v15 offset:20480
s_add_u32 m0, s62, 20480
s_mov_b32 s63, 409600
buffer_load_dwordx4 v4, s[24:27], s63 offen offset:0 lds
v_mfma_f32_32x32x16_bf16 v[48:63], a[24:27], v[168:171], v[48:63]
ds_read_b64_tr_b16 a[2:3], v15 offset:23040
ds_read_b64_tr_b16 a[4:5], v15 offset:20544
ds_read_b64_tr_b16 a[6:7], v15 offset:23104
ds_read_b64_tr_b16 a[8:9], v15 offset:20608
v_mfma_f32_32x32x16_bf16 v[64:79], a[28:31], v[168:171], v[64:79]
s_add_u32 m0, s62, 20480
s_nop 0
buffer_load_dwordx4 v5, s[24:27], s63 offen offset:1024 lds
ds_read_b64_tr_b16 a[10:11], v15 offset:23168
v_mfma_f32_32x32x16_bf16 v[80:95], a[32:35], v[168:171], v[80:95]
s_add_u32 m0, s62, 20480
s_nop 0
buffer_load_dwordx4 v6, s[24:27], s63 offen offset:2048 lds
ds_read_b64_tr_b16 a[12:13], v15 offset:20672
v_mfma_f32_32x32x16_bf16 v[96:111], a[36:39], v[168:171], v[96:111]
s_add_u32 m0, s62, 20480
s_nop 0
buffer_load_dwordx4 v7, s[24:27], s63 offen offset:3072 lds
ds_read_b64_tr_b16 a[14:15], v15 offset:23232
s_waitcnt lgkmcnt(8)
v_mfma_f32_32x32x16_bf16 v[32:47], a[40:43], v[172:175], v[32:47]
ds_read_b64_tr_b16 a[16:17], v15 offset:20736
ds_read_b64_tr_b16 a[18:19], v15 offset:23296
ds_read_b64_tr_b16 a[20:21], v15 offset:25600
ds_read_b64_tr_b16 a[22:23], v15 offset:28160
v_mfma_f32_32x32x16_bf16 v[48:63], a[44:47], v[172:175], v[48:63]
s_add_u32 m0, s62, 24576
s_nop 0
buffer_load_dwordx4 v8, s[24:27], s63 offen lds
ds_read_b64_tr_b16 a[24:25], v15 offset:25664
v_mfma_f32_32x32x16_bf16 v[64:79], a[48:51], v[172:175], v[64:79]
buffer_load_dwordx4 v[152:155], v3, s[28:31], s65 offen offset:2048 sc1
ds_read_b64_tr_b16 a[26:27], v15 offset:28224
v_mfma_f32_32x32x16_bf16 v[80:95], a[52:55], v[172:175], v[80:95]
buffer_load_dwordx4 v[156:159], v3, s[28:31], s65 offen offset:3072 sc1
ds_read_b64_tr_b16 a[28:29], v15 offset:25728
v_mfma_f32_32x32x16_bf16 v[96:111], a[56:59], v[172:175], v[96:111]
s_mov_b32 s64, 40960
buffer_load_dwordx4 v[160:163], v3, s[28:31], s64 offen offset:0 sc1
buffer_load_dwordx4 v[164:167], v3, s[28:31], s64 offen offset:1024 sc1
ds_read_b64_tr_b16 a[30:31], v15 offset:28288
ds_read_b64_tr_b16 a[32:33], v15 offset:25792
ds_read_b64_tr_b16 a[34:35], v15 offset:28352
ds_read_b64_tr_b16 a[36:37], v15 offset:25856
ds_read_b64_tr_b16 a[38:39], v15 offset:28416
s_waitcnt lgkmcnt(10)
v_mfma_f32_32x32x16_bf16 v[32:47], a[0:3], v[176:179], v[32:47]
ds_read_b64_tr_b16 a[40:41], v15 offset:30720
ds_read_b64_tr_b16 a[42:43], v15 offset:33280
ds_read_b64_tr_b16 a[44:45], v15 offset:30784
ds_read_b64_tr_b16 a[46:47], v15 offset:33344
v_mfma_f32_32x32x16_bf16 v[48:63], a[4:7], v[176:179], v[48:63]
s_add_u32 m0, s67, 86016
s_add_u32 s68, s66, 221184
buffer_load_dwordx4 v16, s[44:47], s68 offen lds
ds_read_b64_tr_b16 a[48:49], v15 offset:30848
v_mfma_f32_32x32x16_bf16 v[64:79], a[8:11], v[176:179], v[64:79]
ds_read_b64_tr_b16 a[50:51], v15 offset:33408
ds_read_b64_tr_b16 a[52:53], v15 offset:30912
ds_read_b64_tr_b16 a[54:55], v15 offset:33472
ds_read_b64_tr_b16 a[56:57], v15 offset:30976
ds_read_b64_tr_b16 a[58:59], v15 offset:33536
v_mfma_f32_32x32x16_bf16 v[80:95], a[12:15], v[176:179], v[80:95]
v_mfma_f32_32x32x16_bf16 v[96:111], a[16:19], v[176:179], v[96:111]
ds_read_b64_tr_b16 a[0:1], v15 offset:35840
ds_read_b64_tr_b16 a[2:3], v15 offset:38400
ds_read_b64_tr_b16 a[4:5], v15 offset:35904
ds_read_b64_tr_b16 a[6:7], v15 offset:38464
ds_read_b64_tr_b16 a[8:9], v15 offset:35968
s_waitcnt lgkmcnt(15)
v_mfma_f32_32x32x16_bf16 v[32:47], a[20:23], v[180:183], v[32:47]
s_add_u32 m0, s67, 87040
s_add_u32 s68, s66, 276480
buffer_load_dwordx4 v16, s[44:47], s68 offen lds
v_mfma_f32_32x32x16_bf16 v[48:63], a[24:27], v[180:183], v[48:63]
ds_read_b64_tr_b16 a[10:11], v15 offset:38528
ds_read_b64_tr_b16 a[12:13], v15 offset:36032
ds_read_b64_tr_b16 a[14:15], v15 offset:38592
ds_read_b64_tr_b16 a[16:17], v15 offset:36096
v_mfma_f32_32x32x16_bf16 v[64:79], a[28:31], v[180:183], v[64:79]
ds_read_b64_tr_b16 a[18:19], v15 offset:38656
v_mfma_f32_32x32x16_bf16 v[80:95], a[32:35], v[180:183], v[80:95]
v_mfma_f32_32x32x16_bf16 v[96:111], a[36:39], v[180:183], v[96:111]
s_waitcnt vmcnt(17)
s_barrier
s_waitcnt lgkmcnt(10)
v_mfma_f32_32x32x16_bf16 v[32:47], a[40:43], v[184:187], v[32:47]
ds_read_b64_tr_b16 a[20:21], v14 offset:0
s_add_u32 m0, s62, 40960
s_mov_b32 s63, 491520
buffer_load_dwordx4 v4, s[24:27], s63 offen offset:0 lds
v_mfma_f32_32x32x16_bf16 v[48:63], a[44:47], v[184:187], v[48:63]
ds_read_b64_tr_b16 a[22:23], v14 offset:2560
ds_read_b64_tr_b16 a[24:25], v14 offset:64
ds_read_b64_tr_b16 a[26:27], v14 offset:2624
ds_read_b64_tr_b16 a[28:29], v14 offset:128
v_mfma_f32_32x32x16_bf16 v[64:79], a[48:51], v[184:187], v[64:79]
s_add_u32 m0, s62, 40960
s_nop 0
buffer_load_dwordx4 v5, s[24:27], s63 offen offset:1024 lds
ds_read_b64_tr_b16 a[30:31], v14 offset:2688
v_mfma_f32_32x32x16_bf16 v[80:95], a[52:55], v[184:187], v[80:95]
s_add_u32 m0, s62, 40960
s_nop 0
buffer_load_dwordx4 v6, s[24:27], s63 offen offset:2048 lds
ds_read_b64_tr_b16 a[32:33], v14 offset:192
v_mfma_f32_32x32x16_bf16 v[96:111], a[56:59], v[184:187], v[96:111]
s_add_u32 m0, s62, 40960
s_nop 0
buffer_load_dwordx4 v7, s[24:27], s63 offen offset:3072 lds
ds_read_b64_tr_b16 a[34:35], v14 offset:2752
s_waitcnt lgkmcnt(8)
v_mfma_f32_32x32x16_bf16 v[32:47], a[0:3], v[188:191], v[32:47]
ds_read_b64_tr_b16 a[36:37], v14 offset:256
ds_read_b64_tr_b16 a[38:39], v14 offset:2816
ds_read_b64_tr_b16 a[40:41], v14 offset:5120
ds_read_b64_tr_b16 a[42:43], v14 offset:7680
v_mfma_f32_32x32x16_bf16 v[48:63], a[4:7], v[188:191], v[48:63]
s_add_u32 m0, s62, 45056
s_nop 0
buffer_load_dwordx4 v8, s[24:27], s63 offen lds
ds_read_b64_tr_b16 a[44:45], v14 offset:5184
v_mfma_f32_32x32x16_bf16 v[64:79], a[8:11], v[188:191], v[64:79]
buffer_load_dwordx4 v[168:171], v3, s[28:31], s64 offen offset:2048 sc1
ds_read_b64_tr_b16 a[46:47], v14 offset:7744
v_mfma_f32_32x32x16_bf16 v[80:95], a[12:15], v[188:191], v[80:95]
buffer_load_dwordx4 v[172:175], v3, s[28:31], s64 offen offset:3072 sc1
ds_read_b64_tr_b16 a[48:49], v14 offset:5248
v_mfma_f32_32x32x16_bf16 v[96:111], a[16:19], v[188:191], v[96:111]
s_mov_b32 s65, 45056
buffer_load_dwordx4 v[176:179], v3, s[28:31], s65 offen offset:0 sc1
buffer_load_dwordx4 v[180:183], v3, s[28:31], s65 offen offset:1024 sc1
ds_read_b64_tr_b16 a[50:51], v14 offset:7808
ds_read_b64_tr_b16 a[52:53], v14 offset:5312
ds_read_b64_tr_b16 a[54:55], v14 offset:7872
ds_read_b64_tr_b16 a[56:57], v14 offset:5376
ds_read_b64_tr_b16 a[58:59], v14 offset:7936
s_waitcnt lgkmcnt(10)
v_mfma_f32_32x32x16_bf16 v[32:47], a[20:23], v[192:195], v[32:47]
ds_read_b64_tr_b16 a[0:1], v14 offset:10240
ds_read_b64_tr_b16 a[2:3], v14 offset:12800
ds_read_b64_tr_b16 a[4:5], v14 offset:10304
ds_read_b64_tr_b16 a[6:7], v14 offset:12864
v_mfma_f32_32x32x16_bf16 v[48:63], a[24:27], v[192:195], v[48:63]
s_add_u32 m0, s67, 88064
s_add_u32 s68, s66, 331776
buffer_load_dwordx4 v16, s[44:47], s68 offen lds
ds_read_b64_tr_b16 a[8:9], v14 offset:10368
v_mfma_f32_32x32x16_bf16 v[64:79], a[28:31], v[192:195], v[64:79]
ds_read_b64_tr_b16 a[10:11], v14 offset:12928
ds_read_b64_tr_b16 a[12:13], v14 offset:10432
ds_read_b64_tr_b16 a[14:15], v14 offset:12992
ds_read_b64_tr_b16 a[16:17], v14 offset:10496
ds_read_b64_tr_b16 a[18:19], v14 offset:13056
v_mfma_f32_32x32x16_bf16 v[80:95], a[32:35], v[192:195], v[80:95]
v_mfma_f32_32x32x16_bf16 v[96:111], a[36:39], v[192:195], v[96:111]
ds_read_b64_tr_b16 a[20:21], v14 offset:15360
ds_read_b64_tr_b16 a[22:23], v14 offset:17920
ds_read_b64_tr_b16 a[24:25], v14 offset:15424
ds_read_b64_tr_b16 a[26:27], v14 offset:17984
ds_read_b64_tr_b16 a[28:29], v14 offset:15488
s_waitcnt lgkmcnt(15)
v_mfma_f32_32x32x16_bf16 v[32:47], a[40:43], v[196:199], v[32:47]
s_add_u32 m0, s67, 89088
s_add_u32 s68, s66, 387072
buffer_load_dwordx4 v16, s[44:47], s68 offen lds
v_mfma_f32_32x32x16_bf16 v[48:63], a[44:47], v[196:199], v[48:63]
ds_read_b64_tr_b16 a[30:31], v14 offset:18048
ds_read_b64_tr_b16 a[32:33], v14 offset:15552
ds_read_b64_tr_b16 a[34:35], v14 offset:18112
ds_read_b64_tr_b16 a[36:37], v14 offset:15616
v_mfma_f32_32x32x16_bf16 v[64:79], a[48:51], v[196:199], v[64:79]
ds_read_b64_tr_b16 a[38:39], v14 offset:18176
v_mfma_f32_32x32x16_bf16 v[80:95], a[52:55], v[196:199], v[80:95]
v_mfma_f32_32x32x16_bf16 v[96:111], a[56:59], v[196:199], v[96:111]
s_waitcnt vmcnt(17)
s_barrier
s_waitcnt lgkmcnt(10)
v_mfma_f32_32x32x16_bf16 v[32:47], a[0:3], v[200:203], v[32:47]
ds_read_b64_tr_b16 a[40:41], v14 offset:20480
s_add_u32 m0, s62, 61440
s_mov_b32 s63, 573440
buffer_load_dwordx4 v4, s[24:27], s63 offen offset:0 lds
v_mfma_f32_32x32x16_bf16 v[48:63], a[4:7], v[200:203], v[48:63]
ds_read_b64_tr_b16 a[42:43], v14 offset:23040
ds_read_b64_tr_b16 a[44:45], v14 offset:20544
ds_read_b64_tr_b16 a[46:47], v14 offset:23104
ds_read_b64_tr_b16 a[48:49], v14 offset:20608
v_mfma_f32_32x32x16_bf16 v[64:79], a[8:11], v[200:203], v[64:79]
s_add_u32 m0, s62, 61440
s_nop 0
buffer_load_dwordx4 v5, s[24:27], s63 offen offset:1024 lds
ds_read_b64_tr_b16 a[50:51], v14 offset:23168
v_mfma_f32_32x32x16_bf16 v[80:95], a[12:15], v[200:203], v[80:95]
s_add_u32 m0, s62, 61440
s_nop 0
buffer_load_dwordx4 v6, s[24:27], s63 offen offset:2048 lds
ds_read_b64_tr_b16 a[52:53], v14 offset:20672
v_mfma_f32_32x32x16_bf16 v[96:111], a[16:19], v[200:203], v[96:111]
s_add_u32 m0, s62, 61440
s_nop 0
buffer_load_dwordx4 v7, s[24:27], s63 offen offset:3072 lds
ds_read_b64_tr_b16 a[54:55], v14 offset:23232
s_waitcnt lgkmcnt(8)
v_mfma_f32_32x32x16_bf16 v[32:47], a[20:23], v[204:207], v[32:47]
ds_read_b64_tr_b16 a[56:57], v14 offset:20736
ds_read_b64_tr_b16 a[58:59], v14 offset:23296
ds_read_b64_tr_b16 a[0:1], v14 offset:25600
ds_read_b64_tr_b16 a[2:3], v14 offset:28160
v_mfma_f32_32x32x16_bf16 v[48:63], a[24:27], v[204:207], v[48:63]
s_add_u32 m0, s62, 65536
s_nop 0
buffer_load_dwordx4 v8, s[24:27], s63 offen lds
ds_read_b64_tr_b16 a[4:5], v14 offset:25664
v_mfma_f32_32x32x16_bf16 v[64:79], a[28:31], v[204:207], v[64:79]
buffer_load_dwordx4 v[184:187], v3, s[28:31], s65 offen offset:2048 sc1
ds_read_b64_tr_b16 a[6:7], v14 offset:28224
v_mfma_f32_32x32x16_bf16 v[80:95], a[32:35], v[204:207], v[80:95]
buffer_load_dwordx4 v[188:191], v3, s[28:31], s65 offen offset:3072 sc1
ds_read_b64_tr_b16 a[8:9], v14 offset:25728
v_mfma_f32_32x32x16_bf16 v[96:111], a[36:39], v[204:207], v[96:111]
s_mov_b32 s64, 49152
buffer_load_dwordx4 v[192:195], v3, s[28:31], s64 offen offset:0 sc1
buffer_load_dwordx4 v[196:199], v3, s[28:31], s64 offen offset:1024 sc1
ds_read_b64_tr_b16 a[10:11], v14 offset:28288
ds_read_b64_tr_b16 a[12:13], v14 offset:25792
ds_read_b64_tr_b16 a[14:15], v14 offset:28352
ds_read_b64_tr_b16 a[16:17], v14 offset:25856
ds_read_b64_tr_b16 a[18:19], v14 offset:28416
s_waitcnt lgkmcnt(10)
v_mfma_f32_32x32x16_bf16 v[32:47], a[40:43], v[208:211], v[32:47]
ds_read_b64_tr_b16 a[20:21], v14 offset:30720
ds_read_b64_tr_b16 a[22:23], v14 offset:33280
ds_read_b64_tr_b16 a[24:25], v14 offset:30784
ds_read_b64_tr_b16 a[26:27], v14 offset:33344
v_mfma_f32_32x32x16_bf16 v[48:63], a[44:47], v[208:211], v[48:63]
s_add_u32 m0, s67, 90112
s_add_u32 s68, s66, 442368
buffer_load_dwordx4 v16, s[44:47], s68 offen lds
ds_read_b64_tr_b16 a[28:29], v14 offset:30848
v_mfma_f32_32x32x16_bf16 v[64:79], a[48:51], v[208:211], v[64:79]
ds_read_b64_tr_b16 a[30:31], v14 offset:33408
ds_read_b64_tr_b16 a[32:33], v14 offset:30912
ds_read_b64_tr_b16 a[34:35], v14 offset:33472
ds_read_b64_tr_b16 a[36:37], v14 offset:30976
ds_read_b64_tr_b16 a[38:39], v14 offset:33536
v_mfma_f32_32x32x16_bf16 v[80:95], a[52:55], v[208:211], v[80:95]
v_mfma_f32_32x32x16_bf16 v[96:111], a[56:59], v[208:211], v[96:111]
ds_read_b64_tr_b16 a[40:41], v14 offset:35840
ds_read_b64_tr_b16 a[42:43], v14 offset:38400
ds_read_b64_tr_b16 a[44:45], v14 offset:35904
ds_read_b64_tr_b16 a[46:47], v14 offset:38464
ds_read_b64_tr_b16 a[48:49], v14 offset:35968
s_waitcnt lgkmcnt(15)
v_mfma_f32_32x32x16_bf16 v[32:47], a[0:3], v[212:215], v[32:47]
s_add_u32 m0, s67, 91136
s_add_u32 s68, s66, 497664
buffer_load_dwordx4 v16, s[44:47], s68 offen lds
v_mfma_f32_32x32x16_bf16 v[48:63], a[4:7], v[212:215], v[48:63]
ds_read_b64_tr_b16 a[50:51], v14 offset:38528
ds_read_b64_tr_b16 a[52:53], v14 offset:36032
ds_read_b64_tr_b16 a[54:55], v14 offset:38592
ds_read_b64_tr_b16 a[56:57], v14 offset:36096
v_mfma_f32_32x32x16_bf16 v[64:79], a[8:11], v[212:215], v[64:79]
ds_read_b64_tr_b16 a[58:59], v14 offset:38656
v_mfma_f32_32x32x16_bf16 v[80:95], a[12:15], v[212:215], v[80:95]
v_mfma_f32_32x32x16_bf16 v[96:111], a[16:19], v[212:215], v[96:111]
s_waitcnt vmcnt(17)
s_barrier
s_waitcnt lgkmcnt(10)
v_mfma_f32_32x32x16_bf16 v[32:47], a[20:23], v[216:219], v[32:47]
ds_read_b64_tr_b16 a[0:1], v15 offset:0
s_add_u32 m0, s62, 0
s_mov_b32 s63, 655360
buffer_load_dwordx4 v4, s[24:27], s63 offen offset:0 lds
v_mfma_f32_32x32x16_bf16 v[48:63], a[24:27], v[216:219], v[48:63]
ds_read_b64_tr_b16 a[2:3], v15 offset:2560
ds_read_b64_tr_b16 a[4:5], v15 offset:64
ds_read_b64_tr_b16 a[6:7], v15 offset:2624
ds_read_b64_tr_b16 a[8:9], v15 offset:128
v_mfma_f32_32x32x16_bf16 v[64:79], a[28:31], v[216:219], v[64:79]
s_add_u32 m0, s62, 0
s_nop 0
buffer_load_dwordx4 v5, s[24:27], s63 offen offset:1024 lds
ds_read_b64_tr_b16 a[10:11], v15 offset:2688
v_mfma_f32_32x32x16_bf16 v[80:95], a[32:35], v[216:219], v[80:95]
s_add_u32 m0, s62, 0
s_nop 0
buffer_load_dwordx4 v6, s[24:27], s63 offen offset:2048 lds
ds_read_b64_tr_b16 a[12:13], v15 offset:192
v_mfma_f32_32x32x16_bf16 v[96:111], a[36:39], v[216:219], v[96:111]
s_add_u32 m0, s62, 0
s_nop 0
buffer_load_dwordx4 v7, s[24:27], s63 offen offset:3072 lds
ds_read_b64_tr_b16 a[14:15], v15 offset:2752
s_waitcnt lgkmcnt(8)
v_mfma_f32_32x32x16_bf16 v[32:47], a[40:43], v[220:223], v[32:47]
ds_read_b64_tr_b16 a[16:17], v15 offset:256
ds_read_b64_tr_b16 a[18:19], v15 offset:2816
ds_read_b64_tr_b16 a[20:21], v15 offset:5120
ds_read_b64_tr_b16 a[22:23], v15 offset:7680
v_mfma_f32_32x32x16_bf16 v[48:63], a[44:47], v[220:223], v[48:63]
s_add_u32 m0, s62, 4096
s_nop 0
buffer_load_dwordx4 v8, s[24:27], s63 offen lds
ds_read_b64_tr_b16 a[24:25], v15 offset:5184
v_mfma_f32_32x32x16_bf16 v[64:79], a[48:51], v[220:223], v[64:79]
buffer_load_dwordx4 v[200:203], v3, s[28:31], s64 offen offset:2048 sc1
ds_read_b64_tr_b16 a[26:27], v15 offset:7744
v_mfma_f32_32x32x16_bf16 v[80:95], a[52:55], v[220:223], v[80:95]
buffer_load_dwordx4 v[204:207], v3, s[28:31], s64 offen offset:3072 sc1
ds_read_b64_tr_b16 a[28:29], v15 offset:5248
v_mfma_f32_32x32x16_bf16 v[96:111], a[56:59], v[220:223], v[96:111]
s_mov_b32 s65, 53248
buffer_load_dwordx4 v[208:211], v3, s[28:31], s65 offen offset:0 sc1
buffer_load_dwordx4 v[212:215], v3, s[28:31], s65 offen offset:1024 sc1
ds_read_b64_tr_b16 a[30:31], v15 offset:7808
ds_read_b64_tr_b16 a[32:33], v15 offset:5312
ds_read_b64_tr_b16 a[34:35], v15 offset:7872
ds_read_b64_tr_b16 a[36:37], v15 offset:5376
ds_read_b64_tr_b16 a[38:39], v15 offset:7936
s_waitcnt lgkmcnt(10)
v_mfma_f32_32x32x16_bf16 v[32:47], a[0:3], v[224:227], v[32:47]
ds_read_b64_tr_b16 a[40:41], v15 offset:10240
ds_read_b64_tr_b16 a[42:43], v15 offset:12800
ds_read_b64_tr_b16 a[44:45], v15 offset:10304
ds_read_b64_tr_b16 a[46:47], v15 offset:12864
v_mfma_f32_32x32x16_bf16 v[48:63], a[4:7], v[224:227], v[48:63]
s_add_u32 m0, s67, 122880
s_add_u32 s68, s66, 0
buffer_load_dwordx4 v16, s[48:51], s68 offen lds
ds_read_b64_tr_b16 a[48:49], v15 offset:10368
v_mfma_f32_32x32x16_bf16 v[64:79], a[8:11], v[224:227], v[64:79]
ds_read_b64_tr_b16 a[50:51], v15 offset:12928
ds_read_b64_tr_b16 a[52:53], v15 offset:10432
ds_read_b64_tr_b16 a[54:55], v15 offset:12992
ds_read_b64_tr_b16 a[56:57], v15 offset:10496
ds_read_b64_tr_b16 a[58:59], v15 offset:13056
v_mfma_f32_32x32x16_bf16 v[80:95], a[12:15], v[224:227], v[80:95]
v_mfma_f32_32x32x16_bf16 v[96:111], a[16:19], v[224:227], v[96:111]
ds_read_b64_tr_b16 a[0:1], v15 offset:15360
ds_read_b64_tr_b16 a[2:3], v15 offset:17920
ds_read_b64_tr_b16 a[4:5], v15 offset:15424
ds_read_b64_tr_b16 a[6:7], v15 offset:17984
ds_read_b64_tr_b16 a[8:9], v15 offset:15488
s_waitcnt lgkmcnt(15)
v_mfma_f32_32x32x16_bf16 v[32:47], a[20:23], v[228:231], v[32:47]
s_add_u32 m0, s67, 123904
s_add_u32 s68, s66, 55296
buffer_load_dwordx4 v16, s[48:51], s68 offen lds
v_mfma_f32_32x32x16_bf16 v[48:63], a[24:27], v[228:231], v[48:63]
ds_read_b64_tr_b16 a[10:11], v15 offset:18048
ds_read_b64_tr_b16 a[12:13], v15 offset:15552
ds_read_b64_tr_b16 a[14:15], v15 offset:18112
ds_read_b64_tr_b16 a[16:17], v15 offset:15616
v_mfma_f32_32x32x16_bf16 v[64:79], a[28:31], v[228:231], v[64:79]
ds_read_b64_tr_b16 a[18:19], v15 offset:18176
v_mfma_f32_32x32x16_bf16 v[80:95], a[32:35], v[228:231], v[80:95]
v_mfma_f32_32x32x16_bf16 v[96:111], a[36:39], v[228:231], v[96:111]
s_waitcnt vmcnt(17)
s_barrier
s_waitcnt lgkmcnt(10)
v_mfma_f32_32x32x16_bf16 v[32:47], a[40:43], v[232:235], v[32:47]
ds_read_b64_tr_b16 a[20:21], v15 offset:20480
s_add_u32 m0, s62, 20480
s_mov_b32 s63, 737280
buffer_load_dwordx4 v4, s[24:27], s63 offen offset:0 lds
v_mfma_f32_32x32x16_bf16 v[48:63], a[44:47], v[232:235], v[48:63]
ds_read_b64_tr_b16 a[22:23], v15 offset:23040
ds_read_b64_tr_b16 a[24:25], v15 offset:20544
ds_read_b64_tr_b16 a[26:27], v15 offset:23104
ds_read_b64_tr_b16 a[28:29], v15 offset:20608
v_mfma_f32_32x32x16_bf16 v[64:79], a[48:51], v[232:235], v[64:79]
s_add_u32 m0, s62, 20480
s_nop 0
buffer_load_dwordx4 v5, s[24:27], s63 offen offset:1024 lds
ds_read_b64_tr_b16 a[30:31], v15 offset:23168
v_mfma_f32_32x32x16_bf16 v[80:95], a[52:55], v[232:235], v[80:95]
s_add_u32 m0, s62, 20480
s_nop 0
buffer_load_dwordx4 v6, s[24:27], s63 offen offset:2048 lds
ds_read_b64_tr_b16 a[32:33], v15 offset:20672
v_mfma_f32_32x32x16_bf16 v[96:111], a[56:59], v[232:235], v[96:111]
s_add_u32 m0, s62, 20480
s_nop 0
buffer_load_dwordx4 v7, s[24:27], s63 offen offset:3072 lds
ds_read_b64_tr_b16 a[34:35], v15 offset:23232
s_waitcnt lgkmcnt(8)
v_mfma_f32_32x32x16_bf16 v[32:47], a[0:3], v[236:239], v[32:47]
ds_read_b64_tr_b16 a[36:37], v15 offset:20736
ds_read_b64_tr_b16 a[38:39], v15 offset:23296
ds_read_b64_tr_b16 a[40:41], v15 offset:25600
ds_read_b64_tr_b16 a[42:43], v15 offset:28160
v_mfma_f32_32x32x16_bf16 v[48:63], a[4:7], v[236:239], v[48:63]
s_add_u32 m0, s62, 24576
s_nop 0
buffer_load_dwordx4 v8, s[24:27], s63 offen lds
ds_read_b64_tr_b16 a[44:45], v15 offset:25664
v_mfma_f32_32x32x16_bf16 v[64:79], a[8:11], v[236:239], v[64:79]
buffer_load_dwordx4 v[216:219], v3, s[28:31], s65 offen offset:2048 sc1
ds_read_b64_tr_b16 a[46:47], v15 offset:28224
v_mfma_f32_32x32x16_bf16 v[80:95], a[12:15], v[236:239], v[80:95]
buffer_load_dwordx4 v[220:223], v3, s[28:31], s65 offen offset:3072 sc1
ds_read_b64_tr_b16 a[48:49], v15 offset:25728
v_mfma_f32_32x32x16_bf16 v[96:111], a[16:19], v[236:239], v[96:111]
s_mov_b32 s64, 57344
buffer_load_dwordx4 v[224:227], v3, s[28:31], s64 offen offset:0 sc1
buffer_load_dwordx4 v[228:231], v3, s[28:31], s64 offen offset:1024 sc1
ds_read_b64_tr_b16 a[50:51], v15 offset:28288
ds_read_b64_tr_b16 a[52:53], v15 offset:25792
ds_read_b64_tr_b16 a[54:55], v15 offset:28352
ds_read_b64_tr_b16 a[56:57], v15 offset:25856
ds_read_b64_tr_b16 a[58:59], v15 offset:28416
s_waitcnt lgkmcnt(10)
v_mfma_f32_32x32x16_bf16 v[32:47], a[20:23], v[240:243], v[32:47]
ds_read_b64_tr_b16 a[0:1], v15 offset:30720
ds_read_b64_tr_b16 a[2:3], v15 offset:33280
ds_read_b64_tr_b16 a[4:5], v15 offset:30784
ds_read_b64_tr_b16 a[6:7], v15 offset:33344
v_mfma_f32_32x32x16_bf16 v[48:63], a[24:27], v[240:243], v[48:63]
s_add_u32 m0, s67, 124928
s_add_u32 s68, s66, 110592
buffer_load_dwordx4 v16, s[48:51], s68 offen lds
ds_read_b64_tr_b16 a[8:9], v15 offset:30848
v_mfma_f32_32x32x16_bf16 v[64:79], a[28:31], v[240:243], v[64:79]
ds_read_b64_tr_b16 a[10:11], v15 offset:33408
ds_read_b64_tr_b16 a[12:13], v15 offset:30912
ds_read_b64_tr_b16 a[14:15], v15 offset:33472
ds_read_b64_tr_b16 a[16:17], v15 offset:30976
ds_read_b64_tr_b16 a[18:19], v15 offset:33536
v_mfma_f32_32x32x16_bf16 v[80:95], a[32:35], v[240:243], v[80:95]
v_mfma_f32_32x32x16_bf16 v[96:111], a[36:39], v[240:243], v[96:111]
ds_read_b64_tr_b16 a[20:21], v15 offset:35840
ds_read_b64_tr_b16 a[22:23], v15 offset:38400
ds_read_b64_tr_b16 a[24:25], v15 offset:35904
ds_read_b64_tr_b16 a[26:27], v15 offset:38464
ds_read_b64_tr_b16 a[28:29], v15 offset:35968
s_waitcnt lgkmcnt(15)
v_mfma_f32_32x32x16_bf16 v[32:47], a[40:43], v[244:247], v[32:47]
s_add_u32 m0, s67, 125952
s_add_u32 s68, s66, 165888
buffer_load_dwordx4 v16, s[48:51], s68 offen lds
v_mfma_f32_32x32x16_bf16 v[48:63], a[44:47], v[244:247], v[48:63]
ds_read_b64_tr_b16 a[30:31], v15 offset:38528
ds_read_b64_tr_b16 a[32:33], v15 offset:36032
ds_read_b64_tr_b16 a[34:35], v15 offset:38592
ds_read_b64_tr_b16 a[36:37], v15 offset:36096
v_mfma_f32_32x32x16_bf16 v[64:79], a[48:51], v[244:247], v[64:79]
ds_read_b64_tr_b16 a[38:39], v15 offset:38656
v_mfma_f32_32x32x16_bf16 v[80:95], a[52:55], v[244:247], v[80:95]
v_mfma_f32_32x32x16_bf16 v[96:111], a[56:59], v[244:247], v[96:111]
s_waitcnt vmcnt(17)
s_barrier
s_waitcnt lgkmcnt(10)
v_mfma_f32_32x32x16_bf16 v[32:47], a[0:3], v[248:251], v[32:47]
ds_read_b64_tr_b16 a[40:41], v14 offset:0
s_add_u32 m0, s62, 40960
s_mov_b32 s63, 819200
buffer_load_dwordx4 v4, s[24:27], s63 offen offset:0 lds
v_mfma_f32_32x32x16_bf16 v[48:63], a[4:7], v[248:251], v[48:63]
ds_read_b64_tr_b16 a[42:43], v14 offset:2560
ds_read_b64_tr_b16 a[44:45], v14 offset:64
ds_read_b64_tr_b16 a[46:47], v14 offset:2624
ds_read_b64_tr_b16 a[48:49], v14 offset:128
v_mfma_f32_32x32x16_bf16 v[64:79], a[8:11], v[248:251], v[64:79]
s_add_u32 m0, s62, 40960
s_nop 0
buffer_load_dwordx4 v5, s[24:27], s63 offen offset:1024 lds
ds_read_b64_tr_b16 a[50:51], v14 offset:2688
v_mfma_f32_32x32x16_bf16 v[80:95], a[12:15], v[248:251], v[80:95]
s_add_u32 m0, s62, 40960
s_nop 0
buffer_load_dwordx4 v6, s[24:27], s63 offen offset:2048 lds
ds_read_b64_tr_b16 a[52:53], v14 offset:192
v_mfma_f32_32x32x16_bf16 v[96:111], a[16:19], v[248:251], v[96:111]
s_add_u32 m0, s62, 40960
s_nop 0
buffer_load_dwordx4 v7, s[24:27], s63 offen offset:3072 lds
ds_read_b64_tr_b16 a[54:55], v14 offset:2752
s_waitcnt lgkmcnt(8)
v_mfma_f32_32x32x16_bf16 v[32:47], a[20:23], v[252:255], v[32:47]
ds_read_b64_tr_b16 a[56:57], v14 offset:256
ds_read_b64_tr_b16 a[58:59], v14 offset:2816
ds_read_b64_tr_b16 a[0:1], v14 offset:5120
ds_read_b64_tr_b16 a[2:3], v14 offset:7680
v_mfma_f32_32x32x16_bf16 v[48:63], a[24:27], v[252:255], v[48:63]
s_add_u32 m0, s62, 45056
s_nop 0
buffer_load_dwordx4 v8, s[24:27], s63 offen lds
ds_read_b64_tr_b16 a[4:5], v14 offset:5184
v_mfma_f32_32x32x16_bf16 v[64:79], a[28:31], v[252:255], v[64:79]
buffer_load_dwordx4 v[232:235], v3, s[28:31], s64 offen offset:2048 sc1
ds_read_b64_tr_b16 a[6:7], v14 offset:7744
v_mfma_f32_32x32x16_bf16 v[80:95], a[32:35], v[252:255], v[80:95]
buffer_load_dwordx4 v[236:239], v3, s[28:31], s64 offen offset:3072 sc1
ds_read_b64_tr_b16 a[8:9], v14 offset:5248
v_mfma_f32_32x32x16_bf16 v[96:111], a[36:39], v[252:255], v[96:111]
s_mov_b32 s65, 61440
buffer_load_dwordx4 v[240:243], v3, s[28:31], s65 offen offset:0 sc1
buffer_load_dwordx4 v[244:247], v3, s[28:31], s65 offen offset:1024 sc1
ds_read_b64_tr_b16 a[10:11], v14 offset:7808
ds_read_b64_tr_b16 a[12:13], v14 offset:5312
ds_read_b64_tr_b16 a[14:15], v14 offset:7872
ds_read_b64_tr_b16 a[16:17], v14 offset:5376
ds_read_b64_tr_b16 a[18:19], v14 offset:7936
s_waitcnt lgkmcnt(10)
v_mfma_f32_32x32x16_bf16 v[32:47], a[40:43], v[128:131], v[32:47]
ds_read_b64_tr_b16 a[20:21], v14 offset:10240
ds_read_b64_tr_b16 a[22:23], v14 offset:12800
ds_read_b64_tr_b16 a[24:25], v14 offset:10304
ds_read_b64_tr_b16 a[26:27], v14 offset:12864
v_mfma_f32_32x32x16_bf16 v[48:63], a[44:47], v[128:131], v[48:63]
s_add_u32 m0, s67, 126976
s_add_u32 s68, s66, 221184
buffer_load_dwordx4 v16, s[48:51], s68 offen lds
ds_read_b64_tr_b16 a[28:29], v14 offset:10368
v_mfma_f32_32x32x16_bf16 v[64:79], a[48:51], v[128:131], v[64:79]
ds_read_b64_tr_b16 a[30:31], v14 offset:12928
ds_read_b64_tr_b16 a[32:33], v14 offset:10432
ds_read_b64_tr_b16 a[34:35], v14 offset:12992
ds_read_b64_tr_b16 a[36:37], v14 offset:10496
ds_read_b64_tr_b16 a[38:39], v14 offset:13056
v_mfma_f32_32x32x16_bf16 v[80:95], a[52:55], v[128:131], v[80:95]
v_mfma_f32_32x32x16_bf16 v[96:111], a[56:59], v[128:131], v[96:111]
ds_read_b64_tr_b16 a[40:41], v14 offset:15360
ds_read_b64_tr_b16 a[42:43], v14 offset:17920
ds_read_b64_tr_b16 a[44:45], v14 offset:15424
ds_read_b64_tr_b16 a[46:47], v14 offset:17984
ds_read_b64_tr_b16 a[48:49], v14 offset:15488
s_waitcnt lgkmcnt(15)
v_mfma_f32_32x32x16_bf16 v[32:47], a[0:3], v[132:135], v[32:47]
s_add_u32 m0, s67, 128000
s_add_u32 s68, s66, 276480
buffer_load_dwordx4 v16, s[48:51], s68 offen lds
v_mfma_f32_32x32x16_bf16 v[48:63], a[4:7], v[132:135], v[48:63]
ds_read_b64_tr_b16 a[50:51], v14 offset:18048
ds_read_b64_tr_b16 a[52:53], v14 offset:15552
ds_read_b64_tr_b16 a[54:55], v14 offset:18112
ds_read_b64_tr_b16 a[56:57], v14 offset:15616
v_mfma_f32_32x32x16_bf16 v[64:79], a[8:11], v[132:135], v[64:79]
ds_read_b64_tr_b16 a[58:59], v14 offset:18176
v_mfma_f32_32x32x16_bf16 v[80:95], a[12:15], v[132:135], v[80:95]
v_mfma_f32_32x32x16_bf16 v[96:111], a[16:19], v[132:135], v[96:111]
s_waitcnt vmcnt(17)
s_barrier
s_waitcnt lgkmcnt(10)
v_mfma_f32_32x32x16_bf16 v[32:47], a[20:23], v[136:139], v[32:47]
ds_read_b64_tr_b16 a[0:1], v14 offset:20480
s_add_u32 m0, s62, 61440
s_mov_b32 s63, 901120
buffer_load_dwordx4 v4, s[24:27], s63 offen offset:0 lds
v_mfma_f32_32x32x16_bf16 v[48:63], a[24:27], v[136:139], v[48:63]
ds_read_b64_tr_b16 a[2:3], v14 offset:23040
ds_read_b64_tr_b16 a[4:5], v14 offset:20544
ds_read_b64_tr_b16 a[6:7], v14 offset:23104
ds_read_b64_tr_b16 a[8:9], v14 offset:20608
v_mfma_f32_32x32x16_bf16 v[64:79], a[28:31], v[136:139], v[64:79]
s_add_u32 m0, s62, 61440
s_nop 0
buffer_load_dwordx4 v5, s[24:27], s63 offen offset:1024 lds
ds_read_b64_tr_b16 a[10:11], v14 offset:23168
v_mfma_f32_32x32x16_bf16 v[80:95], a[32:35], v[136:139], v[80:95]
s_add_u32 m0, s62, 61440
s_nop 0
buffer_load_dwordx4 v6, s[24:27], s63 offen offset:2048 lds
ds_read_b64_tr_b16 a[12:13], v14 offset:20672
v_mfma_f32_32x32x16_bf16 v[96:111], a[36:39], v[136:139], v[96:111]
s_add_u32 m0, s62, 61440
s_nop 0
buffer_load_dwordx4 v7, s[24:27], s63 offen offset:3072 lds
ds_read_b64_tr_b16 a[14:15], v14 offset:23232
s_waitcnt lgkmcnt(8)
v_mfma_f32_32x32x16_bf16 v[32:47], a[40:43], v[140:143], v[32:47]
ds_read_b64_tr_b16 a[16:17], v14 offset:20736
ds_read_b64_tr_b16 a[18:19], v14 offset:23296
ds_read_b64_tr_b16 a[20:21], v14 offset:25600
ds_read_b64_tr_b16 a[22:23], v14 offset:28160
v_mfma_f32_32x32x16_bf16 v[48:63], a[44:47], v[140:143], v[48:63]
s_add_u32 m0, s62, 65536
s_nop 0
buffer_load_dwordx4 v8, s[24:27], s63 offen lds
ds_read_b64_tr_b16 a[24:25], v14 offset:25664
v_mfma_f32_32x32x16_bf16 v[64:79], a[48:51], v[140:143], v[64:79]
buffer_load_dwordx4 v[248:251], v3, s[28:31], s65 offen offset:2048 sc1
ds_read_b64_tr_b16 a[26:27], v14 offset:28224
v_mfma_f32_32x32x16_bf16 v[80:95], a[52:55], v[140:143], v[80:95]
buffer_load_dwordx4 v[252:255], v3, s[28:31], s65 offen offset:3072 sc1
ds_read_b64_tr_b16 a[28:29], v14 offset:25728
v_mfma_f32_32x32x16_bf16 v[96:111], a[56:59], v[140:143], v[96:111]
ds_read_b64_tr_b16 a[30:31], v14 offset:28288
ds_read_b64_tr_b16 a[32:33], v14 offset:25792
ds_read_b64_tr_b16 a[34:35], v14 offset:28352
ds_read_b64_tr_b16 a[36:37], v14 offset:25856
ds_read_b64_tr_b16 a[38:39], v14 offset:28416
s_waitcnt lgkmcnt(10)
v_mfma_f32_32x32x16_bf16 v[32:47], a[0:3], v[144:147], v[32:47]
ds_read_b64_tr_b16 a[40:41], v14 offset:30720
ds_read_b64_tr_b16 a[42:43], v14 offset:33280
ds_read_b64_tr_b16 a[44:45], v14 offset:30784
ds_read_b64_tr_b16 a[46:47], v14 offset:33344
v_mfma_f32_32x32x16_bf16 v[48:63], a[4:7], v[144:147], v[48:63]
s_add_u32 m0, s67, 129024
s_add_u32 s68, s66, 331776
buffer_load_dwordx4 v16, s[48:51], s68 offen lds
ds_read_b64_tr_b16 a[48:49], v14 offset:30848
v_mfma_f32_32x32x16_bf16 v[64:79], a[8:11], v[144:147], v[64:79]
ds_read_b64_tr_b16 a[50:51], v14 offset:33408
ds_read_b64_tr_b16 a[52:53], v14 offset:30912
ds_read_b64_tr_b16 a[54:55], v14 offset:33472
ds_read_b64_tr_b16 a[56:57], v14 offset:30976
ds_read_b64_tr_b16 a[58:59], v14 offset:33536
v_mfma_f32_32x32x16_bf16 v[80:95], a[12:15], v[144:147], v[80:95]
v_mfma_f32_32x32x16_bf16 v[96:111], a[16:19], v[144:147], v[96:111]
ds_read_b64_tr_b16 a[0:1], v14 offset:35840
ds_read_b64_tr_b16 a[2:3], v14 offset:38400
ds_read_b64_tr_b16 a[4:5], v14 offset:35904
ds_read_b64_tr_b16 a[6:7], v14 offset:38464
ds_read_b64_tr_b16 a[8:9], v14 offset:35968
s_waitcnt lgkmcnt(15)
v_mfma_f32_32x32x16_bf16 v[32:47], a[20:23], v[148:151], v[32:47]
s_add_u32 m0, s67, 130048
s_add_u32 s68, s66, 387072
buffer_load_dwordx4 v16, s[48:51], s68 offen lds
v_mfma_f32_32x32x16_bf16 v[48:63], a[24:27], v[148:151], v[48:63]
ds_read_b64_tr_b16 a[10:11], v14 offset:38528
ds_read_b64_tr_b16 a[12:13], v14 offset:36032
ds_read_b64_tr_b16 a[14:15], v14 offset:38592
ds_read_b64_tr_b16 a[16:17], v14 offset:36096
v_mfma_f32_32x32x16_bf16 v[64:79], a[28:31], v[148:151], v[64:79]
ds_read_b64_tr_b16 a[18:19], v14 offset:38656
v_mfma_f32_32x32x16_bf16 v[80:95], a[32:35], v[148:151], v[80:95]
v_mfma_f32_32x32x16_bf16 v[96:111], a[36:39], v[148:151], v[96:111]
s_waitcnt vmcnt(15)
s_barrier
s_waitcnt lgkmcnt(10)
v_mfma_f32_32x32x16_bf16 v[32:47], a[40:43], v[152:155], v[32:47]
ds_read_b64_tr_b16 a[20:21], v15 offset:0
s_add_u32 m0, s62, 0
s_mov_b32 s63, 983040
buffer_load_dwordx4 v4, s[24:27], s63 offen offset:0 lds
v_mfma_f32_32x32x16_bf16 v[48:63], a[44:47], v[152:155], v[48:63]
ds_read_b64_tr_b16 a[22:23], v15 offset:2560
ds_read_b64_tr_b16 a[24:25], v15 offset:64
ds_read_b64_tr_b16 a[26:27], v15 offset:2624
ds_read_b64_tr_b16 a[28:29], v15 offset:128
v_mfma_f32_32x32x16_bf16 v[64:79], a[48:51], v[152:155], v[64:79]
s_add_u32 m0, s62, 0
s_nop 0
buffer_load_dwordx4 v5, s[24:27], s63 offen offset:1024 lds
ds_read_b64_tr_b16 a[30:31], v15 offset:2688
v_mfma_f32_32x32x16_bf16 v[80:95], a[52:55], v[152:155], v[80:95]
s_add_u32 m0, s62, 0
s_nop 0
buffer_load_dwordx4 v6, s[24:27], s63 offen offset:2048 lds
ds_read_b64_tr_b16 a[32:33], v15 offset:192
v_mfma_f32_32x32x16_bf16 v[96:111], a[56:59], v[152:155], v[96:111]
s_add_u32 m0, s62, 0
s_nop 0
buffer_load_dwordx4 v7, s[24:27], s63 offen offset:3072 lds
ds_read_b64_tr_b16 a[34:35], v15 offset:2752
s_waitcnt lgkmcnt(8)
v_mfma_f32_32x32x16_bf16 v[32:47], a[0:3], v[156:159], v[32:47]
ds_read_b64_tr_b16 a[36:37], v15 offset:256
ds_read_b64_tr_b16 a[38:39], v15 offset:2816
ds_read_b64_tr_b16 a[40:41], v15 offset:5120
ds_read_b64_tr_b16 a[42:43], v15 offset:7680
v_mfma_f32_32x32x16_bf16 v[48:63], a[4:7], v[156:159], v[48:63]
s_add_u32 m0, s62, 4096
s_nop 0
buffer_load_dwordx4 v8, s[24:27], s63 offen lds
ds_read_b64_tr_b16 a[44:45], v15 offset:5184
v_mfma_f32_32x32x16_bf16 v[64:79], a[8:11], v[156:159], v[64:79]
ds_read_b64_tr_b16 a[46:47], v15 offset:7744
ds_read_b64_tr_b16 a[48:49], v15 offset:5248
ds_read_b64_tr_b16 a[50:51], v15 offset:7808
ds_read_b64_tr_b16 a[52:53], v15 offset:5312
ds_read_b64_tr_b16 a[54:55], v15 offset:7872
v_mfma_f32_32x32x16_bf16 v[80:95], a[12:15], v[156:159], v[80:95]
ds_read_b64_tr_b16 a[56:57], v15 offset:5376
ds_read_b64_tr_b16 a[58:59], v15 offset:7936
v_mfma_f32_32x32x16_bf16 v[96:111], a[16:19], v[156:159], v[96:111]
s_waitcnt lgkmcnt(10)
v_mfma_f32_32x32x16_bf16 v[32:47], a[20:23], v[160:163], v[32:47]
ds_read_b64_tr_b16 a[0:1], v15 offset:10240
ds_read_b64_tr_b16 a[2:3], v15 offset:12800
ds_read_b64_tr_b16 a[4:5], v15 offset:10304
ds_read_b64_tr_b16 a[6:7], v15 offset:12864
v_mfma_f32_32x32x16_bf16 v[48:63], a[24:27], v[160:163], v[48:63]
s_add_u32 m0, s67, 131072
s_add_u32 s68, s66, 442368
buffer_load_dwordx4 v16, s[48:51], s68 offen lds
ds_read_b64_tr_b16 a[8:9], v15 offset:10368
v_mfma_f32_32x32x16_bf16 v[64:79], a[28:31], v[160:163], v[64:79]
ds_read_b64_tr_b16 a[10:11], v15 offset:12928
ds_read_b64_tr_b16 a[12:13], v15 offset:10432
ds_read_b64_tr_b16 a[14:15], v15 offset:12992
ds_read_b64_tr_b16 a[16:17], v15 offset:10496
ds_read_b64_tr_b16 a[18:19], v15 offset:13056
v_mfma_f32_32x32x16_bf16 v[80:95], a[32:35], v[160:163], v[80:95]
v_mfma_f32_32x32x16_bf16 v[96:111], a[36:39], v[160:163], v[96:111]
ds_read_b64_tr_b16 a[20:21], v15 offset:15360
ds_read_b64_tr_b16 a[22:23], v15 offset:17920
ds_read_b64_tr_b16 a[24:25], v15 offset:15424
ds_read_b64_tr_b16 a[26:27], v15 offset:17984
ds_read_b64_tr_b16 a[28:29], v15 offset:15488
s_waitcnt lgkmcnt(15)
v_mfma_f32_32x32x16_bf16 v[32:47], a[40:43], v[164:167], v[32:47]
s_add_u32 m0, s67, 132096
s_add_u32 s68, s66, 497664
buffer_load_dwordx4 v16, s[48:51], s68 offen lds
v_mfma_f32_32x32x16_bf16 v[48:63], a[44:47], v[164:167], v[48:63]
ds_read_b64_tr_b16 a[30:31], v15 offset:18048
ds_read_b64_tr_b16 a[32:33], v15 offset:15552
ds_read_b64_tr_b16 a[34:35], v15 offset:18112
ds_read_b64_tr_b16 a[36:37], v15 offset:15616
v_mfma_f32_32x32x16_bf16 v[64:79], a[48:51], v[164:167], v[64:79]
ds_read_b64_tr_b16 a[38:39], v15 offset:18176
v_mfma_f32_32x32x16_bf16 v[80:95], a[52:55], v[164:167], v[80:95]
v_mfma_f32_32x32x16_bf16 v[96:111], a[56:59], v[164:167], v[96:111]
s_waitcnt vmcnt(11)
s_barrier
s_waitcnt lgkmcnt(10)
v_mfma_f32_32x32x16_bf16 v[32:47], a[0:3], v[168:171], v[32:47]
ds_read_b64_tr_b16 a[40:41], v15 offset:20480
s_add_u32 m0, s62, 20480
s_mov_b32 s63, 1064960
buffer_load_dwordx4 v4, s[24:27], s63 offen offset:0 lds
v_mfma_f32_32x32x16_bf16 v[48:63], a[4:7], v[168:171], v[48:63]
ds_read_b64_tr_b16 a[42:43], v15 offset:23040
ds_read_b64_tr_b16 a[44:45], v15 offset:20544
ds_read_b64_tr_b16 a[46:47], v15 offset:23104
ds_read_b64_tr_b16 a[48:49], v15 offset:20608
v_mfma_f32_32x32x16_bf16 v[64:79], a[8:11], v[168:171], v[64:79]
s_add_u32 m0, s62, 20480
s_nop 0
buffer_load_dwordx4 v5, s[24:27], s63 offen offset:1024 lds
ds_read_b64_tr_b16 a[50:51], v15 offset:23168
v_mfma_f32_32x32x16_bf16 v[80:95], a[12:15], v[168:171], v[80:95]
s_add_u32 m0, s62, 20480
s_nop 0
buffer_load_dwordx4 v6, s[24:27], s63 offen offset:2048 lds
ds_read_b64_tr_b16 a[52:53], v15 offset:20672
v_mfma_f32_32x32x16_bf16 v[96:111], a[16:19], v[168:171], v[96:111]
s_add_u32 m0, s62, 20480
s_nop 0
buffer_load_dwordx4 v7, s[24:27], s63 offen offset:3072 lds
ds_read_b64_tr_b16 a[54:55], v15 offset:23232
s_waitcnt lgkmcnt(8)
v_mfma_f32_32x32x16_bf16 v[32:47], a[20:23], v[172:175], v[32:47]
ds_read_b64_tr_b16 a[56:57], v15 offset:20736
ds_read_b64_tr_b16 a[58:59], v15 offset:23296
ds_read_b64_tr_b16 a[0:1], v15 offset:25600
ds_read_b64_tr_b16 a[2:3], v15 offset:28160
v_mfma_f32_32x32x16_bf16 v[48:63], a[24:27], v[172:175], v[48:63]
s_add_u32 m0, s62, 24576
s_nop 0
buffer_load_dwordx4 v8, s[24:27], s63 offen lds
ds_read_b64_tr_b16 a[4:5], v15 offset:25664
v_mfma_f32_32x32x16_bf16 v[64:79], a[28:31], v[172:175], v[64:79]
ds_read_b64_tr_b16 a[6:7], v15 offset:28224
ds_read_b64_tr_b16 a[8:9], v15 offset:25728
ds_read_b64_tr_b16 a[10:11], v15 offset:28288
ds_read_b64_tr_b16 a[12:13], v15 offset:25792
ds_read_b64_tr_b16 a[14:15], v15 offset:28352
v_mfma_f32_32x32x16_bf16 v[80:95], a[32:35], v[172:175], v[80:95]
ds_read_b64_tr_b16 a[16:17], v15 offset:25856
ds_read_b64_tr_b16 a[18:19], v15 offset:28416
v_mfma_f32_32x32x16_bf16 v[96:111], a[36:39], v[172:175], v[96:111]
s_waitcnt lgkmcnt(10)
v_mfma_f32_32x32x16_bf16 v[32:47], a[40:43], v[176:179], v[32:47]
ds_read_b64_tr_b16 a[20:21], v15 offset:30720
ds_read_b64_tr_b16 a[22:23], v15 offset:33280
ds_read_b64_tr_b16 a[24:25], v15 offset:30784
ds_read_b64_tr_b16 a[26:27], v15 offset:33344
v_mfma_f32_32x32x16_bf16 v[48:63], a[44:47], v[176:179], v[48:63]
ds_read_b64_tr_b16 a[28:29], v15 offset:30848
ds_read_b64_tr_b16 a[30:31], v15 offset:33408
ds_read_b64_tr_b16 a[32:33], v15 offset:30912
ds_read_b64_tr_b16 a[34:35], v15 offset:33472
ds_read_b64_tr_b16 a[36:37], v15 offset:30976
v_mfma_f32_32x32x16_bf16 v[64:79], a[48:51], v[176:179], v[64:79]
ds_read_b64_tr_b16 a[38:39], v15 offset:33536
v_mfma_f32_32x32x16_bf16 v[80:95], a[52:55], v[176:179], v[80:95]
v_mfma_f32_32x32x16_bf16 v[96:111], a[56:59], v[176:179], v[96:111]
ds_read_b64_tr_b16 a[40:41], v15 offset:35840
ds_read_b64_tr_b16 a[42:43], v15 offset:38400
ds_read_b64_tr_b16 a[44:45], v15 offset:35904
ds_read_b64_tr_b16 a[46:47], v15 offset:38464
ds_read_b64_tr_b16 a[48:49], v15 offset:35968
s_waitcnt lgkmcnt(15)
v_mfma_f32_32x32x16_bf16 v[32:47], a[0:3], v[180:183], v[32:47]
ds_read_b64_tr_b16 a[50:51], v15 offset:38528
ds_read_b64_tr_b16 a[52:53], v15 offset:36032
v_mfma_f32_32x32x16_bf16 v[48:63], a[4:7], v[180:183], v[48:63]
ds_read_b64_tr_b16 a[54:55], v15 offset:38592
ds_read_b64_tr_b16 a[56:57], v15 offset:36096
v_mfma_f32_32x32x16_bf16 v[64:79], a[8:11], v[180:183], v[64:79]
ds_read_b64_tr_b16 a[58:59], v15 offset:38656
v_mfma_f32_32x32x16_bf16 v[80:95], a[12:15], v[180:183], v[80:95]
v_mfma_f32_32x32x16_bf16 v[96:111], a[16:19], v[180:183], v[96:111]
s_waitcnt vmcnt(7)
s_barrier
s_waitcnt lgkmcnt(10)
v_mfma_f32_32x32x16_bf16 v[32:47], a[20:23], v[184:187], v[32:47]
ds_read_b64_tr_b16 a[0:1], v14 offset:0
s_add_u32 m0, s62, 40960
s_mov_b32 s63, 1146880
buffer_load_dwordx4 v4, s[24:27], s63 offen offset:0 lds
v_mfma_f32_32x32x16_bf16 v[48:63], a[24:27], v[184:187], v[48:63]
ds_read_b64_tr_b16 a[2:3], v14 offset:2560
ds_read_b64_tr_b16 a[4:5], v14 offset:64
ds_read_b64_tr_b16 a[6:7], v14 offset:2624
ds_read_b64_tr_b16 a[8:9], v14 offset:128
v_mfma_f32_32x32x16_bf16 v[64:79], a[28:31], v[184:187], v[64:79]
s_add_u32 m0, s62, 40960
s_nop 0
buffer_load_dwordx4 v5, s[24:27], s63 offen offset:1024 lds
ds_read_b64_tr_b16 a[10:11], v14 offset:2688
v_mfma_f32_32x32x16_bf16 v[80:95], a[32:35], v[184:187], v[80:95]
s_add_u32 m0, s62, 40960
s_nop 0
buffer_load_dwordx4 v6, s[24:27], s63 offen offset:2048 lds
ds_read_b64_tr_b16 a[12:13], v14 offset:192
v_mfma_f32_32x32x16_bf16 v[96:111], a[36:39], v[184:187], v[96:111]
s_add_u32 m0, s62, 40960
s_nop 0
buffer_load_dwordx4 v7, s[24:27], s63 offen offset:3072 lds
ds_read_b64_tr_b16 a[14:15], v14 offset:2752
s_waitcnt lgkmcnt(8)
v_mfma_f32_32x32x16_bf16 v[32:47], a[40:43], v[188:191], v[32:47]
ds_read_b64_tr_b16 a[16:17], v14 offset:256
ds_read_b64_tr_b16 a[18:19], v14 offset:2816
ds_read_b64_tr_b16 a[20:21], v14 offset:5120
ds_read_b64_tr_b16 a[22:23], v14 offset:7680
v_mfma_f32_32x32x16_bf16 v[48:63], a[44:47], v[188:191], v[48:63]
s_add_u32 m0, s62, 45056
s_nop 0
buffer_load_dwordx4 v8, s[24:27], s63 offen lds
ds_read_b64_tr_b16 a[24:25], v14 offset:5184
v_mfma_f32_32x32x16_bf16 v[64:79], a[48:51], v[188:191], v[64:79]
ds_read_b64_tr_b16 a[26:27], v14 offset:7744
ds_read_b64_tr_b16 a[28:29], v14 offset:5248
ds_read_b64_tr_b16 a[30:31], v14 offset:7808
ds_read_b64_tr_b16 a[32:33], v14 offset:5312
ds_read_b64_tr_b16 a[34:35], v14 offset:7872
v_mfma_f32_32x32x16_bf16 v[80:95], a[52:55], v[188:191], v[80:95]
ds_read_b64_tr_b16 a[36:37], v14 offset:5376
ds_read_b64_tr_b16 a[38:39], v14 offset:7936
v_mfma_f32_32x32x16_bf16 v[96:111], a[56:59], v[188:191], v[96:111]
s_waitcnt lgkmcnt(10)
v_mfma_f32_32x32x16_bf16 v[32:47], a[0:3], v[192:195], v[32:47]
ds_read_b64_tr_b16 a[40:41], v14 offset:10240
ds_read_b64_tr_b16 a[42:43], v14 offset:12800
ds_read_b64_tr_b16 a[44:45], v14 offset:10304
ds_read_b64_tr_b16 a[46:47], v14 offset:12864
v_mfma_f32_32x32x16_bf16 v[48:63], a[4:7], v[192:195], v[48:63]
ds_read_b64_tr_b16 a[48:49], v14 offset:10368
ds_read_b64_tr_b16 a[50:51], v14 offset:12928
ds_read_b64_tr_b16 a[52:53], v14 offset:10432
ds_read_b64_tr_b16 a[54:55], v14 offset:12992
ds_read_b64_tr_b16 a[56:57], v14 offset:10496
v_mfma_f32_32x32x16_bf16 v[64:79], a[8:11], v[192:195], v[64:79]
ds_read_b64_tr_b16 a[58:59], v14 offset:13056
v_mfma_f32_32x32x16_bf16 v[80:95], a[12:15], v[192:195], v[80:95]
v_mfma_f32_32x32x16_bf16 v[96:111], a[16:19], v[192:195], v[96:111]
ds_read_b64_tr_b16 a[0:1], v14 offset:15360
ds_read_b64_tr_b16 a[2:3], v14 offset:17920
ds_read_b64_tr_b16 a[4:5], v14 offset:15424
ds_read_b64_tr_b16 a[6:7], v14 offset:17984
ds_read_b64_tr_b16 a[8:9], v14 offset:15488
s_waitcnt lgkmcnt(15)
v_mfma_f32_32x32x16_bf16 v[32:47], a[20:23], v[196:199], v[32:47]
ds_read_b64_tr_b16 a[10:11], v14 offset:18048
ds_read_b64_tr_b16 a[12:13], v14 offset:15552
v_mfma_f32_32x32x16_bf16 v[48:63], a[24:27], v[196:199], v[48:63]
ds_read_b64_tr_b16 a[14:15], v14 offset:18112
ds_read_b64_tr_b16 a[16:17], v14 offset:15616
v_mfma_f32_32x32x16_bf16 v[64:79], a[28:31], v[196:199], v[64:79]
ds_read_b64_tr_b16 a[18:19], v14 offset:18176
v_mfma_f32_32x32x16_bf16 v[80:95], a[32:35], v[196:199], v[80:95]
v_mfma_f32_32x32x16_bf16 v[96:111], a[36:39], v[196:199], v[96:111]
s_waitcnt vmcnt(5)
s_barrier
s_waitcnt lgkmcnt(10)
v_mfma_f32_32x32x16_bf16 v[32:47], a[40:43], v[200:203], v[32:47]
ds_read_b64_tr_b16 a[20:21], v14 offset:20480
s_add_u32 m0, s62, 61440
s_mov_b32 s63, 1228800
buffer_load_dwordx4 v4, s[24:27], s63 offen offset:0 lds
v_mfma_f32_32x32x16_bf16 v[48:63], a[44:47], v[200:203], v[48:63]
ds_read_b64_tr_b16 a[22:23], v14 offset:23040
ds_read_b64_tr_b16 a[24:25], v14 offset:20544
ds_read_b64_tr_b16 a[26:27], v14 offset:23104
ds_read_b64_tr_b16 a[28:29], v14 offset:20608
v_mfma_f32_32x32x16_bf16 v[64:79], a[48:51], v[200:203], v[64:79]
s_add_u32 m0, s62, 61440
s_nop 0
buffer_load_dwordx4 v5, s[24:27], s63 offen offset:1024 lds
ds_read_b64_tr_b16 a[30:31], v14 offset:23168
v_mfma_f32_32x32x16_bf16 v[80:95], a[52:55], v[200:203], v[80:95]
s_add_u32 m0, s62, 61440
s_nop 0
buffer_load_dwordx4 v6, s[24:27], s63 offen offset:2048 lds
ds_read_b64_tr_b16 a[32:33], v14 offset:20672
v_mfma_f32_32x32x16_bf16 v[96:111], a[56:59], v[200:203], v[96:111]
s_add_u32 m0, s62, 61440
s_nop 0
buffer_load_dwordx4 v7, s[24:27], s63 offen offset:3072 lds
ds_read_b64_tr_b16 a[34:35], v14 offset:23232
s_waitcnt lgkmcnt(8)
v_mfma_f32_32x32x16_bf16 v[32:47], a[0:3], v[204:207], v[32:47]
ds_read_b64_tr_b16 a[36:37], v14 offset:20736
ds_read_b64_tr_b16 a[38:39], v14 offset:23296
ds_read_b64_tr_b16 a[40:41], v14 offset:25600
ds_read_b64_tr_b16 a[42:43], v14 offset:28160
v_mfma_f32_32x32x16_bf16 v[48:63], a[4:7], v[204:207], v[48:63]
s_add_u32 m0, s62, 65536
s_nop 0
buffer_load_dwordx4 v8, s[24:27], s63 offen lds
ds_read_b64_tr_b16 a[44:45], v14 offset:25664
v_mfma_f32_32x32x16_bf16 v[64:79], a[8:11], v[204:207], v[64:79]
ds_read_b64_tr_b16 a[46:47], v14 offset:28224
ds_read_b64_tr_b16 a[48:49], v14 offset:25728
ds_read_b64_tr_b16 a[50:51], v14 offset:28288
ds_read_b64_tr_b16 a[52:53], v14 offset:25792
ds_read_b64_tr_b16 a[54:55], v14 offset:28352
v_mfma_f32_32x32x16_bf16 v[80:95], a[12:15], v[204:207], v[80:95]
ds_read_b64_tr_b16 a[56:57], v14 offset:25856
ds_read_b64_tr_b16 a[58:59], v14 offset:28416
v_mfma_f32_32x32x16_bf16 v[96:111], a[16:19], v[204:207], v[96:111]
s_waitcnt lgkmcnt(10)
v_mfma_f32_32x32x16_bf16 v[32:47], a[20:23], v[208:211], v[32:47]
ds_read_b64_tr_b16 a[0:1], v14 offset:30720
ds_read_b64_tr_b16 a[2:3], v14 offset:33280
ds_read_b64_tr_b16 a[4:5], v14 offset:30784
ds_read_b64_tr_b16 a[6:7], v14 offset:33344
v_mfma_f32_32x32x16_bf16 v[48:63], a[24:27], v[208:211], v[48:63]
ds_read_b64_tr_b16 a[8:9], v14 offset:30848
ds_read_b64_tr_b16 a[10:11], v14 offset:33408
ds_read_b64_tr_b16 a[12:13], v14 offset:30912
ds_read_b64_tr_b16 a[14:15], v14 offset:33472
ds_read_b64_tr_b16 a[16:17], v14 offset:30976
v_mfma_f32_32x32x16_bf16 v[64:79], a[28:31], v[208:211], v[64:79]
ds_read_b64_tr_b16 a[18:19], v14 offset:33536
v_mfma_f32_32x32x16_bf16 v[80:95], a[32:35], v[208:211], v[80:95]
v_mfma_f32_32x32x16_bf16 v[96:111], a[36:39], v[208:211], v[96:111]
ds_read_b64_tr_b16 a[20:21], v14 offset:35840
ds_read_b64_tr_b16 a[22:23], v14 offset:38400
ds_read_b64_tr_b16 a[24:25], v14 offset:35904
ds_read_b64_tr_b16 a[26:27], v14 offset:38464
ds_read_b64_tr_b16 a[28:29], v14 offset:35968
s_waitcnt lgkmcnt(15)
v_mfma_f32_32x32x16_bf16 v[32:47], a[40:43], v[212:215], v[32:47]
ds_read_b64_tr_b16 a[30:31], v14 offset:38528
ds_read_b64_tr_b16 a[32:33], v14 offset:36032
v_mfma_f32_32x32x16_bf16 v[48:63], a[44:47], v[212:215], v[48:63]
ds_read_b64_tr_b16 a[34:35], v14 offset:38592
ds_read_b64_tr_b16 a[36:37], v14 offset:36096
v_mfma_f32_32x32x16_bf16 v[64:79], a[48:51], v[212:215], v[64:79]
ds_read_b64_tr_b16 a[38:39], v14 offset:38656
v_mfma_f32_32x32x16_bf16 v[80:95], a[52:55], v[212:215], v[80:95]
v_mfma_f32_32x32x16_bf16 v[96:111], a[56:59], v[212:215], v[96:111]
s_waitcnt vmcnt(5)
s_barrier
s_waitcnt lgkmcnt(10)
v_mfma_f32_32x32x16_bf16 v[32:47], a[0:3], v[216:219], v[32:47]
ds_read_b64_tr_b16 a[40:41], v15 offset:0
ds_read_b64_tr_b16 a[42:43], v15 offset:2560
ds_read_b64_tr_b16 a[44:45], v15 offset:64
ds_read_b64_tr_b16 a[46:47], v15 offset:2624
v_mfma_f32_32x32x16_bf16 v[48:63], a[4:7], v[216:219], v[48:63]
ds_read_b64_tr_b16 a[48:49], v15 offset:128
ds_read_b64_tr_b16 a[50:51], v15 offset:2688
ds_read_b64_tr_b16 a[52:53], v15 offset:192
ds_read_b64_tr_b16 a[54:55], v15 offset:2752
ds_read_b64_tr_b16 a[56:57], v15 offset:256
v_mfma_f32_32x32x16_bf16 v[64:79], a[8:11], v[216:219], v[64:79]
ds_read_b64_tr_b16 a[58:59], v15 offset:2816
v_mfma_f32_32x32x16_bf16 v[80:95], a[12:15], v[216:219], v[80:95]
v_mfma_f32_32x32x16_bf16 v[96:111], a[16:19], v[216:219], v[96:111]
ds_read_b64_tr_b16 a[0:1], v15 offset:5120
ds_read_b64_tr_b16 a[2:3], v15 offset:7680
ds_read_b64_tr_b16 a[4:5], v15 offset:5184
ds_read_b64_tr_b16 a[6:7], v15 offset:7744
ds_read_b64_tr_b16 a[8:9], v15 offset:5248
s_waitcnt lgkmcnt(15)
v_mfma_f32_32x32x16_bf16 v[32:47], a[20:23], v[220:223], v[32:47]
ds_read_b64_tr_b16 a[10:11], v15 offset:7808
ds_read_b64_tr_b16 a[12:13], v15 offset:5312
v_mfma_f32_32x32x16_bf16 v[48:63], a[24:27], v[220:223], v[48:63]
ds_read_b64_tr_b16 a[14:15], v15 offset:7872
ds_read_b64_tr_b16 a[16:17], v15 offset:5376
v_mfma_f32_32x32x16_bf16 v[64:79], a[28:31], v[220:223], v[64:79]
ds_read_b64_tr_b16 a[18:19], v15 offset:7936
v_mfma_f32_32x32x16_bf16 v[80:95], a[32:35], v[220:223], v[80:95]
v_mfma_f32_32x32x16_bf16 v[96:111], a[36:39], v[220:223], v[96:111]
s_waitcnt lgkmcnt(10)
v_mfma_f32_32x32x16_bf16 v[32:47], a[40:43], v[224:227], v[32:47]
ds_read_b64_tr_b16 a[20:21], v15 offset:10240
ds_read_b64_tr_b16 a[22:23], v15 offset:12800
ds_read_b64_tr_b16 a[24:25], v15 offset:10304
ds_read_b64_tr_b16 a[26:27], v15 offset:12864
v_mfma_f32_32x32x16_bf16 v[48:63], a[44:47], v[224:227], v[48:63]
ds_read_b64_tr_b16 a[28:29], v15 offset:10368
ds_read_b64_tr_b16 a[30:31], v15 offset:12928
ds_read_b64_tr_b16 a[32:33], v15 offset:10432
ds_read_b64_tr_b16 a[34:35], v15 offset:12992
ds_read_b64_tr_b16 a[36:37], v15 offset:10496
v_mfma_f32_32x32x16_bf16 v[64:79], a[48:51], v[224:227], v[64:79]
ds_read_b64_tr_b16 a[38:39], v15 offset:13056
v_mfma_f32_32x32x16_bf16 v[80:95], a[52:55], v[224:227], v[80:95]
v_mfma_f32_32x32x16_bf16 v[96:111], a[56:59], v[224:227], v[96:111]
ds_read_b64_tr_b16 a[40:41], v15 offset:15360
ds_read_b64_tr_b16 a[42:43], v15 offset:17920
ds_read_b64_tr_b16 a[44:45], v15 offset:15424
ds_read_b64_tr_b16 a[46:47], v15 offset:17984
ds_read_b64_tr_b16 a[48:49], v15 offset:15488
s_waitcnt lgkmcnt(15)
v_mfma_f32_32x32x16_bf16 v[32:47], a[0:3], v[228:231], v[32:47]
ds_read_b64_tr_b16 a[50:51], v15 offset:18048
ds_read_b64_tr_b16 a[52:53], v15 offset:15552
v_mfma_f32_32x32x16_bf16 v[48:63], a[4:7], v[228:231], v[48:63]
ds_read_b64_tr_b16 a[54:55], v15 offset:18112
ds_read_b64_tr_b16 a[56:57], v15 offset:15616
v_mfma_f32_32x32x16_bf16 v[64:79], a[8:11], v[228:231], v[64:79]
ds_read_b64_tr_b16 a[58:59], v15 offset:18176
v_mfma_f32_32x32x16_bf16 v[80:95], a[12:15], v[228:231], v[80:95]
v_mfma_f32_32x32x16_bf16 v[96:111], a[16:19], v[228:231], v[96:111]
s_waitcnt vmcnt(0)
s_barrier
s_waitcnt lgkmcnt(10)
v_mfma_f32_32x32x16_bf16 v[32:47], a[20:23], v[232:235], v[32:47]
ds_read_b64_tr_b16 a[0:1], v15 offset:20480
ds_read_b64_tr_b16 a[2:3], v15 offset:23040
ds_read_b64_tr_b16 a[4:5], v15 offset:20544
ds_read_b64_tr_b16 a[6:7], v15 offset:23104
v_mfma_f32_32x32x16_bf16 v[48:63], a[24:27], v[232:235], v[48:63]
ds_read_b64_tr_b16 a[8:9], v15 offset:20608
ds_read_b64_tr_b16 a[10:11], v15 offset:23168
ds_read_b64_tr_b16 a[12:13], v15 offset:20672
ds_read_b64_tr_b16 a[14:15], v15 offset:23232
ds_read_b64_tr_b16 a[16:17], v15 offset:20736
v_mfma_f32_32x32x16_bf16 v[64:79], a[28:31], v[232:235], v[64:79]
ds_read_b64_tr_b16 a[18:19], v15 offset:23296
v_mfma_f32_32x32x16_bf16 v[80:95], a[32:35], v[232:235], v[80:95]
v_mfma_f32_32x32x16_bf16 v[96:111], a[36:39], v[232:235], v[96:111]
ds_read_b64_tr_b16 a[20:21], v15 offset:25600
ds_read_b64_tr_b16 a[22:23], v15 offset:28160
ds_read_b64_tr_b16 a[24:25], v15 offset:25664
ds_read_b64_tr_b16 a[26:27], v15 offset:28224
ds_read_b64_tr_b16 a[28:29], v15 offset:25728
s_waitcnt lgkmcnt(15)
v_mfma_f32_32x32x16_bf16 v[32:47], a[40:43], v[236:239], v[32:47]
ds_read_b64_tr_b16 a[30:31], v15 offset:28288
ds_read_b64_tr_b16 a[32:33], v15 offset:25792
v_mfma_f32_32x32x16_bf16 v[48:63], a[44:47], v[236:239], v[48:63]
ds_read_b64_tr_b16 a[34:35], v15 offset:28352
ds_read_b64_tr_b16 a[36:37], v15 offset:25856
v_mfma_f32_32x32x16_bf16 v[64:79], a[48:51], v[236:239], v[64:79]
ds_read_b64_tr_b16 a[38:39], v15 offset:28416
v_mfma_f32_32x32x16_bf16 v[80:95], a[52:55], v[236:239], v[80:95]
v_mfma_f32_32x32x16_bf16 v[96:111], a[56:59], v[236:239], v[96:111]
s_waitcnt lgkmcnt(10)
v_mfma_f32_32x32x16_bf16 v[32:47], a[0:3], v[240:243], v[32:47]
ds_read_b64_tr_b16 a[40:41], v15 offset:30720
ds_read_b64_tr_b16 a[42:43], v15 offset:33280
ds_read_b64_tr_b16 a[44:45], v15 offset:30784
ds_read_b64_tr_b16 a[46:47], v15 offset:33344
v_mfma_f32_32x32x16_bf16 v[48:63], a[4:7], v[240:243], v[48:63]
ds_read_b64_tr_b16 a[48:49], v15 offset:30848
ds_read_b64_tr_b16 a[50:51], v15 offset:33408
ds_read_b64_tr_b16 a[52:53], v15 offset:30912
ds_read_b64_tr_b16 a[54:55], v15 offset:33472
ds_read_b64_tr_b16 a[56:57], v15 offset:30976
v_mfma_f32_32x32x16_bf16 v[64:79], a[8:11], v[240:243], v[64:79]
ds_read_b64_tr_b16 a[58:59], v15 offset:33536
v_mfma_f32_32x32x16_bf16 v[80:95], a[12:15], v[240:243], v[80:95]
v_mfma_f32_32x32x16_bf16 v[96:111], a[16:19], v[240:243], v[96:111]
ds_read_b64_tr_b16 a[0:1], v15 offset:35840
ds_read_b64_tr_b16 a[2:3], v15 offset:38400
ds_read_b64_tr_b16 a[4:5], v15 offset:35904
ds_read_b64_tr_b16 a[6:7], v15 offset:38464
ds_read_b64_tr_b16 a[8:9], v15 offset:35968
s_waitcnt lgkmcnt(15)
v_mfma_f32_32x32x16_bf16 v[32:47], a[20:23], v[244:247], v[32:47]
ds_read_b64_tr_b16 a[10:11], v15 offset:38528
ds_read_b64_tr_b16 a[12:13], v15 offset:36032
v_mfma_f32_32x32x16_bf16 v[48:63], a[24:27], v[244:247], v[48:63]
ds_read_b64_tr_b16 a[14:15], v15 offset:38592
ds_read_b64_tr_b16 a[16:17], v15 offset:36096
v_mfma_f32_32x32x16_bf16 v[64:79], a[28:31], v[244:247], v[64:79]
ds_read_b64_tr_b16 a[18:19], v15 offset:38656
v_mfma_f32_32x32x16_bf16 v[80:95], a[32:35], v[244:247], v[80:95]
v_mfma_f32_32x32x16_bf16 v[96:111], a[36:39], v[244:247], v[96:111]
s_waitcnt lgkmcnt(10)
v_mfma_f32_32x32x16_bf16 v[32:47], a[40:43], v[248:251], v[32:47]
v_mfma_f32_32x32x16_bf16 v[48:63], a[44:47], v[248:251], v[48:63]
v_mfma_f32_32x32x16_bf16 v[64:79], a[48:51], v[248:251], v[64:79]
v_mfma_f32_32x32x16_bf16 v[80:95], a[52:55], v[248:251], v[80:95]
v_mfma_f32_32x32x16_bf16 v[96:111], a[56:59], v[248:251], v[96:111]
s_waitcnt lgkmcnt(0)
v_mfma_f32_32x32x16_bf16 v[32:47], a[0:3], v[252:255], v[32:47]
v_mfma_f32_32x32x16_bf16 v[48:63], a[4:7], v[252:255], v[48:63]
v_mfma_f32_32x32x16_bf16 v[64:79], a[8:11], v[252:255], v[64:79]
v_mfma_f32_32x32x16_bf16 v[80:95], a[12:15], v[252:255], v[80:95]
v_mfma_f32_32x32x16_bf16 v[96:111], a[16:19], v[252:255], v[96:111]
s_nop 15
v_cvt_pk_bf16_f32 v112, v32, v33
v_cvt_pk_bf16_f32 v113, v34, v35
v_cvt_pk_bf16_f32 v114, v36, v37
v_cvt_pk_bf16_f32 v115, v38, v39
s_mov_b32 s60, 0
buffer_store_dwordx4 v[112:115], v3, s[32:35], s60 offen offset:0 sc1
v_cvt_pk_bf16_f32 v116, v40, v41
v_cvt_pk_bf16_f32 v117, v42, v43
v_cvt_pk_bf16_f32 v118, v44, v45
v_cvt_pk_bf16_f32 v119, v46, v47
buffer_store_dwordx4 v[116:119], v3, s[32:35], s60 offen offset:1024 sc1
v_cvt_pk_bf16_f32 v120, v48, v49
v_cvt_pk_bf16_f32 v121, v50, v51
v_cvt_pk_bf16_f32 v122, v52, v53
v_cvt_pk_bf16_f32 v123, v54, v55
buffer_store_dwordx4 v[120:123], v3, s[32:35], s60 offen offset:2048 sc1
v_cvt_pk_bf16_f32 v112, v56, v57
v_cvt_pk_bf16_f32 v113, v58, v59
v_cvt_pk_bf16_f32 v114, v60, v61
v_cvt_pk_bf16_f32 v115, v62, v63
buffer_store_dwordx4 v[112:115], v3, s[32:35], s60 offen offset:3072 sc1
v_cvt_pk_bf16_f32 v116, v64, v65
v_cvt_pk_bf16_f32 v117, v66, v67
v_cvt_pk_bf16_f32 v118, v68, v69
v_cvt_pk_bf16_f32 v119, v70, v71
s_mov_b32 s60, 4096
buffer_store_dwordx4 v[116:119], v3, s[32:35], s60 offen offset:0 sc1
v_cvt_pk_bf16_f32 v120, v72, v73
v_cvt_pk_bf16_f32 v121, v74, v75
v_cvt_pk_bf16_f32 v122, v76, v77
v_cvt_pk_bf16_f32 v123, v78, v79
buffer_store_dwordx4 v[120:123], v3, s[32:35], s60 offen offset:1024 sc1
v_cvt_pk_bf16_f32 v112, v80, v81
v_cvt_pk_bf16_f32 v113, v82, v83
v_cvt_pk_bf16_f32 v114, v84, v85
v_cvt_pk_bf16_f32 v115, v86, v87
buffer_store_dwordx4 v[112:115], v3, s[32:35], s60 offen offset:2048 sc1
v_cvt_pk_bf16_f32 v116, v88, v89
v_cvt_pk_bf16_f32 v117, v90, v91
v_cvt_pk_bf16_f32 v118, v92, v93
v_cvt_pk_bf16_f32 v119, v94, v95
buffer_store_dwordx4 v[116:119], v3, s[32:35], s60 offen offset:3072 sc1
v_cvt_pk_bf16_f32 v120, v96, v97
v_cvt_pk_bf16_f32 v121, v98, v99
v_cvt_pk_bf16_f32 v122, v100, v101
v_cvt_pk_bf16_f32 v123, v102, v103
s_mov_b32 s60, 8192
buffer_store_dwordx4 v[120:123], v3, s[32:35], s60 offen offset:0 sc1
v_cvt_pk_bf16_f32 v112, v104, v105
v_cvt_pk_bf16_f32 v113, v106, v107
v_cvt_pk_bf16_f32 v114, v108, v109
v_cvt_pk_bf16_f32 v115, v110, v111
buffer_store_dwordx4 v[112:115], v3, s[32:35], s60 offen offset:1024 sc1
s_waitcnt vmcnt(0)
s_barrier
s_cmp_lg_u32 s22, 0
s_cbranch_scc1 Lps_128
s_lshl_b32 s60, s13, 7
s_lshl_b32 s61, s15, 4
s_add_u32 s60, s60, s61
s_lshl_b32 s61, s12, 2
s_add_u32 s60, s60, s61
s_add_u32 s60, s60, 16384
s_add_u32 s60, s60, 0x5800000
v_mov_b32 v10, s60
v_mov_b32 v11, 1
s_mov_b64 s[60:61], exec
s_mov_b64 exec, 1
global_store_dword v10, v11, s[18:19] sc1
s_mov_b64 exec, s[60:61]
Lps_128:
s_and_b32 s12, s2, 3
s_bfe_u32 s13, s2, 0x10002
s_lshr_b32 s15, s2, 3
s_and_b32 s60, s15, 7
s_lshl_b32 s13, s13, 3
s_add_u32 s13, s13, s60
s_lshr_b32 s15, s15, 3
s_load_dwordx2 s[4:5], s[0:1], 0
s_load_dwordx2 s[6:7], s[0:1], 56
s_load_dwordx2 s[8:9], s[0:1], 88
s_lshl_b32 s20, s13, 2
s_add_u32 s20, s20, s15
s_mov_b32 s21, s12
s_waitcnt lgkmcnt(0)
s_mov_b32 s60, 0x3400000
s_add_u32 s24, s18, s60
s_addc_u32 s25, s19, 0
s_mov_b32 s26, 0xa00000
s_mov_b32 s27, 0x20000
s_mov_b32 s28, s4
s_mov_b32 s29, s5
s_mov_b32 s30, 0x280000
s_mov_b32 s31, 0x20000
s_mov_b32 s32, s8
s_mov_b32 s33, s9
s_mov_b32 s34, 0x280000
s_mov_b32 s35, 0x20000
s_mov_b32 s60, 0x4c00000
s_add_u32 s36, s18, s60
s_addc_u32 s37, s19, 0
s_mov_b32 s38, 0x280000
s_mov_b32 s39, 0x20000
s_mov_b32 s60, 0x5000000
s_add_u32 s56, s18, s60
s_addc_u32 s57, s19, 0
s_mov_b32 s58, 0x280000
s_mov_b32 s59, 0x20000
s_mov_b32 s84, s6
s_mov_b32 s85, s7
s_mov_b32 s86, 0x500
s_mov_b32 s87, 0x20000
v_and_b32 v3, 7, v1
v_lshrrev_b32 v4, 3, v1
v_lshrrev_b32 v5, 1, v4
v_and_b32 v6, 1, v4
v_lshlrev_b32 v7, 5, v6
v_add_u32 v7, v7, v3
s_lshl_b32 s60, s21, 3
v_add_u32 v7, s60, v7
v_lshlrev_b32 v7, 4, v7
v_lshrrev_b32 v14, 1, v5
v_lshlrev_b32 v14, 10, v14
v_add_u32 v7, v7, v14
v_and_b32 v14, 1, v5
v_lshlrev_b32 v14, 3, v14
v_add_u32 v7, v7, v14
s_mul_i32 s61, s20, 20
s_add_u32 s61, s61, s22
s_lshl_b32 s61, s61, 11
s_mov_b32 s70, s61
v_lshlrev_b32 v15, 3, v5
v_lshlrev_b32 v16, 2, v6
v_add_u32 v15, v15, v16
s_lshl_b32 s60, s22, 5
v_add_u32 v15, s60, v15
v_lshlrev_b32 v15, 1, v15
s_lshl_b32 s60, s20, 5
s_lshl_b32 s61, s21, 3
s_add_u32 s60, s60, s61
v_add_u32 v16, s60, v3
s_movk_i32 s60, 1280
v_mul_lo_u32 v17, v16, s60
v_add_u32 v17, v17, v15
buffer_load_dwordx2 v[112:113], v17, s[28:31], 0 offen offset:0
buffer_load_dwordx2 v[114:115], v17, s[28:31], 0 offen offset:256
buffer_load_dwordx2 v[116:117], v17, s[28:31], 0 offen offset:512
buffer_load_dwordx2 v[118:119], v17, s[28:31], 0 offen offset:768
buffer_load_dwordx2 v[120:121], v17, s[28:31], 0 offen offset:1024
buffer_load_dwordx2 v[18:19], v15, s[84:87], 0 offen offset:0
buffer_load_dwordx2 v[20:21], v15, s[84:87], 0 offen offset:256
buffer_load_dwordx2 v[22:23], v15, s[84:87], 0 offen offset:512
buffer_load_dwordx2 v[24:25], v15, s[84:87], 0 offen offset:768
buffer_load_dwordx2 v[26:27], v15, s[84:87], 0 offen offset:1024
v_lshlrev_b32 v8, 4, v3
v_add_u32 v8, 0, v8
s_lshl_b32 s60, s22, 7
v_add_u32 v9, s60, v8
v_and_b32 v10, 15, v1
v_lshlrev_b32 v10, 2, v10
s_lshl_b32 s60, s13, 7
s_add_u32 s60, s60, 0x5804000
v_add_u32 v10, s60, v10
s_mov_b32 s61, 0
Lsf_129:
global_load_dword v11, v10, s[18:19] sc1
s_waitcnt vmcnt(0)
v_cmp_ne_u32 vcc, 0, v11
s_nop 1
s_and_b32 s60, vcc_lo, 0xffff
s_cmp_eq_u32 s60, 0xffff
s_cbranch_scc1 Lsfd_130
s_add_u32 s61, s61, 1
s_cmp_lt_u32 s61, 0x40000
s_sleep 2
s_cbranch_scc1 Lsf_129
Lsfd_130:
s_add_u32 s62, s70, 0
buffer_load_dwordx2 v[32:33], v7, s[24:27], s62 offen sc1
s_add_u32 s62, s70, 2621440
buffer_load_dwordx2 v[34:35], v7, s[24:27], s62 offen sc1
s_add_u32 s62, s70, 5242880
buffer_load_dwordx2 v[36:37], v7, s[24:27], s62 offen sc1
s_add_u32 s62, s70, 7864320
buffer_load_dwordx2 v[38:39], v7, s[24:27], s62 offen sc1
s_add_u32 s62, s70, 8192
buffer_load_dwordx2 v[40:41], v7, s[24:27], s62 offen sc1
s_add_u32 s62, s70, 2629632
buffer_load_dwordx2 v[42:43], v7, s[24:27], s62 offen sc1
s_add_u32 s62, s70, 5251072
buffer_load_dwordx2 v[44:45], v7, s[24:27], s62 offen sc1
s_add_u32 s62, s70, 7872512
buffer_load_dwordx2 v[46:47], v7, s[24:27], s62 offen sc1
s_add_u32 s62, s70, 16384
buffer_load_dwordx2 v[48:49], v7, s[24:27], s62 offen sc1
s_add_u32 s62, s70, 2637824
buffer_load_dwordx2 v[50:51], v7, s[24:27], s62 offen sc1
s_add_u32 s62, s70, 5259264
buffer_load_dwordx2 v[52:53], v7, s[24:27], s62 offen sc1
s_add_u32 s62, s70, 7880704
buffer_load_dwordx2 v[54:55], v7, s[24:27], s62 offen sc1
s_add_u32 s62, s70, 24576
buffer_load_dwordx2 v[56:57], v7, s[24:27], s62 offen sc1
s_add_u32 s62, s70, 2646016
buffer_load_dwordx2 v[58:59], v7, s[24:27], s62 offen sc1
s_add_u32 s62, s70, 5267456
buffer_load_dwordx2 v[60:61], v7, s[24:27], s62 offen sc1
s_add_u32 s62, s70, 7888896
buffer_load_dwordx2 v[62:63], v7, s[24:27], s62 offen sc1
s_add_u32 s62, s70, 32768
buffer_load_dwordx2 v[64:65], v7, s[24:27], s62 offen sc1
s_add_u32 s62, s70, 2654208
buffer_load_dwordx2 v[66:67], v7, s[24:27], s62 offen sc1
s_add_u32 s62, s70, 5275648
buffer_load_dwordx2 v[68:69], v7, s[24:27], s62 offen sc1
s_add_u32 s62, s70, 7897088
buffer_load_dwordx2 v[70:71], v7, s[24:27], s62 offen sc1
s_waitcnt vmcnt(20)
v_lshlrev_b32 v72, 16, v112
v_and_b32 v73, 0xffff0000, v112
v_lshlrev_b32 v92, 16, v18
v_and_b32 v93, 0xffff0000, v18
v_lshlrev_b32 v74, 16, v113
v_and_b32 v75, 0xffff0000, v113
v_lshlrev_b32 v94, 16, v19
v_and_b32 v95, 0xffff0000, v19
v_lshlrev_b32 v76, 16, v114
v_and_b32 v77, 0xffff0000, v114
v_lshlrev_b32 v96, 16, v20
v_and_b32 v97, 0xffff0000, v20
v_lshlrev_b32 v78, 16, v115
v_and_b32 v79, 0xffff0000, v115
v_lshlrev_b32 v98, 16, v21
v_and_b32 v99, 0xffff0000, v21
v_lshlrev_b32 v80, 16, v116
v_and_b32 v81, 0xffff0000, v116
v_lshlrev_b32 v100, 16, v22
v_and_b32 v101, 0xffff0000, v22
v_lshlrev_b32 v82, 16, v117
v_and_b32 v83, 0xffff0000, v117
v_lshlrev_b32 v102, 16, v23
v_and_b32 v103, 0xffff0000, v23
v_lshlrev_b32 v84, 16, v118
v_and_b32 v85, 0xffff0000, v118
v_lshlrev_b32 v104, 16, v24
v_and_b32 v105, 0xffff0000, v24
v_lshlrev_b32 v86, 16, v119
v_and_b32 v87, 0xffff0000, v119
v_lshlrev_b32 v106, 16, v25
v_and_b32 v107, 0xffff0000, v25
v_lshlrev_b32 v88, 16, v120
v_and_b32 v89, 0xffff0000, v120
v_lshlrev_b32 v108, 16, v26
v_and_b32 v109, 0xffff0000, v26
v_lshlrev_b32 v90, 16, v121
v_and_b32 v91, 0xffff0000, v121
v_lshlrev_b32 v110, 16, v27
v_and_b32 v111, 0xffff0000, v27
v_mov_b32 v28, 0
v_mov_b32 v29, 0
v_mov_b32 v30, 0
v_mov_b32 v31, 0
s_waitcnt vmcnt(16)
v_lshlrev_b32 v128, 16, v32
v_lshlrev_b32 v148, 16, v34
v_add_f32 v128, v128, v148
v_lshlrev_b32 v148, 16, v36
v_lshlrev_b32 v149, 16, v38
v_add_f32 v148, v148, v149
v_add_f32 v128, v128, v148
v_and_b32 v129, 0xffff0000, v32
v_and_b32 v148, 0xffff0000, v34
v_add_f32 v129, v129, v148
v_and_b32 v148, 0xffff0000, v36
v_and_b32 v149, 0xffff0000, v38
v_add_f32 v148, v148, v149
v_add_f32 v129, v129, v148
v_lshlrev_b32 v130, 16, v33
v_lshlrev_b32 v148, 16, v35
v_add_f32 v130, v130, v148
v_lshlrev_b32 v148, 16, v37
v_lshlrev_b32 v149, 16, v39
v_add_f32 v148, v148, v149
v_add_f32 v130, v130, v148
v_and_b32 v131, 0xffff0000, v33
v_and_b32 v148, 0xffff0000, v35
v_add_f32 v131, v131, v148
v_and_b32 v148, 0xffff0000, v37
v_and_b32 v149, 0xffff0000, v39
v_add_f32 v148, v148, v149
v_add_f32 v131, v131, v148
v_cvt_pk_bf16_f32 v148, v128, v129
v_lshlrev_b32 v128, 16, v148
v_and_b32 v129, 0xffff0000, v148
v_add_f32 v128, v128, v72
v_add_f32 v129, v129, v73
v_cvt_pk_bf16_f32 v112, v128, v129
v_lshlrev_b32 v128, 16, v112
v_and_b32 v129, 0xffff0000, v112
v_cvt_pk_bf16_f32 v148, v130, v131
v_lshlrev_b32 v130, 16, v148
v_and_b32 v131, 0xffff0000, v148
v_add_f32 v130, v130, v74
v_add_f32 v131, v131, v75
v_cvt_pk_bf16_f32 v113, v130, v131
v_lshlrev_b32 v130, 16, v113
v_and_b32 v131, 0xffff0000, v113
buffer_store_dwordx2 v[112:113], v17, s[56:59], 0 offen offset:0 sc1
v_add_f32 v28, v28, v128
v_fmac_f32 v29, v128, v128
v_fmac_f32 v30, v128, v92
v_add_f32 v31, v31, v92
v_add_f32 v28, v28, v129
v_fmac_f32 v29, v129, v129
v_fmac_f32 v30, v129, v93
v_add_f32 v31, v31, v93
v_add_f32 v28, v28, v130
v_fmac_f32 v29, v130, v130
v_fmac_f32 v30, v130, v94
v_add_f32 v31, v31, v94
v_add_f32 v28, v28, v131
v_fmac_f32 v29, v131, v131
v_fmac_f32 v30, v131, v95
v_add_f32 v31, v31, v95
s_waitcnt vmcnt(13)
v_lshlrev_b32 v132, 16, v40
v_lshlrev_b32 v148, 16, v42
v_add_f32 v132, v132, v148
v_lshlrev_b32 v148, 16, v44
v_lshlrev_b32 v149, 16, v46
v_add_f32 v148, v148, v149
v_add_f32 v132, v132, v148
v_and_b32 v133, 0xffff0000, v40
v_and_b32 v148, 0xffff0000, v42
v_add_f32 v133, v133, v148
v_and_b32 v148, 0xffff0000, v44
v_and_b32 v149, 0xffff0000, v46
v_add_f32 v148, v148, v149
v_add_f32 v133, v133, v148
v_lshlrev_b32 v134, 16, v41
v_lshlrev_b32 v148, 16, v43
v_add_f32 v134, v134, v148
v_lshlrev_b32 v148, 16, v45
v_lshlrev_b32 v149, 16, v47
v_add_f32 v148, v148, v149
v_add_f32 v134, v134, v148
v_and_b32 v135, 0xffff0000, v41
v_and_b32 v148, 0xffff0000, v43
v_add_f32 v135, v135, v148
v_and_b32 v148, 0xffff0000, v45
v_and_b32 v149, 0xffff0000, v47
v_add_f32 v148, v148, v149
v_add_f32 v135, v135, v148
v_cvt_pk_bf16_f32 v148, v132, v133
v_lshlrev_b32 v132, 16, v148
v_and_b32 v133, 0xffff0000, v148
v_add_f32 v132, v132, v76
v_add_f32 v133, v133, v77
v_cvt_pk_bf16_f32 v114, v132, v133
v_lshlrev_b32 v132, 16, v114
v_and_b32 v133, 0xffff0000, v114
v_cvt_pk_bf16_f32 v148, v134, v135
v_lshlrev_b32 v134, 16, v148
v_and_b32 v135, 0xffff0000, v148
v_add_f32 v134, v134, v78
v_add_f32 v135, v135, v79
v_cvt_pk_bf16_f32 v115, v134, v135
v_lshlrev_b32 v134, 16, v115
v_and_b32 v135, 0xffff0000, v115
buffer_store_dwordx2 v[114:115], v17, s[56:59], 0 offen offset:256 sc1
v_add_f32 v28, v28, v132
v_fmac_f32 v29, v132, v132
v_fmac_f32 v30, v132, v96
v_add_f32 v31, v31, v96
v_add_f32 v28, v28, v133
v_fmac_f32 v29, v133, v133
v_fmac_f32 v30, v133, v97
v_add_f32 v31, v31, v97
v_add_f32 v28, v28, v134
v_fmac_f32 v29, v134, v134
v_fmac_f32 v30, v134, v98
v_add_f32 v31, v31, v98
v_add_f32 v28, v28, v135
v_fmac_f32 v29, v135, v135
v_fmac_f32 v30, v135, v99
v_add_f32 v31, v31, v99
s_waitcnt vmcnt(10)
v_lshlrev_b32 v136, 16, v48
v_lshlrev_b32 v148, 16, v50
v_add_f32 v136, v136, v148
v_lshlrev_b32 v148, 16, v52
v_lshlrev_b32 v149, 16, v54
v_add_f32 v148, v148, v149
v_add_f32 v136, v136, v148
v_and_b32 v137, 0xffff0000, v48
v_and_b32 v148, 0xffff0000, v50
v_add_f32 v137, v137, v148
v_and_b32 v148, 0xffff0000, v52
v_and_b32 v149, 0xffff0000, v54
v_add_f32 v148, v148, v149
v_add_f32 v137, v137, v148
v_lshlrev_b32 v138, 16, v49
v_lshlrev_b32 v148, 16, v51
v_add_f32 v138, v138, v148
v_lshlrev_b32 v148, 16, v53
v_lshlrev_b32 v149, 16, v55
v_add_f32 v148, v148, v149
v_add_f32 v138, v138, v148
v_and_b32 v139, 0xffff0000, v49
v_and_b32 v148, 0xffff0000, v51
v_add_f32 v139, v139, v148
v_and_b32 v148, 0xffff0000, v53
v_and_b32 v149, 0xffff0000, v55
v_add_f32 v148, v148, v149
v_add_f32 v139, v139, v148
v_cvt_pk_bf16_f32 v148, v136, v137
v_lshlrev_b32 v136, 16, v148
v_and_b32 v137, 0xffff0000, v148
v_add_f32 v136, v136, v80
v_add_f32 v137, v137, v81
v_cvt_pk_bf16_f32 v116, v136, v137
v_lshlrev_b32 v136, 16, v116
v_and_b32 v137, 0xffff0000, v116
v_cvt_pk_bf16_f32 v148, v138, v139
v_lshlrev_b32 v138, 16, v148
v_and_b32 v139, 0xffff0000, v148
v_add_f32 v138, v138, v82
v_add_f32 v139, v139, v83
v_cvt_pk_bf16_f32 v117, v138, v139
v_lshlrev_b32 v138, 16, v117
v_and_b32 v139, 0xffff0000, v117
buffer_store_dwordx2 v[116:117], v17, s[56:59], 0 offen offset:512 sc1
v_add_f32 v28, v28, v136
v_fmac_f32 v29, v136, v136
v_fmac_f32 v30, v136, v100
v_add_f32 v31, v31, v100
v_add_f32 v28, v28, v137
v_fmac_f32 v29, v137, v137
v_fmac_f32 v30, v137, v101
v_add_f32 v31, v31, v101
v_add_f32 v28, v28, v138
v_fmac_f32 v29, v138, v138
v_fmac_f32 v30, v138, v102
v_add_f32 v31, v31, v102
v_add_f32 v28, v28, v139
v_fmac_f32 v29, v139, v139
v_fmac_f32 v30, v139, v103
v_add_f32 v31, v31, v103
s_waitcnt vmcnt(7)
v_lshlrev_b32 v140, 16, v56
v_lshlrev_b32 v148, 16, v58
v_add_f32 v140, v140, v148
v_lshlrev_b32 v148, 16, v60
v_lshlrev_b32 v149, 16, v62
v_add_f32 v148, v148, v149
v_add_f32 v140, v140, v148
v_and_b32 v141, 0xffff0000, v56
v_and_b32 v148, 0xffff0000, v58
v_add_f32 v141, v141, v148
v_and_b32 v148, 0xffff0000, v60
v_and_b32 v149, 0xffff0000, v62
v_add_f32 v148, v148, v149
v_add_f32 v141, v141, v148
v_lshlrev_b32 v142, 16, v57
v_lshlrev_b32 v148, 16, v59
v_add_f32 v142, v142, v148
v_lshlrev_b32 v148, 16, v61
v_lshlrev_b32 v149, 16, v63
v_add_f32 v148, v148, v149
v_add_f32 v142, v142, v148
v_and_b32 v143, 0xffff0000, v57
v_and_b32 v148, 0xffff0000, v59
v_add_f32 v143, v143, v148
v_and_b32 v148, 0xffff0000, v61
v_and_b32 v149, 0xffff0000, v63
v_add_f32 v148, v148, v149
v_add_f32 v143, v143, v148
v_cvt_pk_bf16_f32 v148, v140, v141
v_lshlrev_b32 v140, 16, v148
v_and_b32 v141, 0xffff0000, v148
v_add_f32 v140, v140, v84
v_add_f32 v141, v141, v85
v_cvt_pk_bf16_f32 v118, v140, v141
v_lshlrev_b32 v140, 16, v118
v_and_b32 v141, 0xffff0000, v118
v_cvt_pk_bf16_f32 v148, v142, v143
v_lshlrev_b32 v142, 16, v148
v_and_b32 v143, 0xffff0000, v148
v_add_f32 v142, v142, v86
v_add_f32 v143, v143, v87
v_cvt_pk_bf16_f32 v119, v142, v143
v_lshlrev_b32 v142, 16, v119
v_and_b32 v143, 0xffff0000, v119
buffer_store_dwordx2 v[118:119], v17, s[56:59], 0 offen offset:768 sc1
v_add_f32 v28, v28, v140
v_fmac_f32 v29, v140, v140
v_fmac_f32 v30, v140, v104
v_add_f32 v31, v31, v104
v_add_f32 v28, v28, v141
v_fmac_f32 v29, v141, v141
v_fmac_f32 v30, v141, v105
v_add_f32 v31, v31, v105
v_add_f32 v28, v28, v142
v_fmac_f32 v29, v142, v142
v_fmac_f32 v30, v142, v106
v_add_f32 v31, v31, v106
v_add_f32 v28, v28, v143
v_fmac_f32 v29, v143, v143
v_fmac_f32 v30, v143, v107
v_add_f32 v31, v31, v107
s_waitcnt vmcnt(4)
v_lshlrev_b32 v144, 16, v64
v_lshlrev_b32 v148, 16, v66
v_add_f32 v144, v144, v148
v_lshlrev_b32 v148, 16, v68
v_lshlrev_b32 v149, 16, v70
v_add_f32 v148, v148, v149
v_add_f32 v144, v144, v148
v_and_b32 v145, 0xffff0000, v64
v_and_b32 v148, 0xffff0000, v66
v_add_f32 v145, v145, v148
v_and_b32 v148, 0xffff0000, v68
v_and_b32 v149, 0xffff0000, v70
v_add_f32 v148, v148, v149
v_add_f32 v145, v145, v148
v_lshlrev_b32 v146, 16, v65
v_lshlrev_b32 v148, 16, v67
v_add_f32 v146, v146, v148
v_lshlrev_b32 v148, 16, v69
v_lshlrev_b32 v149, 16, v71
v_add_f32 v148, v148, v149
v_add_f32 v146, v146, v148
v_and_b32 v147, 0xffff0000, v65
v_and_b32 v148, 0xffff0000, v67
v_add_f32 v147, v147, v148
v_and_b32 v148, 0xffff0000, v69
v_and_b32 v149, 0xffff0000, v71
v_add_f32 v148, v148, v149
v_add_f32 v147, v147, v148
v_cvt_pk_bf16_f32 v148, v144, v145
v_lshlrev_b32 v144, 16, v148
v_and_b32 v145, 0xffff0000, v148
v_add_f32 v144, v144, v88
v_add_f32 v145, v145, v89
v_cvt_pk_bf16_f32 v120, v144, v145
v_lshlrev_b32 v144, 16, v120
v_and_b32 v145, 0xffff0000, v120
v_cvt_pk_bf16_f32 v148, v146, v147
v_lshlrev_b32 v146, 16, v148
v_and_b32 v147, 0xffff0000, v148
v_add_f32 v146, v146, v90
v_add_f32 v147, v147, v91
v_cvt_pk_bf16_f32 v121, v146, v147
v_lshlrev_b32 v146, 16, v121
v_and_b32 v147, 0xffff0000, v121
buffer_store_dwordx2 v[120:121], v17, s[56:59], 0 offen offset:1024 sc1
v_add_f32 v28, v28, v144
v_fmac_f32 v29, v144, v144
v_fmac_f32 v30, v144, v108
v_add_f32 v31, v31, v108
v_add_f32 v28, v28, v145
v_fmac_f32 v29, v145, v145
v_fmac_f32 v30, v145, v109
v_add_f32 v31, v31, v109
v_add_f32 v28, v28, v146
v_fmac_f32 v29, v146, v146
v_fmac_f32 v30, v146, v110
v_add_f32 v31, v31, v110
v_add_f32 v28, v28, v147
v_fmac_f32 v29, v147, v147
v_fmac_f32 v30, v147, v111
v_add_f32 v31, v31, v111
s_nop 1
v_add_f32_dpp v28, v28, v28 row_ror:8 row_mask:0xf bank_mask:0xf
v_add_f32_dpp v29, v29, v29 row_ror:8 row_mask:0xf bank_mask:0xf
v_add_f32_dpp v30, v30, v30 row_ror:8 row_mask:0xf bank_mask:0xf
v_add_f32_dpp v31, v31, v31 row_ror:8 row_mask:0xf bank_mask:0xf
s_nop 0
ds_swizzle_b32 v24, v28 offset:0x401F
ds_swizzle_b32 v25, v29 offset:0x401F
ds_swizzle_b32 v26, v30 offset:0x401F
ds_swizzle_b32 v27, v31 offset:0x401F
s_waitcnt lgkmcnt(0)
v_add_f32 v28, v28, v24
v_add_f32 v29, v29, v25
v_add_f32 v30, v30, v26
v_add_f32 v31, v31, v27
v_mov_b32 v24, v28
v_mov_b32 v25, v29
v_mov_b32 v26, v30
v_mov_b32 v27, v31
s_nop 1
v_permlane32_swap_b32 v28, v24
v_permlane32_swap_b32 v29, v25
v_permlane32_swap_b32 v30, v26
v_permlane32_swap_b32 v31, v27
s_nop 1
v_add_f32 v28, v28, v24
v_add_f32 v29, v29, v25
v_add_f32 v30, v30, v26
v_add_f32 v31, v31, v27
ds_write_b128 v9, v[28:31]
s_waitcnt lgkmcnt(0)
s_barrier
ds_read_b128 v[32:35], v8 offset:0
ds_read_b128 v[36:39], v8 offset:128
ds_read_b128 v[40:43], v8 offset:256
ds_read_b128 v[44:47], v8 offset:384
s_waitcnt lgkmcnt(0)
v_add_f32 v32, v32, v36
v_add_f32 v40, v40, v44
v_add_f32 v28, v32, v40
v_add_f32 v33, v33, v37
v_add_f32 v41, v41, v45
v_add_f32 v29, v33, v41
v_add_f32 v34, v34, v38
v_add_f32 v42, v42, v46
v_add_f32 v30, v34, v42
v_add_f32 v35, v35, v39
v_add_f32 v43, v43, v47
v_add_f32 v31, v35, v43
v_mul_f32 v28, 0x3acccccd, v28
v_mul_f32 v29, 0x3acccccd, v29
v_fma_f32 v29, -v28, v28, v29
v_max_f32 v29, 0, v29
v_add_f32 v29, 0x3727c5ac, v29
v_rsq_f32 v29, v29
v_fma_f32 v30, -v28, v31, v30
s_nop 0
v_mul_f32 v30, v30, v29
s_cmp_lg_u32 s22, 0
s_cbranch_scc1 LCr_131
v_lshlrev_b32 v14, 2, v16
v_add_u32 v14, 0x5400000, v14
s_mov_b64 exec, 0xff
global_store_dword v14, v30, s[18:19] sc1
s_mov_b64 exec, -1
LCr_131:
v_sub_f32 v148, v128, v28
v_sub_f32 v149, v129, v28
v_mul_f32 v148, v148, v29
v_mul_f32 v149, v149, v29
v_cvt_pk_bf16_f32 v32, v148, v149
v_sub_f32 v148, v130, v28
v_sub_f32 v149, v131, v28
v_mul_f32 v148, v148, v29
v_mul_f32 v149, v149, v29
v_cvt_pk_bf16_f32 v33, v148, v149
buffer_store_dwordx2 v[32:33], v17, s[36:39], 0 offen offset:0 sc1
v_sub_f32 v148, v132, v28
v_sub_f32 v149, v133, v28
v_mul_f32 v148, v148, v29
v_mul_f32 v149, v149, v29
v_cvt_pk_bf16_f32 v34, v148, v149
v_sub_f32 v148, v134, v28
v_sub_f32 v149, v135, v28
v_mul_f32 v148, v148, v29
v_mul_f32 v149, v149, v29
v_cvt_pk_bf16_f32 v35, v148, v149
buffer_store_dwordx2 v[34:35], v17, s[36:39], 0 offen offset:256 sc1
v_sub_f32 v148, v136, v28
v_sub_f32 v149, v137, v28
v_mul_f32 v148, v148, v29
v_mul_f32 v149, v149, v29
v_cvt_pk_bf16_f32 v36, v148, v149
v_sub_f32 v148, v138, v28
v_sub_f32 v149, v139, v28
v_mul_f32 v148, v148, v29
v_mul_f32 v149, v149, v29
v_cvt_pk_bf16_f32 v37, v148, v149
buffer_store_dwordx2 v[36:37], v17, s[36:39], 0 offen offset:512 sc1
v_sub_f32 v148, v140, v28
v_sub_f32 v149, v141, v28
v_mul_f32 v148, v148, v29
v_mul_f32 v149, v149, v29
v_cvt_pk_bf16_f32 v38, v148, v149
v_sub_f32 v148, v142, v28
v_sub_f32 v149, v143, v28
v_mul_f32 v148, v148, v29
v_mul_f32 v149, v149, v29
v_cvt_pk_bf16_f32 v39, v148, v149
buffer_store_dwordx2 v[38:39], v17, s[36:39], 0 offen offset:768 sc1
v_sub_f32 v148, v144, v28
v_sub_f32 v149, v145, v28
v_mul_f32 v148, v148, v29
v_mul_f32 v149, v149, v29
v_cvt_pk_bf16_f32 v40, v148, v149
v_sub_f32 v148, v146, v28
v_sub_f32 v149, v147, v28
v_mul_f32 v148, v148, v29
v_mul_f32 v149, v149, v29
v_cvt_pk_bf16_f32 v41, v148, v149
buffer_store_dwordx2 v[40:41], v17, s[36:39], 0 offen offset:1024 sc1
v_lshlrev_b32 v148, 16, v32
v_and_b32 v149, 0xffff0000, v32
v_add_f32 v148, v148, v128
v_add_f32 v149, v149, v129
v_cvt_pk_bf16_f32 v48, v148, v149
v_lshlrev_b32 v148, 16, v33
v_and_b32 v149, 0xffff0000, v33
v_add_f32 v148, v148, v130
v_add_f32 v149, v149, v131
v_cvt_pk_bf16_f32 v49, v148, v149
buffer_store_dwordx2 v[48:49], v17, s[32:35], 0 offen offset:0 sc1
v_lshlrev_b32 v148, 16, v34
v_and_b32 v149, 0xffff0000, v34
v_add_f32 v148, v148, v132
v_add_f32 v149, v149, v133
v_cvt_pk_bf16_f32 v50, v148, v149
v_lshlrev_b32 v148, 16, v35
v_and_b32 v149, 0xffff0000, v35
v_add_f32 v148, v148, v134
v_add_f32 v149, v149, v135
v_cvt_pk_bf16_f32 v51, v148, v149
buffer_store_dwordx2 v[50:51], v17, s[32:35], 0 offen offset:256 sc1
v_lshlrev_b32 v148, 16, v36
v_and_b32 v149, 0xffff0000, v36
v_add_f32 v148, v148, v136
v_add_f32 v149, v149, v137
v_cvt_pk_bf16_f32 v52, v148, v149
v_lshlrev_b32 v148, 16, v37
v_and_b32 v149, 0xffff0000, v37
v_add_f32 v148, v148, v138
v_add_f32 v149, v149, v139
v_cvt_pk_bf16_f32 v53, v148, v149
buffer_store_dwordx2 v[52:53], v17, s[32:35], 0 offen offset:512 sc1
v_lshlrev_b32 v148, 16, v38
v_and_b32 v149, 0xffff0000, v38
v_add_f32 v148, v148, v140
v_add_f32 v149, v149, v141
v_cvt_pk_bf16_f32 v54, v148, v149
v_lshlrev_b32 v148, 16, v39
v_and_b32 v149, 0xffff0000, v39
v_add_f32 v148, v148, v142
v_add_f32 v149, v149, v143
v_cvt_pk_bf16_f32 v55, v148, v149
buffer_store_dwordx2 v[54:55], v17, s[32:35], 0 offen offset:768 sc1
v_lshlrev_b32 v148, 16, v40
v_and_b32 v149, 0xffff0000, v40
v_add_f32 v148, v148, v144
v_add_f32 v149, v149, v145
v_cvt_pk_bf16_f32 v56, v148, v149
v_lshlrev_b32 v148, 16, v41
v_and_b32 v149, 0xffff0000, v41
v_add_f32 v148, v148, v146
v_add_f32 v149, v149, v147
v_cvt_pk_bf16_f32 v57, v148, v149
buffer_store_dwordx2 v[56:57], v17, s[32:35], 0 offen offset:1024 sc1
s_cmp_ge_u32 s2, 74
s_cbranch_scc1 LA_end2
s_load_dwordx2 s[10:11], s[0:1], 80
s_waitcnt lgkmcnt(0)
s_sub_u32 s61, s2, 54
s_cmp_ge_u32 s61, 20
s_cbranch_scc1 Lwd_132
s_lshl_b32 s60, s61, 6
s_add_u32 s52, s10, s60
s_addc_u32 s53, s11, 0
s_mov_b32 s54, 0x0
s_mov_b32 s55, 0x20000
s_sub_u32 s54, 2211840, s60
v_lshrrev_b32 v6, 2, v1
v_mul_u32_u24 v6, 1280, v6
v_and_b32 v5, 3, v1
v_lshlrev_b32 v5, 4, v5
v_add_u32 v6, v6, v5
s_mul_i32 s66, s22, 552960
s_mul_i32 s68, s22, 27648
s_add_u32 s68, s68, 4096
s_add_u32 m0, s68, 0
s_add_u32 s69, s66, 0
buffer_load_dwordx4 v6, s[52:55], s69 offen lds
s_add_u32 m0, s68, 1024
s_add_u32 s69, s66, 20480
buffer_load_dwordx4 v6, s[52:55], s69 offen lds
s_add_u32 m0, s68, 2048
s_add_u32 s69, s66, 40960
buffer_load_dwordx4 v6, s[52:55], s69 offen lds
s_add_u32 m0, s68, 3072
s_add_u32 s69, s66, 61440
buffer_load_dwordx4 v6, s[52:55], s69 offen lds
s_add_u32 m0, s68, 4096
s_add_u32 s69, s66, 81920
buffer_load_dwordx4 v6, s[52:55], s69 offen lds
s_add_u32 m0, s68, 5120
s_add_u32 s69, s66, 102400
buffer_load_dwordx4 v6, s[52:55], s69 offen lds
s_add_u32 m0, s68, 6144
s_add_u32 s69, s66, 122880
buffer_load_dwordx4 v6, s[52:55], s69 offen lds
s_add_u32 m0, s68, 7168
s_add_u32 s69, s66, 143360
buffer_load_dwordx4 v6, s[52:55], s69 offen lds
s_add_u32 m0, s68, 8192
s_add_u32 s69, s66, 163840
buffer_load_dwordx4 v6, s[52:55], s69 offen lds
s_add_u32 m0, s68, 9216
s_add_u32 s69, s66, 184320
buffer_load_dwordx4 v6, s[52:55], s69 offen lds
s_add_u32 m0, s68, 10240
s_add_u32 s69, s66, 204800
buffer_load_dwordx4 v6, s[52:55], s69 offen lds
s_add_u32 m0, s68, 11264
s_add_u32 s69, s66, 225280
buffer_load_dwordx4 v6, s[52:55], s69 offen lds
s_add_u32 m0, s68, 12288
s_add_u32 s69, s66, 245760
buffer_load_dwordx4 v6, s[52:55], s69 offen lds
s_add_u32 m0, s68, 13312
s_add_u32 s69, s66, 266240
buffer_load_dwordx4 v6, s[52:55], s69 offen lds
s_add_u32 m0, s68, 14336
s_add_u32 s69, s66, 286720
buffer_load_dwordx4 v6, s[52:55], s69 offen lds
s_add_u32 m0, s68, 15360
s_add_u32 s69, s66, 307200
buffer_load_dwordx4 v6, s[52:55], s69 offen lds
s_add_u32 m0, s68, 16384
s_add_u32 s69, s66, 327680
buffer_load_dwordx4 v6, s[52:55], s69 offen lds
s_add_u32 m0, s68, 17408
s_add_u32 s69, s66, 348160
buffer_load_dwordx4 v6, s[52:55], s69 offen lds
s_add_u32 m0, s68, 18432
s_add_u32 s69, s66, 368640
buffer_load_dwordx4 v6, s[52:55], s69 offen lds
s_add_u32 m0, s68, 19456
s_add_u32 s69, s66, 389120
buffer_load_dwordx4 v6, s[52:55], s69 offen lds
s_add_u32 m0, s68, 20480
s_add_u32 s69, s66, 409600
buffer_load_dwordx4 v6, s[52:55], s69 offen lds
s_add_u32 m0, s68, 21504
s_add_u32 s69, s66, 430080
buffer_load_dwordx4 v6, s[52:55], s69 offen lds
s_add_u32 m0, s68, 22528
s_add_u32 s69, s66, 450560
buffer_load_dwordx4 v6, s[52:55], s69 offen lds
s_add_u32 m0, s68, 23552
s_add_u32 s69, s66, 471040
buffer_load_dwordx4 v6, s[52:55], s69 offen lds
s_add_u32 m0, s68, 24576
s_add_u32 s69, s66, 491520
buffer_load_dwordx4 v6, s[52:55], s69 offen lds
s_add_u32 m0, s68, 25600
s_add_u32 s69, s66, 512000
buffer_load_dwordx4 v6, s[52:55], s69 offen lds
s_add_u32 m0, s68, 26624
s_add_u32 s69, s66, 532480
buffer_load_dwordx4 v6, s[52:55], s69 offen lds
Lwd_132:
s_load_dwordx2 s[10:11], s[0:1], 88
s_mov_b32 s60, 0x4c00000
s_add_u32 s36, s18, s60
s_addc_u32 s37, s19, 0
s_mov_b32 s38, 0x280000
s_mov_b32 s39, 0x20000
s_mov_b32 s60, 0x5000000
s_add_u32 s24, s18, s60
s_addc_u32 s25, s19, 0
s_mov_b32 s26, 0x280000
s_mov_b32 s27, 0x20000
s_waitcnt lgkmcnt(0)
s_mov_b32 s28, s10
s_mov_b32 s29, s11
s_mov_b32 s30, 0x280000
s_mov_b32 s31, 0x20000
v_lshlrev_b32 v3, 5, v0
v_add_u32 v3, 0x5400000, v3
v_lshrrev_b32 v12, 5, v1
v_lshlrev_b32 v12, 3, v12
v_lshrrev_b32 v13, 2, v1
v_and_b32 v13, 3, v13
v_add_u32 v12, v12, v13
v_lshlrev_b32 v14, 6, v12
v_lshrrev_b32 v13, 4, v1
v_and_b32 v13, 1, v13
v_lshlrev_b32 v13, 5, v13
v_and_b32 v15, 3, v1
v_lshlrev_b32 v15, 3, v15
v_add_u32 v13, v13, v15
v_add_u32 v14, v14, v13
s_waitcnt vmcnt(0)
s_barrier
s_cmp_ge_u32 s2, 54
s_cbranch_scc1 Ldnw_133
s_mul_i32 s60, s22, 10240
s_add_u32 s60, s60, 81920
v_add_u32 v15, s60, v14
ds_read_b64_tr_b16 a[0:1], v15 offset:0
ds_read_b64_tr_b16 a[2:3], v15 offset:256
ds_read_b64_tr_b16 a[4:5], v15 offset:40960
ds_read_b64_tr_b16 a[6:7], v15 offset:41216
ds_read_b64_tr_b16 a[8:9], v15 offset:1024
ds_read_b64_tr_b16 a[10:11], v15 offset:1280
ds_read_b64_tr_b16 a[12:13], v15 offset:41984
ds_read_b64_tr_b16 a[14:15], v15 offset:42240
ds_read_b64_tr_b16 a[16:17], v15 offset:2048
ds_read_b64_tr_b16 a[18:19], v15 offset:2304
ds_read_b64_tr_b16 a[20:21], v15 offset:43008
ds_read_b64_tr_b16 a[22:23], v15 offset:43264
s_waitcnt lgkmcnt(0)
ds_read_b64_tr_b16 a[24:25], v15 offset:3072
ds_read_b64_tr_b16 a[26:27], v15 offset:3328
ds_read_b64_tr_b16 a[28:29], v15 offset:44032
ds_read_b64_tr_b16 a[30:31], v15 offset:44288
ds_read_b64_tr_b16 a[32:33], v15 offset:4096
ds_read_b64_tr_b16 a[34:35], v15 offset:4352
ds_read_b64_tr_b16 a[36:37], v15 offset:45056
ds_read_b64_tr_b16 a[38:39], v15 offset:45312
ds_read_b64_tr_b16 a[40:41], v15 offset:5120
ds_read_b64_tr_b16 a[42:43], v15 offset:5376
ds_read_b64_tr_b16 a[44:45], v15 offset:46080
ds_read_b64_tr_b16 a[46:47], v15 offset:46336
s_waitcnt lgkmcnt(0)
ds_read_b64_tr_b16 a[48:49], v15 offset:6144
ds_read_b64_tr_b16 a[50:51], v15 offset:6400
ds_read_b64_tr_b16 a[52:53], v15 offset:47104
ds_read_b64_tr_b16 a[54:55], v15 offset:47360
ds_read_b64_tr_b16 a[56:57], v15 offset:7168
ds_read_b64_tr_b16 a[58:59], v15 offset:7424
ds_read_b64_tr_b16 a[60:61], v15 offset:48128
ds_read_b64_tr_b16 a[62:63], v15 offset:48384
ds_read_b64_tr_b16 a[64:65], v15 offset:8192
ds_read_b64_tr_b16 a[66:67], v15 offset:8448
ds_read_b64_tr_b16 a[68:69], v15 offset:49152
ds_read_b64_tr_b16 a[70:71], v15 offset:49408
s_waitcnt lgkmcnt(0)
ds_read_b64_tr_b16 a[72:73], v15 offset:9216
ds_read_b64_tr_b16 a[74:75], v15 offset:9472
ds_read_b64_tr_b16 a[76:77], v15 offset:50176
ds_read_b64_tr_b16 a[78:79], v15 offset:50432
s_branch Ldnj_134
Ldnw_133:
s_mul_i32 s60, s22, 27648
s_add_u32 s60, s60, 4096
v_add_u32 v15, s60, v14
ds_read_b64_tr_b16 a[0:1], v15 offset:0
ds_read_b64_tr_b16 a[2:3], v15 offset:256
ds_read_b64_tr_b16 a[4:5], v15 offset:1024
ds_read_b64_tr_b16 a[6:7], v15 offset:1280
ds_read_b64_tr_b16 a[8:9], v15 offset:2048
ds_read_b64_tr_b16 a[10:11], v15 offset:2304
ds_read_b64_tr_b16 a[12:13], v15 offset:3072
ds_read_b64_tr_b16 a[14:15], v15 offset:3328
ds_read_b64_tr_b16 a[16:17], v15 offset:4096
ds_read_b64_tr_b16 a[18:19], v15 offset:4352
ds_read_b64_tr_b16 a[20:21], v15 offset:5120
ds_read_b64_tr_b16 a[22:23], v15 offset:5376
s_waitcnt lgkmcnt(0)
ds_read_b64_tr_b16 a[24:25], v15 offset:6144
ds_read_b64_tr_b16 a[26:27], v15 offset:6400
ds_read_b64_tr_b16 a[28:29], v15 offset:7168
ds_read_b64_tr_b16 a[30:31], v15 offset:7424
ds_read_b64_tr_b16 a[32:33], v15 offset:8192
ds_read_b64_tr_b16 a[34:35], v15 offset:8448
ds_read_b64_tr_b16 a[36:37], v15 offset:9216
ds_read_b64_tr_b16 a[38:39], v15 offset:9472
ds_read_b64_tr_b16 a[40:41], v15 offset:10240
ds_read_b64_tr_b16 a[42:43], v15 offset:10496
ds_read_b64_tr_b16 a[44:45], v15 offset:11264
ds_read_b64_tr_b16 a[46:47], v15 offset:11520
s_waitcnt lgkmcnt(0)
ds_read_b64_tr_b16 a[48:49], v15 offset:12288
ds_read_b64_tr_b16 a[50:51], v15 offset:12544
ds_read_b64_tr_b16 a[52:53], v15 offset:13312
ds_read_b64_tr_b16 a[54:55], v15 offset:13568
ds_read_b64_tr_b16 a[56:57], v15 offset:14336
ds_read_b64_tr_b16 a[58:59], v15 offset:14592
ds_read_b64_tr_b16 a[60:61], v15 offset:15360
ds_read_b64_tr_b16 a[62:63], v15 offset:15616
ds_read_b64_tr_b16 a[64:65], v15 offset:16384
ds_read_b64_tr_b16 a[66:67], v15 offset:16640
ds_read_b64_tr_b16 a[68:69], v15 offset:17408
ds_read_b64_tr_b16 a[70:71], v15 offset:17664
s_waitcnt lgkmcnt(0)
ds_read_b64_tr_b16 a[72:73], v15 offset:18432
ds_read_b64_tr_b16 a[74:75], v15 offset:18688
ds_read_b64_tr_b16 a[76:77], v15 offset:19456
ds_read_b64_tr_b16 a[78:79], v15 offset:19712
ds_read_b64_tr_b16 a[80:81], v15 offset:20480
ds_read_b64_tr_b16 a[82:83], v15 offset:20736
ds_read_b64_tr_b16 a[84:85], v15 offset:21504
ds_read_b64_tr_b16 a[86:87], v15 offset:21760
ds_read_b64_tr_b16 a[88:89], v15 offset:22528
ds_read_b64_tr_b16 a[90:91], v15 offset:22784
ds_read_b64_tr_b16 a[92:93], v15 offset:23552
ds_read_b64_tr_b16 a[94:95], v15 offset:23808
s_waitcnt lgkmcnt(0)
ds_read_b64_tr_b16 a[96:97], v15 offset:24576
ds_read_b64_tr_b16 a[98:99], v15 offset:24832
ds_read_b64_tr_b16 a[100:101], v15 offset:25600
ds_read_b64_tr_b16 a[102:103], v15 offset:25856
ds_read_b64_tr_b16 a[104:105], v15 offset:26624
ds_read_b64_tr_b16 a[106:107], v15 offset:26880
Ldnj_134:
s_mov_b32 s61, 0
v_mov_b32 v44, 0x7fc0dead
global_load_dwordx4 v[200:203], v3, s[18:19] sc1
global_load_dwordx4 v[204:207], v3, s[18:19] offset:16 sc1
s_sleep 6
global_load_dwordx4 v[208:211], v3, s[18:19] sc1
global_load_dwordx4 v[212:215], v3, s[18:19] offset:16 sc1
Lrp_135:
s_waitcnt vmcnt(2)
v_cmp_eq_u32 vcc, v200, v44
v_cmp_eq_u32 s[62:63], v201, v44
s_or_b64 vcc, vcc, s[62:63]
v_cmp_eq_u32 s[62:63], v202, v44
s_or_b64 vcc, vcc, s[62:63]
v_cmp_eq_u32 s[62:63], v203, v44
s_or_b64 vcc, vcc, s[62:63]
v_cmp_eq_u32 s[62:63], v204, v44
s_or_b64 vcc, vcc, s[62:63]
v_cmp_eq_u32 s[62:63], v205, v44
s_or_b64 vcc, vcc, s[62:63]
v_cmp_eq_u32 s[62:63], v206, v44
s_or_b64 vcc, vcc, s[62:63]
v_cmp_eq_u32 s[62:63], v207, v44
s_or_b64 vcc, vcc, s[62:63]
s_cmp_eq_u64 vcc, 0
s_cbranch_scc1 LrA_137
global_load_dwordx4 v[200:203], v3, s[18:19] sc1
global_load_dwordx4 v[204:207], v3, s[18:19] offset:16 sc1
s_waitcnt vmcnt(2)
v_cmp_eq_u32 vcc, v208, v44
v_cmp_eq_u32 s[62:63], v209, v44
s_or_b64 vcc, vcc, s[62:63]
v_cmp_eq_u32 s[62:63], v210, v44
s_or_b64 vcc, vcc, s[62:63]
v_cmp_eq_u32 s[62:63], v211, v44
s_or_b64 vcc, vcc, s[62:63]
v_cmp_eq_u32 s[62:63], v212, v44
s_or_b64 vcc, vcc, s[62:63]
v_cmp_eq_u32 s[62:63], v213, v44
s_or_b64 vcc, vcc, s[62:63]
v_cmp_eq_u32 s[62:63], v214, v44
s_or_b64 vcc, vcc, s[62:63]
v_cmp_eq_u32 s[62:63], v215, v44
s_or_b64 vcc, vcc, s[62:63]
s_cmp_eq_u64 vcc, 0
s_cbranch_scc1 LrB_138
global_load_dwordx4 v[208:211], v3, s[18:19] sc1
global_load_dwordx4 v[212:215], v3, s[18:19] offset:16 sc1
s_add_u32 s61, s61, 1
s_cmp_lt_u32 s61, 0x20000
s_cbranch_scc1 Lrp_135
LrB_138:
v_mov_b32 v32, v208
v_mov_b32 v33, v209
v_mov_b32 v34, v210
v_mov_b32 v35, v211
v_mov_b32 v36, v212
v_mov_b32 v37, v213
v_mov_b32 v38, v214
v_mov_b32 v39, v215
s_branch Lrd_136
LrA_137:
v_mov_b32 v32, v200
v_mov_b32 v33, v201
v_mov_b32 v34, v202
v_mov_b32 v35, v203
v_mov_b32 v36, v204
v_mov_b32 v37, v205
v_mov_b32 v38, v206
v_mov_b32 v39, v207
Lrd_136:
v_lshlrev_b32 v7, 3, v0
v_sub_u32 v7, 2047, v7
v_bfrev_b32 v45, 1
v_ashrrev_i32 v46, 31, v32
v_or_b32 v46, v46, v45
v_xor_b32 v32, v32, v46
v_and_b32 v32, 0xfffff800, v32
v_subrev_u32 v46, 0, v7
v_or_b32 v32, v32, v46
v_ashrrev_i32 v46, 31, v33
v_or_b32 v46, v46, v45
v_xor_b32 v33, v33, v46
v_and_b32 v33, 0xfffff800, v33
v_subrev_u32 v46, 1, v7
v_or_b32 v33, v33, v46
v_ashrrev_i32 v46, 31, v34
v_or_b32 v46, v46, v45
v_xor_b32 v34, v34, v46
v_and_b32 v34, 0xfffff800, v34
v_subrev_u32 v46, 2, v7
v_or_b32 v34, v34, v46
v_ashrrev_i32 v46, 31, v35
v_or_b32 v46, v46, v45
v_xor_b32 v35, v35, v46
v_and_b32 v35, 0xfffff800, v35
v_subrev_u32 v46, 3, v7
v_or_b32 v35, v35, v46
v_ashrrev_i32 v46, 31, v36
v_or_b32 v46, v46, v45
v_xor_b32 v36, v36, v46
v_and_b32 v36, 0xfffff800, v36
v_subrev_u32 v46, 4, v7
v_or_b32 v36, v36, v46
v_ashrrev_i32 v46, 31, v37
v_or_b32 v46, v46, v45
v_xor_b32 v37, v37, v46
v_and_b32 v37, 0xfffff800, v37
v_subrev_u32 v46, 5, v7
v_or_b32 v37, v37, v46
v_ashrrev_i32 v46, 31, v38
v_or_b32 v46, v46, v45
v_xor_b32 v38, v38, v46
v_and_b32 v38, 0xfffff800, v38
v_subrev_u32 v46, 6, v7
v_or_b32 v38, v38, v46
v_ashrrev_i32 v46, 31, v39
v_or_b32 v46, v46, v45
v_xor_b32 v39, v39, v46
v_and_b32 v39, 0xfffff800, v39
v_subrev_u32 v46, 7, v7
v_or_b32 v39, v39, v46
v_max_u32 v40, v32, v33
v_min_u32 v41, v32, v33
v_min_u32 v46, v40, v34
v_max_u32 v40, v40, v34
v_max_u32 v41, v41, v46
v_min_u32 v46, v40, v35
v_max_u32 v40, v40, v35
v_max_u32 v41, v41, v46
v_min_u32 v46, v40, v36
v_max_u32 v40, v40, v36
v_max_u32 v41, v41, v46
v_min_u32 v46, v40, v37
v_max_u32 v40, v40, v37
v_max_u32 v41, v41, v46
v_min_u32 v46, v40, v38
v_max_u32 v40, v40, v38
v_max_u32 v41, v41, v46
v_min_u32 v46, v40, v39
v_max_u32 v40, v40, v39
v_max_u32 v41, v41, v46
s_nop 1
v_mov_b32_dpp v42, v40 row_ror:1 row_mask:0xf bank_mask:0xf
v_mov_b32_dpp v43, v41 row_ror:1 row_mask:0xf bank_mask:0xf
v_min_u32 v46, v40, v42
v_max_u32 v40, v40, v42
v_max_u32 v41, v41, v43
v_max_u32 v41, v41, v46
s_nop 1
v_mov_b32_dpp v42, v40 row_ror:2 row_mask:0xf bank_mask:0xf
v_mov_b32_dpp v43, v41 row_ror:2 row_mask:0xf bank_mask:0xf
v_min_u32 v46, v40, v42
v_max_u32 v40, v40, v42
v_max_u32 v41, v41, v43
v_max_u32 v41, v41, v46
s_nop 1
v_mov_b32_dpp v42, v40 row_ror:4 row_mask:0xf bank_mask:0xf
v_mov_b32_dpp v43, v41 row_ror:4 row_mask:0xf bank_mask:0xf
v_min_u32 v46, v40, v42
v_max_u32 v40, v40, v42
v_max_u32 v41, v41, v43
v_max_u32 v41, v41, v46
s_nop 1
v_mov_b32_dpp v42, v40 row_ror:8 row_mask:0xf bank_mask:0xf
v_mov_b32_dpp v43, v41 row_ror:8 row_mask:0xf bank_mask:0xf
v_min_u32 v46, v40, v42
v_max_u32 v40, v40, v42
v_max_u32 v41, v41, v43
v_max_u32 v41, v41, v46
ds_swizzle_b32 v42, v40 offset:0x401F
ds_swizzle_b32 v43, v41 offset:0x401F
s_waitcnt lgkmcnt(0)
v_min_u32 v46, v40, v42
v_max_u32 v40, v40, v42
v_max_u32 v41, v41, v43
v_max_u32 v41, v41, v46
v_mov_b32 v42, v40
v_mov_b32 v43, v41
v_mov_b32 v47, v40
v_mov_b32 v48, v41
s_nop 1
v_permlane32_swap_b32 v47, v42
v_permlane32_swap_b32 v48, v43
s_nop 1
v_mov_b32 v40, v47
v_mov_b32 v41, v48
v_min_u32 v46, v40, v42
v_max_u32 v40, v40, v42
v_max_u32 v41, v41, v43
v_max_u32 v41, v41, v46
s_lshl_b32 s60, s22, 3
s_add_u32 s60, s60, 1024
v_mov_b32 v8, s60
ds_write_b64 v8, v[40:41]
s_waitcnt lgkmcnt(0)
s_barrier
v_mov_b32 v8, 1024
ds_read_b128 v[40:43], v8
ds_read_b128 v[48:51], v8 offset:16
s_waitcnt lgkmcnt(0)
v_min_u32 v46, v40, v42
v_max_u32 v40, v40, v42
v_max_u32 v41, v41, v43
v_max_u32 v41, v41, v46
v_min_u32 v46, v48, v50
v_max_u32 v48, v48, v50
v_max_u32 v49, v49, v51
v_max_u32 v49, v49, v46
v_min_u32 v46, v40, v48
v_max_u32 v40, v40, v48
v_max_u32 v41, v41, v49
v_max_u32 v41, v41, v46
v_and_b32 v42, 2047, v40
v_sub_u32 v42, 2047, v42
v_and_b32 v43, 2047, v41
v_sub_u32 v43, 2047, v43
s_cmp_ge_u32 s2, 54
s_cbranch_scc1 LA_down
v_and_b32 v9, 1, v1
v_cmp_eq_u32 vcc, 1, v9
s_nop 1
v_cndmask_b32 v10, v42, v43, vcc
s_movk_i32 s60, 1280
v_mul_lo_u32 v10, v10, s60
v_lshrrev_b32 v11, 5, v1
v_lshlrev_b32 v11, 4, v11
v_add_u32 v10, v10, v11
s_mul_i32 s60, s22, 320
v_and_b32 v16, 1, v1
v_lshlrev_b32 v16, 7, v16
v_lshrrev_b32 v17, 5, v1
v_lshlrev_b32 v17, 4, v17
v_add_u32 v16, v16, v17
s_lshl_b32 s61, s22, 9
s_add_u32 s61, s61, 1280
v_add_u32 v16, s61, v16
s_mov_b32 s61, 0
Lxp_139:
buffer_load_dwordx4 v[64:67], v10, s[36:39], s60 offen offset:0 sc1
buffer_load_dwordx4 v[68:71], v10, s[36:39], s60 offen offset:32 sc1
buffer_load_dwordx4 v[72:75], v10, s[36:39], s60 offen offset:64 sc1
buffer_load_dwordx4 v[76:79], v10, s[36:39], s60 offen offset:96 sc1
buffer_load_dwordx4 v[80:83], v10, s[36:39], s60 offen offset:128 sc1
buffer_load_dwordx4 v[84:87], v10, s[36:39], s60 offen offset:160 sc1
buffer_load_dwordx4 v[88:91], v10, s[36:39], s60 offen offset:192 sc1
buffer_load_dwordx4 v[92:95], v10, s[36:39], s60 offen offset:224 sc1
buffer_load_dwordx4 v[96:99], v10, s[36:39], s60 offen offset:256 sc1
buffer_load_dwordx4 v[100:103], v10, s[36:39], s60 offen offset:288 sc1
s_waitcnt vmcnt(0)
v_max3_u32 v46, v64, v65, v66
v_max3_u32 v46, v46, v67, v68
v_max3_u32 v46, v46, v69, v70
v_max3_u32 v46, v46, v71, v72
v_max3_u32 v46, v46, v73, v74
v_max3_u32 v46, v46, v75, v76
v_max3_u32 v46, v46, v77, v78
v_max3_u32 v46, v46, v79, v80
v_max3_u32 v46, v46, v81, v82
v_max3_u32 v46, v46, v83, v84
v_max3_u32 v46, v46, v85, v86
v_max3_u32 v46, v46, v87, v88
v_max3_u32 v46, v46, v89, v90
v_max3_u32 v46, v46, v91, v92
v_max3_u32 v46, v46, v93, v94
v_max3_u32 v46, v46, v95, v96
v_max3_u32 v46, v46, v97, v98
v_max3_u32 v46, v46, v99, v100
v_max3_u32 v46, v46, v101, v102
v_max_u32 v46, v46, v103
v_cmp_eq_u32 vcc, -1, v46
s_nop 1
s_cmp_eq_u64 vcc, 0
s_cbranch_scc1 Lxd_140
s_add_u32 s61, s61, 1
s_cmp_lt_u32 s61, 0x40000
s_cbranch_scc1 Lxp_139
Lxd_140:
v_mfma_f32_32x32x16_bf16 v[112:127], a[0:3], v[64:67], 0
v_mfma_f32_32x32x16_bf16 v[128:143], a[4:7], v[64:67], 0
v_mfma_f32_32x32x16_bf16 v[112:127], a[8:11], v[68:71], v[112:127]
v_mfma_f32_32x32x16_bf16 v[128:143], a[12:15], v[68:71], v[128:143]
v_mfma_f32_32x32x16_bf16 v[112:127], a[16:19], v[72:75], v[112:127]
v_mfma_f32_32x32x16_bf16 v[128:143], a[20:23], v[72:75], v[128:143]
v_mfma_f32_32x32x16_bf16 v[112:127], a[24:27], v[76:79], v[112:127]
v_mfma_f32_32x32x16_bf16 v[128:143], a[28:31], v[76:79], v[128:143]
v_mfma_f32_32x32x16_bf16 v[112:127], a[32:35], v[80:83], v[112:127]
v_mfma_f32_32x32x16_bf16 v[128:143], a[36:39], v[80:83], v[128:143]
v_mfma_f32_32x32x16_bf16 v[112:127], a[40:43], v[84:87], v[112:127]
v_mfma_f32_32x32x16_bf16 v[128:143], a[44:47], v[84:87], v[128:143]
v_mfma_f32_32x32x16_bf16 v[112:127], a[48:51], v[88:91], v[112:127]
v_mfma_f32_32x32x16_bf16 v[128:143], a[52:55], v[88:91], v[128:143]
v_mfma_f32_32x32x16_bf16 v[112:127], a[56:59], v[92:95], v[112:127]
v_mfma_f32_32x32x16_bf16 v[128:143], a[60:63], v[92:95], v[128:143]
v_mfma_f32_32x32x16_bf16 v[112:127], a[64:67], v[96:99], v[112:127]
v_mfma_f32_32x32x16_bf16 v[128:143], a[68:71], v[96:99], v[128:143]
v_mfma_f32_32x32x16_bf16 v[112:127], a[72:75], v[100:103], v[112:127]
v_mfma_f32_32x32x16_bf16 v[128:143], a[76:79], v[100:103], v[128:143]
s_nop 15
s_mov_b32 exec_lo, 3
s_mov_b32 exec_hi, 3
ds_write_b128 v16, v[112:115] offset:0
ds_write_b128 v16, v[116:119] offset:32
ds_write_b128 v16, v[120:123] offset:64
ds_write_b128 v16, v[124:127] offset:96
ds_write_b128 v16, v[128:131] offset:256
ds_write_b128 v16, v[132:135] offset:288
ds_write_b128 v16, v[136:139] offset:320
ds_write_b128 v16, v[140:143] offset:352
s_mov_b64 exec, -1
s_waitcnt lgkmcnt(0)
s_barrier
s_cmp_lg_u32 s22, 0
s_cbranch_scc1 LA_end2
v_lshrrev_b32 v16, 5, v1
v_lshlrev_b32 v16, 7, v16
v_and_b32 v17, 31, v1
v_lshlrev_b32 v17, 2, v17
v_add_u32 v16, v16, v17
v_add_u32 v16, 1280, v16
ds_read_b32 v20, v16 offset:0
ds_read_b32 v24, v16 offset:256
ds_read_b32 v21, v16 offset:512
ds_read_b32 v25, v16 offset:768
ds_read_b32 v22, v16 offset:1024
ds_read_b32 v26, v16 offset:1280
ds_read_b32 v23, v16 offset:1536
ds_read_b32 v27, v16 offset:1792
v_lshrrev_b32 v16, 5, v1
v_mul_u32_u24 v16, 3456, v16
v_and_b32 v17, 31, v1
v_lshlrev_b32 v17, 1, v17
v_add_u32 v16, v16, v17
s_lshl_b32 s60, s2, 6
s_add_u32 s60, s60, 0x5500000
v_add_u32 v16, s60, v16
s_waitcnt lgkmcnt(0)
v_add_f32 v20, v20, v21
v_add_f32 v22, v22, v23
v_add_f32 v20, v20, v22
v_add_f32 v24, v24, v25
v_add_f32 v26, v26, v27
v_add_f32 v24, v24, v26
v_cvt_pk_bf16_f32 v28, v20, v20
v_lshlrev_b32 v20, 16, v28
v_cvt_pk_bf16_f32 v28, v24, v24
v_lshlrev_b32 v24, 16, v28
v_mul_f32 v21, 0xbfb8aa3b, v20
v_exp_f32 v21, v21
s_nop 0
v_add_f32 v21, 1.0, v21
v_rcp_f32 v21, v21
s_nop 0
v_mul_f32 v20, v20, v21
v_cvt_pk_bf16_f32 v28, v20, v20
v_lshlrev_b32 v20, 16, v28
v_mul_f32 v20, v20, v24
s_nop 1
v_mov_b32_dpp v21, v20 quad_perm:[1,0,3,2] row_mask:0xf bank_mask:0xf
v_cvt_pk_bf16_f32 v20, v20, v21
s_mov_b32 exec_lo, 0x55555555
s_mov_b32 exec_hi, 0x55555555
global_store_dword v16, v20, s[18:19] sc1
s_branch LA_end2
LA_down:
v_cmp_le_u32 vcc, 32, v1
s_nop 1
v_cndmask_b32 v4, v42, v43, vcc
s_sub_u32 s60, s2, 54
s_lshl_b32 s60, s60, 6
s_movk_i32 s62, 1280
v_mul_lo_u32 v9, v4, s62
v_and_b32 v7, 31, v1
v_lshlrev_b32 v7, 1, v7
v_add_u32 v9, v9, v7
v_add_u32 v9, s60, v9
buffer_load_ushort v24, v9, s[36:39], 0 offen sc1
buffer_load_ushort v25, v9, s[24:27], 0 offen sc1
v_lshlrev_b32 v5, 2, v4
v_add_u32 v5, 0x5400000, v5
global_load_dword v5, v5, s[18:19] sc1
v_and_b32 v10, 1, v1
v_mul_u32_u24 v10, 3456, v10
v_lshrrev_b32 v11, 5, v1
v_lshlrev_b32 v11, 4, v11
v_add_u32 v10, v10, v11
s_mul_i32 s60, s22, 864
s_add_u32 s60, s60, 0x5500000
v_add_u32 v10, s60, v10
s_mov_b32 s61, 0
Lap_142:
global_load_dwordx4 v[64:67], v10, s[18:19] offset:0 sc1
global_load_dwordx4 v[68:71], v10, s[18:19] offset:32 sc1
global_load_dwordx4 v[72:75], v10, s[18:19] offset:64 sc1
global_load_dwordx4 v[76:79], v10, s[18:19] offset:96 sc1
global_load_dwordx4 v[80:83], v10, s[18:19] offset:128 sc1
global_load_dwordx4 v[84:87], v10, s[18:19] offset:160 sc1
global_load_dwordx4 v[88:91], v10, s[18:19] offset:192 sc1
global_load_dwordx4 v[92:95], v10, s[18:19] offset:224 sc1
global_load_dwordx4 v[96:99], v10, s[18:19] offset:256 sc1
global_load_dwordx4 v[100:103], v10, s[18:19] offset:288 sc1
global_load_dwordx4 v[104:107], v10, s[18:19] offset:320 sc1
global_load_dwordx4 v[108:111], v10, s[18:19] offset:352 sc1
global_load_dwordx4 v[112:115], v10, s[18:19] offset:384 sc1
global_load_dwordx4 v[116:119], v10, s[18:19] offset:416 sc1
global_load_dwordx4 v[120:123], v10, s[18:19] offset:448 sc1
global_load_dwordx4 v[124:127], v10, s[18:19] offset:480 sc1
global_load_dwordx4 v[128:131], v10, s[18:19] offset:512 sc1
global_load_dwordx4 v[132:135], v10, s[18:19] offset:544 sc1
global_load_dwordx4 v[136:139], v10, s[18:19] offset:576 sc1
global_load_dwordx4 v[140:143], v10, s[18:19] offset:608 sc1
global_load_dwordx4 v[144:147], v10, s[18:19] offset:640 sc1
global_load_dwordx4 v[148:151], v10, s[18:19] offset:672 sc1
global_load_dwordx4 v[152:155], v10, s[18:19] offset:704 sc1
global_load_dwordx4 v[156:159], v10, s[18:19] offset:736 sc1
global_load_dwordx4 v[160:163], v10, s[18:19] offset:768 sc1
global_load_dwordx4 v[164:167], v10, s[18:19] offset:800 sc1
global_load_dwordx4 v[168:171], v10, s[18:19] offset:832 sc1
s_waitcnt vmcnt(0)
v_max3_u32 v46, v64, v65, v66
v_max3_u32 v46, v46, v67, v68
v_max3_u32 v46, v46, v69, v70
v_max3_u32 v46, v46, v71, v72
v_max3_u32 v46, v46, v73, v74
v_max3_u32 v46, v46, v75, v76
v_max3_u32 v46, v46, v77, v78
v_max3_u32 v46, v46, v79, v80
v_max3_u32 v46, v46, v81, v82
v_max3_u32 v46, v46, v83, v84
v_max3_u32 v46, v46, v85, v86
v_max3_u32 v46, v46, v87, v88
v_max3_u32 v46, v46, v89, v90
v_max3_u32 v46, v46, v91, v92
v_max3_u32 v46, v46, v93, v94
v_max3_u32 v46, v46, v95, v96
v_max3_u32 v46, v46, v97, v98
v_max3_u32 v46, v46, v99, v100
v_max3_u32 v46, v46, v101, v102
v_max3_u32 v46, v46, v103, v104
v_max3_u32 v46, v46, v105, v106
v_max3_u32 v46, v46, v107, v108
v_max3_u32 v46, v46, v109, v110
v_max3_u32 v46, v46, v111, v112
v_max3_u32 v46, v46, v113, v114
v_max3_u32 v46, v46, v115, v116
v_max3_u32 v46, v46, v117, v118
v_max3_u32 v46, v46, v119, v120
v_max3_u32 v46, v46, v121, v122
v_max3_u32 v46, v46, v123, v124
v_max3_u32 v46, v46, v125, v126
v_max3_u32 v46, v46, v127, v128
v_max3_u32 v46, v46, v129, v130
v_max3_u32 v46, v46, v131, v132
v_max3_u32 v46, v46, v133, v134
v_max3_u32 v46, v46, v135, v136
v_max3_u32 v46, v46, v137, v138
v_max3_u32 v46, v46, v139, v140
v_max3_u32 v46, v46, v141, v142
v_max3_u32 v46, v46, v143, v144
v_max3_u32 v46, v46, v145, v146
v_max3_u32 v46, v46, v147, v148
v_max3_u32 v46, v46, v149, v150
v_max3_u32 v46, v46, v151, v152
v_max3_u32 v46, v46, v153, v154
v_max3_u32 v46, v46, v155, v156
v_max3_u32 v46, v46, v157, v158
v_max3_u32 v46, v46, v159, v160
v_max3_u32 v46, v46, v161, v162
v_max3_u32 v46, v46, v163, v164
v_max3_u32 v46, v46, v165, v166
v_max3_u32 v46, v46, v167, v168
v_max3_u32 v46, v46, v169, v170
v_max_u32 v46, v46, v171
v_cmp_eq_u32 vcc, -1, v46
s_nop 1
s_cmp_eq_u64 vcc, 0
s_cbranch_scc1 Lad_143
s_add_u32 s61, s61, 1
s_cmp_lt_u32 s61, 0x40000
s_cbranch_scc1 Lap_142
Lad_143:
v_mfma_f32_32x32x16_bf16 v[176:191], v[64:67], a[0:3], 0
v_mfma_f32_32x32x16_bf16 v[176:191], v[68:71], a[4:7], v[176:191]
v_mfma_f32_32x32x16_bf16 v[176:191], v[72:75], a[8:11], v[176:191]
v_mfma_f32_32x32x16_bf16 v[176:191], v[76:79], a[12:15], v[176:191]
v_mfma_f32_32x32x16_bf16 v[176:191], v[80:83], a[16:19], v[176:191]
v_mfma_f32_32x32x16_bf16 v[176:191], v[84:87], a[20:23], v[176:191]
v_mfma_f32_32x32x16_bf16 v[176:191], v[88:91], a[24:27], v[176:191]
v_mfma_f32_32x32x16_bf16 v[176:191], v[92:95], a[28:31], v[176:191]
v_mfma_f32_32x32x16_bf16 v[176:191], v[96:99], a[32:35], v[176:191]
v_mfma_f32_32x32x16_bf16 v[176:191], v[100:103], a[36:39], v[176:191]
v_mfma_f32_32x32x16_bf16 v[176:191], v[104:107], a[40:43], v[176:191]
v_mfma_f32_32x32x16_bf16 v[176:191], v[108:111], a[44:47], v[176:191]
v_mfma_f32_32x32x16_bf16 v[176:191], v[112:115], a[48:51], v[176:191]
v_mfma_f32_32x32x16_bf16 v[176:191], v[116:119], a[52:55], v[176:191]
v_mfma_f32_32x32x16_bf16 v[176:191], v[120:123], a[56:59], v[176:191]
v_mfma_f32_32x32x16_bf16 v[176:191], v[124:127], a[60:63], v[176:191]
v_mfma_f32_32x32x16_bf16 v[176:191], v[128:131], a[64:67], v[176:191]
v_mfma_f32_32x32x16_bf16 v[176:191], v[132:135], a[68:71], v[176:191]
v_mfma_f32_32x32x16_bf16 v[176:191], v[136:139], a[72:75], v[176:191]
v_mfma_f32_32x32x16_bf16 v[176:191], v[140:143], a[76:79], v[176:191]
v_mfma_f32_32x32x16_bf16 v[176:191], v[144:147], a[80:83], v[176:191]
v_mfma_f32_32x32x16_bf16 v[176:191], v[148:151], a[84:87], v[176:191]
v_mfma_f32_32x32x16_bf16 v[176:191], v[152:155], a[88:91], v[176:191]
v_mfma_f32_32x32x16_bf16 v[176:191], v[156:159], a[92:95], v[176:191]
v_mfma_f32_32x32x16_bf16 v[176:191], v[160:163], a[96:99], v[176:191]
v_mfma_f32_32x32x16_bf16 v[176:191], v[164:167], a[100:103], v[176:191]
v_mfma_f32_32x32x16_bf16 v[176:191], v[168:171], a[104:107], v[176:191]
v_cvt_pk_bf16_f32 v10, v5, v5
v_lshlrev_b32 v5, 16, v10
v_mul_f32 v5, 0xbfb8aa3b, v5
v_exp_f32 v5, v5
s_nop 0
v_add_f32 v5, 1.0, v5
v_rcp_f32 v5, v5
s_nop 0
v_cvt_pk_bf16_f32 v10, v5, v5
v_lshlrev_b32 v5, 16, v10
v_lshlrev_b32 v16, 2, v1
s_lshl_b32 s60, s22, 8
s_add_u32 s60, s60, 2048
v_add_u32 v16, s60, v16
s_nop 15
s_mov_b32 exec_hi, 0
ds_write_b32 v16, v176
ds_write_b32 v16, v177 offset:128
s_mov_b64 exec, -1
s_waitcnt lgkmcnt(0)
s_barrier
s_cmp_lg_u32 s22, 0
s_cbranch_scc1 LA_end2
v_lshlrev_b32 v16, 2, v1
v_add_u32 v16, 2048, v16
ds_read_b32 v20, v16 offset:0
ds_read_b32 v21, v16 offset:256
ds_read_b32 v22, v16 offset:512
ds_read_b32 v23, v16 offset:768
s_mov_b32 s61, 0
v_mov_b32 v11, 0xffff
Lhp_144:
v_cmp_eq_u32 vcc, v24, v11
v_cmp_eq_u32 s[62:63], v25, v11
s_nop 1
s_or_b64 vcc, vcc, s[62:63]
s_cmp_eq_u64 vcc, 0
s_cbranch_scc1 Lhd_145
buffer_load_ushort v24, v9, s[36:39], 0 offen sc1
buffer_load_ushort v25, v9, s[24:27], 0 offen sc1
s_waitcnt vmcnt(0)
s_add_u32 s61, s61, 1
s_cmp_lt_u32 s61, 0x40000
s_cbranch_scc1 Lhp_144
Lhd_145:
s_waitcnt lgkmcnt(0)
v_add_f32 v20, v20, v21
v_add_f32 v22, v22, v23
v_add_f32 v20, v20, v22
v_cvt_pk_bf16_f32 v10, v20, v20
v_lshlrev_b32 v20, 16, v10
v_mul_f32 v20, v20, v5
v_cvt_pk_bf16_f32 v10, v20, v20
v_lshlrev_b32 v20, 16, v10
v_lshlrev_b32 v24, 16, v24
v_lshlrev_b32 v25, 16, v25
v_add_f32 v20, v20, v24
v_cvt_pk_bf16_f32 v10, v20, v20
v_lshlrev_b32 v20, 16, v10
v_add_f32 v20, v20, v25
v_cvt_pk_bf16_f32 v20, v20, v20
buffer_store_short v20, v9, s[28:31], 0 offen sc1
LA_end2:
s_mov_b64 exec, -1
LA_end:
s_endpgm
LA_codeend:
.section .rodata,"a"
.p2align 6
.amdhsa_kernel sequential_preLN__compressed_kv_cla__moe_arch_mod__prompt_kernel
.amdhsa_next_free_vgpr 512
.amdhsa_next_free_sgpr 102
.amdhsa_accum_offset 256
.amdhsa_group_segment_fixed_size 0
.amdhsa_kernarg_size 112
.amdhsa_user_sgpr_count 2
.amdhsa_user_sgpr_kernarg_segment_ptr 1
.amdhsa_system_sgpr_workgroup_id_x 1
.end_amdhsa_kernel
```
